```python
import torch

def _softmax(x, axis=-1):
    return torch.softmax(x, dim=axis)
def _gelu(x):
    return torch.nn.functional.gelu(x, approximate="tanh")
def _silu(x):
    return torch.nn.functional.silu(x)
def _sigmoid(x):
    return torch.sigmoid(x)
def _layernorm(x, axis=-1, eps=1e-5):
    m = x.mean(dim=axis, keepdim=True)
    v = x.var(dim=axis, keepdim=True, unbiased=False)
    return (x - m) / torch.sqrt(v + eps)
def _scatter_add(tgt, idx, src, axis=0):
    return tgt.clone().index_add_(axis, idx, src)
def _segment_sum(src, seg, n):
    out = torch.zeros((n,) + src.shape[1:], dtype=src.dtype)
    return out.index_add_(0, seg, src)
def _pad(x, pw):
    flat = tuple(v for pair in reversed(pw) for v in pair)
    return torch.nn.functional.pad(x, flat)

kernel_name = 'concat_heads__mha_block_cached__mha_block_cached__near_ridge'

def setup_inputs():

    _w = (lambda a: (lambda t: t.to(torch.bfloat16) if t.is_floating_point() else t)(torch.as_tensor(a)))
    def _A_setup():
        B, Sq, D = 16, 144, 512
        H, Sk, Dh = 32, 512, 128
        return {
            "x": _w((lambda *s: torch.randn(*s, dtype=torch.bfloat16) * 0.8)(B, Sq, D)),
            "k_cache": _w((lambda *s: torch.randn(*s, dtype=torch.bfloat16) * 0.8)(B, H, Sk, Dh)),
            "v_cache": _w((lambda *s: torch.randn(*s, dtype=torch.bfloat16) * 0.05)(B, H, Sk, Dh)),
            "wq": _w((lambda *s: torch.randn(*s, dtype=torch.bfloat16) * 0.8)(D, H * Dh) * (D ** -0.5)),
            "wo": _w((lambda *s: torch.randn(*s, dtype=torch.bfloat16) * 0.05)(H * Dh, D) * ((H * Dh) ** -0.5)),
        }
    _A_in = _A_setup()

    def _B_setup():
        B, Sq, D = 16, 144, 512
        H, Sk, Dh = 32, 512, 128
        return {
            "x": _w((lambda *s: torch.randn(*s, dtype=torch.bfloat16) * 0.8)(B, Sq, D)),
            "k_cache": _w((lambda *s: torch.randn(*s, dtype=torch.bfloat16) * 0.8)(B, H, Sk, Dh)),
            "v_cache": _w((lambda *s: torch.randn(*s, dtype=torch.bfloat16) * 0.05)(B, H, Sk, Dh)),
            "wq": _w((lambda *s: torch.randn(*s, dtype=torch.bfloat16) * 0.8)(D, H * Dh) * (D ** -0.5)),
            "wo": _w((lambda *s: torch.randn(*s, dtype=torch.bfloat16) * 0.05)(H * Dh, D) * ((H * Dh) ** -0.5)),
        }
    _B_in = _B_setup()

    return {
        "A_x": _A_in["x"],
        "A_k_cache": _A_in["k_cache"],
        "A_v_cache": _A_in["v_cache"],
        "A_wq": _A_in["wq"],
        "A_wo": _A_in["wo"],
        "B_x": _B_in["x"],
        "B_k_cache": _B_in["k_cache"],
        "B_v_cache": _B_in["v_cache"],
        "B_wq": _B_in["wq"],
        "B_wo": _B_in["wo"],
    }

def reference(A_x, A_k_cache, A_v_cache, A_wq, A_wo, B_x, B_k_cache, B_v_cache, B_wq, B_wo):
    def _A_ref(x, k_cache, v_cache, wq, wo):
        B, Sq, D = x.shape
        H, Dh = 32, 128
        q = (lambda x, *d: x.permute(*d))((x @ wq).reshape(B, Sq, H, Dh), 0, 2, 1, 3)
        scores = torch.einsum("bhqd,bhkd->bhqk", q, k_cache) * (Dh ** -0.5)
        p = _softmax(scores, axis=-1)
        o = torch.einsum("bhqk,bhkd->bhqd", p, v_cache)
        return (lambda x, *d: x.permute(*d))(o, 0, 2, 1, 3).reshape(B, Sq, H * Dh) @ wo

    def _B_ref(x, k_cache, v_cache, wq, wo):
        B, Sq, D = x.shape
        H, Dh = 32, 128
        q = (lambda x, *d: x.permute(*d))((x @ wq).reshape(B, Sq, H, Dh), 0, 2, 1, 3)
        scores = torch.einsum("bhqd,bhkd->bhqk", q, k_cache) * (Dh ** -0.5)
        p = _softmax(scores, axis=-1)
        o = torch.einsum("bhqk,bhkd->bhqd", p, v_cache)
        return (lambda x, *d: x.permute(*d))(o, 0, 2, 1, 3).reshape(B, Sq, H * Dh) @ wo

    a = _A_ref(A_x, A_k_cache, A_v_cache, A_wq, A_wo)
    b = _B_ref(B_x, B_k_cache, B_v_cache, B_wq, B_wo)
    return torch.concatenate([a, b], axis=-1)
```

```asm
; @launch grid=(256,1,1) block=(256,1,1) lds=162048
.amdgcn_target "amdgcn-amd-amdhsa--gfx950"
.text
.globl concat_heads__mha_block_cached__mha_block_cached__near_ridge_kernel
.p2align 8
.type concat_heads__mha_block_cached__mha_block_cached__near_ridge_kernel,@function
concat_heads__mha_block_cached__mha_block_cached__near_ridge_kernel:
  s_cmp_ge_u32 s2, 256
  s_cbranch_scc0 L_go
  s_endpgm
L_go:
  s_load_dwordx16 s[68:83], s[0:1], 0
  s_load_dwordx4 s[84:87], s[0:1], 64
  s_load_dwordx4 s[28:31], s[0:1], 80
  s_load_dwordx2 s[92:93], s[0:1], 96
  s_getpc_b64 s[4:5]
  v_lshrrev_b32 v1, 6, v0
  v_and_b32 v2, 63, v0
  v_readfirstlane_b32 s36, v1
  s_and_b32 s5, s5, 0xffff
  s_and_b32 s4, s4, 0xffffff00
  s_mov_b32 s6, L_code_end-concat_heads__mha_block_cached__mha_block_cached__near_ridge_kernel
  s_mov_b32 s7, 0x20000
  s_and_b32 s3, s2, 7
  s_lshr_b32 s42, s2, 3
  s_lshr_b32 s58, s42, 1
  s_and_b32 s59, s3, 3
  s_lshl_b32 s59, s59, 1
  s_and_b32 s65, s42, 0
  s_and_b32 s43, s42, 1
  s_add_u32 s59, s59, s43
  s_lshr_b32 s43, s3, 2
  s_lshl_b32 s60, s43, 4
  s_add_u32 s60, s60, s58
  s_and_b32 s42, s42, 3
  s_lshl_b32 s42, s42, 15
  v_lshlrev_b32 v3, 7, v0
  buffer_load_dword v229, v3, s[4:7], s42 offen
  s_mul_i32 s37, s36, 8704
  s_add_u32 s38, s37, 69632
  s_add_u32 s39, s37, 34816
  s_add_u32 s40, s37, 104448
  s_movk_i32 s52, 4096
  s_movk_i32 s53, 4128
  s_movk_i32 s49, 8192
  s_movk_i32 s50, 1088
  s_movk_i32 s51, 1096
  v_lshlrev_b32 v225, 4, v2
  v_lshrrev_b32 v4, 4, v2
  v_and_b32 v5, 15, v2
  v_lshlrev_b32 v6, 4, v5
  v_lshl_add_u32 v244, v4, 13, v6
  v_lshl_add_u32 v227, v4, 16, v6
  s_lshl_b32 s42, s58, 2
  s_add_u32 s42, s42, s36
  s_lshl_b32 s42, s42, 16
  v_lshrrev_b32 v8, 3, v2
  v_lshlrev_b32 v8, 13, v8
  v_and_b32 v9, 4, v2
  v_lshl_add_u32 v8, v9, 5, v8
  v_add_u32 v228, s42, v8
  s_lshl_b32 s42, s65, 9
  v_xor_b32 v7, s42, v225
  s_lshl_b32 s90, s36, 15
  s_sub_u32 s91, s90, s42
  s_add_u32 s90, s90, s42
  s_lshl_b32 s42, s65, 21
  s_lshl_b32 s47, s36, 18
  s_sub_u32 s48, s47, s42
  s_add_u32 s47, s47, s42
  s_waitcnt lgkmcnt(0)
  s_cmp_eq_u32 s43, 0
  s_cselect_b32 s68, s68, s78
  s_cselect_b32 s69, s69, s79
  s_cselect_b32 s16, s70, s80
  s_cselect_b32 s17, s71, s81
  s_cselect_b32 s20, s72, s82
  s_cselect_b32 s21, s73, s83
  s_cselect_b32 s74, s74, s84
  s_cselect_b32 s75, s75, s85
  s_cselect_b32 s24, s76, s86
  s_cselect_b32 s25, s77, s87
  s_lshl_b32 s42, s59, 10
  s_add_u32 s12, s74, s42
  s_addc_u32 s13, s75, 0
  s_and_b32 s13, s13, 0xffff
  s_sub_u32 s14, 4194304, s42
  s_mov_b32 s15, 0x20000
  buffer_load_dword v229, v228, s[12:15], 0 offen
  s_mul_i32 s42, s58, 147456
  s_add_u32 s8, s68, s42
  s_addc_u32 s9, s69, 0
  s_and_b32 s9, s9, 0xffff
  s_mov_b32 s10, 147456
  s_mov_b32 s11, 0x20000
  s_lshl_b32 s42, s58, 5
  s_lshl_b32 s65, s59, 2
  s_add_u32 s42, s42, s65
  s_lshl_b32 s42, s42, 17
  s_add_u32 s16, s16, s42
  s_addc_u32 s17, s17, 0
  s_and_b32 s17, s17, 0xffff
  s_mov_b32 s18, 524288
  s_mov_b32 s19, 0x20000
  s_add_u32 s20, s20, s42
  s_addc_u32 s21, s21, 0
  s_and_b32 s21, s21, 0xffff
  s_mov_b32 s22, 524288
  s_mov_b32 s23, 0x20000
  s_lshl_b32 s0, s36, 13
  s_bitcmp1_b32 s58, 0
  s_cbranch_scc1 L_b1
  s_add_u32 s42, s90, 0
  s_mov_b32 m0, s37
  s_nop 0
  buffer_load_dwordx4 v244, s[8:11], s42 offen lds
  s_add_u32 m0, m0, 32
  s_nop 0
  buffer_load_dwordx4 v244, s[8:11], s42 offen offset:1024 lds
  s_add_u32 m0, m0, 32
  s_nop 0
  buffer_load_dwordx4 v244, s[8:11], s42 offen offset:2048 lds
  s_add_u32 m0, m0, 32
  s_nop 0
  buffer_load_dwordx4 v244, s[8:11], s42 offen offset:3072 lds
  s_add_u32 s42, s42, s52
  s_add_u32 m0, m0, s53
  s_nop 0
  buffer_load_dwordx4 v244, s[8:11], s42 offen lds
  s_add_u32 m0, m0, 32
  s_nop 0
  buffer_load_dwordx4 v244, s[8:11], s42 offen offset:1024 lds
  s_add_u32 m0, m0, 32
  s_nop 0
  buffer_load_dwordx4 v244, s[8:11], s42 offen offset:2048 lds
  s_add_u32 m0, m0, 32
  s_nop 0
  buffer_load_dwordx4 v244, s[8:11], s42 offen offset:3072 lds
  s_lshl_b32 s42, s36, 12
  s_add_u32 s42, s42, 131072
  s_mul_i32 s65, s36, 4160
  s_add_u32 m0, s65, 139264
  s_nop 0
  buffer_load_dwordx4 v7, s[8:11], s42 offen lds
  s_add_u32 m0, m0, 16
  s_nop 0
  buffer_load_dwordx4 v7, s[8:11], s42 offen offset:1024 lds
  s_add_u32 m0, m0, 16
  s_nop 0
  buffer_load_dwordx4 v7, s[8:11], s42 offen offset:2048 lds
  s_add_u32 m0, m0, 16
  s_nop 0
  buffer_load_dwordx4 v7, s[8:11], s42 offen offset:3072 lds
L_join:
  s_mov_b32 s66, s28
  s_mov_b32 s67, s29
  s_mov_b32 s4, s30
  s_and_b32 s5, s31, 0xffff
  s_movk_i32 s6, 256
  s_mov_b32 s7, 0x20000
  s_mov_b32 s28, s92
  s_and_b32 s29, s93, 0xffff
  s_mov_b32 s30, 37879808
  s_mov_b32 s31, 0x20000
  s_mov_b32 s32, s16
  s_mov_b32 s33, s17
  s_mov_b32 s34, 524288
  s_mov_b32 s35, 0x20000
  s_lshl_b32 s42, s59, 19
  s_add_u32 s24, s24, s42
  s_addc_u32 s25, s25, 0
  s_and_b32 s25, s25, 0xffff
  s_mov_b32 s26, 524288
  s_mov_b32 s27, 0x20000
  s_lshl_b32 s61, s60, 5
  s_add_u32 s61, s61, s36
  s_lshl_b32 s61, s61, 7
  s_add_u32 s61, s61, 37748736
  s_lshl_b32 s65, s59, 9
  s_add_u32 s62, s61, s65
  s_lshl_b32 s65, s59, 2
  s_add_u32 s61, s61, s65
  s_mul_hi_u32 s65, s2, 357913942
  s_mul_i32 s65, s65, 12
  s_sub_u32 s94, s2, s65
  s_lshl_b32 s95, s60, 3
  s_add_u32 s95, s95, s59
  s_lshl_b32 s65, s36, 10
  s_add_u32 s95, s95, s65
  s_mov_b32 s41, 0
  s_mov_b32 s44, 0
  s_mov_b32 s93, 0
  s_mov_b32 s54, 0x3e0293ee
  s_mov_b32 s55, 0x33800000
  s_mov_b32 s56, 0x53800000
  s_mov_b32 s57, 0x7fc00000
  s_lshl_b32 s65, s36, 9
  s_lshl_b32 s68, s36, 12
  s_sub_u32 s64, s65, s68
  s_add_u32 s64, s64, 16384
  s_lshl_b32 s69, s60, 3
  s_add_u32 s69, s69, s59
  s_mul_i32 s69, s69, 147456
  s_add_u32 s63, s69, s68
  s_lshl_b32 s69, s60, 6
  s_add_u32 s69, s69, s59
  s_mul_i32 s69, s69, 18432
  s_add_u32 s69, s69, s68
  s_lshl_b32 s68, s36, 16
  s_mul_i32 s88, s58, 294912
  s_lshl_b32 s65, s43, 10
  s_add_u32 s88, s88, s65
  s_lshl_b32 s65, s59, 7
  s_add_u32 s88, s88, s65
  s_add_u32 s65, s59, 1
  s_and_b32 s65, s65, 7
  s_mul_i32 s80, s65, 147456
  s_add_u32 s80, s80, s69
  s_lshl_b32 s65, s65, 7
  s_add_u32 s72, s65, s68
  s_add_u32 s65, s59, 2
  s_and_b32 s65, s65, 7
  s_mul_i32 s81, s65, 147456
  s_add_u32 s81, s81, s69
  s_lshl_b32 s65, s65, 7
  s_add_u32 s73, s65, s68
  s_add_u32 s65, s59, 3
  s_and_b32 s65, s65, 7
  s_mul_i32 s82, s65, 147456
  s_add_u32 s82, s82, s69
  s_lshl_b32 s65, s65, 7
  s_add_u32 s74, s65, s68
  s_add_u32 s65, s59, 4
  s_and_b32 s65, s65, 7
  s_mul_i32 s83, s65, 147456
  s_add_u32 s83, s83, s69
  s_lshl_b32 s65, s65, 7
  s_add_u32 s75, s65, s68
  s_add_u32 s65, s59, 5
  s_and_b32 s65, s65, 7
  s_mul_i32 s84, s65, 147456
  s_add_u32 s84, s84, s69
  s_lshl_b32 s65, s65, 7
  s_add_u32 s76, s65, s68
  s_add_u32 s65, s59, 6
  s_and_b32 s65, s65, 7
  s_mul_i32 s85, s65, 147456
  s_add_u32 s85, s85, s69
  s_lshl_b32 s65, s65, 7
  s_add_u32 s77, s65, s68
  s_add_u32 s65, s59, 7
  s_and_b32 s65, s65, 7
  s_mul_i32 s86, s65, 147456
  s_add_u32 s86, s86, s69
  s_lshl_b32 s65, s65, 7
  s_add_u32 s78, s65, s68
  s_add_u32 s65, s59, 8
  s_and_b32 s65, s65, 7
  s_mul_i32 s87, s65, 147456
  s_add_u32 s87, s87, s69
  s_lshl_b32 s65, s65, 7
  s_add_u32 s79, s65, s68
  s_add_u32 s1, s0, 32768
  s_add_u32 s2, s0, 65536
  s_add_u32 s3, s0, 98304
  v_mov_b32 v226, v225
  v_and_b32 v8, 7, v2
  v_mul_u32_u24 v8, 1056, v8
  v_bfe_u32 v9, v2, 3, 1
  v_lshl_add_u32 v8, v9, 8, v8
  v_lshl_add_u32 v10, v4, 3, v8
  v_add_u32 v245, s37, v10
  v_add_u32 v246, 69632, v245
  v_bfe_u32 v9, v2, 2, 3
  v_lshrrev_b32 v12, 5, v2
  v_and_b32 v13, 3, v2
  v_mul_u32_u24 v14, 1088, v9
  v_lshrrev_b32 v15, 2, v9
  v_lshl_add_u32 v14, v15, 3, v14
  v_lshl_add_u32 v14, v12, 8, v14
  v_lshl_add_u32 v14, v13, 4, v14
  v_add_u32 v220, 34816, v14
  v_add_u32 v221, 104448, v14
  s_lshl_b32 s42, s36, 6
  v_add_u32 v222, s42, v220
  v_add_u32 v223, s42, v221
  v_mul_u32_u24 v14, 1040, v5
  v_lshl_add_u32 v14, v4, 3, v14
  v_add_u32 v224, 139264, v14
  s_lshl_b32 s42, s36, 10
  s_add_u32 s42, s42, 155904
  v_add_u32 v230, s42, v225
  v_add_u32 v248, 155904, v225
  s_lshl_b32 s42, s36, 13
  s_add_u32 s42, s42, 69632
  v_add_u32 v249, s42, v225
  s_lshl_b32 s42, s36, 11
  s_add_u32 s42, s42, 69632
  v_add_u32 v253, s42, v225
  v_lshlrev_b32 v14, 2, v2
  v_add_u32 v254, 160000, v14
  s_lshl_b32 s42, s36, 8
  v_add_u32 v231, s42, v254
  v_and_b32 v247, 31, v2
  v_lshlrev_b32 v247, 2, v247
  v_lshrrev_b32 v20, 4, v225
  v_and_b32 v21, 7, v20
  v_mul_u32_u24 v21, 1056, v21
  v_bfe_u32 v22, v20, 3, 1
  v_lshl_add_u32 v21, v22, 8, v21
  v_lshrrev_b32 v22, 4, v20
  v_lshl_add_u32 v212, v22, 4, v21
  v_bfe_u32 v21, v20, 2, 3
  v_mul_u32_u24 v21, 1056, v21
  v_lshrrev_b32 v22, 5, v20
  v_lshl_add_u32 v21, v22, 8, v21
  v_and_b32 v22, 3, v20
  v_lshl_add_u32 v21, v22, 3, v21
  v_add_u32 v216, 69632, v21
  s_add_u32 s42, s36, 3
  s_and_b32 s42, s42, 3
  s_mul_i32 s42, s42, 8704
  v_add_u32 v215, s42, v212
  v_add_u32 v219, s42, v216
  s_add_u32 s42, s36, 2
  s_and_b32 s42, s42, 3
  s_mul_i32 s42, s42, 8704
  v_add_u32 v214, s42, v212
  v_add_u32 v218, s42, v216
  s_add_u32 s42, s36, 1
  s_and_b32 s42, s42, 3
  s_mul_i32 s42, s42, 8704
  v_add_u32 v213, s42, v212
  v_add_u32 v217, s42, v216
  s_add_u32 s42, s36, 0
  s_and_b32 s42, s42, 3
  s_mul_i32 s42, s42, 8704
  v_add_u32 v212, s42, v212
  v_add_u32 v216, s42, v216
  v_mov_b32 v196, 0x3f803f80
  v_mov_b32 v197, 0x3f803f80
  v_mov_b32 v198, 0x3f803f80
  v_mov_b32 v199, 0x3f803f80
  v_mov_b32 v136, 0
  v_mov_b32 v137, 0
  v_mov_b32 v138, 0
  v_mov_b32 v139, 0
  v_mov_b32 v140, 0
  v_mov_b32 v141, 0
  v_mov_b32 v142, 0
  v_mov_b32 v143, 0
  v_mov_b32 v144, 0
  v_mov_b32 v145, 0
  v_mov_b32 v146, 0
  v_mov_b32 v147, 0
  s_bitcmp1_b32 s58, 0
  s_cbranch_scc1 L_b2
  s_add_u32 s42, s47, 0
  s_mov_b32 m0, s39
  s_nop 0
  buffer_load_dwordx4 v227, s[12:15], s42 offen lds
  s_add_u32 s42, s42, s49
  s_add_u32 m0, m0, s50
  s_nop 0
  buffer_load_dwordx4 v227, s[12:15], s42 offen lds
  s_add_u32 s42, s42, s49
  s_add_u32 m0, m0, s50
  s_nop 0
  buffer_load_dwordx4 v227, s[12:15], s42 offen lds
  s_add_u32 s42, s42, s49
  s_add_u32 m0, m0, s50
  s_nop 0
  buffer_load_dwordx4 v227, s[12:15], s42 offen lds
  s_add_u32 s42, s42, s49
  s_add_u32 m0, m0, s51
  s_nop 0
  buffer_load_dwordx4 v227, s[12:15], s42 offen lds
  s_add_u32 s42, s42, s49
  s_add_u32 m0, m0, s50
  s_nop 0
  buffer_load_dwordx4 v227, s[12:15], s42 offen lds
  s_add_u32 s42, s42, s49
  s_add_u32 m0, m0, s50
  s_nop 0
  buffer_load_dwordx4 v227, s[12:15], s42 offen lds
  s_add_u32 s42, s42, s49
  s_add_u32 m0, m0, s50
  s_nop 0
  buffer_load_dwordx4 v227, s[12:15], s42 offen lds
  s_add_u32 s42, s90, 256
  s_mov_b32 m0, s38
  s_nop 0
  buffer_load_dwordx4 v244, s[8:11], s42 offen lds
  s_add_u32 m0, m0, 32
  s_nop 0
  buffer_load_dwordx4 v244, s[8:11], s42 offen offset:1024 lds
  s_add_u32 m0, m0, 32
  s_nop 0
  buffer_load_dwordx4 v244, s[8:11], s42 offen offset:2048 lds
  s_add_u32 m0, m0, 32
  s_nop 0
  buffer_load_dwordx4 v244, s[8:11], s42 offen offset:3072 lds
  s_add_u32 s42, s42, s52
  s_add_u32 m0, m0, s53
  s_nop 0
  buffer_load_dwordx4 v244, s[8:11], s42 offen lds
  s_add_u32 m0, m0, 32
  s_nop 0
  buffer_load_dwordx4 v244, s[8:11], s42 offen offset:1024 lds
  s_add_u32 m0, m0, 32
  s_nop 0
  buffer_load_dwordx4 v244, s[8:11], s42 offen offset:2048 lds
  s_add_u32 m0, m0, 32
  s_nop 0
  buffer_load_dwordx4 v244, s[8:11], s42 offen offset:3072 lds
  s_waitcnt vmcnt(20)
  ds_read_b64 a[0:1], v245 offset:0
  ds_read_b64 a[2:3], v245 offset:32
  ds_read_b64 a[4:5], v245 offset:64
  ds_read_b64 a[6:7], v245 offset:96
  ds_read_b64 a[8:9], v245 offset:128
  ds_read_b64 a[10:11], v245 offset:160
  ds_read_b64 a[12:13], v245 offset:192
  ds_read_b64 a[14:15], v245 offset:224
  ds_read_b64 a[64:65], v245 offset:512
  ds_read_b64 a[66:67], v245 offset:544
  ds_read_b64 a[68:69], v245 offset:576
  ds_read_b64 a[70:71], v245 offset:608
  ds_read_b64 a[72:73], v245 offset:640
  ds_read_b64 a[74:75], v245 offset:672
  ds_read_b64 a[76:77], v245 offset:704
  ds_read_b64 a[78:79], v245 offset:736
  s_waitcnt lgkmcnt(0)
  s_waitcnt vmcnt(8)
  s_barrier
  ds_read_b64_tr_b16 v[148:149], v220 offset:0
  ds_read_b64_tr_b16 v[150:151], v220 offset:512
  ds_read_b64_tr_b16 v[152:153], v220 offset:8704
  ds_read_b64_tr_b16 v[154:155], v220 offset:9216
  ds_read_b64_tr_b16 v[156:157], v220 offset:17408
  ds_read_b64_tr_b16 v[158:159], v220 offset:17920
  ds_read_b64_tr_b16 v[160:161], v220 offset:26112
  ds_read_b64_tr_b16 v[162:163], v220 offset:26624
  ds_read_b64 v[164:165], v224 offset:0
  ds_read_b64 v[166:167], v224 offset:32
  ds_read_b64_tr_b16 v[168:169], v222 offset:0
  ds_read_b64_tr_b16 v[170:171], v222 offset:512
  ds_read_b64_tr_b16 v[172:173], v222 offset:8
  ds_read_b64_tr_b16 v[174:175], v222 offset:520
  s_add_u32 s42, s47, 1048576
  s_mov_b32 m0, s40
  s_waitcnt lgkmcnt(12)
  v_mfma_f32_16x16x32_bf16 v[0:3], v[148:151], a[0:3], 0
  s_waitcnt lgkmcnt(10)
  v_mfma_f32_16x16x32_bf16 v[0:3], v[152:155], a[4:7], v[0:3]
  s_waitcnt lgkmcnt(8)
  v_mfma_f32_16x16x32_bf16 v[0:3], v[156:159], a[8:11], v[0:3]
  s_waitcnt lgkmcnt(6)
  ds_read_b64_tr_b16 v[176:177], v220 offset:8
  ds_read_b64_tr_b16 v[178:179], v220 offset:520
  v_mfma_f32_16x16x32_bf16 v[0:3], v[160:163], a[12:15], v[0:3]
  s_nop 0
  buffer_load_dwordx4 v227, s[12:15], s42 offen lds
  ds_read_b64_tr_b16 a[224:225], v220 offset:8712
  ds_read_b64_tr_b16 a[226:227], v220 offset:9224
  v_mfma_f32_16x16x32_bf16 v[4:7], v[148:151], a[64:67], 0
  s_add_u32 s42, s42, s49
  s_add_u32 m0, m0, s50
  ds_read_b64_tr_b16 a[228:229], v220 offset:17416
  ds_read_b64_tr_b16 a[230:231], v220 offset:17928
  v_mfma_f32_16x16x32_bf16 v[4:7], v[152:155], a[68:71], v[4:7]
  s_nop 0
  buffer_load_dwordx4 v227, s[12:15], s42 offen lds
  ds_read_b64_tr_b16 a[232:233], v220 offset:26120
  ds_read_b64_tr_b16 a[234:235], v220 offset:26632
  v_mfma_f32_16x16x32_bf16 v[4:7], v[156:159], a[72:75], v[4:7]
  s_add_u32 s42, s42, s49
  s_add_u32 m0, m0, s50
  v_mfma_f32_16x16x32_bf16 v[4:7], v[160:163], a[76:79], v[4:7]
  s_waitcnt lgkmcnt(8)
  buffer_load_dwordx4 v227, s[12:15], s42 offen lds
  s_add_u32 s42, s42, s49
  v_mfma_f32_16x16x32_bf16 v[128:131], v[168:171], v[164:167], 0
  s_add_u32 m0, m0, s50
  v_mfma_f32_16x16x32_bf16 v[132:135], v[172:175], v[164:167], 0
  s_waitcnt lgkmcnt(6)
  buffer_load_dwordx4 v227, s[12:15], s42 offen lds
  s_add_u32 s42, s42, s49
  v_mfma_f32_16x16x32_bf16 v[8:11], v[176:179], a[0:3], 0
  s_waitcnt lgkmcnt(4)
  s_add_u32 m0, m0, s51
  ds_read_b64 a[236:237], v224 offset:64
  ds_read_b64 a[238:239], v224 offset:96
  ds_read_b64_tr_b16 a[240:241], v222 offset:8704
  ds_read_b64_tr_b16 a[242:243], v222 offset:9216
  v_mfma_f32_16x16x32_bf16 v[8:11], a[224:227], a[4:7], v[8:11]
  s_waitcnt lgkmcnt(6)
  buffer_load_dwordx4 v227, s[12:15], s42 offen lds
  ds_read_b64_tr_b16 a[244:245], v222 offset:8712
  ds_read_b64_tr_b16 a[246:247], v222 offset:9224
  v_mfma_f32_16x16x32_bf16 v[8:11], a[228:231], a[8:11], v[8:11]
  s_waitcnt lgkmcnt(6)
  s_add_u32 s42, s42, s49
  s_add_u32 m0, m0, s50
  ds_read_b64_tr_b16 a[248:249], v220 offset:64
  ds_read_b64_tr_b16 a[250:251], v220 offset:576
  v_mfma_f32_16x16x32_bf16 v[8:11], a[232:235], a[12:15], v[8:11]
  s_nop 0
  buffer_load_dwordx4 v227, s[12:15], s42 offen lds
  ds_read_b64_tr_b16 a[252:253], v220 offset:8768
  ds_read_b64_tr_b16 a[254:255], v220 offset:9280
  v_mfma_f32_16x16x32_bf16 v[12:15], v[176:179], a[64:67], 0
  s_add_u32 s42, s42, s49
  s_add_u32 m0, m0, s50
  ds_read_b64_tr_b16 v[148:149], v220 offset:17472
  ds_read_b64_tr_b16 v[150:151], v220 offset:17984
  v_mfma_f32_16x16x32_bf16 v[12:15], a[224:227], a[68:71], v[12:15]
  s_nop 0
  buffer_load_dwordx4 v227, s[12:15], s42 offen lds
  ds_read_b64_tr_b16 v[152:153], v220 offset:26176
  ds_read_b64_tr_b16 v[154:155], v220 offset:26688
  v_mfma_f32_16x16x32_bf16 v[12:15], a[228:231], a[72:75], v[12:15]
  s_add_u32 s42, s42, s49
  s_add_u32 m0, m0, s50
  v_mfma_f32_16x16x32_bf16 v[12:15], a[232:235], a[76:79], v[12:15]
  s_waitcnt lgkmcnt(10)
  buffer_load_dwordx4 v227, s[12:15], s42 offen lds
  s_add_u32 s42, s91, 512
  v_mfma_f32_16x16x32_bf16 v[128:131], a[240:243], a[236:239], v[128:131]
  s_waitcnt lgkmcnt(8)
  s_mov_b32 m0, s37
  v_mfma_f32_16x16x32_bf16 v[132:135], a[244:247], a[236:239], v[132:135]
  s_waitcnt lgkmcnt(6)
  v_mfma_f32_16x16x32_bf16 v[16:19], a[248:251], a[0:3], 0
  s_waitcnt lgkmcnt(4)
  buffer_load_dwordx4 v244, s[8:11], s42 offen lds
  ds_read_b64 v[156:157], v224 offset:128
  ds_read_b64 v[158:159], v224 offset:160
  ds_read_b64_tr_b16 v[160:161], v222 offset:17408
  ds_read_b64_tr_b16 v[162:163], v222 offset:17920
  v_mfma_f32_16x16x32_bf16 v[16:19], a[252:255], a[4:7], v[16:19]
  s_waitcnt lgkmcnt(6)
  s_add_u32 m0, m0, 32
  ds_read_b64_tr_b16 v[164:165], v222 offset:17416
  ds_read_b64_tr_b16 v[166:167], v222 offset:17928
  v_mfma_f32_16x16x32_bf16 v[16:19], v[148:151], a[8:11], v[16:19]
  s_waitcnt lgkmcnt(6)
  buffer_load_dwordx4 v244, s[8:11], s42 offen offset:1024 lds
  ds_read_b64_tr_b16 v[168:169], v220 offset:72
  ds_read_b64_tr_b16 v[170:171], v220 offset:584
  v_mfma_f32_16x16x32_bf16 v[16:19], v[152:155], a[12:15], v[16:19]
  s_add_u32 m0, m0, 32
  ds_read_b64_tr_b16 v[172:173], v220 offset:8776
  ds_read_b64_tr_b16 v[174:175], v220 offset:9288
  v_mfma_f32_16x16x32_bf16 v[20:23], a[248:251], a[64:67], 0
  s_nop 0
  buffer_load_dwordx4 v244, s[8:11], s42 offen offset:2048 lds
  ds_read_b64_tr_b16 v[176:177], v220 offset:17480
  ds_read_b64_tr_b16 v[178:179], v220 offset:17992
  v_mfma_f32_16x16x32_bf16 v[20:23], a[252:255], a[68:71], v[20:23]
  s_add_u32 m0, m0, 32
  ds_read_b64_tr_b16 a[224:225], v220 offset:26184
  ds_read_b64_tr_b16 a[226:227], v220 offset:26696
  v_mfma_f32_16x16x32_bf16 v[20:23], v[148:151], a[72:75], v[20:23]
  s_waitcnt vmcnt(11)
  buffer_load_dwordx4 v244, s[8:11], s42 offen offset:3072 lds
  s_add_u32 s42, s42, s52
  v_mfma_f32_16x16x32_bf16 v[20:23], v[152:155], a[76:79], v[20:23]
  s_waitcnt lgkmcnt(10)
  s_add_u32 m0, m0, s53
  v_mfma_f32_16x16x32_bf16 v[128:131], v[160:163], v[156:159], v[128:131]
  s_waitcnt lgkmcnt(8)
  buffer_load_dwordx4 v244, s[8:11], s42 offen lds
  s_add_u32 m0, m0, 32
  v_mfma_f32_16x16x32_bf16 v[132:135], v[164:167], v[156:159], v[132:135]
  s_waitcnt lgkmcnt(6)
  v_mfma_f32_16x16x32_bf16 v[24:27], v[168:171], a[0:3], 0
  s_waitcnt lgkmcnt(4)
  buffer_load_dwordx4 v244, s[8:11], s42 offen offset:1024 lds
  ds_read_b64 a[228:229], v224 offset:192
  ds_read_b64 a[230:231], v224 offset:224
  ds_read_b64_tr_b16 a[232:233], v222 offset:26112
  ds_read_b64_tr_b16 a[234:235], v222 offset:26624
  v_mfma_f32_16x16x32_bf16 v[24:27], v[172:175], a[4:7], v[24:27]
  s_waitcnt lgkmcnt(6)
  s_add_u32 m0, m0, 32
  ds_read_b64_tr_b16 a[236:237], v222 offset:26120
  ds_read_b64_tr_b16 a[238:239], v222 offset:26632
  v_mfma_f32_16x16x32_bf16 v[24:27], v[176:179], a[8:11], v[24:27]
  s_waitcnt lgkmcnt(6)
  buffer_load_dwordx4 v244, s[8:11], s42 offen offset:2048 lds
  ds_read_b64_tr_b16 a[240:241], v220 offset:128
  ds_read_b64_tr_b16 a[242:243], v220 offset:640
  v_mfma_f32_16x16x32_bf16 v[24:27], a[224:227], a[12:15], v[24:27]
  s_add_u32 m0, m0, 32
  ds_read_b64_tr_b16 a[244:245], v220 offset:8832
  ds_read_b64_tr_b16 a[246:247], v220 offset:9344
  v_mfma_f32_16x16x32_bf16 v[28:31], v[168:171], a[64:67], 0
  s_nop 0
  buffer_load_dwordx4 v244, s[8:11], s42 offen offset:3072 lds
  ds_read_b64_tr_b16 a[248:249], v220 offset:17536
  ds_read_b64_tr_b16 a[250:251], v220 offset:18048
  v_mfma_f32_16x16x32_bf16 v[28:31], v[172:175], a[68:71], v[28:31]
  s_nop 0
  ds_read_b64_tr_b16 a[252:253], v220 offset:26240
  ds_read_b64_tr_b16 a[254:255], v220 offset:26752
  v_mfma_f32_16x16x32_bf16 v[28:31], v[176:179], a[72:75], v[28:31]
  v_mfma_f32_16x16x32_bf16 v[28:31], a[224:227], a[76:79], v[28:31]
  s_waitcnt lgkmcnt(10)
  v_mfma_f32_16x16x32_bf16 v[128:131], a[232:235], a[228:231], v[128:131]
  s_waitcnt lgkmcnt(8)
  v_mfma_f32_16x16x32_bf16 v[132:135], a[236:239], a[228:231], v[132:135]
  s_waitcnt lgkmcnt(6)
  ds_read_b64_tr_b16 v[148:149], v220 offset:136
  ds_read_b64_tr_b16 v[150:151], v220 offset:648
  ds_read_b64_tr_b16 v[152:153], v220 offset:8840
  ds_read_b64_tr_b16 v[154:155], v220 offset:9352
  v_mfma_f32_16x16x32_bf16 v[32:35], a[240:243], a[0:3], 0
  s_waitcnt lgkmcnt(8)
  ds_read_b64_tr_b16 v[156:157], v220 offset:17544
  ds_read_b64_tr_b16 v[158:159], v220 offset:18056
  ds_read_b64_tr_b16 v[160:161], v220 offset:26248
  ds_read_b64_tr_b16 v[162:163], v220 offset:26760
  v_mfma_f32_16x16x32_bf16 v[32:35], a[244:247], a[4:7], v[32:35]
  s_waitcnt lgkmcnt(10)
  v_mfma_f32_16x16x32_bf16 v[32:35], a[248:251], a[8:11], v[32:35]
  s_waitcnt lgkmcnt(8)
  ds_read_b64 a[16:17], v246 offset:0
  ds_read_b64 a[18:19], v246 offset:32
  ds_read_b64 a[20:21], v246 offset:64
  ds_read_b64 a[22:23], v246 offset:96
  ds_read_b64 a[24:25], v246 offset:128
  ds_read_b64 a[26:27], v246 offset:160
  ds_read_b64 a[28:29], v246 offset:192
  ds_read_b64 a[30:31], v246 offset:224
  ds_read_b64 a[80:81], v246 offset:512
  ds_read_b64 a[82:83], v246 offset:544
  ds_read_b64 a[84:85], v246 offset:576
  ds_read_b64 a[86:87], v246 offset:608
  ds_read_b64 a[88:89], v246 offset:640
  ds_read_b64 a[90:91], v246 offset:672
  ds_read_b64 a[92:93], v246 offset:704
  ds_read_b64 a[94:95], v246 offset:736
  v_mfma_f32_16x16x32_bf16 v[32:35], a[252:255], a[12:15], v[32:35]
  v_mfma_f32_16x16x32_bf16 v[36:39], a[240:243], a[64:67], 0
  s_nop 0
  ds_read_b64_tr_b16 v[164:165], v220 offset:192
  ds_read_b64_tr_b16 v[166:167], v220 offset:704
  v_mfma_f32_16x16x32_bf16 v[36:39], a[244:247], a[68:71], v[36:39]
  s_nop 0
  ds_read_b64_tr_b16 v[168:169], v220 offset:8896
  ds_read_b64_tr_b16 v[170:171], v220 offset:9408
  ds_read_b64_tr_b16 v[172:173], v220 offset:17600
  ds_read_b64_tr_b16 v[174:175], v220 offset:18112
  ds_read_b64_tr_b16 v[176:177], v220 offset:26304
  ds_read_b64_tr_b16 v[178:179], v220 offset:26816
  v_mfma_f32_16x16x32_bf16 v[36:39], a[248:251], a[72:75], v[36:39]
  s_waitcnt lgkmcnt(8)
  v_mfma_f32_16x16x32_bf16 v[36:39], a[252:255], a[76:79], v[36:39]
  s_add_u32 s42, s91, 768
  s_mov_b32 m0, s38
  v_mfma_f32_16x16x32_bf16 v[40:43], v[148:151], a[0:3], 0
  buffer_load_dwordx4 v244, s[8:11], s42 offen lds
  s_add_u32 m0, m0, 32
  v_mfma_f32_16x16x32_bf16 v[40:43], v[152:155], a[4:7], v[40:43]
  v_mfma_f32_16x16x32_bf16 v[40:43], v[156:159], a[8:11], v[40:43]
  s_nop 0
  buffer_load_dwordx4 v244, s[8:11], s42 offen offset:1024 lds
  ds_read_b64_tr_b16 a[224:225], v220 offset:200
  ds_read_b64_tr_b16 a[226:227], v220 offset:712
  ds_read_b64_tr_b16 a[228:229], v220 offset:8904
  ds_read_b64_tr_b16 a[230:231], v220 offset:9416
  ds_read_b64_tr_b16 a[232:233], v220 offset:17608
  ds_read_b64_tr_b16 a[234:235], v220 offset:18120
  v_mfma_f32_16x16x32_bf16 v[40:43], v[160:163], a[12:15], v[40:43]
  s_add_u32 m0, m0, 32
  ds_read_b64_tr_b16 a[236:237], v220 offset:26312
  ds_read_b64_tr_b16 a[238:239], v220 offset:26824
  v_mfma_f32_16x16x32_bf16 v[44:47], v[148:151], a[64:67], 0
  buffer_load_dwordx4 v244, s[8:11], s42 offen offset:2048 lds
  s_add_u32 m0, m0, 32
  v_mfma_f32_16x16x32_bf16 v[44:47], v[152:155], a[68:71], v[44:47]
  v_mfma_f32_16x16x32_bf16 v[44:47], v[156:159], a[72:75], v[44:47]
  buffer_load_dwordx4 v244, s[8:11], s42 offen offset:3072 lds
  s_add_u32 s42, s42, s52
  s_add_u32 m0, m0, s53
  v_mfma_f32_16x16x32_bf16 v[44:47], v[160:163], a[76:79], v[44:47]
  s_waitcnt lgkmcnt(8)
  v_mfma_f32_16x16x32_bf16 v[48:51], v[164:167], a[0:3], 0
  buffer_load_dwordx4 v244, s[8:11], s42 offen lds
  s_add_u32 m0, m0, 32
  v_mfma_f32_16x16x32_bf16 v[48:51], v[168:171], a[4:7], v[48:51]
  s_waitcnt lgkmcnt(0)
  s_waitcnt vmcnt(13)
  s_barrier
  v_mfma_f32_16x16x32_bf16 v[48:51], v[172:175], a[8:11], v[48:51]
  buffer_load_dwordx4 v244, s[8:11], s42 offen offset:1024 lds
  s_add_u32 m0, m0, 32
  v_mfma_f32_16x16x32_bf16 v[48:51], v[176:179], a[12:15], v[48:51]
  v_mfma_f32_16x16x32_bf16 v[52:55], v[164:167], a[64:67], 0
  buffer_load_dwordx4 v244, s[8:11], s42 offen offset:2048 lds
  s_add_u32 m0, m0, 32
  v_mfma_f32_16x16x32_bf16 v[52:55], v[168:171], a[68:71], v[52:55]
  v_mfma_f32_16x16x32_bf16 v[52:55], v[172:175], a[72:75], v[52:55]
  buffer_load_dwordx4 v244, s[8:11], s42 offen offset:3072 lds
  s_add_u32 s42, s48, 2097152
  s_mov_b32 m0, s39
  v_mfma_f32_16x16x32_bf16 v[52:55], v[176:179], a[76:79], v[52:55]
  v_mfma_f32_16x16x32_bf16 v[56:59], a[224:227], a[0:3], 0
  s_nop 0
  ds_read_b64_tr_b16 a[240:241], v221 offset:0
  ds_read_b64_tr_b16 a[242:243], v221 offset:512
  v_mfma_f32_16x16x32_bf16 v[56:59], a[228:231], a[4:7], v[56:59]
  s_nop 0
  ds_read_b64_tr_b16 a[244:245], v221 offset:8704
  ds_read_b64_tr_b16 a[246:247], v221 offset:9216
  v_mfma_f32_16x16x32_bf16 v[56:59], a[232:235], a[8:11], v[56:59]
  s_nop 0
  ds_read_b64_tr_b16 a[248:249], v221 offset:17408
  ds_read_b64_tr_b16 a[250:251], v221 offset:17920
  v_mfma_f32_16x16x32_bf16 v[56:59], a[236:239], a[12:15], v[56:59]
  s_nop 0
  ds_read_b64_tr_b16 a[252:253], v221 offset:26112
  ds_read_b64_tr_b16 a[254:255], v221 offset:26624
  v_mfma_f32_16x16x32_bf16 v[60:63], a[224:227], a[64:67], 0
  buffer_load_dwordx4 v227, s[12:15], s42 offen lds
  v_mfma_f32_16x16x32_bf16 v[60:63], a[228:231], a[68:71], v[60:63]
  v_mfma_f32_16x16x32_bf16 v[60:63], a[232:235], a[72:75], v[60:63]
  s_add_u32 s42, s42, s49
  s_add_u32 m0, m0, s50
  v_mfma_f32_16x16x32_bf16 v[60:63], a[236:239], a[76:79], v[60:63]
  s_waitcnt lgkmcnt(6)
  v_mfma_f32_16x16x32_bf16 v[0:3], a[240:243], a[16:19], v[0:3]
  s_waitcnt lgkmcnt(4)
  buffer_load_dwordx4 v227, s[12:15], s42 offen lds
  ds_read_b64 v[148:149], v224 offset:256
  ds_read_b64 v[150:151], v224 offset:288
  ds_read_b64_tr_b16 v[152:153], v223 offset:0
  ds_read_b64_tr_b16 v[154:155], v223 offset:512
  v_mfma_f32_16x16x32_bf16 v[0:3], a[244:247], a[20:23], v[0:3]
  s_waitcnt lgkmcnt(6)
  ds_read_b64_tr_b16 v[156:157], v223 offset:8
  ds_read_b64_tr_b16 v[158:159], v223 offset:520
  v_mfma_f32_16x16x32_bf16 v[0:3], a[248:251], a[24:27], v[0:3]
  s_waitcnt lgkmcnt(6)
  ds_read_b64_tr_b16 v[160:161], v221 offset:8
  ds_read_b64_tr_b16 v[162:163], v221 offset:520
  v_mfma_f32_16x16x32_bf16 v[0:3], a[252:255], a[28:31], v[0:3]
  s_add_u32 s42, s42, s49
  s_add_u32 m0, m0, s50
  ds_read_b64_tr_b16 v[164:165], v221 offset:8712
  ds_read_b64_tr_b16 v[166:167], v221 offset:9224
  v_mfma_f32_16x16x32_bf16 v[4:7], a[240:243], a[80:83], v[4:7]
  s_nop 0
  buffer_load_dwordx4 v227, s[12:15], s42 offen lds
  ds_read_b64_tr_b16 v[168:169], v221 offset:17416
  ds_read_b64_tr_b16 v[170:171], v221 offset:17928
  v_mfma_f32_16x16x32_bf16 v[4:7], a[244:247], a[84:87], v[4:7]
  s_nop 0
  ds_read_b64_tr_b16 v[172:173], v221 offset:26120
  ds_read_b64_tr_b16 v[174:175], v221 offset:26632
  v_mfma_f32_16x16x32_bf16 v[4:7], a[248:251], a[88:91], v[4:7]
  s_add_u32 s42, s42, s49
  s_add_u32 m0, m0, s50
  v_mfma_f32_16x16x32_bf16 v[4:7], a[252:255], a[92:95], v[4:7]
  s_waitcnt lgkmcnt(10)
  v_mfma_f32_16x16x32_bf16 v[128:131], v[152:155], v[148:151], v[128:131]
  s_waitcnt lgkmcnt(8)
  buffer_load_dwordx4 v227, s[12:15], s42 offen lds
  v_mfma_f32_16x16x32_bf16 v[132:135], v[156:159], v[148:151], v[132:135]
  s_waitcnt lgkmcnt(6)
  v_mfma_f32_16x16x32_bf16 v[8:11], v[160:163], a[16:19], v[8:11]
  s_waitcnt lgkmcnt(4)
  ds_read_b64 v[176:177], v224 offset:320
  ds_read_b64 v[178:179], v224 offset:352
  ds_read_b64_tr_b16 a[224:225], v223 offset:8704
  ds_read_b64_tr_b16 a[226:227], v223 offset:9216
  v_mfma_f32_16x16x32_bf16 v[8:11], v[164:167], a[20:23], v[8:11]
  s_waitcnt lgkmcnt(6)
  s_add_u32 s42, s42, s49
  s_add_u32 m0, m0, s51
  ds_read_b64_tr_b16 a[228:229], v223 offset:8712
  ds_read_b64_tr_b16 a[230:231], v223 offset:9224
  v_mfma_f32_16x16x32_bf16 v[8:11], v[168:171], a[24:27], v[8:11]
  s_waitcnt lgkmcnt(6)
  buffer_load_dwordx4 v227, s[12:15], s42 offen lds
  ds_read_b64_tr_b16 a[232:233], v221 offset:64
  ds_read_b64_tr_b16 a[234:235], v221 offset:576
  v_mfma_f32_16x16x32_bf16 v[8:11], v[172:175], a[28:31], v[8:11]
  s_nop 0
  ds_read_b64_tr_b16 a[236:237], v221 offset:8768
  ds_read_b64_tr_b16 a[238:239], v221 offset:9280
  v_mfma_f32_16x16x32_bf16 v[12:15], v[160:163], a[80:83], v[12:15]
  s_add_u32 s42, s42, s49
  ds_read_b64_tr_b16 a[240:241], v221 offset:17472
  ds_read_b64_tr_b16 a[242:243], v221 offset:17984
  v_mfma_f32_16x16x32_bf16 v[12:15], v[164:167], a[84:87], v[12:15]
  s_add_u32 m0, m0, s50
  ds_read_b64_tr_b16 a[244:245], v221 offset:26176
  ds_read_b64_tr_b16 a[246:247], v221 offset:26688
  v_mfma_f32_16x16x32_bf16 v[12:15], v[168:171], a[88:91], v[12:15]
  s_waitcnt vmcnt(13)
  buffer_load_dwordx4 v227, s[12:15], s42 offen lds
  v_mfma_f32_16x16x32_bf16 v[12:15], v[172:175], a[92:95], v[12:15]
  s_waitcnt lgkmcnt(10)
  v_mfma_f32_16x16x32_bf16 v[128:131], a[224:227], v[176:179], v[128:131]
  s_waitcnt lgkmcnt(8)
  s_add_u32 s42, s42, s49
  s_add_u32 m0, m0, s50
  v_mfma_f32_16x16x32_bf16 v[132:135], a[228:231], v[176:179], v[132:135]
  s_waitcnt lgkmcnt(6)
  v_mfma_f32_16x16x32_bf16 v[16:19], a[232:235], a[16:19], v[16:19]
  s_waitcnt lgkmcnt(4)
  buffer_load_dwordx4 v227, s[12:15], s42 offen lds
  ds_read_b64 a[248:249], v224 offset:384
  ds_read_b64 a[250:251], v224 offset:416
  ds_read_b64_tr_b16 a[252:253], v223 offset:17408
  ds_read_b64_tr_b16 a[254:255], v223 offset:17920
  v_mfma_f32_16x16x32_bf16 v[16:19], a[236:239], a[20:23], v[16:19]
  s_waitcnt lgkmcnt(6)
  ds_read_b64_tr_b16 v[148:149], v223 offset:17416
  ds_read_b64_tr_b16 v[150:151], v223 offset:17928
  v_mfma_f32_16x16x32_bf16 v[16:19], a[240:243], a[24:27], v[16:19]
  s_waitcnt lgkmcnt(6)
  ds_read_b64_tr_b16 v[152:153], v221 offset:72
  ds_read_b64_tr_b16 v[154:155], v221 offset:584
  v_mfma_f32_16x16x32_bf16 v[16:19], a[244:247], a[28:31], v[16:19]
  s_add_u32 s42, s42, s49
  s_add_u32 m0, m0, s50
  ds_read_b64_tr_b16 v[156:157], v221 offset:8776
  ds_read_b64_tr_b16 v[158:159], v221 offset:9288
  v_mfma_f32_16x16x32_bf16 v[20:23], a[232:235], a[80:83], v[20:23]
  s_nop 0
  buffer_load_dwordx4 v227, s[12:15], s42 offen lds
  ds_read_b64_tr_b16 v[160:161], v221 offset:17480
  ds_read_b64_tr_b16 v[162:163], v221 offset:17992
  v_mfma_f32_16x16x32_bf16 v[20:23], a[236:239], a[84:87], v[20:23]
  s_nop 0
  ds_read_b64_tr_b16 v[164:165], v221 offset:26184
  ds_read_b64_tr_b16 v[166:167], v221 offset:26696
  v_mfma_f32_16x16x32_bf16 v[20:23], a[240:243], a[88:91], v[20:23]
  v_mfma_f32_16x16x32_bf16 v[20:23], a[244:247], a[92:95], v[20:23]
  s_waitcnt lgkmcnt(10)
  v_mfma_f32_16x16x32_bf16 v[128:131], a[252:255], a[248:251], v[128:131]
  s_waitcnt lgkmcnt(8)
  ds_read_b64 a[32:33], v245 offset:0
  ds_read_b64 a[34:35], v245 offset:32
  v_mfma_f32_16x16x32_bf16 v[132:135], v[148:151], a[248:251], v[132:135]
  s_waitcnt lgkmcnt(8)
  ds_read_b64 a[36:37], v245 offset:64
  ds_read_b64 a[38:39], v245 offset:96
  v_mfma_f32_16x16x32_bf16 v[24:27], v[152:155], a[16:19], v[24:27]
  s_waitcnt lgkmcnt(8)
  ds_read_b64 v[168:169], v224 offset:448
  ds_read_b64 v[170:171], v224 offset:480
  ds_read_b64_tr_b16 v[172:173], v223 offset:26112
  ds_read_b64_tr_b16 v[174:175], v223 offset:26624
  v_mfma_f32_16x16x32_bf16 v[24:27], v[156:159], a[20:23], v[24:27]
  s_waitcnt lgkmcnt(10)
  ds_read_b64_tr_b16 v[176:177], v223 offset:26120
  ds_read_b64_tr_b16 v[178:179], v223 offset:26632
  v_mfma_f32_16x16x32_bf16 v[24:27], v[160:163], a[24:27], v[24:27]
  s_waitcnt lgkmcnt(10)
  ds_read_b64_tr_b16 a[224:225], v221 offset:128
  ds_read_b64_tr_b16 a[226:227], v221 offset:640
  v_mfma_f32_16x16x32_bf16 v[24:27], v[164:167], a[28:31], v[24:27]
  s_nop 0
  ds_read_b64_tr_b16 a[228:229], v221 offset:8832
  ds_read_b64_tr_b16 a[230:231], v221 offset:9344
  v_mfma_f32_16x16x32_bf16 v[28:31], v[152:155], a[80:83], v[28:31]
  s_nop 0
  ds_read_b64 a[40:41], v245 offset:128
  ds_read_b64 a[42:43], v245 offset:160
  ds_read_b64 a[44:45], v245 offset:192
  ds_read_b64 a[46:47], v245 offset:224
  ds_read_b64 a[96:97], v245 offset:512
  ds_read_b64 a[98:99], v245 offset:544
  ds_read_b64 a[100:101], v245 offset:576
  ds_read_b64 a[102:103], v245 offset:608
  ds_read_b64 a[104:105], v245 offset:640
  ds_read_b64 a[106:107], v245 offset:672
  ds_read_b64 a[108:109], v245 offset:704
  ds_read_b64 a[110:111], v245 offset:736
  ds_read_b64_tr_b16 a[232:233], v221 offset:17536
  ds_read_b64_tr_b16 a[234:235], v221 offset:18048
  v_mfma_f32_16x16x32_bf16 v[28:31], v[156:159], a[84:87], v[28:31]
  s_nop 0
  ds_read_b64_tr_b16 a[236:237], v221 offset:26240
  ds_read_b64_tr_b16 a[238:239], v221 offset:26752
  v_mfma_f32_16x16x32_bf16 v[28:31], v[160:163], a[88:91], v[28:31]
  v_mfma_f32_16x16x32_bf16 v[28:31], v[164:167], a[92:95], v[28:31]
  s_waitcnt lgkmcnt(15)
  v_mfma_f32_16x16x32_bf16 v[128:131], v[172:175], v[168:171], v[128:131]
  s_waitcnt lgkmcnt(4)
  v_mfma_f32_16x16x32_bf16 v[132:135], v[176:179], v[168:171], v[132:135]
  ds_read_b64_tr_b16 a[240:241], v221 offset:136
  ds_read_b64_tr_b16 a[242:243], v221 offset:648
  ds_read_b64_tr_b16 a[244:245], v221 offset:8840
  ds_read_b64_tr_b16 a[246:247], v221 offset:9352
  v_mfma_f32_16x16x32_bf16 v[32:35], a[224:227], a[16:19], v[32:35]
  ds_read_b64_tr_b16 a[248:249], v221 offset:17544
  ds_read_b64_tr_b16 a[250:251], v221 offset:18056
  ds_read_b64_tr_b16 a[252:253], v221 offset:26248
  ds_read_b64_tr_b16 a[254:255], v221 offset:26760
  v_mfma_f32_16x16x32_bf16 v[32:35], a[228:231], a[20:23], v[32:35]
  s_waitcnt lgkmcnt(10)
  s_add_u32 s42, s0, 0
  s_mov_b32 m0, s37
  v_mfma_f32_16x16x32_bf16 v[32:35], a[232:235], a[24:27], v[32:35]
  s_waitcnt lgkmcnt(8)
  v_mfma_f32_16x16x32_bf16 v[32:35], a[236:239], a[28:31], v[32:35]
  buffer_load_dwordx4 v225, s[16:19], s42 offen nt lds
  v_mfma_f32_16x16x32_bf16 v[36:39], a[224:227], a[80:83], v[36:39]
  s_add_u32 m0, m0, 32
  ds_read_b64_tr_b16 v[148:149], v221 offset:192
  ds_read_b64_tr_b16 v[150:151], v221 offset:704
  v_mfma_f32_16x16x32_bf16 v[36:39], a[228:231], a[84:87], v[36:39]
  s_nop 0
  ds_read_b64_tr_b16 v[152:153], v221 offset:8896
  ds_read_b64_tr_b16 v[154:155], v221 offset:9408
  ds_read_b64_tr_b16 v[156:157], v221 offset:17600
  ds_read_b64_tr_b16 v[158:159], v221 offset:18112
  ds_read_b64_tr_b16 v[160:161], v221 offset:26304
  ds_read_b64_tr_b16 v[162:163], v221 offset:26816
  v_mfma_f32_16x16x32_bf16 v[36:39], a[232:235], a[88:91], v[36:39]
  buffer_load_dwordx4 v225, s[16:19], s42 offen offset:1024 nt lds
  v_mfma_f32_16x16x32_bf16 v[36:39], a[236:239], a[92:95], v[36:39]
  s_waitcnt lgkmcnt(8)
  s_add_u32 m0, m0, 32
  v_mfma_f32_16x16x32_bf16 v[40:43], a[240:243], a[16:19], v[40:43]
  v_mfma_f32_16x16x32_bf16 v[40:43], a[244:247], a[20:23], v[40:43]
  buffer_load_dwordx4 v225, s[16:19], s42 offen offset:2048 nt lds
  v_mfma_f32_16x16x32_bf16 v[40:43], a[248:251], a[24:27], v[40:43]
  s_nop 0
  ds_read_b64_tr_b16 v[164:165], v221 offset:200
  ds_read_b64_tr_b16 v[166:167], v221 offset:712
  ds_read_b64_tr_b16 v[168:169], v221 offset:8904
  ds_read_b64_tr_b16 v[170:171], v221 offset:9416
  ds_read_b64_tr_b16 v[172:173], v221 offset:17608
  ds_read_b64_tr_b16 v[174:175], v221 offset:18120
  v_mfma_f32_16x16x32_bf16 v[40:43], a[252:255], a[28:31], v[40:43]
  s_add_u32 m0, m0, 32
  ds_read_b64_tr_b16 v[176:177], v221 offset:26312
  ds_read_b64_tr_b16 v[178:179], v221 offset:26824
  v_mfma_f32_16x16x32_bf16 v[44:47], a[240:243], a[80:83], v[44:47]
  buffer_load_dwordx4 v225, s[16:19], s42 offen offset:3072 nt lds
  v_mfma_f32_16x16x32_bf16 v[44:47], a[244:247], a[84:87], v[44:47]
  s_add_u32 s42, s42, s52
  s_add_u32 m0, m0, s53
  v_mfma_f32_16x16x32_bf16 v[44:47], a[248:251], a[88:91], v[44:47]
  v_mfma_f32_16x16x32_bf16 v[44:47], a[252:255], a[92:95], v[44:47]
  s_waitcnt lgkmcnt(8)
  buffer_load_dwordx4 v225, s[16:19], s42 offen nt lds
  v_mfma_f32_16x16x32_bf16 v[48:51], v[148:151], a[16:19], v[48:51]
  s_add_u32 m0, m0, 32
  v_mfma_f32_16x16x32_bf16 v[48:51], v[152:155], a[20:23], v[48:51]
  s_waitcnt lgkmcnt(0)
  s_waitcnt vmcnt(5)
  s_barrier
  buffer_load_dwordx4 v225, s[16:19], s42 offen offset:1024 nt lds
  v_mfma_f32_16x16x32_bf16 v[48:51], v[156:159], a[24:27], v[48:51]
  s_add_u32 m0, m0, 32
  ds_read_b64_tr_b16 a[224:225], v220 offset:0
  v_mfma_f32_16x16x32_bf16 v[48:51], v[160:163], a[28:31], v[48:51]
  s_nop 0
  buffer_load_dwordx4 v225, s[16:19], s42 offen offset:2048 nt lds
  ds_read_b64_tr_b16 a[226:227], v220 offset:512
  v_mfma_f32_16x16x32_bf16 v[52:55], v[148:151], a[80:83], v[52:55]
  s_add_u32 m0, m0, 32
  ds_read_b64_tr_b16 a[228:229], v220 offset:8704
  ds_read_b64_tr_b16 a[230:231], v220 offset:9216
  v_mfma_f32_16x16x32_bf16 v[52:55], v[152:155], a[84:87], v[52:55]
  buffer_load_dwordx4 v225, s[16:19], s42 offen offset:3072 nt lds
  s_add_u32 s42, s48, 3145728
  s_mov_b32 m0, s40
  v_mfma_f32_16x16x32_bf16 v[52:55], v[156:159], a[88:91], v[52:55]
  s_nop 0
  ds_read_b64_tr_b16 a[232:233], v220 offset:17408
  ds_read_b64_tr_b16 a[234:235], v220 offset:17920
  v_mfma_f32_16x16x32_bf16 v[52:55], v[160:163], a[92:95], v[52:55]
  ds_read_b64_tr_b16 a[236:237], v220 offset:26112
  ds_read_b64_tr_b16 a[238:239], v220 offset:26624
  v_mfma_f32_16x16x32_bf16 v[56:59], v[164:167], a[16:19], v[56:59]
  s_nop 0
  buffer_load_dwordx4 v227, s[12:15], s42 offen lds
  ds_read_b64 a[240:241], v224 offset:512
  v_mfma_f32_16x16x32_bf16 v[56:59], v[168:171], a[20:23], v[56:59]
  s_nop 0
  ds_read_b64 a[242:243], v224 offset:544
  ds_read_b64_tr_b16 a[244:245], v222 offset:0
  v_mfma_f32_16x16x32_bf16 v[56:59], v[172:175], a[24:27], v[56:59]
  s_add_u32 s42, s42, s49
  s_add_u32 m0, m0, s50
  v_mfma_f32_16x16x32_bf16 v[56:59], v[176:179], a[28:31], v[56:59]
  s_nop 0
  buffer_load_dwordx4 v227, s[12:15], s42 offen lds
  ds_read_b64_tr_b16 a[246:247], v222 offset:512
  v_mfma_f32_16x16x32_bf16 v[60:63], v[164:167], a[80:83], v[60:63]
  s_nop 0
  ds_read_b64_tr_b16 a[248:249], v222 offset:8
  ds_read_b64_tr_b16 a[250:251], v222 offset:520
  v_mfma_f32_16x16x32_bf16 v[60:63], v[168:171], a[84:87], v[60:63]
  s_add_u32 s42, s42, s49
  s_add_u32 m0, m0, s50
  ds_read_b64_tr_b16 a[252:253], v220 offset:8
  v_mfma_f32_16x16x32_bf16 v[60:63], v[172:175], a[88:91], v[60:63]
  s_nop 0
  ds_read_b64_tr_b16 a[254:255], v220 offset:520
  ds_read_b64_tr_b16 v[148:149], v220 offset:8712
  v_mfma_f32_16x16x32_bf16 v[60:63], v[176:179], a[92:95], v[60:63]
  s_waitcnt lgkmcnt(9)
  ds_read_b64_tr_b16 v[150:151], v220 offset:9224
  buffer_load_dwordx4 v227, s[12:15], s42 offen lds
  v_mfma_f32_16x16x32_bf16 v[0:3], a[224:227], a[32:35], v[0:3]
  ds_read_b64_tr_b16 v[152:153], v220 offset:17416
  v_mfma_f32_16x16x32_bf16 v[0:3], a[228:231], a[36:39], v[0:3]
  s_nop 0
  ds_read_b64_tr_b16 v[154:155], v220 offset:17928
  ds_read_b64_tr_b16 v[156:157], v220 offset:26120
  v_mfma_f32_16x16x32_bf16 v[0:3], a[232:235], a[40:43], v[0:3]
  s_add_u32 s42, s42, s49
  ds_read_b64_tr_b16 v[158:159], v220 offset:26632
  v_mfma_f32_16x16x32_bf16 v[0:3], a[236:239], a[44:47], v[0:3]
  s_add_u32 m0, m0, s50
  ds_read_b64 a[48:49], v246 offset:0
  ds_read_b64 a[50:51], v246 offset:32
  v_mfma_f32_16x16x32_bf16 v[4:7], a[224:227], a[96:99], v[4:7]
  s_nop 0
  ds_read_b64 a[52:53], v246 offset:64
  ds_read_b64 a[54:55], v246 offset:96
  v_mfma_f32_16x16x32_bf16 v[4:7], a[228:231], a[100:103], v[4:7]
  s_nop 0
  ds_read_b64 a[56:57], v246 offset:128
  ds_read_b64 a[58:59], v246 offset:160
  v_mfma_f32_16x16x32_bf16 v[4:7], a[232:235], a[104:107], v[4:7]
  s_nop 0
  ds_read_b64 a[60:61], v246 offset:192
  ds_read_b64 a[62:63], v246 offset:224
  v_mfma_f32_16x16x32_bf16 v[4:7], a[236:239], a[108:111], v[4:7]
  s_waitcnt lgkmcnt(12)
  ds_read_b64 a[112:113], v246 offset:512
  ds_read_b64 a[114:115], v246 offset:544
  v_mfma_f32_16x16x32_bf16 v[128:131], a[244:247], a[240:243], v[128:131]
  s_nop 0
  buffer_load_dwordx4 v227, s[12:15], s42 offen lds
  ds_read_b64 a[116:117], v246 offset:576
  v_mfma_f32_16x16x32_bf16 v[132:135], a[248:251], a[240:243], v[132:135]
  s_nop 0
  ds_read_b64 a[118:119], v246 offset:608
  ds_read_b64 a[120:121], v246 offset:640
  v_mfma_f32_16x16x32_bf16 v[8:11], a[252:255], a[32:35], v[8:11]
  s_nop 0
  ds_read_b64 v[160:161], v224 offset:576
  ds_read_b64 v[162:163], v224 offset:608
  ds_read_b64_tr_b16 v[164:165], v222 offset:8704
  ds_read_b64_tr_b16 v[166:167], v222 offset:9216
  v_mfma_f32_16x16x32_bf16 v[8:11], v[148:151], a[36:39], v[8:11]
  s_waitcnt lgkmcnt(15)
  s_add_u32 s42, s42, s49
  s_add_u32 m0, m0, s51
  ds_read_b64_tr_b16 v[168:169], v222 offset:8712
  ds_read_b64_tr_b16 v[170:171], v222 offset:9224
  v_mfma_f32_16x16x32_bf16 v[8:11], v[152:155], a[40:43], v[8:11]
  s_nop 0
  buffer_load_dwordx4 v227, s[12:15], s42 offen lds
  ds_read_b64_tr_b16 v[172:173], v220 offset:64
  ds_read_b64_tr_b16 v[174:175], v220 offset:576
  v_mfma_f32_16x16x32_bf16 v[8:11], v[156:159], a[44:47], v[8:11]
  s_nop 0
  ds_read_b64_tr_b16 v[176:177], v220 offset:8768
  ds_read_b64_tr_b16 v[178:179], v220 offset:9280
  v_mfma_f32_16x16x32_bf16 v[12:15], a[252:255], a[96:99], v[12:15]
  s_add_u32 s42, s42, s49
  ds_read_b64_tr_b16 a[224:225], v220 offset:17472
  ds_read_b64_tr_b16 a[226:227], v220 offset:17984
  v_mfma_f32_16x16x32_bf16 v[12:15], v[148:151], a[100:103], v[12:15]
  s_add_u32 m0, m0, s50
  ds_read_b64_tr_b16 a[228:229], v220 offset:26176
  ds_read_b64_tr_b16 a[230:231], v220 offset:26688
  v_mfma_f32_16x16x32_bf16 v[12:15], v[152:155], a[104:107], v[12:15]
  buffer_load_dwordx4 v227, s[12:15], s42 offen lds
  v_mfma_f32_16x16x32_bf16 v[12:15], v[156:159], a[108:111], v[12:15]
  s_waitcnt lgkmcnt(10)
  v_mfma_f32_16x16x32_bf16 v[128:131], v[164:167], v[160:163], v[128:131]
  s_waitcnt lgkmcnt(8)
  ds_read_b64 a[122:123], v246 offset:672
  ds_read_b64 a[124:125], v246 offset:704
  v_mfma_f32_16x16x32_bf16 v[132:135], v[168:171], v[160:163], v[132:135]
  s_waitcnt lgkmcnt(8)
  s_add_u32 s42, s42, s49
  s_add_u32 m0, m0, s50
  v_mfma_f32_16x16x32_bf16 v[16:19], v[172:175], a[32:35], v[16:19]
  s_waitcnt lgkmcnt(6)
  ds_read_b64 a[126:127], v246 offset:736
  buffer_load_dwordx4 v227, s[12:15], s42 offen lds
  ds_read_b64 a[232:233], v224 offset:640
  ds_read_b64 a[234:235], v224 offset:672
  ds_read_b64_tr_b16 a[236:237], v222 offset:17408
  ds_read_b64_tr_b16 a[238:239], v222 offset:17920
  v_mfma_f32_16x16x32_bf16 v[16:19], v[176:179], a[36:39], v[16:19]
  s_waitcnt lgkmcnt(9)
  ds_read_b64_tr_b16 a[240:241], v222 offset:17416
  ds_read_b64_tr_b16 a[242:243], v222 offset:17928
  v_mfma_f32_16x16x32_bf16 v[16:19], a[224:227], a[40:43], v[16:19]
  s_waitcnt lgkmcnt(9)
  ds_read_b64_tr_b16 a[244:245], v220 offset:72
  ds_read_b64_tr_b16 a[246:247], v220 offset:584
  v_mfma_f32_16x16x32_bf16 v[16:19], a[228:231], a[44:47], v[16:19]
  s_add_u32 s42, s42, s49
  s_add_u32 m0, m0, s50
  ds_read_b64_tr_b16 a[248:249], v220 offset:8776
  ds_read_b64_tr_b16 a[250:251], v220 offset:9288
  v_mfma_f32_16x16x32_bf16 v[20:23], v[172:175], a[96:99], v[20:23]
  s_waitcnt lgkmcnt(10)
  buffer_load_dwordx4 v227, s[12:15], s42 offen lds
  ds_read_b64_tr_b16 a[252:253], v220 offset:17480
  ds_read_b64_tr_b16 a[254:255], v220 offset:17992
  v_mfma_f32_16x16x32_bf16 v[20:23], v[176:179], a[100:103], v[20:23]
  s_add_u32 s42, s0, 0
  ds_read_b64_tr_b16 v[148:149], v220 offset:26184
  ds_read_b64_tr_b16 v[150:151], v220 offset:26696
  v_mfma_f32_16x16x32_bf16 v[20:23], a[224:227], a[104:107], v[20:23]
  s_mov_b32 m0, s38
  v_mfma_f32_16x16x32_bf16 v[20:23], a[228:231], a[108:111], v[20:23]
  s_waitcnt lgkmcnt(10)
  v_mfma_f32_16x16x32_bf16 v[128:131], a[236:239], a[232:235], v[128:131]
  s_waitcnt lgkmcnt(8)
  ds_read_b64 v[152:153], v224 offset:704
  v_mfma_f32_16x16x32_bf16 v[132:135], a[240:243], a[232:235], v[132:135]
  s_waitcnt lgkmcnt(7)
  ds_read_b64 v[154:155], v224 offset:736
  ds_read_b64_tr_b16 v[156:157], v222 offset:26112
  v_mfma_f32_16x16x32_bf16 v[24:27], a[244:247], a[32:35], v[24:27]
  s_waitcnt lgkmcnt(7)
  ds_read_b64_tr_b16 v[158:159], v222 offset:26624
  ds_read_b64_tr_b16 v[160:161], v222 offset:26120
  v_mfma_f32_16x16x32_bf16 v[24:27], a[248:251], a[36:39], v[24:27]
  s_waitcnt lgkmcnt(7)
  ds_read_b64_tr_b16 v[162:163], v222 offset:26632
  ds_read_b64_tr_b16 v[164:165], v220 offset:128
  v_mfma_f32_16x16x32_bf16 v[24:27], a[252:255], a[40:43], v[24:27]
  s_waitcnt lgkmcnt(7)
  ds_read_b64_tr_b16 v[166:167], v220 offset:640
  ds_read_b64_tr_b16 v[168:169], v220 offset:8832
  v_mfma_f32_16x16x32_bf16 v[24:27], v[148:151], a[44:47], v[24:27]
  s_nop 0
  ds_read_b64_tr_b16 v[170:171], v220 offset:9344
  buffer_load_dwordx4 v225, s[20:23], s42 offen nt lds
  v_mfma_f32_16x16x32_bf16 v[28:31], a[244:247], a[96:99], v[28:31]
  s_nop 0
  ds_read_b64_tr_b16 v[172:173], v220 offset:17536
  ds_read_b64_tr_b16 v[174:175], v220 offset:18048
  v_mfma_f32_16x16x32_bf16 v[28:31], a[248:251], a[100:103], v[28:31]
  s_add_u32 m0, m0, 32
  ds_read_b64_tr_b16 v[176:177], v220 offset:26240
  ds_read_b64_tr_b16 v[178:179], v220 offset:26752
  v_mfma_f32_16x16x32_bf16 v[28:31], a[252:255], a[104:107], v[28:31]
  s_nop 0
  buffer_load_dwordx4 v225, s[20:23], s42 offen offset:1024 nt lds
  ds_read_b64_tr_b16 a[224:225], v220 offset:136
  v_mfma_f32_16x16x32_bf16 v[28:31], v[148:151], a[108:111], v[28:31]
  s_waitcnt lgkmcnt(11)
  ds_read_b64_tr_b16 a[226:227], v220 offset:648
  ds_read_b64_tr_b16 a[228:229], v220 offset:8840
  v_mfma_f32_16x16x32_bf16 v[128:131], v[156:159], v[152:155], v[128:131]
  s_waitcnt lgkmcnt(11)
  s_add_u32 m0, m0, 32
  ds_read_b64_tr_b16 a[230:231], v220 offset:9352
  v_mfma_f32_16x16x32_bf16 v[132:135], v[160:163], v[152:155], v[132:135]
  s_waitcnt lgkmcnt(10)
  ds_read_b64_tr_b16 a[232:233], v220 offset:17544
  ds_read_b64_tr_b16 a[234:235], v220 offset:18056
  v_mfma_f32_16x16x32_bf16 v[32:35], v[164:167], a[32:35], v[32:35]
  s_waitcnt lgkmcnt(10)
  ds_read_b64_tr_b16 a[236:237], v220 offset:26248
  ds_read_b64_tr_b16 a[238:239], v220 offset:26760
  v_mfma_f32_16x16x32_bf16 v[32:35], v[168:171], a[36:39], v[32:35]
  s_waitcnt lgkmcnt(10)
  buffer_load_dwordx4 v225, s[20:23], s42 offen offset:2048 nt lds
  ds_read_b64_tr_b16 a[240:241], v220 offset:192
  v_mfma_f32_16x16x32_bf16 v[32:35], v[172:175], a[40:43], v[32:35]
  s_waitcnt lgkmcnt(9)
  ds_read_b64_tr_b16 a[242:243], v220 offset:704
  ds_read_b64_tr_b16 a[244:245], v220 offset:8896
  v_mfma_f32_16x16x32_bf16 v[32:35], v[176:179], a[44:47], v[32:35]
  s_add_u32 m0, m0, 32
  ds_read_b64_tr_b16 a[246:247], v220 offset:9408
  ds_read_b64_tr_b16 a[248:249], v220 offset:17600
  v_mfma_f32_16x16x32_bf16 v[36:39], v[164:167], a[96:99], v[36:39]
  s_nop 0
  ds_read_b64_tr_b16 a[250:251], v220 offset:18112
  ds_read_b64_tr_b16 a[252:253], v220 offset:26304
  v_mfma_f32_16x16x32_bf16 v[36:39], v[168:171], a[100:103], v[36:39]
  s_nop 0
  ds_read_b64_tr_b16 a[254:255], v220 offset:26816
  buffer_load_dwordx4 v225, s[20:23], s42 offen offset:3072 nt lds
  v_mfma_f32_16x16x32_bf16 v[36:39], v[172:175], a[104:107], v[36:39]
  s_nop 0
  ds_read_b64_tr_b16 v[148:149], v220 offset:200
  ds_read_b64_tr_b16 v[150:151], v220 offset:712
  v_mfma_f32_16x16x32_bf16 v[36:39], v[176:179], a[108:111], v[36:39]
  s_waitcnt lgkmcnt(10)
  s_add_u32 s42, s42, s52
  s_add_u32 m0, m0, s53
  v_mfma_f32_16x16x32_bf16 v[40:43], a[224:227], a[32:35], v[40:43]
  s_nop 0
  buffer_load_dwordx4 v225, s[20:23], s42 offen nt lds
  ds_read_b64_tr_b16 v[152:153], v220 offset:8904
  v_mfma_f32_16x16x32_bf16 v[40:43], a[228:231], a[36:39], v[40:43]
  s_nop 0
  ds_read_b64_tr_b16 v[154:155], v220 offset:9416
  ds_read_b64_tr_b16 v[156:157], v220 offset:17608
  v_mfma_f32_16x16x32_bf16 v[40:43], a[232:235], a[40:43], v[40:43]
  s_nop 0
  ds_read_b64_tr_b16 v[158:159], v220 offset:18120
  ds_read_b64_tr_b16 v[160:161], v220 offset:26312
  v_mfma_f32_16x16x32_bf16 v[40:43], a[236:239], a[44:47], v[40:43]
  s_add_u32 m0, m0, 32
  ds_read_b64_tr_b16 v[162:163], v220 offset:26824
  v_mfma_f32_16x16x32_bf16 v[44:47], a[224:227], a[96:99], v[44:47]
  buffer_load_dwordx4 v225, s[20:23], s42 offen offset:1024 nt lds
  v_mfma_f32_16x16x32_bf16 v[44:47], a[228:231], a[100:103], v[44:47]
  v_mfma_f32_16x16x32_bf16 v[44:47], a[232:235], a[104:107], v[44:47]
  s_add_u32 m0, m0, 32
  v_mfma_f32_16x16x32_bf16 v[44:47], a[236:239], a[108:111], v[44:47]
  s_waitcnt lgkmcnt(8)
  buffer_load_dwordx4 v225, s[20:23], s42 offen offset:2048 nt lds
  v_mfma_f32_16x16x32_bf16 v[48:51], a[240:243], a[32:35], v[48:51]
  v_mfma_f32_16x16x32_bf16 v[48:51], a[244:247], a[36:39], v[48:51]
  s_add_u32 m0, m0, 32
  s_waitcnt lgkmcnt(0)
  s_waitcnt vmcnt(7)
  s_barrier
  v_mfma_f32_16x16x32_bf16 v[48:51], a[248:251], a[40:43], v[48:51]
  s_nop 0
  buffer_load_dwordx4 v225, s[20:23], s42 offen offset:3072 nt lds
  ds_read_b64_tr_b16 v[164:165], v221 offset:0
  v_mfma_f32_16x16x32_bf16 v[48:51], a[252:255], a[44:47], v[48:51]
  s_add_u32 s42, s1, 0
  ds_read_b64_tr_b16 v[166:167], v221 offset:512
  ds_read_b64_tr_b16 v[168:169], v221 offset:8704
  v_mfma_f32_16x16x32_bf16 v[52:55], a[240:243], a[96:99], v[52:55]
  s_mov_b32 m0, s39
  ds_read_b64_tr_b16 v[170:171], v221 offset:9216
  ds_read_b64_tr_b16 v[172:173], v221 offset:17408
  v_mfma_f32_16x16x32_bf16 v[52:55], a[244:247], a[100:103], v[52:55]
  s_nop 0
  ds_read_b64_tr_b16 v[174:175], v221 offset:17920
  ds_read_b64_tr_b16 v[176:177], v221 offset:26112
  v_mfma_f32_16x16x32_bf16 v[52:55], a[248:251], a[104:107], v[52:55]
  s_nop 0
  ds_read_b64_tr_b16 v[178:179], v221 offset:26624
  buffer_load_dwordx4 v225, s[16:19], s42 offen nt lds
  v_mfma_f32_16x16x32_bf16 v[52:55], a[252:255], a[108:111], v[52:55]
  ds_read_b64 a[224:225], v224 offset:768
  ds_read_b64 a[226:227], v224 offset:800
  v_mfma_f32_16x16x32_bf16 v[56:59], v[148:151], a[32:35], v[56:59]
  s_nop 0
  ds_read_b64_tr_b16 a[228:229], v223 offset:0
  ds_read_b64_tr_b16 a[230:231], v223 offset:512
  v_mfma_f32_16x16x32_bf16 v[56:59], v[152:155], a[36:39], v[56:59]
  s_add_u32 m0, m0, 32
  ds_read_b64_tr_b16 a[232:233], v223 offset:8
  v_mfma_f32_16x16x32_bf16 v[56:59], v[156:159], a[40:43], v[56:59]
  s_nop 0
  ds_read_b64_tr_b16 a[234:235], v223 offset:520
  buffer_load_dwordx4 v225, s[16:19], s42 offen offset:1024 nt lds
  v_mfma_f32_16x16x32_bf16 v[56:59], v[160:163], a[44:47], v[56:59]
  s_nop 0
  ds_read_b64_tr_b16 a[236:237], v221 offset:8
  ds_read_b64_tr_b16 a[238:239], v221 offset:520
  v_mfma_f32_16x16x32_bf16 v[60:63], v[148:151], a[96:99], v[60:63]
  s_nop 0
  ds_read_b64_tr_b16 a[240:241], v221 offset:8712
  ds_read_b64_tr_b16 a[242:243], v221 offset:9224
  v_mfma_f32_16x16x32_bf16 v[60:63], v[152:155], a[100:103], v[60:63]
  s_add_u32 m0, m0, 32
  ds_read_b64_tr_b16 a[244:245], v221 offset:17416
  ds_read_b64_tr_b16 a[246:247], v221 offset:17928
  v_mfma_f32_16x16x32_bf16 v[60:63], v[156:159], a[104:107], v[60:63]
  s_nop 0
  ds_read_b64_tr_b16 a[248:249], v221 offset:26120
  ds_read_b64_tr_b16 a[250:251], v221 offset:26632
  v_mfma_f32_16x16x32_bf16 v[60:63], v[160:163], a[108:111], v[60:63]
  s_waitcnt lgkmcnt(14)
  buffer_load_dwordx4 v225, s[16:19], s42 offen offset:2048 nt lds
  v_mfma_f32_16x16x32_bf16 v[0:3], v[164:167], a[48:51], v[0:3]
  ds_read_b64 a[252:253], v224 offset:832
  v_mfma_f32_16x16x32_bf16 v[0:3], v[168:171], a[52:55], v[0:3]
  s_nop 0
  ds_read_b64 a[254:255], v224 offset:864
  ds_read_b64_tr_b16 v[148:149], v223 offset:8704
  v_mfma_f32_16x16x32_bf16 v[0:3], v[172:175], a[56:59], v[0:3]
  s_add_u32 m0, m0, 32
  ds_read_b64_tr_b16 v[150:151], v223 offset:9216
  v_mfma_f32_16x16x32_bf16 v[0:3], v[176:179], a[60:63], v[0:3]
  s_nop 0
  ds_read_b64_tr_b16 v[152:153], v223 offset:8712
  ds_read_b64_tr_b16 v[154:155], v223 offset:9224
  v_mfma_f32_16x16x32_bf16 v[4:7], v[164:167], a[112:115], v[4:7]
  s_nop 0
  buffer_load_dwordx4 v225, s[16:19], s42 offen offset:3072 nt lds
  ds_read_b64_tr_b16 v[156:157], v221 offset:64
  v_mfma_f32_16x16x32_bf16 v[4:7], v[168:171], a[116:119], v[4:7]
  s_nop 0
  ds_read_b64_tr_b16 v[158:159], v221 offset:576
  ds_read_b64_tr_b16 v[160:161], v221 offset:8768
  v_mfma_f32_16x16x32_bf16 v[4:7], v[172:175], a[120:123], v[4:7]
  s_nop 0
  ds_read_b64_tr_b16 v[162:163], v221 offset:9280
  ds_read_b64_tr_b16 v[164:165], v221 offset:17472
  v_mfma_f32_16x16x32_bf16 v[4:7], v[176:179], a[124:127], v[4:7]
  s_waitcnt lgkmcnt(11)
  s_add_u32 s42, s42, s52
  ds_read_b64_tr_b16 v[166:167], v221 offset:17984
  v_mfma_f32_16x16x32_bf16 v[128:131], a[228:231], a[224:227], v[128:131]
  s_add_u32 m0, m0, s53
  ds_read_b64_tr_b16 v[168:169], v221 offset:26176
  v_mfma_f32_16x16x32_bf16 v[132:135], a[232:235], a[224:227], v[132:135]
  s_nop 0
  ds_read_b64_tr_b16 v[170:171], v221 offset:26688
  buffer_load_dwordx4 v225, s[16:19], s42 offen nt lds
  v_mfma_f32_16x16x32_bf16 v[8:11], a[236:239], a[48:51], v[8:11]
  ds_read_b64 v[172:173], v224 offset:896
  v_mfma_f32_16x16x32_bf16 v[8:11], a[240:243], a[52:55], v[8:11]
  v_mul_f32 v0, s54, v0
  v_mul_f32 v1, s54, v1
  v_mfma_f32_16x16x32_bf16 v[8:11], a[244:247], a[56:59], v[8:11]
  v_mul_f32 v2, s54, v2
  v_mul_f32 v3, s54, v3
  v_mfma_f32_16x16x32_bf16 v[8:11], a[248:251], a[60:63], v[8:11]
  s_add_u32 m0, m0, 32
  v_cvt_pk_bf16_f32 v64, v0, v1
  v_cvt_pk_bf16_f32 v65, v2, v3
  v_mfma_f32_16x16x32_bf16 v[12:15], a[236:239], a[112:115], v[12:15]
  v_mul_f32 v4, s54, v4
  v_mul_f32 v5, s54, v5
  v_mfma_f32_16x16x32_bf16 v[12:15], a[240:243], a[116:119], v[12:15]
  v_mul_f32 v6, s54, v6
  v_mul_f32 v7, s54, v7
  v_mfma_f32_16x16x32_bf16 v[12:15], a[244:247], a[120:123], v[12:15]
  v_cvt_pk_bf16_f32 v80, v4, v5
  v_cvt_pk_bf16_f32 v81, v6, v7
  v_mfma_f32_16x16x32_bf16 v[12:15], a[248:251], a[124:127], v[12:15]
  s_waitcnt lgkmcnt(1)
  ds_read_b64 v[174:175], v224 offset:928
  ds_read_b64_tr_b16 v[176:177], v223 offset:17408
  v_mfma_f32_16x16x32_bf16 v[128:131], v[148:151], a[252:255], v[128:131]
  s_nop 0
  ds_read_b64_tr_b16 v[178:179], v223 offset:17920
  ds_read_b64_tr_b16 a[224:225], v223 offset:17416
  v_mfma_f32_16x16x32_bf16 v[132:135], v[152:155], a[252:255], v[132:135]
  s_nop 0
  ds_read_b64_tr_b16 a[226:227], v223 offset:17928
  buffer_load_dwordx4 v225, s[16:19], s42 offen offset:1024 nt lds
  v_mfma_f32_16x16x32_bf16 v[16:19], v[156:159], a[48:51], v[16:19]
  s_nop 0
  ds_read_b64_tr_b16 a[228:229], v221 offset:72
  ds_read_b64_tr_b16 a[230:231], v221 offset:584
  v_mfma_f32_16x16x32_bf16 v[16:19], v[160:163], a[52:55], v[16:19]
  s_nop 0
  ds_read_b64_tr_b16 a[232:233], v221 offset:8776
  ds_read_b64_tr_b16 a[234:235], v221 offset:9288
  v_mfma_f32_16x16x32_bf16 v[16:19], v[164:167], a[56:59], v[16:19]
  s_nop 0
  ds_read_b64_tr_b16 a[236:237], v221 offset:17480
  ds_read_b64_tr_b16 a[238:239], v221 offset:17992
  v_mfma_f32_16x16x32_bf16 v[16:19], v[168:171], a[60:63], v[16:19]
  s_add_u32 m0, m0, 32
  ds_read_b64_tr_b16 a[240:241], v221 offset:26184
  ds_read_b64_tr_b16 a[242:243], v221 offset:26696
  v_mfma_f32_16x16x32_bf16 v[20:23], v[156:159], a[112:115], v[20:23]
  buffer_load_dwordx4 v225, s[16:19], s42 offen offset:2048 nt lds
  v_mul_f32 v8, s54, v8
  v_mfma_f32_16x16x32_bf16 v[20:23], v[160:163], a[116:119], v[20:23]
  v_mul_f32 v9, s54, v9
  v_mul_f32 v10, s54, v10
  v_mfma_f32_16x16x32_bf16 v[20:23], v[164:167], a[120:123], v[20:23]
  v_mul_f32 v11, s54, v11
  v_cvt_pk_bf16_f32 v66, v8, v9
  v_mfma_f32_16x16x32_bf16 v[20:23], v[168:171], a[124:127], v[20:23]
  s_waitcnt lgkmcnt(6)
  v_cvt_pk_bf16_f32 v67, v10, v11
  v_mul_f32 v12, s54, v12
  v_mfma_f32_16x16x32_bf16 v[128:131], v[176:179], v[172:175], v[128:131]
  v_mul_f32 v13, s54, v13
  v_mul_f32 v14, s54, v14
  v_mfma_f32_16x16x32_bf16 v[132:135], a[224:227], v[172:175], v[132:135]
  v_mul_f32 v15, s54, v15
  v_cvt_pk_bf16_f32 v82, v12, v13
  v_mfma_f32_16x16x32_bf16 v[24:27], a[228:231], a[48:51], v[24:27]
  s_waitcnt lgkmcnt(0)
  ds_read_b64 a[244:245], v224 offset:960
  ds_read_b64 a[246:247], v224 offset:992
  ds_read_b64_tr_b16 a[248:249], v223 offset:26112
  ds_read_b64_tr_b16 a[250:251], v223 offset:26624
  v_mfma_f32_16x16x32_bf16 v[24:27], a[232:235], a[52:55], v[24:27]
  s_add_u32 m0, m0, 32
  ds_read_b64_tr_b16 a[252:253], v223 offset:26120
  ds_read_b64_tr_b16 a[254:255], v223 offset:26632
  v_mfma_f32_16x16x32_bf16 v[24:27], a[236:239], a[56:59], v[24:27]
  s_nop 0
  buffer_load_dwordx4 v225, s[16:19], s42 offen offset:3072 nt lds
  ds_read_b64_tr_b16 v[148:149], v221 offset:128
  ds_read_b64_tr_b16 v[150:151], v221 offset:640
  v_mfma_f32_16x16x32_bf16 v[24:27], a[240:243], a[60:63], v[24:27]
  s_nop 0
  ds_read_b64_tr_b16 v[152:153], v221 offset:8832
  ds_read_b64_tr_b16 v[154:155], v221 offset:9344
  v_mfma_f32_16x16x32_bf16 v[28:31], a[228:231], a[112:115], v[28:31]
  s_nop 0
  ds_read_b64_tr_b16 v[156:157], v221 offset:17536
  ds_read_b64_tr_b16 v[158:159], v221 offset:18048
  v_mfma_f32_16x16x32_bf16 v[28:31], a[232:235], a[116:119], v[28:31]
  s_nop 0
  ds_read_b64_tr_b16 v[160:161], v221 offset:26240
  ds_read_b64_tr_b16 v[162:163], v221 offset:26752
  v_mfma_f32_16x16x32_bf16 v[28:31], a[236:239], a[120:123], v[28:31]
  v_cvt_pk_bf16_f32 v83, v14, v15
  v_mul_f32 v16, s54, v16
  v_mfma_f32_16x16x32_bf16 v[28:31], a[240:243], a[124:127], v[28:31]
  s_waitcnt lgkmcnt(10)
  v_mul_f32 v17, s54, v17
  v_mul_f32 v18, s54, v18
  v_mfma_f32_16x16x32_bf16 v[128:131], a[248:251], a[244:247], v[128:131]
  s_waitcnt lgkmcnt(8)
  v_mul_f32 v19, s54, v19
  v_cvt_pk_bf16_f32 v68, v16, v17
  v_mfma_f32_16x16x32_bf16 v[132:135], a[252:255], a[244:247], v[132:135]
  s_waitcnt lgkmcnt(6)
  ds_read_b64_tr_b16 v[164:165], v221 offset:136
  ds_read_b64_tr_b16 v[166:167], v221 offset:648
  ds_read_b64_tr_b16 v[168:169], v221 offset:8840
  ds_read_b64_tr_b16 v[170:171], v221 offset:9352
  v_mfma_f32_16x16x32_bf16 v[32:35], v[148:151], a[48:51], v[32:35]
  s_waitcnt lgkmcnt(8)
  ds_read_b64_tr_b16 v[172:173], v221 offset:17544
  ds_read_b64_tr_b16 v[174:175], v221 offset:18056
  ds_read_b64_tr_b16 v[176:177], v221 offset:26248
  ds_read_b64_tr_b16 v[178:179], v221 offset:26760
  v_mfma_f32_16x16x32_bf16 v[32:35], v[152:155], a[52:55], v[32:35]
  s_waitcnt lgkmcnt(10)
  v_cvt_pk_bf16_f32 v69, v18, v19
  v_mul_f32 v20, s54, v20
  v_mfma_f32_16x16x32_bf16 v[32:35], v[156:159], a[56:59], v[32:35]
  s_waitcnt lgkmcnt(8)
  v_mul_f32 v21, s54, v21
  v_mul_f32 v22, s54, v22
  v_mfma_f32_16x16x32_bf16 v[32:35], v[160:163], a[60:63], v[32:35]
  v_mul_f32 v23, s54, v23
  v_cvt_pk_bf16_f32 v84, v20, v21
  v_mfma_f32_16x16x32_bf16 v[36:39], v[148:151], a[112:115], v[36:39]
  s_nop 0
  ds_read_b64_tr_b16 a[224:225], v221 offset:192
  ds_read_b64_tr_b16 a[226:227], v221 offset:704
  v_mfma_f32_16x16x32_bf16 v[36:39], v[152:155], a[116:119], v[36:39]
  s_nop 0
  ds_read_b64_tr_b16 a[228:229], v221 offset:8896
  ds_read_b64_tr_b16 a[230:231], v221 offset:9408
  ds_read_b64_tr_b16 a[232:233], v221 offset:17600
  ds_read_b64_tr_b16 a[234:235], v221 offset:18112
  ds_read_b64_tr_b16 a[236:237], v221 offset:26304
  ds_read_b64_tr_b16 a[238:239], v221 offset:26816
  v_mfma_f32_16x16x32_bf16 v[36:39], v[156:159], a[120:123], v[36:39]
  v_cvt_pk_bf16_f32 v85, v22, v23
  v_mul_f32 v128, s54, v128
  v_mfma_f32_16x16x32_bf16 v[36:39], v[160:163], a[124:127], v[36:39]
  s_waitcnt lgkmcnt(8)
  v_mul_f32 v129, s54, v129
  v_mul_f32 v130, s54, v130
  v_mfma_f32_16x16x32_bf16 v[40:43], v[164:167], a[48:51], v[40:43]
  v_mul_f32 v131, s54, v131
  v_mul_f32 v132, s54, v132
  v_mfma_f32_16x16x32_bf16 v[40:43], v[168:171], a[52:55], v[40:43]
  v_mul_f32 v133, s54, v133
  v_mul_f32 v134, s54, v134
  v_mfma_f32_16x16x32_bf16 v[40:43], v[172:175], a[56:59], v[40:43]
  s_nop 0
  ds_read_b64_tr_b16 a[240:241], v221 offset:200
  ds_read_b64_tr_b16 a[242:243], v221 offset:712
  ds_read_b64_tr_b16 a[244:245], v221 offset:8904
  ds_read_b64_tr_b16 a[246:247], v221 offset:9416
  ds_read_b64_tr_b16 a[248:249], v221 offset:17608
  ds_read_b64_tr_b16 a[250:251], v221 offset:18120
  v_mfma_f32_16x16x32_bf16 v[40:43], v[176:179], a[60:63], v[40:43]
  s_nop 0
  ds_read_b64_tr_b16 a[252:253], v221 offset:26312
  ds_read_b64_tr_b16 a[254:255], v221 offset:26824
  v_mul_f32 v135, s54, v135
  v_mfma_f32_16x16x32_bf16 v[44:47], v[164:167], a[112:115], v[44:47]
  v_cvt_pk_bf16_f32 v128, v128, v129
  v_cvt_pk_bf16_f32 v129, v130, v131
  v_mfma_f32_16x16x32_bf16 v[44:47], v[168:171], a[116:119], v[44:47]
  v_cvt_pk_bf16_f32 v130, v132, v133
  v_cvt_pk_bf16_f32 v131, v134, v135
  v_mfma_f32_16x16x32_bf16 v[44:47], v[172:175], a[120:123], v[44:47]
  ds_write_b128 v230, v[128:131]
  v_mfma_f32_16x16x32_bf16 v[44:47], v[176:179], a[124:127], v[44:47]
  s_waitcnt lgkmcnt(9)
  v_mul_f32 v24, s54, v24
  v_mul_f32 v25, s54, v25
  v_mfma_f32_16x16x32_bf16 v[48:51], a[224:227], a[48:51], v[48:51]
  v_mul_f32 v26, s54, v26
  v_mul_f32 v27, s54, v27
  v_mfma_f32_16x16x32_bf16 v[48:51], a[228:231], a[52:55], v[48:51]
  v_cvt_pk_bf16_f32 v70, v24, v25
  v_cvt_pk_bf16_f32 v71, v26, v27
  v_mfma_f32_16x16x32_bf16 v[48:51], a[232:235], a[56:59], v[48:51]
  v_mul_f32 v28, s54, v28
  v_mul_f32 v29, s54, v29
  v_mfma_f32_16x16x32_bf16 v[48:51], a[236:239], a[60:63], v[48:51]
  v_mul_f32 v30, s54, v30
  v_mul_f32 v31, s54, v31
  v_mfma_f32_16x16x32_bf16 v[52:55], a[224:227], a[112:115], v[52:55]
  v_cvt_pk_bf16_f32 v86, v28, v29
  v_cvt_pk_bf16_f32 v87, v30, v31
  v_mfma_f32_16x16x32_bf16 v[52:55], a[228:231], a[116:119], v[52:55]
  buffer_store_dword v136, v247, s[28:31], s62 offen sc1
  v_mul_f32 v32, s54, v32
  v_mfma_f32_16x16x32_bf16 v[52:55], a[232:235], a[120:123], v[52:55]
  v_mul_f32 v33, s54, v33
  v_mul_f32 v34, s54, v34
  v_mfma_f32_16x16x32_bf16 v[52:55], a[236:239], a[124:127], v[52:55]
  s_waitcnt lgkmcnt(1)
  v_mul_f32 v35, s54, v35
  v_cvt_pk_bf16_f32 v72, v32, v33
  v_mfma_f32_16x16x32_bf16 v[56:59], a[240:243], a[48:51], v[56:59]
  s_waitcnt lgkmcnt(0)
  s_barrier
  v_cvt_pk_bf16_f32 v73, v34, v35
  v_mfma_f32_16x16x32_bf16 v[56:59], a[244:247], a[52:55], v[56:59]
  v_mul_f32 v36, s54, v36
  v_mul_f32 v37, s54, v37
  v_mfma_f32_16x16x32_bf16 v[56:59], a[248:251], a[56:59], v[56:59]
  v_mul_f32 v38, s54, v38
  v_mul_f32 v39, s54, v39
  v_mfma_f32_16x16x32_bf16 v[56:59], a[252:255], a[60:63], v[56:59]
  v_cvt_pk_bf16_f32 v88, v36, v37
  v_cvt_pk_bf16_f32 v89, v38, v39
  v_mfma_f32_16x16x32_bf16 v[60:63], a[240:243], a[112:115], v[60:63]
  s_nop 0
  ds_read_b128 v[148:151], v212 offset:0
  ds_read_b128 v[180:183], v248 offset:0
  v_mfma_f32_16x16x32_bf16 v[60:63], a[244:247], a[116:119], v[60:63]
  s_nop 0
  ds_read_b128 v[184:187], v248 offset:1024
  ds_read_b128 v[188:191], v248 offset:2048
  v_mfma_f32_16x16x32_bf16 v[60:63], a[248:251], a[120:123], v[60:63]
  s_nop 0
  ds_read_b128 v[192:195], v248 offset:3072
  ds_read_b128 v[152:155], v212 offset:64
  v_mfma_f32_16x16x32_bf16 v[60:63], a[252:255], a[124:127], v[60:63]
  s_nop 5
  s_nop 0
  ds_read_b128 v[156:159], v212 offset:128
  ds_read_b128 v[160:163], v212 offset:192
  v_mul_f32 v40, s54, v40
  v_mul_f32 v41, s54, v41
  v_mul_f32 v42, s54, v42
  v_mul_f32 v43, s54, v43
  v_cvt_pk_bf16_f32 v74, v40, v41
  v_cvt_pk_bf16_f32 v75, v42, v43
  v_mul_f32 v44, s54, v44
  v_mul_f32 v45, s54, v45
  v_mul_f32 v46, s54, v46
  v_mul_f32 v47, s54, v47
  v_cvt_pk_bf16_f32 v90, v44, v45
  v_cvt_pk_bf16_f32 v91, v46, v47
  v_mul_f32 v48, s54, v48
  v_mul_f32 v49, s54, v49
  v_mul_f32 v50, s54, v50
  v_mul_f32 v51, s54, v51
  v_cvt_pk_bf16_f32 v76, v48, v49
  v_cvt_pk_bf16_f32 v77, v50, v51
  v_mul_f32 v52, s54, v52
  v_mul_f32 v53, s54, v53
  v_mul_f32 v54, s54, v54
  v_mul_f32 v55, s54, v55
  v_cvt_pk_bf16_f32 v92, v52, v53
  v_cvt_pk_bf16_f32 v93, v54, v55
  v_mul_f32 v56, s54, v56
  v_mul_f32 v57, s54, v57
  v_mul_f32 v58, s54, v58
  v_mul_f32 v59, s54, v59
  v_cvt_pk_bf16_f32 v78, v56, v57
  v_cvt_pk_bf16_f32 v79, v58, v59
  v_mul_f32 v60, s54, v60
  v_mul_f32 v61, s54, v61
  v_mul_f32 v62, s54, v62
  v_mul_f32 v63, s54, v63
  v_cvt_pk_bf16_f32 v94, v60, v61
  v_cvt_pk_bf16_f32 v95, v62, v63
  s_add_u32 s45, s0, 131072
  s_add_u32 s46, s47, 256
  s_mov_b32 s42, 256
  buffer_load_dword v229, v228, s[12:15], s42 offen
  s_lshl_b32 s65, s58, 2
  s_add_u32 s65, s65, s36
  s_lshl_b32 s65, s65, 11
  s_add_u32 s65, s65, 0
  v_lshlrev_b32 v250, 1, v225
  buffer_load_dword v229, v250, s[24:27], s65 offen
  s_mov_b32 s8, s66
  s_and_b32 s9, s67, 0xffff
  s_mov_b32 s10, 4718592
L_attn:
  s_waitcnt lgkmcnt(7)
  v_mfma_f32_16x16x32_bf16 v[96:99], v[148:151], v[64:67], v[136:139]
  s_waitcnt lgkmcnt(2)
  s_add_u32 s42, s1, 0
  ds_read_b128 v[164:167], v212 offset:512
  v_mfma_f32_16x16x32_bf16 v[96:99], v[152:155], v[68:71], v[96:99]
  s_waitcnt lgkmcnt(2)
  s_mov_b32 m0, s40
  ds_read_b128 v[168:171], v212 offset:576
  v_mfma_f32_16x16x32_bf16 v[96:99], v[156:159], v[72:75], v[96:99]
  s_waitcnt lgkmcnt(2)
  ds_read_b128 v[172:175], v212 offset:640
  buffer_load_dwordx4 v225, s[20:23], s42 offen nt lds
  v_mfma_f32_16x16x32_bf16 v[96:99], v[160:163], v[76:79], v[96:99]
  ds_read_b128 v[176:179], v212 offset:704
  v_mfma_f32_16x16x32_bf16 v[104:107], v[148:151], v[80:83], v[140:143]
  v_mfma_f32_16x16x32_bf16 v[104:107], v[152:155], v[84:87], v[104:107]
  s_add_u32 m0, m0, 32
  v_mfma_f32_16x16x32_bf16 v[104:107], v[156:159], v[88:91], v[104:107]
  buffer_load_dwordx4 v225, s[20:23], s42 offen offset:1024 nt lds
  v_mfma_f32_16x16x32_bf16 v[104:107], v[160:163], v[92:95], v[104:107]
  s_waitcnt lgkmcnt(3)
  v_exp_f32 v96, v96
  v_mfma_f32_16x16x32_bf16 v[128:131], v[148:151], v[180:183], v[144:147]
  v_exp_f32 v97, v97
  v_mfma_f32_16x16x32_bf16 v[128:131], v[152:155], v[184:187], v[128:131]
  s_add_u32 m0, m0, 32
  v_exp_f32 v98, v98
  v_mfma_f32_16x16x32_bf16 v[128:131], v[156:159], v[188:191], v[128:131]
  v_exp_f32 v99, v99
  v_mfma_f32_16x16x32_bf16 v[128:131], v[160:163], v[192:195], v[128:131]
  v_cvt_pk_bf16_f32 v96, v96, v97
  v_cvt_pk_bf16_f32 v97, v98, v99
  v_mfma_f32_16x16x32_bf16 v[100:103], v[164:167], v[64:67], v[136:139]
  s_waitcnt lgkmcnt(0)
  v_exp_f32 v104, v104
  v_mfma_f32_16x16x32_bf16 v[100:103], v[168:171], v[68:71], v[100:103]
  v_exp_f32 v105, v105
  v_mfma_f32_16x16x32_bf16 v[100:103], v[172:175], v[72:75], v[100:103]
  v_exp_f32 v106, v106
  v_mfma_f32_16x16x32_bf16 v[100:103], v[176:179], v[76:79], v[100:103]
  v_exp_f32 v107, v107
  v_mfma_f32_16x16x32_bf16 v[108:111], v[164:167], v[80:83], v[140:143]
  ds_read_b128 v[148:151], v213 offset:0
  v_cvt_pk_bf16_f32 v104, v104, v105
  v_mfma_f32_16x16x32_bf16 v[108:111], v[168:171], v[84:87], v[108:111]
  s_nop 0
  buffer_load_dwordx4 v225, s[20:23], s42 offen offset:2048 nt lds
  ds_read_b128 v[152:155], v213 offset:64
  v_mfma_f32_16x16x32_bf16 v[108:111], v[172:175], v[88:91], v[108:111]
  ds_read_b128 v[156:159], v213 offset:128
  v_cvt_pk_bf16_f32 v105, v106, v107
  v_mfma_f32_16x16x32_bf16 v[108:111], v[176:179], v[92:95], v[108:111]
  ds_read_b128 v[160:163], v213 offset:192
  v_mfma_f32_16x16x32_bf16 v[132:135], v[164:167], v[180:183], v[144:147]
  s_add_u32 m0, m0, 32
  v_exp_f32 v128, v128
  v_mfma_f32_16x16x32_bf16 v[132:135], v[168:171], v[184:187], v[132:135]
  v_exp_f32 v129, v129
  v_mfma_f32_16x16x32_bf16 v[132:135], v[172:175], v[188:191], v[132:135]
  s_nop 0
  buffer_load_dwordx4 v225, s[20:23], s42 offen offset:3072 nt lds
  ds_read_b128 v[164:167], v213 offset:512
  v_mfma_f32_16x16x32_bf16 v[132:135], v[176:179], v[192:195], v[132:135]
  s_waitcnt lgkmcnt(4)
  v_exp_f32 v130, v130
  v_mfma_f32_16x16x32_bf16 v[112:115], v[148:151], v[64:67], v[136:139]
  s_waitcnt lgkmcnt(3)
  v_exp_f32 v131, v131
  v_mfma_f32_16x16x32_bf16 v[112:115], v[152:155], v[68:71], v[112:115]
  s_waitcnt lgkmcnt(2)
  ds_read_b128 v[168:171], v213 offset:576
  v_cvt_pk_bf16_f32 v128, v128, v129
  v_mfma_f32_16x16x32_bf16 v[112:115], v[156:159], v[72:75], v[112:115]
  s_waitcnt lgkmcnt(2)
  s_add_u32 s42, s42, s52
  s_add_u32 m0, m0, s53
  ds_read_b128 v[172:175], v213 offset:640
  v_mfma_f32_16x16x32_bf16 v[112:115], v[160:163], v[76:79], v[112:115]
  s_nop 0
  buffer_load_dwordx4 v225, s[20:23], s42 offen nt lds
  ds_read_b128 v[176:179], v213 offset:704
  v_mfma_f32_16x16x32_bf16 v[120:123], v[148:151], v[80:83], v[140:143]
  s_waitcnt vmcnt(16)
  s_barrier
  v_cvt_pk_bf16_f32 v129, v130, v131
  v_mfma_f32_16x16x32_bf16 v[120:123], v[152:155], v[84:87], v[120:123]
  v_exp_f32 v100, v100
  v_mfma_f32_16x16x32_bf16 v[120:123], v[156:159], v[88:91], v[120:123]
  s_add_u32 m0, m0, 32
  v_exp_f32 v101, v101
  v_mfma_f32_16x16x32_bf16 v[120:123], v[160:163], v[92:95], v[120:123]
  s_waitcnt lgkmcnt(3)
  v_exp_f32 v102, v102
  v_mfma_f32_16x16x32_bf16 v[116:119], v[164:167], v[64:67], v[136:139]
  s_waitcnt lgkmcnt(2)
  buffer_load_dwordx4 v225, s[20:23], s42 offen offset:1024 nt lds
  ds_read_b64_tr_b16 v[148:149], v216 offset:0
  v_mfma_f32_16x16x32_bf16 v[116:119], v[168:171], v[68:71], v[116:119]
  s_waitcnt lgkmcnt(2)
  v_exp_f32 v103, v103
  v_mfma_f32_16x16x32_bf16 v[116:119], v[172:175], v[72:75], v[116:119]
  s_waitcnt lgkmcnt(1)
  v_cvt_pk_bf16_f32 v98, v100, v101
  v_cvt_pk_bf16_f32 v99, v102, v103
  v_mfma_f32_16x16x32_bf16 v[116:119], v[176:179], v[76:79], v[116:119]
  s_add_u32 m0, m0, 32
  ds_read_b64_tr_b16 v[150:151], v216 offset:512
  ds_read_b64_tr_b16 v[152:153], v216 offset:32
  v_mfma_f32_16x16x32_bf16 v[124:127], v[164:167], v[80:83], v[140:143]
  v_exp_f32 v108, v108
  v_mfma_f32_16x16x32_bf16 v[124:127], v[168:171], v[84:87], v[124:127]
  s_nop 0
  buffer_load_dwordx4 v225, s[20:23], s42 offen offset:2048 nt lds
  ds_read_b64_tr_b16 v[154:155], v216 offset:544
  v_mfma_f32_16x16x32_bf16 v[124:127], v[172:175], v[88:91], v[124:127]
  v_exp_f32 v109, v109
  v_exp_f32 v110, v110
  v_exp_f32 v111, v111
  v_cvt_pk_bf16_f32 v106, v108, v109
  v_cvt_pk_bf16_f32 v107, v110, v111
  v_exp_f32 v132, v132
  v_exp_f32 v133, v133
  v_exp_f32 v134, v134
  v_exp_f32 v135, v135
  v_cvt_pk_bf16_f32 v130, v132, v133
  v_cvt_pk_bf16_f32 v131, v134, v135
  v_mfma_f32_16x16x32_bf16 v[124:127], v[176:179], v[92:95], v[124:127]
  s_nop 0
  ds_read_b64_tr_b16 v[156:157], v216 offset:64
  ds_read_b64_tr_b16 v[158:159], v216 offset:576
  v_mfma_f32_16x16x32_bf16 v[200:203], v[196:199], v[96:99], 0
  s_add_u32 m0, m0, 32
  ds_read_b64_tr_b16 v[160:161], v216 offset:96
  ds_read_b64_tr_b16 v[162:163], v216 offset:608
  v_mfma_f32_16x16x32_bf16 v[204:207], v[196:199], v[104:107], 0
  s_nop 0
  buffer_load_dwordx4 v225, s[20:23], s42 offen offset:3072 nt lds
  ds_read_b64_tr_b16 v[164:165], v216 offset:128
  v_mfma_f32_16x16x32_bf16 v[208:211], v[196:199], v[128:131], 0
  s_waitcnt lgkmcnt(7)
  ds_read_b64_tr_b16 v[166:167], v216 offset:640
  ds_read_b64_tr_b16 v[168:169], v216 offset:160
  v_mfma_f32_16x16x32_bf16 a[224:227], v[148:151], v[128:131], 0
  ds_read_b64_tr_b16 v[170:171], v216 offset:672
  v_mfma_f32_16x16x32_bf16 v[4:7], v[148:151], v[104:107], 0
  s_nop 0
  ds_read_b64_tr_b16 v[172:173], v216 offset:192
  ds_read_b64_tr_b16 v[174:175], v216 offset:704
  v_mfma_f32_16x16x32_bf16 v[0:3], v[148:151], v[96:99], 0
  s_waitcnt lgkmcnt(10)
  ds_read_b64_tr_b16 v[176:177], v216 offset:224
  v_mfma_f32_16x16x32_bf16 v[8:11], v[152:155], v[96:99], 0
  ds_read_b64_tr_b16 v[178:179], v216 offset:736
  v_mfma_f32_16x16x32_bf16 v[12:15], v[152:155], v[104:107], 0
  v_exp_f32 v112, v112
  v_mfma_f32_16x16x32_bf16 a[228:231], v[152:155], v[128:131], 0
  s_waitcnt lgkmcnt(8)
  ds_read_b128 v[148:151], v214 offset:0
  v_mfma_f32_16x16x32_bf16 a[232:235], v[156:159], v[128:131], 0
  v_exp_f32 v113, v113
  v_mfma_f32_16x16x32_bf16 v[20:23], v[156:159], v[104:107], 0
  ds_read_b128 v[152:155], v214 offset:64
  v_mfma_f32_16x16x32_bf16 v[16:19], v[156:159], v[96:99], 0
  v_exp_f32 v114, v114
  v_mfma_f32_16x16x32_bf16 v[24:27], v[160:163], v[96:99], 0
  ds_read_b128 v[156:159], v214 offset:128
  v_mfma_f32_16x16x32_bf16 v[28:31], v[160:163], v[104:107], 0
  v_exp_f32 v115, v115
  v_mfma_f32_16x16x32_bf16 a[236:239], v[160:163], v[128:131], 0
  s_waitcnt lgkmcnt(7)
  ds_read_b128 v[160:163], v214 offset:192
  v_cvt_pk_bf16_f32 v112, v112, v113
  v_mfma_f32_16x16x32_bf16 a[240:243], v[164:167], v[128:131], 0
  v_cvt_pk_bf16_f32 v113, v114, v115
  v_mfma_f32_16x16x32_bf16 v[36:39], v[164:167], v[104:107], 0
  v_exp_f32 v120, v120
  v_mfma_f32_16x16x32_bf16 v[32:35], v[164:167], v[96:99], 0
  v_exp_f32 v121, v121
  v_mfma_f32_16x16x32_bf16 v[40:43], v[168:171], v[96:99], 0
  v_exp_f32 v122, v122
  v_mfma_f32_16x16x32_bf16 v[44:47], v[168:171], v[104:107], 0
  ds_read_b128 v[164:167], v214 offset:512
  v_mfma_f32_16x16x32_bf16 a[244:247], v[168:171], v[128:131], 0
  s_waitcnt lgkmcnt(5)
  v_exp_f32 v123, v123
  v_mfma_f32_16x16x32_bf16 a[248:251], v[172:175], v[128:131], 0
  ds_read_b128 v[168:171], v214 offset:576
  v_cvt_pk_bf16_f32 v120, v120, v121
  v_mfma_f32_16x16x32_bf16 v[52:55], v[172:175], v[104:107], 0
  v_cvt_pk_bf16_f32 v121, v122, v123
  v_mfma_f32_16x16x32_bf16 v[48:51], v[172:175], v[96:99], 0
  ds_read_b128 v[172:175], v214 offset:640
  v_mfma_f32_16x16x32_bf16 v[56:59], v[176:179], v[96:99], 0
  v_exp_f32 v116, v116
  v_mfma_f32_16x16x32_bf16 v[60:63], v[176:179], v[104:107], 0
  v_exp_f32 v117, v117
  v_mfma_f32_16x16x32_bf16 a[252:255], v[176:179], v[128:131], 0
  s_waitcnt lgkmcnt(3)
  ds_read_b128 v[176:179], v214 offset:704
  v_mfma_f32_16x16x32_bf16 v[96:99], v[148:151], v[64:67], v[136:139]
  v_exp_f32 v118, v118
  v_mfma_f32_16x16x32_bf16 v[96:99], v[152:155], v[68:71], v[96:99]
  v_exp_f32 v119, v119
  v_mfma_f32_16x16x32_bf16 v[96:99], v[156:159], v[72:75], v[96:99]
  v_cvt_pk_bf16_f32 v114, v116, v117
  v_cvt_pk_bf16_f32 v115, v118, v119
  v_mfma_f32_16x16x32_bf16 v[96:99], v[160:163], v[76:79], v[96:99]
  v_exp_f32 v124, v124
  v_mfma_f32_16x16x32_bf16 v[104:107], v[148:151], v[80:83], v[140:143]
  s_nop 0
  ds_read_b64_tr_b16 v[148:149], v217 offset:0
  ds_read_b64_tr_b16 v[150:151], v217 offset:512
  v_mfma_f32_16x16x32_bf16 v[104:107], v[152:155], v[84:87], v[104:107]
  v_exp_f32 v125, v125
  v_mfma_f32_16x16x32_bf16 v[104:107], v[156:159], v[88:91], v[104:107]
  v_exp_f32 v126, v126
  v_mfma_f32_16x16x32_bf16 v[104:107], v[160:163], v[92:95], v[104:107]
  s_waitcnt lgkmcnt(2)
  ds_read_b64_tr_b16 v[152:153], v217 offset:32
  ds_read_b64_tr_b16 v[154:155], v217 offset:544
  v_mfma_f32_16x16x32_bf16 v[100:103], v[164:167], v[64:67], v[136:139]
  v_exp_f32 v127, v127
  v_mfma_f32_16x16x32_bf16 v[100:103], v[168:171], v[68:71], v[100:103]
  ds_read_b64_tr_b16 v[156:157], v217 offset:64
  v_cvt_pk_bf16_f32 v122, v124, v125
  v_mfma_f32_16x16x32_bf16 v[100:103], v[172:175], v[72:75], v[100:103]
  ds_read_b64_tr_b16 v[158:159], v217 offset:576
  v_cvt_pk_bf16_f32 v123, v126, v127
  v_mfma_f32_16x16x32_bf16 v[100:103], v[176:179], v[76:79], v[100:103]
  s_nop 0
  ds_read_b64_tr_b16 v[160:161], v217 offset:96
  ds_read_b64_tr_b16 v[162:163], v217 offset:608
  v_mfma_f32_16x16x32_bf16 v[108:111], v[164:167], v[80:83], v[140:143]
  s_nop 0
  ds_read_b64_tr_b16 v[164:165], v217 offset:128
  ds_read_b64_tr_b16 v[166:167], v217 offset:640
  v_mfma_f32_16x16x32_bf16 v[108:111], v[168:171], v[84:87], v[108:111]
  s_nop 0
  ds_read_b64_tr_b16 v[168:169], v217 offset:160
  ds_read_b64_tr_b16 v[170:171], v217 offset:672
  v_mfma_f32_16x16x32_bf16 v[108:111], v[172:175], v[88:91], v[108:111]
  s_nop 0
  ds_read_b64_tr_b16 v[172:173], v217 offset:192
  ds_read_b64_tr_b16 v[174:175], v217 offset:704
  v_mfma_f32_16x16x32_bf16 v[108:111], v[176:179], v[92:95], v[108:111]
  s_nop 0
  ds_read_b64_tr_b16 v[176:177], v217 offset:224
  ds_read_b64_tr_b16 v[178:179], v217 offset:736
  v_mfma_f32_16x16x32_bf16 v[200:203], v[196:199], v[112:115], v[200:203]
  v_exp_f32 v96, v96
  v_mfma_f32_16x16x32_bf16 v[204:207], v[196:199], v[120:123], v[204:207]
  s_waitcnt lgkmcnt(10)
  v_exp_f32 v97, v97
  v_mfma_f32_16x16x32_bf16 v[4:7], v[148:151], v[120:123], v[4:7]
  v_exp_f32 v98, v98
  v_mfma_f32_16x16x32_bf16 v[0:3], v[148:151], v[112:115], v[0:3]
  ds_read_b128 v[148:151], v215 offset:0
  v_mfma_f32_16x16x32_bf16 v[8:11], v[152:155], v[112:115], v[8:11]
  v_exp_f32 v99, v99
  v_mfma_f32_16x16x32_bf16 v[12:15], v[152:155], v[120:123], v[12:15]
  ds_read_b128 v[152:155], v215 offset:64
  v_cvt_pk_bf16_f32 v96, v96, v97
  v_mfma_f32_16x16x32_bf16 v[20:23], v[156:159], v[120:123], v[20:23]
  v_cvt_pk_bf16_f32 v97, v98, v99
  v_mfma_f32_16x16x32_bf16 v[16:19], v[156:159], v[112:115], v[16:19]
  s_waitcnt lgkmcnt(6)
  ds_read_b128 v[156:159], v215 offset:128
  v_mfma_f32_16x16x32_bf16 v[24:27], v[160:163], v[112:115], v[24:27]
  v_exp_f32 v104, v104
  v_mfma_f32_16x16x32_bf16 v[28:31], v[160:163], v[120:123], v[28:31]
  ds_read_b128 v[160:163], v215 offset:192
  v_mfma_f32_16x16x32_bf16 v[36:39], v[164:167], v[120:123], v[36:39]
  v_exp_f32 v105, v105
  v_mfma_f32_16x16x32_bf16 v[32:35], v[164:167], v[112:115], v[32:35]
  v_exp_f32 v106, v106
  v_mfma_f32_16x16x32_bf16 v[40:43], v[168:171], v[112:115], v[40:43]
  ds_read_b128 v[164:167], v215 offset:512
  v_mfma_f32_16x16x32_bf16 v[44:47], v[168:171], v[120:123], v[44:47]
  s_waitcnt lgkmcnt(3)
  v_exp_f32 v107, v107
  v_mfma_f32_16x16x32_bf16 v[52:55], v[172:175], v[120:123], v[52:55]
  ds_read_b128 v[168:171], v215 offset:576
  v_cvt_pk_bf16_f32 v104, v104, v105
  v_mfma_f32_16x16x32_bf16 v[48:51], v[172:175], v[112:115], v[48:51]
  ds_read_b128 v[172:175], v215 offset:640
  v_cvt_pk_bf16_f32 v105, v106, v107
  v_mfma_f32_16x16x32_bf16 v[56:59], v[176:179], v[112:115], v[56:59]
  v_exp_f32 v100, v100
  v_mfma_f32_16x16x32_bf16 v[60:63], v[176:179], v[120:123], v[60:63]
  ds_read_b128 v[176:179], v215 offset:704
  v_mfma_f32_16x16x32_bf16 v[112:115], v[148:151], v[64:67], v[136:139]
  v_exp_f32 v101, v101
  v_mfma_f32_16x16x32_bf16 v[112:115], v[152:155], v[68:71], v[112:115]
  s_waitcnt lgkmcnt(4)
  v_exp_f32 v102, v102
  v_mfma_f32_16x16x32_bf16 v[112:115], v[156:159], v[72:75], v[112:115]
  v_exp_f32 v103, v103
  v_mfma_f32_16x16x32_bf16 v[112:115], v[160:163], v[76:79], v[112:115]
  v_cvt_pk_bf16_f32 v98, v100, v101
  v_cvt_pk_bf16_f32 v99, v102, v103
  v_mfma_f32_16x16x32_bf16 v[120:123], v[148:151], v[80:83], v[140:143]
  v_exp_f32 v108, v108
  v_mfma_f32_16x16x32_bf16 v[120:123], v[152:155], v[84:87], v[120:123]
  s_nop 0
  ds_read_b64_tr_b16 v[148:149], v218 offset:0
  ds_read_b64_tr_b16 v[150:151], v218 offset:512
  v_mfma_f32_16x16x32_bf16 v[120:123], v[156:159], v[88:91], v[120:123]
  v_exp_f32 v109, v109
  v_mfma_f32_16x16x32_bf16 v[120:123], v[160:163], v[92:95], v[120:123]
  s_waitcnt lgkmcnt(2)
  v_exp_f32 v110, v110
  v_mfma_f32_16x16x32_bf16 v[116:119], v[164:167], v[64:67], v[136:139]
  s_nop 0
  ds_read_b64_tr_b16 v[152:153], v218 offset:32
  ds_read_b64_tr_b16 v[154:155], v218 offset:544
  v_mfma_f32_16x16x32_bf16 v[116:119], v[168:171], v[68:71], v[116:119]
  v_exp_f32 v111, v111
  v_mfma_f32_16x16x32_bf16 v[116:119], v[172:175], v[72:75], v[116:119]
  ds_read_b64_tr_b16 v[156:157], v218 offset:64
  v_cvt_pk_bf16_f32 v106, v108, v109
  v_mfma_f32_16x16x32_bf16 v[116:119], v[176:179], v[76:79], v[116:119]
  ds_read_b64_tr_b16 v[158:159], v218 offset:576
  v_cvt_pk_bf16_f32 v107, v110, v111
  v_mfma_f32_16x16x32_bf16 v[124:127], v[164:167], v[80:83], v[140:143]
  s_nop 0
  ds_read_b64_tr_b16 v[160:161], v218 offset:96
  ds_read_b64_tr_b16 v[162:163], v218 offset:608
  v_mfma_f32_16x16x32_bf16 v[124:127], v[168:171], v[84:87], v[124:127]
  s_nop 0
  ds_read_b64_tr_b16 v[164:165], v218 offset:128
  ds_read_b64_tr_b16 v[166:167], v218 offset:640
  v_mfma_f32_16x16x32_bf16 v[124:127], v[172:175], v[88:91], v[124:127]
  s_nop 0
  ds_read_b64_tr_b16 v[168:169], v218 offset:160
  ds_read_b64_tr_b16 v[170:171], v218 offset:672
  v_mfma_f32_16x16x32_bf16 v[124:127], v[176:179], v[92:95], v[124:127]
  s_nop 0
  ds_read_b64_tr_b16 v[172:173], v218 offset:192
  ds_read_b64_tr_b16 v[174:175], v218 offset:704
  v_mfma_f32_16x16x32_bf16 v[200:203], v[196:199], v[96:99], v[200:203]
  s_nop 0
  ds_read_b64_tr_b16 v[176:177], v218 offset:224
  ds_read_b64_tr_b16 v[178:179], v218 offset:736
  v_mfma_f32_16x16x32_bf16 v[204:207], v[196:199], v[104:107], v[204:207]
  s_waitcnt lgkmcnt(12)
  s_waitcnt vmcnt(10)
  s_barrier
  v_mfma_f32_16x16x32_bf16 v[4:7], v[148:151], v[104:107], v[4:7]
  s_add_u32 s42, s2, 0
  s_mov_b32 m0, s37
  v_mfma_f32_16x16x32_bf16 v[0:3], v[148:151], v[96:99], v[0:3]
  ds_read_b128 v[148:151], v212 offset:34816
  v_mfma_f32_16x16x32_bf16 v[8:11], v[152:155], v[96:99], v[8:11]
  buffer_load_dwordx4 v225, s[16:19], s42 offen nt lds
  v_mfma_f32_16x16x32_bf16 v[12:15], v[152:155], v[104:107], v[12:15]
  s_waitcnt lgkmcnt(7)
  ds_read_b128 v[152:155], v212 offset:34880
  v_mfma_f32_16x16x32_bf16 v[20:23], v[156:159], v[104:107], v[20:23]
  v_exp_f32 v112, v112
  v_mfma_f32_16x16x32_bf16 v[16:19], v[156:159], v[96:99], v[16:19]
  s_add_u32 m0, m0, 32
  ds_read_b128 v[156:159], v212 offset:34944
  v_mfma_f32_16x16x32_bf16 v[24:27], v[160:163], v[96:99], v[24:27]
  v_exp_f32 v113, v113
  v_mfma_f32_16x16x32_bf16 v[28:31], v[160:163], v[104:107], v[28:31]
  ds_read_b128 v[160:163], v212 offset:35008
  v_mfma_f32_16x16x32_bf16 v[36:39], v[164:167], v[104:107], v[36:39]
  v_exp_f32 v114, v114
  v_mfma_f32_16x16x32_bf16 v[32:35], v[164:167], v[96:99], v[32:35]
  s_waitcnt lgkmcnt(4)
  buffer_load_dwordx4 v225, s[16:19], s42 offen offset:1024 nt lds
  v_mfma_f32_16x16x32_bf16 v[40:43], v[168:171], v[96:99], v[40:43]
  v_exp_f32 v115, v115
  v_mfma_f32_16x16x32_bf16 v[44:47], v[168:171], v[104:107], v[44:47]
  ds_read_b128 v[164:167], v212 offset:35328
  v_cvt_pk_bf16_f32 v112, v112, v113
  v_mfma_f32_16x16x32_bf16 v[52:55], v[172:175], v[104:107], v[52:55]
  s_add_u32 m0, m0, 32
  ds_read_b128 v[168:171], v212 offset:35392
  v_cvt_pk_bf16_f32 v113, v114, v115
  v_mfma_f32_16x16x32_bf16 v[48:51], v[172:175], v[96:99], v[48:51]
  v_exp_f32 v120, v120
  v_mfma_f32_16x16x32_bf16 v[56:59], v[176:179], v[96:99], v[56:59]
  s_nop 0
  ds_read_b128 v[172:175], v212 offset:35456
  buffer_load_dwordx4 v225, s[16:19], s42 offen offset:2048 nt lds
  v_mfma_f32_16x16x32_bf16 v[60:63], v[176:179], v[104:107], v[60:63]
  s_waitcnt lgkmcnt(3)
  v_exp_f32 v121, v121
  v_mfma_f32_16x16x32_bf16 v[96:99], v[148:151], v[64:67], v[136:139]
  ds_read_b128 v[176:179], v212 offset:35520
  v_mfma_f32_16x16x32_bf16 v[96:99], v[152:155], v[68:71], v[96:99]
  v_exp_f32 v122, v122
  v_mfma_f32_16x16x32_bf16 v[96:99], v[156:159], v[72:75], v[96:99]
  v_exp_f32 v123, v123
  v_mfma_f32_16x16x32_bf16 v[96:99], v[160:163], v[76:79], v[96:99]
  s_add_u32 m0, m0, 32
  v_cvt_pk_bf16_f32 v120, v120, v121
  v_cvt_pk_bf16_f32 v121, v122, v123
  v_mfma_f32_16x16x32_bf16 v[104:107], v[148:151], v[80:83], v[140:143]
  v_exp_f32 v116, v116
  v_mfma_f32_16x16x32_bf16 v[104:107], v[152:155], v[84:87], v[104:107]
  buffer_load_dwordx4 v225, s[16:19], s42 offen offset:3072 nt lds
  v_mfma_f32_16x16x32_bf16 v[104:107], v[156:159], v[88:91], v[104:107]
  v_exp_f32 v117, v117
  v_mfma_f32_16x16x32_bf16 v[104:107], v[160:163], v[92:95], v[104:107]
  v_exp_f32 v118, v118
  v_mfma_f32_16x16x32_bf16 v[128:131], v[148:151], v[180:183], v[144:147]
  s_add_u32 s42, s42, s52
  v_exp_f32 v119, v119
  v_mfma_f32_16x16x32_bf16 v[128:131], v[152:155], v[184:187], v[128:131]
  s_add_u32 m0, m0, s53
  v_cvt_pk_bf16_f32 v114, v116, v117
  v_cvt_pk_bf16_f32 v115, v118, v119
  v_mfma_f32_16x16x32_bf16 v[128:131], v[156:159], v[188:191], v[128:131]
  s_nop 0
  buffer_load_dwordx4 v225, s[16:19], s42 offen nt lds
  ds_read_b64_tr_b16 v[148:149], v219 offset:0
  v_mfma_f32_16x16x32_bf16 v[128:131], v[160:163], v[192:195], v[128:131]
  s_waitcnt lgkmcnt(1)
  v_exp_f32 v124, v124
  v_mfma_f32_16x16x32_bf16 v[100:103], v[164:167], v[64:67], v[136:139]
  s_nop 0
  ds_read_b64_tr_b16 v[150:151], v219 offset:512
  ds_read_b64_tr_b16 v[152:153], v219 offset:32
  v_mfma_f32_16x16x32_bf16 v[100:103], v[168:171], v[68:71], v[100:103]
  v_exp_f32 v125, v125
  v_mfma_f32_16x16x32_bf16 v[100:103], v[172:175], v[72:75], v[100:103]
  v_exp_f32 v126, v126
  v_mfma_f32_16x16x32_bf16 v[100:103], v[176:179], v[76:79], v[100:103]
  s_add_u32 m0, m0, 32
  ds_read_b64_tr_b16 v[154:155], v219 offset:544
  ds_read_b64_tr_b16 v[156:157], v219 offset:64
  v_mfma_f32_16x16x32_bf16 v[108:111], v[164:167], v[80:83], v[140:143]
  v_exp_f32 v127, v127
  v_mfma_f32_16x16x32_bf16 v[108:111], v[168:171], v[84:87], v[108:111]
  buffer_load_dwordx4 v225, s[16:19], s42 offen offset:1024 nt lds
  v_cvt_pk_bf16_f32 v122, v124, v125
  v_mfma_f32_16x16x32_bf16 v[108:111], v[172:175], v[88:91], v[108:111]
  ds_read_b64_tr_b16 v[158:159], v219 offset:576
  v_cvt_pk_bf16_f32 v123, v126, v127
  v_mfma_f32_16x16x32_bf16 v[108:111], v[176:179], v[92:95], v[108:111]
  v_exp_f32 v96, v96
  v_mfma_f32_16x16x32_bf16 v[132:135], v[164:167], v[180:183], v[144:147]
  s_add_u32 m0, m0, 32
  v_exp_f32 v97, v97
  v_mfma_f32_16x16x32_bf16 v[132:135], v[168:171], v[184:187], v[132:135]
  v_exp_f32 v98, v98
  v_mfma_f32_16x16x32_bf16 v[132:135], v[172:175], v[188:191], v[132:135]
  s_nop 0
  ds_read_b64_tr_b16 v[160:161], v219 offset:96
  ds_read_b64_tr_b16 v[162:163], v219 offset:608
  v_mfma_f32_16x16x32_bf16 v[132:135], v[176:179], v[192:195], v[132:135]
  v_exp_f32 v99, v99
  v_mfma_f32_16x16x32_bf16 v[200:203], v[196:199], v[112:115], v[200:203]
  ds_read_b64_tr_b16 v[164:165], v219 offset:128
  v_cvt_pk_bf16_f32 v96, v96, v97
  v_mfma_f32_16x16x32_bf16 v[204:207], v[196:199], v[120:123], v[204:207]
  s_waitcnt lgkmcnt(3)
  ds_read_b64_tr_b16 v[166:167], v219 offset:640
  v_cvt_pk_bf16_f32 v97, v98, v99
  v_mfma_f32_16x16x32_bf16 v[4:7], v[148:151], v[120:123], v[4:7]
  s_nop 0
  buffer_load_dwordx4 v225, s[16:19], s42 offen offset:2048 nt lds
  ds_read_b64_tr_b16 v[168:169], v219 offset:160
  v_mfma_f32_16x16x32_bf16 v[0:3], v[148:151], v[112:115], v[0:3]
  v_exp_f32 v104, v104
  v_mfma_f32_16x16x32_bf16 v[8:11], v[152:155], v[112:115], v[8:11]
  s_nop 0
  ds_read_b64_tr_b16 v[170:171], v219 offset:672
  ds_read_b64_tr_b16 v[172:173], v219 offset:192
  v_mfma_f32_16x16x32_bf16 v[12:15], v[152:155], v[120:123], v[12:15]
  v_exp_f32 v105, v105
  v_mfma_f32_16x16x32_bf16 v[20:23], v[156:159], v[120:123], v[20:23]
  s_add_u32 m0, m0, 32
  ds_read_b64_tr_b16 v[174:175], v219 offset:704
  ds_read_b64_tr_b16 v[176:177], v219 offset:224
  v_mfma_f32_16x16x32_bf16 v[16:19], v[156:159], v[112:115], v[16:19]
  s_waitcnt lgkmcnt(7)
  v_exp_f32 v106, v106
  v_mfma_f32_16x16x32_bf16 v[24:27], v[160:163], v[112:115], v[24:27]
  s_nop 0
  buffer_load_dwordx4 v225, s[16:19], s42 offen offset:3072 nt lds
  ds_read_b64_tr_b16 v[178:179], v219 offset:736
  v_mfma_f32_16x16x32_bf16 v[28:31], v[160:163], v[120:123], v[28:31]
  s_waitcnt lgkmcnt(6)
  v_exp_f32 v107, v107
  v_mfma_f32_16x16x32_bf16 v[36:39], v[164:167], v[120:123], v[36:39]
  ds_read_b128 v[148:151], v213 offset:34816
  v_cvt_pk_bf16_f32 v104, v104, v105
  v_mfma_f32_16x16x32_bf16 v[32:35], v[164:167], v[112:115], v[32:35]
  s_waitcnt lgkmcnt(5)
  ds_read_b128 v[152:155], v213 offset:34880
  v_cvt_pk_bf16_f32 v105, v106, v107
  v_mfma_f32_16x16x32_bf16 v[40:43], v[168:171], v[112:115], v[40:43]
  s_nop 0
  ds_read_b128 v[156:159], v213 offset:34944
  ds_read_b128 v[160:163], v213 offset:35008
  v_mfma_f32_16x16x32_bf16 v[44:47], v[168:171], v[120:123], v[44:47]
  s_waitcnt lgkmcnt(6)
  v_exp_f32 v128, v128
  v_mfma_f32_16x16x32_bf16 v[52:55], v[172:175], v[120:123], v[52:55]
  v_exp_f32 v129, v129
  v_mfma_f32_16x16x32_bf16 v[48:51], v[172:175], v[112:115], v[48:51]
  s_waitcnt lgkmcnt(4)
  v_exp_f32 v130, v130
  v_mfma_f32_16x16x32_bf16 v[56:59], v[176:179], v[112:115], v[56:59]
  v_exp_f32 v131, v131
  v_mfma_f32_16x16x32_bf16 v[60:63], v[176:179], v[120:123], v[60:63]
  s_waitcnt lgkmcnt(3)
  v_cvt_pk_bf16_f32 v128, v128, v129
  v_cvt_pk_bf16_f32 v129, v130, v131
  v_mfma_f32_16x16x32_bf16 v[112:115], v[148:151], v[64:67], v[136:139]
  s_waitcnt lgkmcnt(2)
  ds_read_b128 v[164:167], v213 offset:35328
  ds_read_b128 v[168:171], v213 offset:35392
  v_mfma_f32_16x16x32_bf16 v[112:115], v[152:155], v[68:71], v[112:115]
  s_waitcnt lgkmcnt(2)
  v_exp_f32 v100, v100
  v_mfma_f32_16x16x32_bf16 v[112:115], v[156:159], v[72:75], v[112:115]
  s_nop 0
  ds_read_b128 v[172:175], v213 offset:35456
  ds_read_b128 v[176:179], v213 offset:35520
  v_mfma_f32_16x16x32_bf16 v[112:115], v[160:163], v[76:79], v[112:115]
  v_exp_f32 v101, v101
  v_mfma_f32_16x16x32_bf16 v[120:123], v[148:151], v[80:83], v[140:143]
  v_exp_f32 v102, v102
  v_mfma_f32_16x16x32_bf16 v[120:123], v[152:155], v[84:87], v[120:123]
  v_exp_f32 v103, v103
  v_mfma_f32_16x16x32_bf16 v[120:123], v[156:159], v[88:91], v[120:123]
  v_cvt_pk_bf16_f32 v98, v100, v101
  v_cvt_pk_bf16_f32 v99, v102, v103
  v_mfma_f32_16x16x32_bf16 v[120:123], v[160:163], v[92:95], v[120:123]
  s_waitcnt lgkmcnt(2)
  v_exp_f32 v108, v108
  v_mfma_f32_16x16x32_bf16 v[116:119], v[164:167], v[64:67], v[136:139]
  v_exp_f32 v109, v109
  v_mfma_f32_16x16x32_bf16 v[116:119], v[168:171], v[68:71], v[116:119]
  s_waitcnt lgkmcnt(0)
  v_exp_f32 v110, v110
  v_mfma_f32_16x16x32_bf16 v[116:119], v[172:175], v[72:75], v[116:119]
  s_waitcnt vmcnt(8)
  s_barrier
  ds_read_b64_tr_b16 v[148:149], v216 offset:34816
  v_mfma_f32_16x16x32_bf16 v[116:119], v[176:179], v[76:79], v[116:119]
  s_add_u32 s42, s2, 0
  s_mov_b32 m0, s38
  ds_read_b64_tr_b16 v[150:151], v216 offset:35328
  v_mfma_f32_16x16x32_bf16 v[124:127], v[164:167], v[80:83], v[140:143]
  v_exp_f32 v111, v111
  v_mfma_f32_16x16x32_bf16 v[124:127], v[168:171], v[84:87], v[124:127]
  v_cvt_pk_bf16_f32 v106, v108, v109
  v_cvt_pk_bf16_f32 v107, v110, v111
  v_mfma_f32_16x16x32_bf16 v[124:127], v[172:175], v[88:91], v[124:127]
  s_nop 0
  ds_read_b64_tr_b16 v[152:153], v216 offset:34848
  ds_read_b64_tr_b16 v[154:155], v216 offset:35360
  v_exp_f32 v132, v132
  v_exp_f32 v133, v133
  v_exp_f32 v134, v134
  v_exp_f32 v135, v135
  v_cvt_pk_bf16_f32 v130, v132, v133
  v_cvt_pk_bf16_f32 v131, v134, v135
  v_mfma_f32_16x16x32_bf16 v[124:127], v[176:179], v[92:95], v[124:127]
  s_nop 0
  buffer_load_dwordx4 v225, s[20:23], s42 offen nt lds
  ds_read_b64_tr_b16 v[156:157], v216 offset:34880
  v_mfma_f32_16x16x32_bf16 v[200:203], v[196:199], v[96:99], v[200:203]
  s_nop 0
  ds_read_b64_tr_b16 v[158:159], v216 offset:35392
  ds_read_b64_tr_b16 v[160:161], v216 offset:34912
  v_mfma_f32_16x16x32_bf16 v[204:207], v[196:199], v[104:107], v[204:207]
  s_nop 0
  ds_read_b64_tr_b16 v[162:163], v216 offset:35424
  ds_read_b64_tr_b16 v[164:165], v216 offset:34944
  v_mfma_f32_16x16x32_bf16 v[208:211], v[196:199], v[128:131], v[208:211]
  s_waitcnt lgkmcnt(7)
  s_add_u32 m0, m0, 32
  ds_read_b64_tr_b16 v[166:167], v216 offset:35456
  v_mfma_f32_16x16x32_bf16 a[224:227], v[148:151], v[128:131], a[224:227]
  s_nop 0
  buffer_load_dwordx4 v225, s[20:23], s42 offen offset:1024 nt lds
  ds_read_b64_tr_b16 v[168:169], v216 offset:34976
  v_mfma_f32_16x16x32_bf16 v[4:7], v[148:151], v[104:107], v[4:7]
  s_nop 0
  ds_read_b64_tr_b16 v[170:171], v216 offset:35488
  ds_read_b64_tr_b16 v[172:173], v216 offset:35008
  v_mfma_f32_16x16x32_bf16 v[0:3], v[148:151], v[96:99], v[0:3]
  s_waitcnt lgkmcnt(9)
  ds_read_b64_tr_b16 v[174:175], v216 offset:35520
  v_mfma_f32_16x16x32_bf16 v[8:11], v[152:155], v[96:99], v[8:11]
  s_add_u32 m0, m0, 32
  ds_read_b64_tr_b16 v[176:177], v216 offset:35040
  v_mfma_f32_16x16x32_bf16 v[12:15], v[152:155], v[104:107], v[12:15]
  s_nop 0
  buffer_load_dwordx4 v225, s[20:23], s42 offen offset:2048 nt lds
  ds_read_b64_tr_b16 v[178:179], v216 offset:35552
  v_mfma_f32_16x16x32_bf16 a[228:231], v[152:155], v[128:131], a[228:231]
  s_waitcnt lgkmcnt(8)
  v_exp_f32 v112, v112
  v_mfma_f32_16x16x32_bf16 a[232:235], v[156:159], v[128:131], a[232:235]
  ds_read_b128 v[148:151], v214 offset:34816
  v_mfma_f32_16x16x32_bf16 v[20:23], v[156:159], v[104:107], v[20:23]
  s_add_u32 m0, m0, 32
  v_exp_f32 v113, v113
  v_mfma_f32_16x16x32_bf16 v[16:19], v[156:159], v[96:99], v[16:19]
  s_nop 0
  buffer_load_dwordx4 v225, s[20:23], s42 offen offset:3072 nt lds
  ds_read_b128 v[152:155], v214 offset:34880
  v_mfma_f32_16x16x32_bf16 v[24:27], v[160:163], v[96:99], v[24:27]
  v_exp_f32 v114, v114
  v_mfma_f32_16x16x32_bf16 v[28:31], v[160:163], v[104:107], v[28:31]
  ds_read_b128 v[156:159], v214 offset:34944
  v_mfma_f32_16x16x32_bf16 a[236:239], v[160:163], v[128:131], a[236:239]
  s_waitcnt lgkmcnt(7)
  s_add_u32 s42, s42, s52
  s_add_u32 m0, m0, s53
  v_mfma_f32_16x16x32_bf16 a[240:243], v[164:167], v[128:131], a[240:243]
  s_nop 0
  buffer_load_dwordx4 v225, s[20:23], s42 offen nt lds
  ds_read_b128 v[160:163], v214 offset:35008
  v_mfma_f32_16x16x32_bf16 v[36:39], v[164:167], v[104:107], v[36:39]
  v_exp_f32 v115, v115
  v_mfma_f32_16x16x32_bf16 v[32:35], v[164:167], v[96:99], v[32:35]
  v_cvt_pk_bf16_f32 v112, v112, v113
  v_cvt_pk_bf16_f32 v113, v114, v115
  v_mfma_f32_16x16x32_bf16 v[40:43], v[168:171], v[96:99], v[40:43]
  s_add_u32 m0, m0, 32
  v_exp_f32 v120, v120
  v_mfma_f32_16x16x32_bf16 v[44:47], v[168:171], v[104:107], v[44:47]
  s_nop 0
  buffer_load_dwordx4 v225, s[20:23], s42 offen offset:1024 nt lds
  ds_read_b128 v[164:167], v214 offset:35328
  v_mfma_f32_16x16x32_bf16 a[244:247], v[168:171], v[128:131], a[244:247]
  s_waitcnt lgkmcnt(5)
  v_exp_f32 v121, v121
  v_mfma_f32_16x16x32_bf16 a[248:251], v[172:175], v[128:131], a[248:251]
  v_exp_f32 v122, v122
  v_mfma_f32_16x16x32_bf16 v[52:55], v[172:175], v[104:107], v[52:55]
  s_add_u32 m0, m0, 32
  v_exp_f32 v123, v123
  v_mfma_f32_16x16x32_bf16 v[48:51], v[172:175], v[96:99], v[48:51]
  ds_read_b128 v[168:171], v214 offset:35392
  v_cvt_pk_bf16_f32 v120, v120, v121
  v_mfma_f32_16x16x32_bf16 v[56:59], v[176:179], v[96:99], v[56:59]
  ds_read_b128 v[172:175], v214 offset:35456
  v_cvt_pk_bf16_f32 v121, v122, v123
  v_mfma_f32_16x16x32_bf16 v[60:63], v[176:179], v[104:107], v[60:63]
  buffer_load_dwordx4 v225, s[20:23], s42 offen offset:2048 nt lds
  v_mfma_f32_16x16x32_bf16 a[252:255], v[176:179], v[128:131], a[252:255]
  s_waitcnt lgkmcnt(3)
  ds_read_b128 v[176:179], v214 offset:35520
  v_mfma_f32_16x16x32_bf16 v[96:99], v[148:151], v[64:67], v[136:139]
  v_exp_f32 v116, v116
  v_mfma_f32_16x16x32_bf16 v[96:99], v[152:155], v[68:71], v[96:99]
  v_exp_f32 v117, v117
  v_mfma_f32_16x16x32_bf16 v[96:99], v[156:159], v[72:75], v[96:99]
  v_exp_f32 v118, v118
  v_mfma_f32_16x16x32_bf16 v[96:99], v[160:163], v[76:79], v[96:99]
  s_add_u32 m0, m0, 32
  v_exp_f32 v119, v119
  v_mfma_f32_16x16x32_bf16 v[104:107], v[148:151], v[80:83], v[140:143]
  buffer_load_dwordx4 v225, s[20:23], s42 offen offset:3072 nt lds
  v_cvt_pk_bf16_f32 v114, v116, v117
  v_mfma_f32_16x16x32_bf16 v[104:107], v[152:155], v[84:87], v[104:107]
  ds_read_b64_tr_b16 v[148:149], v217 offset:34816
  v_cvt_pk_bf16_f32 v115, v118, v119
  v_mfma_f32_16x16x32_bf16 v[104:107], v[156:159], v[88:91], v[104:107]
  v_exp_f32 v124, v124
  v_mfma_f32_16x16x32_bf16 v[104:107], v[160:163], v[92:95], v[104:107]
  s_waitcnt lgkmcnt(1)
  ds_read_b64_tr_b16 v[150:151], v217 offset:35328
  ds_read_b64_tr_b16 v[152:153], v217 offset:34848
  v_mfma_f32_16x16x32_bf16 v[100:103], v[164:167], v[64:67], v[136:139]
  v_exp_f32 v125, v125
  v_mfma_f32_16x16x32_bf16 v[100:103], v[168:171], v[68:71], v[100:103]
  v_exp_f32 v126, v126
  v_mfma_f32_16x16x32_bf16 v[100:103], v[172:175], v[72:75], v[100:103]
  s_nop 0
  ds_read_b64_tr_b16 v[154:155], v217 offset:35360
  ds_read_b64_tr_b16 v[156:157], v217 offset:34880
  v_mfma_f32_16x16x32_bf16 v[100:103], v[176:179], v[76:79], v[100:103]
  v_exp_f32 v127, v127
  v_mfma_f32_16x16x32_bf16 v[108:111], v[164:167], v[80:83], v[140:143]
  ds_read_b64_tr_b16 v[158:159], v217 offset:35392
  v_cvt_pk_bf16_f32 v122, v124, v125
  v_mfma_f32_16x16x32_bf16 v[108:111], v[168:171], v[84:87], v[108:111]
  ds_read_b64_tr_b16 v[160:161], v217 offset:34912
  v_cvt_pk_bf16_f32 v123, v126, v127
  v_mfma_f32_16x16x32_bf16 v[108:111], v[172:175], v[88:91], v[108:111]
  s_nop 0
  ds_read_b64_tr_b16 v[162:163], v217 offset:35424
  ds_read_b64_tr_b16 v[164:165], v217 offset:34944
  v_mfma_f32_16x16x32_bf16 v[108:111], v[176:179], v[92:95], v[108:111]
  s_nop 0
  ds_read_b64_tr_b16 v[166:167], v217 offset:35456
  ds_read_b64_tr_b16 v[168:169], v217 offset:34976
  v_mfma_f32_16x16x32_bf16 v[200:203], v[196:199], v[112:115], v[200:203]
  s_nop 0
  ds_read_b64_tr_b16 v[170:171], v217 offset:35488
  ds_read_b64_tr_b16 v[172:173], v217 offset:35008
  v_mfma_f32_16x16x32_bf16 v[204:207], v[196:199], v[120:123], v[204:207]
  s_waitcnt lgkmcnt(9)
  ds_read_b64_tr_b16 v[174:175], v217 offset:35520
  ds_read_b64_tr_b16 v[176:177], v217 offset:35040
  v_mfma_f32_16x16x32_bf16 v[4:7], v[148:151], v[120:123], v[4:7]
  ds_read_b64_tr_b16 v[178:179], v217 offset:35552
  v_mfma_f32_16x16x32_bf16 v[0:3], v[148:151], v[112:115], v[0:3]
  v_exp_f32 v96, v96
  v_mfma_f32_16x16x32_bf16 v[8:11], v[152:155], v[112:115], v[8:11]
  ds_read_b128 v[148:151], v215 offset:34816
  v_mfma_f32_16x16x32_bf16 v[12:15], v[152:155], v[120:123], v[12:15]
  s_waitcnt lgkmcnt(9)
  v_exp_f32 v97, v97
  v_mfma_f32_16x16x32_bf16 v[20:23], v[156:159], v[120:123], v[20:23]
  ds_read_b128 v[152:155], v215 offset:34880
  v_mfma_f32_16x16x32_bf16 v[16:19], v[156:159], v[112:115], v[16:19]
  v_exp_f32 v98, v98
  v_mfma_f32_16x16x32_bf16 v[24:27], v[160:163], v[112:115], v[24:27]
  ds_read_b128 v[156:159], v215 offset:34944
  v_mfma_f32_16x16x32_bf16 v[28:31], v[160:163], v[120:123], v[28:31]
  s_waitcnt lgkmcnt(5)
  v_exp_f32 v99, v99
  v_mfma_f32_16x16x32_bf16 v[36:39], v[164:167], v[120:123], v[36:39]
  ds_read_b128 v[160:163], v215 offset:35008
  v_cvt_pk_bf16_f32 v96, v96, v97
  v_mfma_f32_16x16x32_bf16 v[32:35], v[164:167], v[112:115], v[32:35]
  ds_read_b128 v[164:167], v215 offset:35328
  v_cvt_pk_bf16_f32 v97, v98, v99
  v_mfma_f32_16x16x32_bf16 v[40:43], v[168:171], v[112:115], v[40:43]
  v_exp_f32 v104, v104
  v_mfma_f32_16x16x32_bf16 v[44:47], v[168:171], v[120:123], v[44:47]
  v_exp_f32 v105, v105
  v_mfma_f32_16x16x32_bf16 v[52:55], v[172:175], v[120:123], v[52:55]
  v_exp_f32 v106, v106
  v_mfma_f32_16x16x32_bf16 v[48:51], v[172:175], v[112:115], v[48:51]
  s_waitcnt lgkmcnt(2)
  v_exp_f32 v107, v107
  v_mfma_f32_16x16x32_bf16 v[56:59], v[176:179], v[112:115], v[56:59]
  ds_read_b128 v[168:171], v215 offset:35392
  v_cvt_pk_bf16_f32 v104, v104, v105
  v_mfma_f32_16x16x32_bf16 v[60:63], v[176:179], v[120:123], v[60:63]
  ds_read_b128 v[172:175], v215 offset:35456
  v_cvt_pk_bf16_f32 v105, v106, v107
  v_mfma_f32_16x16x32_bf16 v[112:115], v[148:151], v[64:67], v[136:139]
  ds_read_b128 v[176:179], v215 offset:35520
  v_mfma_f32_16x16x32_bf16 v[112:115], v[152:155], v[68:71], v[112:115]
  v_exp_f32 v100, v100
  v_mfma_f32_16x16x32_bf16 v[112:115], v[156:159], v[72:75], v[112:115]
  s_waitcnt lgkmcnt(3)
  v_exp_f32 v101, v101
  v_mfma_f32_16x16x32_bf16 v[112:115], v[160:163], v[76:79], v[112:115]
  v_exp_f32 v102, v102
  v_mfma_f32_16x16x32_bf16 v[120:123], v[148:151], v[80:83], v[140:143]
  v_exp_f32 v103, v103
  v_mfma_f32_16x16x32_bf16 v[120:123], v[152:155], v[84:87], v[120:123]
  v_cvt_pk_bf16_f32 v98, v100, v101
  v_cvt_pk_bf16_f32 v99, v102, v103
  v_mfma_f32_16x16x32_bf16 v[120:123], v[156:159], v[88:91], v[120:123]
  v_exp_f32 v108, v108
  v_mfma_f32_16x16x32_bf16 v[120:123], v[160:163], v[92:95], v[120:123]
  s_nop 0
  ds_read_b64_tr_b16 v[148:149], v218 offset:34816
  ds_read_b64_tr_b16 v[150:151], v218 offset:35328
  v_mfma_f32_16x16x32_bf16 v[116:119], v[164:167], v[64:67], v[136:139]
  s_waitcnt lgkmcnt(2)
  v_exp_f32 v109, v109
  v_mfma_f32_16x16x32_bf16 v[116:119], v[168:171], v[68:71], v[116:119]
  v_exp_f32 v110, v110
  v_mfma_f32_16x16x32_bf16 v[116:119], v[172:175], v[72:75], v[116:119]
  s_nop 0
  ds_read_b64_tr_b16 v[152:153], v218 offset:34848
  ds_read_b64_tr_b16 v[154:155], v218 offset:35360
  v_mfma_f32_16x16x32_bf16 v[116:119], v[176:179], v[76:79], v[116:119]
  v_exp_f32 v111, v111
  v_mfma_f32_16x16x32_bf16 v[124:127], v[164:167], v[80:83], v[140:143]
  ds_read_b64_tr_b16 v[156:157], v218 offset:34880
  v_cvt_pk_bf16_f32 v106, v108, v109
  v_mfma_f32_16x16x32_bf16 v[124:127], v[168:171], v[84:87], v[124:127]
  ds_read_b64_tr_b16 v[158:159], v218 offset:35392
  v_cvt_pk_bf16_f32 v107, v110, v111
  v_mfma_f32_16x16x32_bf16 v[124:127], v[172:175], v[88:91], v[124:127]
  s_nop 0
  ds_read_b64_tr_b16 v[160:161], v218 offset:34912
  ds_read_b64_tr_b16 v[162:163], v218 offset:35424
  v_mfma_f32_16x16x32_bf16 v[124:127], v[176:179], v[92:95], v[124:127]
  s_nop 0
  ds_read_b64_tr_b16 v[164:165], v218 offset:34944
  ds_read_b64_tr_b16 v[166:167], v218 offset:35456
  v_mfma_f32_16x16x32_bf16 v[200:203], v[196:199], v[96:99], v[200:203]
  s_nop 0
  ds_read_b64_tr_b16 v[168:169], v218 offset:34976
  ds_read_b64_tr_b16 v[170:171], v218 offset:35488
  v_mfma_f32_16x16x32_bf16 v[204:207], v[196:199], v[104:107], v[204:207]
  s_waitcnt lgkmcnt(8)
  ds_read_b64_tr_b16 v[172:173], v218 offset:35008
  ds_read_b64_tr_b16 v[174:175], v218 offset:35520
  v_mfma_f32_16x16x32_bf16 v[4:7], v[148:151], v[104:107], v[4:7]
  s_nop 0
  ds_read_b64_tr_b16 v[176:177], v218 offset:35040
  ds_read_b64_tr_b16 v[178:179], v218 offset:35552
  v_mfma_f32_16x16x32_bf16 v[0:3], v[148:151], v[96:99], v[0:3]
  s_waitcnt vmcnt(8)
  s_barrier
  ds_read_b128 v[148:151], v212 offset:0
  v_mfma_f32_16x16x32_bf16 v[8:11], v[152:155], v[96:99], v[8:11]
  s_add_u32 s42, s3, 0
  s_mov_b32 m0, s39
  v_mfma_f32_16x16x32_bf16 v[12:15], v[152:155], v[104:107], v[12:15]
  s_waitcnt lgkmcnt(9)
  ds_read_b128 v[152:155], v212 offset:64
  buffer_load_dwordx4 v225, s[16:19], s42 offen nt lds
  v_mfma_f32_16x16x32_bf16 v[20:23], v[156:159], v[104:107], v[20:23]
  v_exp_f32 v112, v112
  v_mfma_f32_16x16x32_bf16 v[16:19], v[156:159], v[96:99], v[16:19]
  ds_read_b128 v[156:159], v212 offset:128
  v_mfma_f32_16x16x32_bf16 v[24:27], v[160:163], v[96:99], v[24:27]
  s_add_u32 m0, m0, 32
  v_exp_f32 v113, v113
  v_mfma_f32_16x16x32_bf16 v[28:31], v[160:163], v[104:107], v[28:31]
  s_waitcnt lgkmcnt(5)
  ds_read_b128 v[160:163], v212 offset:192
  v_mfma_f32_16x16x32_bf16 v[36:39], v[164:167], v[104:107], v[36:39]
  v_exp_f32 v114, v114
  v_mfma_f32_16x16x32_bf16 v[32:35], v[164:167], v[96:99], v[32:35]
  buffer_load_dwordx4 v225, s[16:19], s42 offen offset:1024 nt lds
  v_mfma_f32_16x16x32_bf16 v[40:43], v[168:171], v[96:99], v[40:43]
  v_exp_f32 v115, v115
  v_mfma_f32_16x16x32_bf16 v[44:47], v[168:171], v[104:107], v[44:47]
  ds_read_b128 v[164:167], v212 offset:512
  v_cvt_pk_bf16_f32 v112, v112, v113
  v_mfma_f32_16x16x32_bf16 v[52:55], v[172:175], v[104:107], v[52:55]
  s_add_u32 m0, m0, 32
  ds_read_b128 v[168:171], v212 offset:576
  v_cvt_pk_bf16_f32 v113, v114, v115
  v_mfma_f32_16x16x32_bf16 v[48:51], v[172:175], v[96:99], v[48:51]
  s_waitcnt lgkmcnt(3)
  v_exp_f32 v120, v120
  v_mfma_f32_16x16x32_bf16 v[56:59], v[176:179], v[96:99], v[56:59]
  s_nop 0
  ds_read_b128 v[172:175], v212 offset:640
  buffer_load_dwordx4 v225, s[16:19], s42 offen offset:2048 nt lds
  v_mfma_f32_16x16x32_bf16 v[60:63], v[176:179], v[104:107], v[60:63]
  v_exp_f32 v121, v121
  v_mfma_f32_16x16x32_bf16 v[96:99], v[148:151], v[64:67], v[136:139]
  ds_read_b128 v[176:179], v212 offset:704
  v_mfma_f32_16x16x32_bf16 v[96:99], v[152:155], v[68:71], v[96:99]
  v_exp_f32 v122, v122
  v_mfma_f32_16x16x32_bf16 v[96:99], v[156:159], v[72:75], v[96:99]
  s_waitcnt lgkmcnt(4)
  v_exp_f32 v123, v123
  v_mfma_f32_16x16x32_bf16 v[96:99], v[160:163], v[76:79], v[96:99]
  s_add_u32 m0, m0, 32
  v_cvt_pk_bf16_f32 v120, v120, v121
  v_cvt_pk_bf16_f32 v121, v122, v123
  v_mfma_f32_16x16x32_bf16 v[104:107], v[148:151], v[80:83], v[140:143]
  v_exp_f32 v116, v116
  v_mfma_f32_16x16x32_bf16 v[104:107], v[152:155], v[84:87], v[104:107]
  buffer_load_dwordx4 v225, s[16:19], s42 offen offset:3072 nt lds
  v_mfma_f32_16x16x32_bf16 v[104:107], v[156:159], v[88:91], v[104:107]
  v_exp_f32 v117, v117
  v_mfma_f32_16x16x32_bf16 v[104:107], v[160:163], v[92:95], v[104:107]
  v_exp_f32 v118, v118
  v_mfma_f32_16x16x32_bf16 v[128:131], v[148:151], v[180:183], v[144:147]
  s_add_u32 s42, s42, s52
  v_exp_f32 v119, v119
  v_mfma_f32_16x16x32_bf16 v[128:131], v[152:155], v[184:187], v[128:131]
  s_add_u32 m0, m0, s53
  v_cvt_pk_bf16_f32 v114, v116, v117
  v_cvt_pk_bf16_f32 v115, v118, v119
  v_mfma_f32_16x16x32_bf16 v[128:131], v[156:159], v[188:191], v[128:131]
  s_nop 0
  buffer_load_dwordx4 v225, s[16:19], s42 offen nt lds
  ds_read_b64_tr_b16 v[148:149], v219 offset:34816
  v_mfma_f32_16x16x32_bf16 v[128:131], v[160:163], v[192:195], v[128:131]
  s_waitcnt lgkmcnt(1)
  v_exp_f32 v124, v124
  v_mfma_f32_16x16x32_bf16 v[100:103], v[164:167], v[64:67], v[136:139]
  s_nop 0
  ds_read_b64_tr_b16 v[150:151], v219 offset:35328
  ds_read_b64_tr_b16 v[152:153], v219 offset:34848
  v_mfma_f32_16x16x32_bf16 v[100:103], v[168:171], v[68:71], v[100:103]
  v_exp_f32 v125, v125
  v_mfma_f32_16x16x32_bf16 v[100:103], v[172:175], v[72:75], v[100:103]
  v_exp_f32 v126, v126
  v_mfma_f32_16x16x32_bf16 v[100:103], v[176:179], v[76:79], v[100:103]
  s_add_u32 m0, m0, 32
  ds_read_b64_tr_b16 v[154:155], v219 offset:35360
  ds_read_b64_tr_b16 v[156:157], v219 offset:34880
  v_mfma_f32_16x16x32_bf16 v[108:111], v[164:167], v[80:83], v[140:143]
  v_exp_f32 v127, v127
  v_mfma_f32_16x16x32_bf16 v[108:111], v[168:171], v[84:87], v[108:111]
  buffer_load_dwordx4 v225, s[16:19], s42 offen offset:1024 nt lds
  v_cvt_pk_bf16_f32 v122, v124, v125
  v_mfma_f32_16x16x32_bf16 v[108:111], v[172:175], v[88:91], v[108:111]
  ds_read_b64_tr_b16 v[158:159], v219 offset:35392
  v_cvt_pk_bf16_f32 v123, v126, v127
  v_mfma_f32_16x16x32_bf16 v[108:111], v[176:179], v[92:95], v[108:111]
  v_exp_f32 v96, v96
  v_mfma_f32_16x16x32_bf16 v[132:135], v[164:167], v[180:183], v[144:147]
  s_add_u32 m0, m0, 32
  v_exp_f32 v97, v97
  v_mfma_f32_16x16x32_bf16 v[132:135], v[168:171], v[184:187], v[132:135]
  v_exp_f32 v98, v98
  v_mfma_f32_16x16x32_bf16 v[132:135], v[172:175], v[188:191], v[132:135]
  s_nop 0
  ds_read_b64_tr_b16 v[160:161], v219 offset:34912
  ds_read_b64_tr_b16 v[162:163], v219 offset:35424
  v_mfma_f32_16x16x32_bf16 v[132:135], v[176:179], v[192:195], v[132:135]
  v_exp_f32 v99, v99
  v_mfma_f32_16x16x32_bf16 v[200:203], v[196:199], v[112:115], v[200:203]
  ds_read_b64_tr_b16 v[164:165], v219 offset:34944
  v_cvt_pk_bf16_f32 v96, v96, v97
  v_mfma_f32_16x16x32_bf16 v[204:207], v[196:199], v[120:123], v[204:207]
  s_waitcnt lgkmcnt(3)
  ds_read_b64_tr_b16 v[166:167], v219 offset:35456
  v_cvt_pk_bf16_f32 v97, v98, v99
  v_mfma_f32_16x16x32_bf16 v[4:7], v[148:151], v[120:123], v[4:7]
  s_nop 0
  buffer_load_dwordx4 v225, s[16:19], s42 offen offset:2048 nt lds
  ds_read_b64_tr_b16 v[168:169], v219 offset:34976
  v_mfma_f32_16x16x32_bf16 v[0:3], v[148:151], v[112:115], v[0:3]
  v_exp_f32 v104, v104
  v_mfma_f32_16x16x32_bf16 v[8:11], v[152:155], v[112:115], v[8:11]
  s_nop 0
  ds_read_b64_tr_b16 v[170:171], v219 offset:35488
  ds_read_b64_tr_b16 v[172:173], v219 offset:35008
  v_mfma_f32_16x16x32_bf16 v[12:15], v[152:155], v[120:123], v[12:15]
  v_exp_f32 v105, v105
  v_mfma_f32_16x16x32_bf16 v[20:23], v[156:159], v[120:123], v[20:23]
  s_add_u32 m0, m0, 32
  ds_read_b64_tr_b16 v[174:175], v219 offset:35520
  ds_read_b64_tr_b16 v[176:177], v219 offset:35040
  v_mfma_f32_16x16x32_bf16 v[16:19], v[156:159], v[112:115], v[16:19]
  s_waitcnt lgkmcnt(7)
  v_exp_f32 v106, v106
  v_mfma_f32_16x16x32_bf16 v[24:27], v[160:163], v[112:115], v[24:27]
  s_nop 0
  buffer_load_dwordx4 v225, s[16:19], s42 offen offset:3072 nt lds
  ds_read_b64_tr_b16 v[178:179], v219 offset:35552
  v_mfma_f32_16x16x32_bf16 v[28:31], v[160:163], v[120:123], v[28:31]
  s_waitcnt lgkmcnt(6)
  v_exp_f32 v107, v107
  v_mfma_f32_16x16x32_bf16 v[36:39], v[164:167], v[120:123], v[36:39]
  ds_read_b128 v[148:151], v213 offset:0
  v_cvt_pk_bf16_f32 v104, v104, v105
  v_mfma_f32_16x16x32_bf16 v[32:35], v[164:167], v[112:115], v[32:35]
  s_waitcnt lgkmcnt(5)
  ds_read_b128 v[152:155], v213 offset:64
  v_cvt_pk_bf16_f32 v105, v106, v107
  v_mfma_f32_16x16x32_bf16 v[40:43], v[168:171], v[112:115], v[40:43]
  s_nop 0
  ds_read_b128 v[156:159], v213 offset:128
  ds_read_b128 v[160:163], v213 offset:192
  v_mfma_f32_16x16x32_bf16 v[44:47], v[168:171], v[120:123], v[44:47]
  s_waitcnt lgkmcnt(6)
  v_exp_f32 v128, v128
  v_mfma_f32_16x16x32_bf16 v[52:55], v[172:175], v[120:123], v[52:55]
  v_exp_f32 v129, v129
  v_mfma_f32_16x16x32_bf16 v[48:51], v[172:175], v[112:115], v[48:51]
  s_waitcnt lgkmcnt(4)
  v_exp_f32 v130, v130
  v_mfma_f32_16x16x32_bf16 v[56:59], v[176:179], v[112:115], v[56:59]
  v_exp_f32 v131, v131
  v_mfma_f32_16x16x32_bf16 v[60:63], v[176:179], v[120:123], v[60:63]
  s_waitcnt lgkmcnt(3)
  v_cvt_pk_bf16_f32 v128, v128, v129
  v_cvt_pk_bf16_f32 v129, v130, v131
  v_mfma_f32_16x16x32_bf16 v[112:115], v[148:151], v[64:67], v[136:139]
  s_waitcnt lgkmcnt(2)
  ds_read_b128 v[164:167], v213 offset:512
  ds_read_b128 v[168:171], v213 offset:576
  v_mfma_f32_16x16x32_bf16 v[112:115], v[152:155], v[68:71], v[112:115]
  s_waitcnt lgkmcnt(2)
  v_exp_f32 v100, v100
  v_mfma_f32_16x16x32_bf16 v[112:115], v[156:159], v[72:75], v[112:115]
  s_nop 0
  ds_read_b128 v[172:175], v213 offset:640
  ds_read_b128 v[176:179], v213 offset:704
  v_mfma_f32_16x16x32_bf16 v[112:115], v[160:163], v[76:79], v[112:115]
  v_exp_f32 v101, v101
  v_mfma_f32_16x16x32_bf16 v[120:123], v[148:151], v[80:83], v[140:143]
  v_exp_f32 v102, v102
  v_mfma_f32_16x16x32_bf16 v[120:123], v[152:155], v[84:87], v[120:123]
  v_exp_f32 v103, v103
  v_mfma_f32_16x16x32_bf16 v[120:123], v[156:159], v[88:91], v[120:123]
  v_cvt_pk_bf16_f32 v98, v100, v101
  v_cvt_pk_bf16_f32 v99, v102, v103
  v_mfma_f32_16x16x32_bf16 v[120:123], v[160:163], v[92:95], v[120:123]
  s_waitcnt lgkmcnt(2)
  v_exp_f32 v108, v108
  v_mfma_f32_16x16x32_bf16 v[116:119], v[164:167], v[64:67], v[136:139]
  v_exp_f32 v109, v109
  v_mfma_f32_16x16x32_bf16 v[116:119], v[168:171], v[68:71], v[116:119]
  s_waitcnt lgkmcnt(0)
  v_exp_f32 v110, v110
  v_mfma_f32_16x16x32_bf16 v[116:119], v[172:175], v[72:75], v[116:119]
  s_waitcnt vmcnt(8)
  s_barrier
  ds_read_b64_tr_b16 v[148:149], v216 offset:0
  v_mfma_f32_16x16x32_bf16 v[116:119], v[176:179], v[76:79], v[116:119]
  s_add_u32 s42, s3, 0
  s_mov_b32 m0, s40
  ds_read_b64_tr_b16 v[150:151], v216 offset:512
  v_mfma_f32_16x16x32_bf16 v[124:127], v[164:167], v[80:83], v[140:143]
  v_exp_f32 v111, v111
  v_mfma_f32_16x16x32_bf16 v[124:127], v[168:171], v[84:87], v[124:127]
  v_cvt_pk_bf16_f32 v106, v108, v109
  v_cvt_pk_bf16_f32 v107, v110, v111
  v_mfma_f32_16x16x32_bf16 v[124:127], v[172:175], v[88:91], v[124:127]
  s_nop 0
  ds_read_b64_tr_b16 v[152:153], v216 offset:32
  ds_read_b64_tr_b16 v[154:155], v216 offset:544
  v_exp_f32 v132, v132
  v_exp_f32 v133, v133
  v_exp_f32 v134, v134
  v_exp_f32 v135, v135
  v_cvt_pk_bf16_f32 v130, v132, v133
  v_cvt_pk_bf16_f32 v131, v134, v135
  v_mfma_f32_16x16x32_bf16 v[124:127], v[176:179], v[92:95], v[124:127]
  s_nop 0
  buffer_load_dwordx4 v225, s[20:23], s42 offen nt lds
  ds_read_b64_tr_b16 v[156:157], v216 offset:64
  v_mfma_f32_16x16x32_bf16 v[200:203], v[196:199], v[96:99], v[200:203]
  s_nop 0
  ds_read_b64_tr_b16 v[158:159], v216 offset:576
  ds_read_b64_tr_b16 v[160:161], v216 offset:96
  v_mfma_f32_16x16x32_bf16 v[204:207], v[196:199], v[104:107], v[204:207]
  s_nop 0
  ds_read_b64_tr_b16 v[162:163], v216 offset:608
  ds_read_b64_tr_b16 v[164:165], v216 offset:128
  v_mfma_f32_16x16x32_bf16 v[208:211], v[196:199], v[128:131], v[208:211]
  s_waitcnt lgkmcnt(7)
  s_add_u32 m0, m0, 32
  ds_read_b64_tr_b16 v[166:167], v216 offset:640
  v_mfma_f32_16x16x32_bf16 a[224:227], v[148:151], v[128:131], a[224:227]
  s_nop 0
  buffer_load_dwordx4 v225, s[20:23], s42 offen offset:1024 nt lds
  ds_read_b64_tr_b16 v[168:169], v216 offset:160
  v_mfma_f32_16x16x32_bf16 v[4:7], v[148:151], v[104:107], v[4:7]
  s_nop 0
  ds_read_b64_tr_b16 v[170:171], v216 offset:672
  ds_read_b64_tr_b16 v[172:173], v216 offset:192
  v_mfma_f32_16x16x32_bf16 v[0:3], v[148:151], v[96:99], v[0:3]
  s_waitcnt lgkmcnt(9)
  ds_read_b64_tr_b16 v[174:175], v216 offset:704
  v_mfma_f32_16x16x32_bf16 v[8:11], v[152:155], v[96:99], v[8:11]
  s_add_u32 m0, m0, 32
  ds_read_b64_tr_b16 v[176:177], v216 offset:224
  v_mfma_f32_16x16x32_bf16 v[12:15], v[152:155], v[104:107], v[12:15]
  s_nop 0
  buffer_load_dwordx4 v225, s[20:23], s42 offen offset:2048 nt lds
  ds_read_b64_tr_b16 v[178:179], v216 offset:736
  v_mfma_f32_16x16x32_bf16 a[228:231], v[152:155], v[128:131], a[228:231]
  s_waitcnt lgkmcnt(8)
  v_exp_f32 v112, v112
  v_mfma_f32_16x16x32_bf16 a[232:235], v[156:159], v[128:131], a[232:235]
  ds_read_b128 v[148:151], v214 offset:0
  v_mfma_f32_16x16x32_bf16 v[20:23], v[156:159], v[104:107], v[20:23]
  s_add_u32 m0, m0, 32
  v_exp_f32 v113, v113
  v_mfma_f32_16x16x32_bf16 v[16:19], v[156:159], v[96:99], v[16:19]
  s_nop 0
  buffer_load_dwordx4 v225, s[20:23], s42 offen offset:3072 nt lds
  ds_read_b128 v[152:155], v214 offset:64
  v_mfma_f32_16x16x32_bf16 v[24:27], v[160:163], v[96:99], v[24:27]
  v_exp_f32 v114, v114
  v_mfma_f32_16x16x32_bf16 v[28:31], v[160:163], v[104:107], v[28:31]
  ds_read_b128 v[156:159], v214 offset:128
  v_mfma_f32_16x16x32_bf16 a[236:239], v[160:163], v[128:131], a[236:239]
  s_waitcnt lgkmcnt(7)
  s_add_u32 s42, s42, s52
  s_add_u32 m0, m0, s53
  v_mfma_f32_16x16x32_bf16 a[240:243], v[164:167], v[128:131], a[240:243]
  s_nop 0
  buffer_load_dwordx4 v225, s[20:23], s42 offen nt lds
  ds_read_b128 v[160:163], v214 offset:192
  v_mfma_f32_16x16x32_bf16 v[36:39], v[164:167], v[104:107], v[36:39]
  v_exp_f32 v115, v115
  v_mfma_f32_16x16x32_bf16 v[32:35], v[164:167], v[96:99], v[32:35]
  v_cvt_pk_bf16_f32 v112, v112, v113
  v_cvt_pk_bf16_f32 v113, v114, v115
  v_mfma_f32_16x16x32_bf16 v[40:43], v[168:171], v[96:99], v[40:43]
  s_add_u32 m0, m0, 32
  v_exp_f32 v120, v120
  v_mfma_f32_16x16x32_bf16 v[44:47], v[168:171], v[104:107], v[44:47]
  s_nop 0
  buffer_load_dwordx4 v225, s[20:23], s42 offen offset:1024 nt lds
  ds_read_b128 v[164:167], v214 offset:512
  v_mfma_f32_16x16x32_bf16 a[244:247], v[168:171], v[128:131], a[244:247]
  s_waitcnt lgkmcnt(5)
  v_exp_f32 v121, v121
  v_mfma_f32_16x16x32_bf16 a[248:251], v[172:175], v[128:131], a[248:251]
  v_exp_f32 v122, v122
  v_mfma_f32_16x16x32_bf16 v[52:55], v[172:175], v[104:107], v[52:55]
  s_add_u32 m0, m0, 32
  v_exp_f32 v123, v123
  v_mfma_f32_16x16x32_bf16 v[48:51], v[172:175], v[96:99], v[48:51]
  ds_read_b128 v[168:171], v214 offset:576
  v_cvt_pk_bf16_f32 v120, v120, v121
  v_mfma_f32_16x16x32_bf16 v[56:59], v[176:179], v[96:99], v[56:59]
  ds_read_b128 v[172:175], v214 offset:640
  v_cvt_pk_bf16_f32 v121, v122, v123
  v_mfma_f32_16x16x32_bf16 v[60:63], v[176:179], v[104:107], v[60:63]
  buffer_load_dwordx4 v225, s[20:23], s42 offen offset:2048 nt lds
  v_mfma_f32_16x16x32_bf16 a[252:255], v[176:179], v[128:131], a[252:255]
  s_waitcnt lgkmcnt(3)
  ds_read_b128 v[176:179], v214 offset:704
  v_mfma_f32_16x16x32_bf16 v[96:99], v[148:151], v[64:67], v[136:139]
  v_exp_f32 v116, v116
  v_mfma_f32_16x16x32_bf16 v[96:99], v[152:155], v[68:71], v[96:99]
  v_exp_f32 v117, v117
  v_mfma_f32_16x16x32_bf16 v[96:99], v[156:159], v[72:75], v[96:99]
  v_exp_f32 v118, v118
  v_mfma_f32_16x16x32_bf16 v[96:99], v[160:163], v[76:79], v[96:99]
  s_add_u32 m0, m0, 32
  v_exp_f32 v119, v119
  v_mfma_f32_16x16x32_bf16 v[104:107], v[148:151], v[80:83], v[140:143]
  buffer_load_dwordx4 v225, s[20:23], s42 offen offset:3072 nt lds
  v_cvt_pk_bf16_f32 v114, v116, v117
  v_mfma_f32_16x16x32_bf16 v[104:107], v[152:155], v[84:87], v[104:107]
  ds_read_b64_tr_b16 v[148:149], v217 offset:0
  v_cvt_pk_bf16_f32 v115, v118, v119
  v_mfma_f32_16x16x32_bf16 v[104:107], v[156:159], v[88:91], v[104:107]
  v_exp_f32 v124, v124
  v_mfma_f32_16x16x32_bf16 v[104:107], v[160:163], v[92:95], v[104:107]
  s_waitcnt lgkmcnt(1)
  ds_read_b64_tr_b16 v[150:151], v217 offset:512
  ds_read_b64_tr_b16 v[152:153], v217 offset:32
  v_mfma_f32_16x16x32_bf16 v[100:103], v[164:167], v[64:67], v[136:139]
  v_exp_f32 v125, v125
  v_mfma_f32_16x16x32_bf16 v[100:103], v[168:171], v[68:71], v[100:103]
  v_exp_f32 v126, v126
  v_mfma_f32_16x16x32_bf16 v[100:103], v[172:175], v[72:75], v[100:103]
  s_nop 0
  ds_read_b64_tr_b16 v[154:155], v217 offset:544
  ds_read_b64_tr_b16 v[156:157], v217 offset:64
  v_mfma_f32_16x16x32_bf16 v[100:103], v[176:179], v[76:79], v[100:103]
  v_exp_f32 v127, v127
  v_mfma_f32_16x16x32_bf16 v[108:111], v[164:167], v[80:83], v[140:143]
  ds_read_b64_tr_b16 v[158:159], v217 offset:576
  v_cvt_pk_bf16_f32 v122, v124, v125
  v_mfma_f32_16x16x32_bf16 v[108:111], v[168:171], v[84:87], v[108:111]
  ds_read_b64_tr_b16 v[160:161], v217 offset:96
  v_cvt_pk_bf16_f32 v123, v126, v127
  v_mfma_f32_16x16x32_bf16 v[108:111], v[172:175], v[88:91], v[108:111]
  s_nop 0
  ds_read_b64_tr_b16 v[162:163], v217 offset:608
  ds_read_b64_tr_b16 v[164:165], v217 offset:128
  v_mfma_f32_16x16x32_bf16 v[108:111], v[176:179], v[92:95], v[108:111]
  s_nop 0
  ds_read_b64_tr_b16 v[166:167], v217 offset:640
  ds_read_b64_tr_b16 v[168:169], v217 offset:160
  v_mfma_f32_16x16x32_bf16 v[200:203], v[196:199], v[112:115], v[200:203]
  s_nop 0
  ds_read_b64_tr_b16 v[170:171], v217 offset:672
  ds_read_b64_tr_b16 v[172:173], v217 offset:192
  v_mfma_f32_16x16x32_bf16 v[204:207], v[196:199], v[120:123], v[204:207]
  s_waitcnt lgkmcnt(9)
  ds_read_b64_tr_b16 v[174:175], v217 offset:704
  ds_read_b64_tr_b16 v[176:177], v217 offset:224
  v_mfma_f32_16x16x32_bf16 v[4:7], v[148:151], v[120:123], v[4:7]
  ds_read_b64_tr_b16 v[178:179], v217 offset:736
  v_mfma_f32_16x16x32_bf16 v[0:3], v[148:151], v[112:115], v[0:3]
  v_exp_f32 v96, v96
  v_mfma_f32_16x16x32_bf16 v[8:11], v[152:155], v[112:115], v[8:11]
  ds_read_b128 v[148:151], v215 offset:0
  v_mfma_f32_16x16x32_bf16 v[12:15], v[152:155], v[120:123], v[12:15]
  s_waitcnt lgkmcnt(9)
  v_exp_f32 v97, v97
  v_mfma_f32_16x16x32_bf16 v[20:23], v[156:159], v[120:123], v[20:23]
  ds_read_b128 v[152:155], v215 offset:64
  v_mfma_f32_16x16x32_bf16 v[16:19], v[156:159], v[112:115], v[16:19]
  v_exp_f32 v98, v98
  v_mfma_f32_16x16x32_bf16 v[24:27], v[160:163], v[112:115], v[24:27]
  ds_read_b128 v[156:159], v215 offset:128
  v_mfma_f32_16x16x32_bf16 v[28:31], v[160:163], v[120:123], v[28:31]
  s_waitcnt lgkmcnt(5)
  v_exp_f32 v99, v99
  v_mfma_f32_16x16x32_bf16 v[36:39], v[164:167], v[120:123], v[36:39]
  ds_read_b128 v[160:163], v215 offset:192
  v_cvt_pk_bf16_f32 v96, v96, v97
  v_mfma_f32_16x16x32_bf16 v[32:35], v[164:167], v[112:115], v[32:35]
  ds_read_b128 v[164:167], v215 offset:512
  v_cvt_pk_bf16_f32 v97, v98, v99
  v_mfma_f32_16x16x32_bf16 v[40:43], v[168:171], v[112:115], v[40:43]
  v_exp_f32 v104, v104
  v_mfma_f32_16x16x32_bf16 v[44:47], v[168:171], v[120:123], v[44:47]
  v_exp_f32 v105, v105
  v_mfma_f32_16x16x32_bf16 v[52:55], v[172:175], v[120:123], v[52:55]
  v_exp_f32 v106, v106
  v_mfma_f32_16x16x32_bf16 v[48:51], v[172:175], v[112:115], v[48:51]
  s_waitcnt lgkmcnt(2)
  v_exp_f32 v107, v107
  v_mfma_f32_16x16x32_bf16 v[56:59], v[176:179], v[112:115], v[56:59]
  ds_read_b128 v[168:171], v215 offset:576
  v_cvt_pk_bf16_f32 v104, v104, v105
  v_mfma_f32_16x16x32_bf16 v[60:63], v[176:179], v[120:123], v[60:63]
  ds_read_b128 v[172:175], v215 offset:640
  v_cvt_pk_bf16_f32 v105, v106, v107
  v_mfma_f32_16x16x32_bf16 v[112:115], v[148:151], v[64:67], v[136:139]
  ds_read_b128 v[176:179], v215 offset:704
  v_mfma_f32_16x16x32_bf16 v[112:115], v[152:155], v[68:71], v[112:115]
  v_exp_f32 v100, v100
  v_mfma_f32_16x16x32_bf16 v[112:115], v[156:159], v[72:75], v[112:115]
  s_waitcnt lgkmcnt(3)
  v_exp_f32 v101, v101
  v_mfma_f32_16x16x32_bf16 v[112:115], v[160:163], v[76:79], v[112:115]
  v_exp_f32 v102, v102
  v_mfma_f32_16x16x32_bf16 v[120:123], v[148:151], v[80:83], v[140:143]
  v_exp_f32 v103, v103
  v_mfma_f32_16x16x32_bf16 v[120:123], v[152:155], v[84:87], v[120:123]
  v_cvt_pk_bf16_f32 v98, v100, v101
  v_cvt_pk_bf16_f32 v99, v102, v103
  v_mfma_f32_16x16x32_bf16 v[120:123], v[156:159], v[88:91], v[120:123]
  v_exp_f32 v108, v108
  v_mfma_f32_16x16x32_bf16 v[120:123], v[160:163], v[92:95], v[120:123]
  s_nop 0
  ds_read_b64_tr_b16 v[148:149], v218 offset:0
  ds_read_b64_tr_b16 v[150:151], v218 offset:512
  v_mfma_f32_16x16x32_bf16 v[116:119], v[164:167], v[64:67], v[136:139]
  s_waitcnt lgkmcnt(2)
  v_exp_f32 v109, v109
  v_mfma_f32_16x16x32_bf16 v[116:119], v[168:171], v[68:71], v[116:119]
  v_exp_f32 v110, v110
  v_mfma_f32_16x16x32_bf16 v[116:119], v[172:175], v[72:75], v[116:119]
  s_nop 0
  ds_read_b64_tr_b16 v[152:153], v218 offset:32
  ds_read_b64_tr_b16 v[154:155], v218 offset:544
  v_mfma_f32_16x16x32_bf16 v[116:119], v[176:179], v[76:79], v[116:119]
  v_exp_f32 v111, v111
  v_mfma_f32_16x16x32_bf16 v[124:127], v[164:167], v[80:83], v[140:143]
  ds_read_b64_tr_b16 v[156:157], v218 offset:64
  v_cvt_pk_bf16_f32 v106, v108, v109
  v_mfma_f32_16x16x32_bf16 v[124:127], v[168:171], v[84:87], v[124:127]
  ds_read_b64_tr_b16 v[158:159], v218 offset:576
  v_cvt_pk_bf16_f32 v107, v110, v111
  v_mfma_f32_16x16x32_bf16 v[124:127], v[172:175], v[88:91], v[124:127]
  s_nop 0
  ds_read_b64_tr_b16 v[160:161], v218 offset:96
  ds_read_b64_tr_b16 v[162:163], v218 offset:608
  v_mfma_f32_16x16x32_bf16 v[124:127], v[176:179], v[92:95], v[124:127]
  s_nop 0
  ds_read_b64_tr_b16 v[164:165], v218 offset:128
  ds_read_b64_tr_b16 v[166:167], v218 offset:640
  v_mfma_f32_16x16x32_bf16 v[200:203], v[196:199], v[96:99], v[200:203]
  s_nop 0
  ds_read_b64_tr_b16 v[168:169], v218 offset:160
  ds_read_b64_tr_b16 v[170:171], v218 offset:672
  v_mfma_f32_16x16x32_bf16 v[204:207], v[196:199], v[104:107], v[204:207]
  s_waitcnt lgkmcnt(8)
  ds_read_b64_tr_b16 v[172:173], v218 offset:192
  ds_read_b64_tr_b16 v[174:175], v218 offset:704
  v_mfma_f32_16x16x32_bf16 v[4:7], v[148:151], v[104:107], v[4:7]
  s_nop 0
  ds_read_b64_tr_b16 v[176:177], v218 offset:224
  ds_read_b64_tr_b16 v[178:179], v218 offset:736
  v_mfma_f32_16x16x32_bf16 v[0:3], v[148:151], v[96:99], v[0:3]
  s_waitcnt vmcnt(8)
  s_barrier
  ds_read_b128 v[148:151], v212 offset:34816
  v_mfma_f32_16x16x32_bf16 v[8:11], v[152:155], v[96:99], v[8:11]
  s_add_u32 s42, s45, 0
  s_mov_b32 m0, s37
  v_mfma_f32_16x16x32_bf16 v[12:15], v[152:155], v[104:107], v[12:15]
  s_waitcnt lgkmcnt(9)
  ds_read_b128 v[152:155], v212 offset:34880
  buffer_load_dwordx4 v226, s[32:35], s42 offen nt lds
  v_mfma_f32_16x16x32_bf16 v[20:23], v[156:159], v[104:107], v[20:23]
  v_exp_f32 v112, v112
  v_mfma_f32_16x16x32_bf16 v[16:19], v[156:159], v[96:99], v[16:19]
  ds_read_b128 v[156:159], v212 offset:34944
  v_mfma_f32_16x16x32_bf16 v[24:27], v[160:163], v[96:99], v[24:27]
  s_add_u32 m0, m0, 32
  v_exp_f32 v113, v113
  v_mfma_f32_16x16x32_bf16 v[28:31], v[160:163], v[104:107], v[28:31]
  s_waitcnt lgkmcnt(5)
  ds_read_b128 v[160:163], v212 offset:35008
  v_mfma_f32_16x16x32_bf16 v[36:39], v[164:167], v[104:107], v[36:39]
  v_exp_f32 v114, v114
  v_mfma_f32_16x16x32_bf16 v[32:35], v[164:167], v[96:99], v[32:35]
  buffer_load_dwordx4 v226, s[32:35], s42 offen offset:1024 nt lds
  v_mfma_f32_16x16x32_bf16 v[40:43], v[168:171], v[96:99], v[40:43]
  v_exp_f32 v115, v115
  v_mfma_f32_16x16x32_bf16 v[44:47], v[168:171], v[104:107], v[44:47]
  ds_read_b128 v[164:167], v212 offset:35328
  v_cvt_pk_bf16_f32 v112, v112, v113
  v_mfma_f32_16x16x32_bf16 v[52:55], v[172:175], v[104:107], v[52:55]
  s_add_u32 m0, m0, 32
  ds_read_b128 v[168:171], v212 offset:35392
  v_cvt_pk_bf16_f32 v113, v114, v115
  v_mfma_f32_16x16x32_bf16 v[48:51], v[172:175], v[96:99], v[48:51]
  s_waitcnt lgkmcnt(3)
  v_exp_f32 v120, v120
  v_mfma_f32_16x16x32_bf16 v[56:59], v[176:179], v[96:99], v[56:59]
  s_nop 0
  ds_read_b128 v[172:175], v212 offset:35456
  buffer_load_dwordx4 v226, s[32:35], s42 offen offset:2048 nt lds
  v_mfma_f32_16x16x32_bf16 v[60:63], v[176:179], v[104:107], v[60:63]
  v_exp_f32 v121, v121
  v_mfma_f32_16x16x32_bf16 v[96:99], v[148:151], v[64:67], v[136:139]
  ds_read_b128 v[176:179], v212 offset:35520
  v_mfma_f32_16x16x32_bf16 v[96:99], v[152:155], v[68:71], v[96:99]
  v_exp_f32 v122, v122
  v_mfma_f32_16x16x32_bf16 v[96:99], v[156:159], v[72:75], v[96:99]
  s_waitcnt lgkmcnt(4)
  v_exp_f32 v123, v123
  v_mfma_f32_16x16x32_bf16 v[96:99], v[160:163], v[76:79], v[96:99]
  s_add_u32 m0, m0, 32
  v_cvt_pk_bf16_f32 v120, v120, v121
  v_cvt_pk_bf16_f32 v121, v122, v123
  v_mfma_f32_16x16x32_bf16 v[104:107], v[148:151], v[80:83], v[140:143]
  v_exp_f32 v116, v116
  v_mfma_f32_16x16x32_bf16 v[104:107], v[152:155], v[84:87], v[104:107]
  buffer_load_dwordx4 v226, s[32:35], s42 offen offset:3072 nt lds
  v_mfma_f32_16x16x32_bf16 v[104:107], v[156:159], v[88:91], v[104:107]
  v_exp_f32 v117, v117
  v_mfma_f32_16x16x32_bf16 v[104:107], v[160:163], v[92:95], v[104:107]
  v_exp_f32 v118, v118
  v_mfma_f32_16x16x32_bf16 v[128:131], v[148:151], v[180:183], v[144:147]
  s_add_u32 s42, s42, s52
  v_exp_f32 v119, v119
  v_mfma_f32_16x16x32_bf16 v[128:131], v[152:155], v[184:187], v[128:131]
  s_add_u32 m0, m0, s53
  v_cvt_pk_bf16_f32 v114, v116, v117
  v_cvt_pk_bf16_f32 v115, v118, v119
  v_mfma_f32_16x16x32_bf16 v[128:131], v[156:159], v[188:191], v[128:131]
  s_nop 0
  buffer_load_dwordx4 v226, s[32:35], s42 offen nt lds
  ds_read_b64_tr_b16 v[148:149], v219 offset:0
  v_mfma_f32_16x16x32_bf16 v[128:131], v[160:163], v[192:195], v[128:131]
  s_waitcnt lgkmcnt(1)
  v_exp_f32 v124, v124
  v_mfma_f32_16x16x32_bf16 v[100:103], v[164:167], v[64:67], v[136:139]
  s_nop 0
  ds_read_b64_tr_b16 v[150:151], v219 offset:512
  ds_read_b64_tr_b16 v[152:153], v219 offset:32
  v_mfma_f32_16x16x32_bf16 v[100:103], v[168:171], v[68:71], v[100:103]
  v_exp_f32 v125, v125
  v_mfma_f32_16x16x32_bf16 v[100:103], v[172:175], v[72:75], v[100:103]
  v_exp_f32 v126, v126
  v_mfma_f32_16x16x32_bf16 v[100:103], v[176:179], v[76:79], v[100:103]
  s_add_u32 m0, m0, 32
  ds_read_b64_tr_b16 v[154:155], v219 offset:544
  ds_read_b64_tr_b16 v[156:157], v219 offset:64
  v_mfma_f32_16x16x32_bf16 v[108:111], v[164:167], v[80:83], v[140:143]
  v_exp_f32 v127, v127
  v_mfma_f32_16x16x32_bf16 v[108:111], v[168:171], v[84:87], v[108:111]
  buffer_load_dwordx4 v226, s[32:35], s42 offen offset:1024 nt lds
  v_cvt_pk_bf16_f32 v122, v124, v125
  v_mfma_f32_16x16x32_bf16 v[108:111], v[172:175], v[88:91], v[108:111]
  ds_read_b64_tr_b16 v[158:159], v219 offset:576
  v_cvt_pk_bf16_f32 v123, v126, v127
  v_mfma_f32_16x16x32_bf16 v[108:111], v[176:179], v[92:95], v[108:111]
  v_exp_f32 v96, v96
  v_mfma_f32_16x16x32_bf16 v[132:135], v[164:167], v[180:183], v[144:147]
  s_add_u32 m0, m0, 32
  v_exp_f32 v97, v97
  v_mfma_f32_16x16x32_bf16 v[132:135], v[168:171], v[184:187], v[132:135]
  v_exp_f32 v98, v98
  v_mfma_f32_16x16x32_bf16 v[132:135], v[172:175], v[188:191], v[132:135]
  s_nop 0
  ds_read_b64_tr_b16 v[160:161], v219 offset:96
  ds_read_b64_tr_b16 v[162:163], v219 offset:608
  v_mfma_f32_16x16x32_bf16 v[132:135], v[176:179], v[192:195], v[132:135]
  v_exp_f32 v99, v99
  v_mfma_f32_16x16x32_bf16 v[200:203], v[196:199], v[112:115], v[200:203]
  ds_read_b64_tr_b16 v[164:165], v219 offset:128
  v_cvt_pk_bf16_f32 v96, v96, v97
  v_mfma_f32_16x16x32_bf16 v[204:207], v[196:199], v[120:123], v[204:207]
  s_waitcnt lgkmcnt(3)
  ds_read_b64_tr_b16 v[166:167], v219 offset:640
  v_cvt_pk_bf16_f32 v97, v98, v99
  v_mfma_f32_16x16x32_bf16 v[4:7], v[148:151], v[120:123], v[4:7]
  s_nop 0
  buffer_load_dwordx4 v226, s[32:35], s42 offen offset:2048 nt lds
  ds_read_b64_tr_b16 v[168:169], v219 offset:160
  v_mfma_f32_16x16x32_bf16 v[0:3], v[148:151], v[112:115], v[0:3]
  v_exp_f32 v104, v104
  v_mfma_f32_16x16x32_bf16 v[8:11], v[152:155], v[112:115], v[8:11]
  s_nop 0
  ds_read_b64_tr_b16 v[170:171], v219 offset:672
  ds_read_b64_tr_b16 v[172:173], v219 offset:192
  v_mfma_f32_16x16x32_bf16 v[12:15], v[152:155], v[120:123], v[12:15]
  v_exp_f32 v105, v105
  v_mfma_f32_16x16x32_bf16 v[20:23], v[156:159], v[120:123], v[20:23]
  s_add_u32 m0, m0, 32
  ds_read_b64_tr_b16 v[174:175], v219 offset:704
  ds_read_b64_tr_b16 v[176:177], v219 offset:224
  v_mfma_f32_16x16x32_bf16 v[16:19], v[156:159], v[112:115], v[16:19]
  s_waitcnt lgkmcnt(7)
  v_exp_f32 v106, v106
  v_mfma_f32_16x16x32_bf16 v[24:27], v[160:163], v[112:115], v[24:27]
  s_nop 0
  buffer_load_dwordx4 v226, s[32:35], s42 offen offset:3072 nt lds
  ds_read_b64_tr_b16 v[178:179], v219 offset:736
  v_mfma_f32_16x16x32_bf16 v[28:31], v[160:163], v[120:123], v[28:31]
  s_waitcnt lgkmcnt(6)
  v_exp_f32 v107, v107
  v_mfma_f32_16x16x32_bf16 v[36:39], v[164:167], v[120:123], v[36:39]
  ds_read_b128 v[148:151], v213 offset:34816
  v_cvt_pk_bf16_f32 v104, v104, v105
  v_mfma_f32_16x16x32_bf16 v[32:35], v[164:167], v[112:115], v[32:35]
  s_waitcnt lgkmcnt(5)
  ds_read_b128 v[152:155], v213 offset:34880
  v_cvt_pk_bf16_f32 v105, v106, v107
  v_mfma_f32_16x16x32_bf16 v[40:43], v[168:171], v[112:115], v[40:43]
  s_nop 0
  ds_read_b128 v[156:159], v213 offset:34944
  ds_read_b128 v[160:163], v213 offset:35008
  v_mfma_f32_16x16x32_bf16 v[44:47], v[168:171], v[120:123], v[44:47]
  s_waitcnt lgkmcnt(6)
  v_exp_f32 v128, v128
  v_mfma_f32_16x16x32_bf16 v[52:55], v[172:175], v[120:123], v[52:55]
  v_exp_f32 v129, v129
  v_mfma_f32_16x16x32_bf16 v[48:51], v[172:175], v[112:115], v[48:51]
  s_waitcnt lgkmcnt(4)
  v_exp_f32 v130, v130
  v_mfma_f32_16x16x32_bf16 v[56:59], v[176:179], v[112:115], v[56:59]
  v_exp_f32 v131, v131
  v_mfma_f32_16x16x32_bf16 v[60:63], v[176:179], v[120:123], v[60:63]
  s_waitcnt lgkmcnt(3)
  v_cvt_pk_bf16_f32 v128, v128, v129
  v_cvt_pk_bf16_f32 v129, v130, v131
  v_mfma_f32_16x16x32_bf16 v[112:115], v[148:151], v[64:67], v[136:139]
  s_waitcnt lgkmcnt(2)
  ds_read_b128 v[164:167], v213 offset:35328
  ds_read_b128 v[168:171], v213 offset:35392
  v_mfma_f32_16x16x32_bf16 v[112:115], v[152:155], v[68:71], v[112:115]
  s_waitcnt lgkmcnt(2)
  v_exp_f32 v100, v100
  v_mfma_f32_16x16x32_bf16 v[112:115], v[156:159], v[72:75], v[112:115]
  s_nop 0
  ds_read_b128 v[172:175], v213 offset:35456
  ds_read_b128 v[176:179], v213 offset:35520
  v_mfma_f32_16x16x32_bf16 v[112:115], v[160:163], v[76:79], v[112:115]
  v_exp_f32 v101, v101
  v_mfma_f32_16x16x32_bf16 v[120:123], v[148:151], v[80:83], v[140:143]
  v_exp_f32 v102, v102
  v_mfma_f32_16x16x32_bf16 v[120:123], v[152:155], v[84:87], v[120:123]
  v_exp_f32 v103, v103
  v_mfma_f32_16x16x32_bf16 v[120:123], v[156:159], v[88:91], v[120:123]
  v_cvt_pk_bf16_f32 v98, v100, v101
  v_cvt_pk_bf16_f32 v99, v102, v103
  v_mfma_f32_16x16x32_bf16 v[120:123], v[160:163], v[92:95], v[120:123]
  s_waitcnt lgkmcnt(2)
  v_exp_f32 v108, v108
  v_mfma_f32_16x16x32_bf16 v[116:119], v[164:167], v[64:67], v[136:139]
  v_exp_f32 v109, v109
  v_mfma_f32_16x16x32_bf16 v[116:119], v[168:171], v[68:71], v[116:119]
  s_waitcnt lgkmcnt(0)
  v_exp_f32 v110, v110
  v_mfma_f32_16x16x32_bf16 v[116:119], v[172:175], v[72:75], v[116:119]
  s_waitcnt vmcnt(8)
  s_barrier
  ds_read_b64_tr_b16 v[148:149], v216 offset:34816
  v_mfma_f32_16x16x32_bf16 v[116:119], v[176:179], v[76:79], v[116:119]
  s_nop 0
  ds_read_b64_tr_b16 v[150:151], v216 offset:35328
  ds_read_b64_tr_b16 v[152:153], v216 offset:34848
  v_mfma_f32_16x16x32_bf16 v[124:127], v[164:167], v[80:83], v[140:143]
  v_exp_f32 v111, v111
  v_mfma_f32_16x16x32_bf16 v[124:127], v[168:171], v[84:87], v[124:127]
  v_cvt_pk_bf16_f32 v106, v108, v109
  v_cvt_pk_bf16_f32 v107, v110, v111
  v_mfma_f32_16x16x32_bf16 v[124:127], v[172:175], v[88:91], v[124:127]
  ds_read_b64_tr_b16 v[154:155], v216 offset:35360
  v_exp_f32 v132, v132
  v_exp_f32 v133, v133
  v_exp_f32 v134, v134
  v_exp_f32 v135, v135
  v_cvt_pk_bf16_f32 v130, v132, v133
  v_cvt_pk_bf16_f32 v131, v134, v135
  v_mfma_f32_16x16x32_bf16 v[124:127], v[176:179], v[92:95], v[124:127]
  s_nop 0
  ds_read_b64_tr_b16 v[156:157], v216 offset:34880
  ds_read_b64_tr_b16 v[158:159], v216 offset:35392
  v_mfma_f32_16x16x32_bf16 v[200:203], v[196:199], v[96:99], v[200:203]
  s_nop 0
  ds_read_b64_tr_b16 v[160:161], v216 offset:34912
  ds_read_b64_tr_b16 v[162:163], v216 offset:35424
  v_mfma_f32_16x16x32_bf16 v[204:207], v[196:199], v[104:107], v[204:207]
  s_nop 0
  ds_read_b64_tr_b16 v[164:165], v216 offset:34944
  ds_read_b64_tr_b16 v[166:167], v216 offset:35456
  v_mfma_f32_16x16x32_bf16 v[208:211], v[196:199], v[128:131], v[208:211]
  s_waitcnt lgkmcnt(8)
  ds_read_b64_tr_b16 v[168:169], v216 offset:34976
  ds_read_b64_tr_b16 v[170:171], v216 offset:35488
  v_mfma_f32_16x16x32_bf16 a[224:227], v[148:151], v[128:131], a[224:227]
  ds_read_b64_tr_b16 v[172:173], v216 offset:35008
  v_mfma_f32_16x16x32_bf16 v[4:7], v[148:151], v[104:107], v[4:7]
  ds_read_b64_tr_b16 v[174:175], v216 offset:35520
  v_mfma_f32_16x16x32_bf16 v[0:3], v[148:151], v[96:99], v[0:3]
  s_waitcnt lgkmcnt(10)
  ds_read_b64_tr_b16 v[176:177], v216 offset:35040
  v_mfma_f32_16x16x32_bf16 v[8:11], v[152:155], v[96:99], v[8:11]
  ds_read_b64_tr_b16 v[178:179], v216 offset:35552
  v_mfma_f32_16x16x32_bf16 v[12:15], v[152:155], v[104:107], v[12:15]
  v_exp_f32 v112, v112
  v_mfma_f32_16x16x32_bf16 a[228:231], v[152:155], v[128:131], a[228:231]
  s_waitcnt lgkmcnt(8)
  ds_read_b128 v[148:151], v214 offset:34816
  v_mfma_f32_16x16x32_bf16 a[232:235], v[156:159], v[128:131], a[232:235]
  v_exp_f32 v113, v113
  v_mfma_f32_16x16x32_bf16 v[20:23], v[156:159], v[104:107], v[20:23]
  ds_read_b128 v[152:155], v214 offset:34880
  v_mfma_f32_16x16x32_bf16 v[16:19], v[156:159], v[96:99], v[16:19]
  v_exp_f32 v114, v114
  v_mfma_f32_16x16x32_bf16 v[24:27], v[160:163], v[96:99], v[24:27]
  ds_read_b128 v[156:159], v214 offset:34944
  v_mfma_f32_16x16x32_bf16 v[28:31], v[160:163], v[104:107], v[28:31]
  v_exp_f32 v115, v115
  v_mfma_f32_16x16x32_bf16 a[236:239], v[160:163], v[128:131], a[236:239]
  s_waitcnt lgkmcnt(7)
  ds_read_b128 v[160:163], v214 offset:35008
  v_cvt_pk_bf16_f32 v112, v112, v113
  v_mfma_f32_16x16x32_bf16 a[240:243], v[164:167], v[128:131], a[240:243]
  ds_write_b32 v231, v208
  v_cvt_pk_bf16_f32 v113, v114, v115
  v_mfma_f32_16x16x32_bf16 v[36:39], v[164:167], v[104:107], v[36:39]
  v_exp_f32 v120, v120
  v_mfma_f32_16x16x32_bf16 v[32:35], v[164:167], v[96:99], v[32:35]
  v_exp_f32 v121, v121
  v_mfma_f32_16x16x32_bf16 v[40:43], v[168:171], v[96:99], v[40:43]
  v_exp_f32 v122, v122
  v_mfma_f32_16x16x32_bf16 v[44:47], v[168:171], v[104:107], v[44:47]
  ds_read_b128 v[164:167], v214 offset:35328
  v_mfma_f32_16x16x32_bf16 a[244:247], v[168:171], v[128:131], a[244:247]
  s_waitcnt lgkmcnt(6)
  v_exp_f32 v123, v123
  v_mfma_f32_16x16x32_bf16 a[248:251], v[172:175], v[128:131], a[248:251]
  ds_read_b128 v[168:171], v214 offset:35392
  v_cvt_pk_bf16_f32 v120, v120, v121
  v_mfma_f32_16x16x32_bf16 v[52:55], v[172:175], v[104:107], v[52:55]
  ds_write_b128 v249, a[224:227] offset:0
  v_mfma_f32_16x16x32_bf16 v[48:51], v[172:175], v[96:99], v[48:51]
  ds_read_b128 v[172:175], v214 offset:35456
  v_cvt_pk_bf16_f32 v121, v122, v123
  v_mfma_f32_16x16x32_bf16 v[56:59], v[176:179], v[96:99], v[56:59]
  v_exp_f32 v116, v116
  v_mfma_f32_16x16x32_bf16 v[60:63], v[176:179], v[104:107], v[60:63]
  v_exp_f32 v117, v117
  v_mfma_f32_16x16x32_bf16 a[252:255], v[176:179], v[128:131], a[252:255]
  s_waitcnt lgkmcnt(5)
  ds_read_b128 v[176:179], v214 offset:35520
  v_mfma_f32_16x16x32_bf16 v[96:99], v[148:151], v[64:67], v[136:139]
  v_exp_f32 v118, v118
  v_mfma_f32_16x16x32_bf16 v[96:99], v[152:155], v[68:71], v[96:99]
  ds_write_b128 v249, a[228:231] offset:1024
  v_mfma_f32_16x16x32_bf16 v[96:99], v[156:159], v[72:75], v[96:99]
  v_exp_f32 v119, v119
  v_mfma_f32_16x16x32_bf16 v[96:99], v[160:163], v[76:79], v[96:99]
  v_cvt_pk_bf16_f32 v114, v116, v117
  v_cvt_pk_bf16_f32 v115, v118, v119
  v_mfma_f32_16x16x32_bf16 v[104:107], v[148:151], v[80:83], v[140:143]
  v_exp_f32 v124, v124
  v_mfma_f32_16x16x32_bf16 v[104:107], v[152:155], v[84:87], v[104:107]
  ds_write_b128 v249, a[232:235] offset:2048
  v_mfma_f32_16x16x32_bf16 v[104:107], v[156:159], v[88:91], v[104:107]
  s_nop 0
  ds_read_b64_tr_b16 v[148:149], v217 offset:34816
  ds_read_b64_tr_b16 v[150:151], v217 offset:35328
  v_mfma_f32_16x16x32_bf16 v[104:107], v[160:163], v[92:95], v[104:107]
  s_waitcnt lgkmcnt(4)
  v_exp_f32 v125, v125
  v_mfma_f32_16x16x32_bf16 v[100:103], v[164:167], v[64:67], v[136:139]
  v_exp_f32 v126, v126
  v_mfma_f32_16x16x32_bf16 v[100:103], v[168:171], v[68:71], v[100:103]
  s_nop 0
  ds_read_b64_tr_b16 v[152:153], v217 offset:34848
  ds_read_b64_tr_b16 v[154:155], v217 offset:35360
  v_mfma_f32_16x16x32_bf16 v[100:103], v[172:175], v[72:75], v[100:103]
  v_exp_f32 v127, v127
  v_mfma_f32_16x16x32_bf16 v[100:103], v[176:179], v[76:79], v[100:103]
  ds_read_b64_tr_b16 v[156:157], v217 offset:34880
  v_cvt_pk_bf16_f32 v122, v124, v125
  v_mfma_f32_16x16x32_bf16 v[108:111], v[164:167], v[80:83], v[140:143]
  ds_write_b128 v249, a[236:239] offset:3072
  v_mfma_f32_16x16x32_bf16 v[108:111], v[168:171], v[84:87], v[108:111]
  ds_read_b64_tr_b16 v[158:159], v217 offset:35392
  v_cvt_pk_bf16_f32 v123, v126, v127
  v_mfma_f32_16x16x32_bf16 v[108:111], v[172:175], v[88:91], v[108:111]
  s_nop 0
  ds_read_b64_tr_b16 v[160:161], v217 offset:34912
  ds_read_b64_tr_b16 v[162:163], v217 offset:35424
  v_mfma_f32_16x16x32_bf16 v[108:111], v[176:179], v[92:95], v[108:111]
  ds_write_b128 v249, a[240:243] offset:4096
  v_mfma_f32_16x16x32_bf16 v[200:203], v[196:199], v[112:115], v[200:203]
  s_nop 0
  ds_read_b64_tr_b16 v[164:165], v217 offset:34944
  ds_read_b64_tr_b16 v[166:167], v217 offset:35456
  v_mfma_f32_16x16x32_bf16 v[204:207], v[196:199], v[120:123], v[204:207]
  s_waitcnt lgkmcnt(8)
  ds_read_b64_tr_b16 v[168:169], v217 offset:34976
  ds_read_b64_tr_b16 v[170:171], v217 offset:35488
  v_mfma_f32_16x16x32_bf16 v[4:7], v[148:151], v[120:123], v[4:7]
  ds_write_b128 v249, a[244:247] offset:5120
  v_mfma_f32_16x16x32_bf16 v[0:3], v[148:151], v[112:115], v[0:3]
  s_nop 0
  ds_read_b64_tr_b16 v[172:173], v217 offset:35008
  ds_read_b64_tr_b16 v[174:175], v217 offset:35520
  v_mfma_f32_16x16x32_bf16 v[8:11], v[152:155], v[112:115], v[8:11]
  s_nop 0
  ds_read_b64_tr_b16 v[176:177], v217 offset:35040
  ds_read_b64_tr_b16 v[178:179], v217 offset:35552
  v_mfma_f32_16x16x32_bf16 v[12:15], v[152:155], v[120:123], v[12:15]
  s_waitcnt lgkmcnt(10)
  v_exp_f32 v96, v96
  v_mfma_f32_16x16x32_bf16 v[20:23], v[156:159], v[120:123], v[20:23]
  ds_write_b128 v249, a[248:251] offset:6144
  v_mfma_f32_16x16x32_bf16 v[16:19], v[156:159], v[112:115], v[16:19]
  s_nop 0
  ds_read_b128 v[148:151], v215 offset:34816
  ds_read_b128 v[152:155], v215 offset:34880
  v_mfma_f32_16x16x32_bf16 v[24:27], v[160:163], v[112:115], v[24:27]
  v_exp_f32 v97, v97
  v_mfma_f32_16x16x32_bf16 v[28:31], v[160:163], v[120:123], v[28:31]
  s_waitcnt lgkmcnt(8)
  v_exp_f32 v98, v98
  v_mfma_f32_16x16x32_bf16 v[36:39], v[164:167], v[120:123], v[36:39]
  s_nop 0
  ds_read_b128 v[156:159], v215 offset:34944
  ds_read_b128 v[160:163], v215 offset:35008
  v_mfma_f32_16x16x32_bf16 v[32:35], v[164:167], v[112:115], v[32:35]
  v_exp_f32 v99, v99
  v_mfma_f32_16x16x32_bf16 v[40:43], v[168:171], v[112:115], v[40:43]
  v_cvt_pk_bf16_f32 v96, v96, v97
  v_cvt_pk_bf16_f32 v97, v98, v99
  v_mfma_f32_16x16x32_bf16 v[44:47], v[168:171], v[120:123], v[44:47]
  s_waitcnt lgkmcnt(5)
  ds_write_b128 v249, a[252:255] offset:7168
  v_mfma_f32_16x16x32_bf16 v[52:55], v[172:175], v[120:123], v[52:55]
  v_exp_f32 v104, v104
  v_mfma_f32_16x16x32_bf16 v[48:51], v[172:175], v[112:115], v[48:51]
  v_exp_f32 v105, v105
  v_mfma_f32_16x16x32_bf16 v[56:59], v[176:179], v[112:115], v[56:59]
  v_exp_f32 v106, v106
  v_mfma_f32_16x16x32_bf16 v[60:63], v[176:179], v[120:123], v[60:63]
  s_waitcnt lgkmcnt(1)
  ds_read_b128 v[164:167], v215 offset:35328
  ds_read_b128 v[168:171], v215 offset:35392
  v_mfma_f32_16x16x32_bf16 v[112:115], v[148:151], v[64:67], v[136:139]
  v_exp_f32 v107, v107
  v_mfma_f32_16x16x32_bf16 v[112:115], v[152:155], v[68:71], v[112:115]
  ds_read_b128 v[172:175], v215 offset:35456
  v_cvt_pk_bf16_f32 v104, v104, v105
  v_mfma_f32_16x16x32_bf16 v[112:115], v[156:159], v[72:75], v[112:115]
  ds_read_b128 v[176:179], v215 offset:35520
  v_cvt_pk_bf16_f32 v105, v106, v107
  v_mfma_f32_16x16x32_bf16 v[112:115], v[160:163], v[76:79], v[112:115]
  v_exp_f32 v100, v100
  v_mfma_f32_16x16x32_bf16 v[120:123], v[148:151], v[80:83], v[140:143]
  v_exp_f32 v101, v101
  v_mfma_f32_16x16x32_bf16 v[120:123], v[152:155], v[84:87], v[120:123]
  v_exp_f32 v102, v102
  v_mfma_f32_16x16x32_bf16 v[120:123], v[156:159], v[88:91], v[120:123]
  v_exp_f32 v103, v103
  v_mfma_f32_16x16x32_bf16 v[120:123], v[160:163], v[92:95], v[120:123]
  s_waitcnt lgkmcnt(2)
  v_cvt_pk_bf16_f32 v98, v100, v101
  v_cvt_pk_bf16_f32 v99, v102, v103
  v_mfma_f32_16x16x32_bf16 v[116:119], v[164:167], v[64:67], v[136:139]
  v_exp_f32 v108, v108
  v_mfma_f32_16x16x32_bf16 v[116:119], v[168:171], v[68:71], v[116:119]
  s_waitcnt lgkmcnt(0)
  ds_read_b64_tr_b16 v[148:149], v218 offset:34816
  ds_read_b64_tr_b16 v[150:151], v218 offset:35328
  v_mfma_f32_16x16x32_bf16 v[116:119], v[172:175], v[72:75], v[116:119]
  v_exp_f32 v109, v109
  v_mfma_f32_16x16x32_bf16 v[116:119], v[176:179], v[76:79], v[116:119]
  v_exp_f32 v110, v110
  v_mfma_f32_16x16x32_bf16 v[124:127], v[164:167], v[80:83], v[140:143]
  s_nop 0
  ds_read_b64_tr_b16 v[152:153], v218 offset:34848
  ds_read_b64_tr_b16 v[154:155], v218 offset:35360
  v_mfma_f32_16x16x32_bf16 v[124:127], v[168:171], v[84:87], v[124:127]
  v_exp_f32 v111, v111
  v_mfma_f32_16x16x32_bf16 v[124:127], v[172:175], v[88:91], v[124:127]
  s_nop 0
  ds_read_b64_tr_b16 v[156:157], v218 offset:34880
  ds_read_b64_tr_b16 v[158:159], v218 offset:35392
  v_cvt_pk_bf16_f32 v106, v108, v109
  v_cvt_pk_bf16_f32 v107, v110, v111
  v_mfma_f32_16x16x32_bf16 v[124:127], v[176:179], v[92:95], v[124:127]
  v_exp_f32 v112, v112
  v_mfma_f32_16x16x32_bf16 v[200:203], v[196:199], v[96:99], v[200:203]
  s_barrier
  ds_read_b64_tr_b16 v[160:161], v218 offset:34912
  ds_read_b64_tr_b16 v[162:163], v218 offset:35424
  v_mfma_f32_16x16x32_bf16 v[204:207], v[196:199], v[104:107], v[204:207]
  s_waitcnt lgkmcnt(6)
  v_exp_f32 v113, v113
  v_mfma_f32_16x16x32_bf16 v[4:7], v[148:151], v[104:107], v[4:7]
  s_mov_b32 s42, s46
  ds_read_b64_tr_b16 v[164:165], v218 offset:34944
  ds_read_b64_tr_b16 v[166:167], v218 offset:35456
  v_mfma_f32_16x16x32_bf16 v[0:3], v[148:151], v[96:99], v[0:3]
  s_waitcnt lgkmcnt(6)
  v_exp_f32 v114, v114
  v_mfma_f32_16x16x32_bf16 v[8:11], v[152:155], v[96:99], v[8:11]
  s_mov_b32 m0, s39
  ds_read_b64_tr_b16 v[168:169], v218 offset:34976
  ds_read_b64_tr_b16 v[170:171], v218 offset:35488
  v_mfma_f32_16x16x32_bf16 v[12:15], v[152:155], v[104:107], v[12:15]
  s_waitcnt lgkmcnt(6)
  v_exp_f32 v115, v115
  v_mfma_f32_16x16x32_bf16 v[20:23], v[156:159], v[104:107], v[20:23]
  s_nop 0
  ds_read_b64_tr_b16 v[172:173], v218 offset:35008
  ds_read_b64_tr_b16 v[174:175], v218 offset:35520
  v_mfma_f32_16x16x32_bf16 v[16:19], v[156:159], v[96:99], v[16:19]
  s_waitcnt lgkmcnt(6)
  v_cvt_pk_bf16_f32 v112, v112, v113
  v_cvt_pk_bf16_f32 v113, v114, v115
  v_mfma_f32_16x16x32_bf16 v[24:27], v[160:163], v[96:99], v[24:27]
  s_nop 0
  ds_read_b64_tr_b16 v[176:177], v218 offset:35040
  ds_read_b64_tr_b16 v[178:179], v218 offset:35552
  v_mfma_f32_16x16x32_bf16 v[28:31], v[160:163], v[104:107], v[28:31]
  s_waitcnt lgkmcnt(6)
  v_exp_f32 v120, v120
  v_mfma_f32_16x16x32_bf16 v[36:39], v[164:167], v[104:107], v[36:39]
  v_exp_f32 v121, v121
  v_mfma_f32_16x16x32_bf16 v[32:35], v[164:167], v[96:99], v[32:35]
  s_waitcnt lgkmcnt(4)
  v_exp_f32 v122, v122
  v_mfma_f32_16x16x32_bf16 v[40:43], v[168:171], v[96:99], v[40:43]
  s_nop 0
  ds_read_b64_tr_b16 v[148:149], v219 offset:34816
  ds_read_b64_tr_b16 v[150:151], v219 offset:35328
  v_mfma_f32_16x16x32_bf16 v[44:47], v[168:171], v[104:107], v[44:47]
  s_waitcnt lgkmcnt(4)
  v_exp_f32 v123, v123
  v_mfma_f32_16x16x32_bf16 v[52:55], v[172:175], v[104:107], v[52:55]
  s_nop 0
  ds_read_b64_tr_b16 v[152:153], v219 offset:34848
  ds_read_b64_tr_b16 v[154:155], v219 offset:35360
  v_mfma_f32_16x16x32_bf16 v[48:51], v[172:175], v[96:99], v[48:51]
  s_waitcnt lgkmcnt(4)
  buffer_load_dwordx4 v227, s[12:15], s42 offen lds
  v_cvt_pk_bf16_f32 v120, v120, v121
  v_mfma_f32_16x16x32_bf16 v[56:59], v[176:179], v[96:99], v[56:59]
  s_nop 0
  ds_read_b64_tr_b16 v[156:157], v219 offset:34880
  ds_read_b64_tr_b16 v[158:159], v219 offset:35392
  v_cvt_pk_bf16_f32 v121, v122, v123
  v_exp_f32 v116, v116
  v_exp_f32 v117, v117
  v_exp_f32 v118, v118
  v_exp_f32 v119, v119
  v_cvt_pk_bf16_f32 v114, v116, v117
  v_cvt_pk_bf16_f32 v115, v118, v119
  v_exp_f32 v124, v124
  v_exp_f32 v125, v125
  v_exp_f32 v126, v126
  v_exp_f32 v127, v127
  v_cvt_pk_bf16_f32 v122, v124, v125
  v_cvt_pk_bf16_f32 v123, v126, v127
  v_mfma_f32_16x16x32_bf16 v[60:63], v[176:179], v[104:107], v[60:63]
  s_add_u32 s42, s42, s49
  s_add_u32 m0, m0, s50
  ds_read_b64_tr_b16 v[160:161], v219 offset:34912
  v_mfma_f32_16x16x32_bf16 v[200:203], v[196:199], v[112:115], v[200:203]
  s_nop 0
  buffer_load_dwordx4 v227, s[12:15], s42 offen lds
  ds_read_b64_tr_b16 v[162:163], v219 offset:35424
  v_mfma_f32_16x16x32_bf16 v[204:207], v[196:199], v[120:123], v[204:207]
  s_waitcnt lgkmcnt(6)
  s_add_u32 s42, s42, s49
  s_add_u32 m0, m0, s50
  v_mfma_f32_16x16x32_bf16 v[4:7], v[148:151], v[120:123], v[4:7]
  s_nop 0
  ds_read_b64_tr_b16 v[164:165], v219 offset:34944
  ds_read_b64_tr_b16 v[166:167], v219 offset:35456
  v_mfma_f32_16x16x32_bf16 v[0:3], v[148:151], v[112:115], v[0:3]
  s_waitcnt lgkmcnt(6)
  buffer_load_dwordx4 v227, s[12:15], s42 offen lds
  ds_read_b64_tr_b16 v[168:169], v219 offset:34976
  v_mfma_f32_16x16x32_bf16 v[8:11], v[152:155], v[112:115], v[8:11]
  s_add_u32 s42, s42, s49
  s_add_u32 m0, m0, s50
  ds_read_b64_tr_b16 v[170:171], v219 offset:35488
  v_mfma_f32_16x16x32_bf16 v[12:15], v[152:155], v[120:123], v[12:15]
  s_waitcnt lgkmcnt(6)
  buffer_load_dwordx4 v227, s[12:15], s42 offen lds
  ds_read_b64_tr_b16 v[172:173], v219 offset:35008
  v_mfma_f32_16x16x32_bf16 v[20:23], v[156:159], v[120:123], v[20:23]
  s_add_u32 s42, s42, s49
  s_add_u32 m0, m0, s51
  ds_read_b64_tr_b16 v[174:175], v219 offset:35520
  v_mfma_f32_16x16x32_bf16 v[16:19], v[156:159], v[112:115], v[16:19]
  s_waitcnt lgkmcnt(6)
  ds_read_b64_tr_b16 v[176:177], v219 offset:35040
  ds_read_b64_tr_b16 v[178:179], v219 offset:35552
  v_mfma_f32_16x16x32_bf16 v[24:27], v[160:163], v[112:115], v[24:27]
  buffer_load_dwordx4 v227, s[12:15], s42 offen lds
  v_mfma_f32_16x16x32_bf16 v[28:31], v[160:163], v[120:123], v[28:31]
  s_waitcnt lgkmcnt(6)
  s_add_u32 s42, s42, s49
  s_add_u32 m0, m0, s50
  v_mfma_f32_16x16x32_bf16 v[36:39], v[164:167], v[120:123], v[36:39]
  buffer_load_dwordx4 v227, s[12:15], s42 offen lds
  v_mfma_f32_16x16x32_bf16 v[32:35], v[164:167], v[112:115], v[32:35]
  s_waitcnt lgkmcnt(4)
  s_add_u32 s42, s42, s49
  s_add_u32 m0, m0, s50
  v_mfma_f32_16x16x32_bf16 v[40:43], v[168:171], v[112:115], v[40:43]
  buffer_load_dwordx4 v227, s[12:15], s42 offen lds
  v_mfma_f32_16x16x32_bf16 v[44:47], v[168:171], v[120:123], v[44:47]
  s_waitcnt lgkmcnt(2)
  s_add_u32 s42, s42, s49
  s_add_u32 m0, m0, s50
  v_mfma_f32_16x16x32_bf16 v[52:55], v[172:175], v[120:123], v[52:55]
  buffer_load_dwordx4 v227, s[12:15], s42 offen lds
  v_mfma_f32_16x16x32_bf16 v[48:51], v[172:175], v[112:115], v[48:51]
  s_waitcnt lgkmcnt(0)
  v_mfma_f32_16x16x32_bf16 v[56:59], v[176:179], v[112:115], v[56:59]
  v_mfma_f32_16x16x32_bf16 v[60:63], v[176:179], v[120:123], v[60:63]
  s_cmp_eq_u32 s41, 1
  s_cbranch_scc1 L_q2
  s_cmp_eq_u32 s41, 2
  s_cbranch_scc1 L_q3
  s_cmp_eq_u32 s41, 3
  s_cbranch_scc1 L_final
L_q1:
  s_waitcnt vmcnt(0)
  s_barrier
  ds_read_b64_tr_b16 v[148:149], v220 offset:0
  ds_read_b64_tr_b16 v[150:151], v220 offset:512
  ds_read_b64_tr_b16 v[152:153], v220 offset:8704
  ds_read_b64_tr_b16 v[154:155], v220 offset:9216
  ds_read_b64_tr_b16 v[156:157], v220 offset:17408
  ds_read_b64_tr_b16 v[158:159], v220 offset:17920
  ds_read_b64_tr_b16 v[160:161], v220 offset:26112
  ds_read_b64_tr_b16 v[162:163], v220 offset:26624
  ds_read_b64 v[164:165], v224 offset:0
  ds_read_b64 v[166:167], v224 offset:32
  ds_read_b64_tr_b16 v[168:169], v222 offset:0
  ds_read_b64_tr_b16 v[170:171], v222 offset:512
  ds_read_b64_tr_b16 v[172:173], v222 offset:8
  ds_read_b64_tr_b16 v[174:175], v222 offset:520
  v_rcp_f32 v251, v200
  v_rcp_f32 v252, v204
  v_cmp_lt_f32 vcc, s55, v200
  v_cmp_gt_f32 s[66:67], s56, v200
  s_and_b64 s[68:69], vcc, s[66:67]
  v_cmp_lt_f32 vcc, s55, v204
  v_cmp_gt_f32 s[66:67], s56, v204
  s_and_b64 s[68:69], s[68:69], vcc
  v_mov_b32 v250, s57
  s_and_b64 vcc, s[68:69], s[66:67]
  v_mul_f32 v0, v251, v0
  v_mul_f32 v1, v251, v1
  v_mul_f32 v2, v251, v2
  v_mul_f32 v3, v251, v3
  v_cvt_pk_bf16_f32 v96, v0, v1
  v_cvt_pk_bf16_f32 v97, v2, v3
  v_mul_f32 v4, v252, v4
  v_mul_f32 v5, v252, v5
  v_mul_f32 v6, v252, v6
  v_mul_f32 v7, v252, v7
  v_cvt_pk_bf16_f32 v112, v4, v5
  v_cvt_pk_bf16_f32 v113, v6, v7
  v_cndmask_b32 v250, v250, 0, vcc
  ds_write_b32 v231, v250 offset:1024
  s_add_u32 s42, s47, 1048832
  s_mov_b32 m0, s40
  s_waitcnt lgkmcnt(13)
  v_mfma_f32_16x16x32_bf16 v[0:3], v[148:151], a[0:3], 0
  s_waitcnt lgkmcnt(11)
  v_mul_f32 v8, v251, v8
  v_mul_f32 v9, v251, v9
  v_mfma_f32_16x16x32_bf16 v[0:3], v[152:155], a[4:7], v[0:3]
  s_waitcnt lgkmcnt(9)
  v_mul_f32 v10, v251, v10
  v_mul_f32 v11, v251, v11
  v_mfma_f32_16x16x32_bf16 v[0:3], v[156:159], a[8:11], v[0:3]
  s_waitcnt lgkmcnt(7)
  ds_read_b64_tr_b16 v[176:177], v220 offset:8
  ds_read_b64_tr_b16 v[178:179], v220 offset:520
  v_mfma_f32_16x16x32_bf16 v[0:3], v[160:163], a[12:15], v[0:3]
  s_nop 0
  ds_read_b64_tr_b16 a[224:225], v220 offset:8712
  ds_read_b64_tr_b16 a[226:227], v220 offset:9224
  v_mfma_f32_16x16x32_bf16 v[4:7], v[148:151], a[64:67], 0
  s_nop 0
  buffer_load_dwordx4 v227, s[12:15], s42 offen lds
  ds_read_b64_tr_b16 a[228:229], v220 offset:17416
  ds_read_b64_tr_b16 a[230:231], v220 offset:17928
  v_mfma_f32_16x16x32_bf16 v[4:7], v[152:155], a[68:71], v[4:7]
  s_nop 0
  ds_read_b64_tr_b16 a[232:233], v220 offset:26120
  ds_read_b64_tr_b16 a[234:235], v220 offset:26632
  v_mfma_f32_16x16x32_bf16 v[4:7], v[156:159], a[72:75], v[4:7]
  s_add_u32 s42, s42, s49
  s_add_u32 m0, m0, s50
  v_cvt_pk_bf16_f32 v98, v8, v9
  v_mfma_f32_16x16x32_bf16 v[4:7], v[160:163], a[76:79], v[4:7]
  s_waitcnt lgkmcnt(9)
  v_cvt_pk_bf16_f32 v99, v10, v11
  v_mul_f32 v12, v252, v12
  v_mfma_f32_16x16x32_bf16 v[128:131], v[168:171], v[164:167], 0
  buffer_load_dwordx4 v227, s[12:15], s42 offen lds
  v_mul_f32 v13, v252, v13
  v_mfma_f32_16x16x32_bf16 v[132:135], v[172:175], v[164:167], 0
  s_waitcnt lgkmcnt(6)
  v_mul_f32 v14, v252, v14
  v_mul_f32 v15, v252, v15
  v_cvt_pk_bf16_f32 v114, v12, v13
  v_cvt_pk_bf16_f32 v115, v14, v15
  v_mfma_f32_16x16x32_bf16 v[8:11], v[176:179], a[0:3], 0
  s_waitcnt lgkmcnt(4)
  ds_read_b64 a[236:237], v224 offset:64
  ds_read_b64 a[238:239], v224 offset:96
  ds_read_b64_tr_b16 a[240:241], v222 offset:8704
  ds_read_b64_tr_b16 a[242:243], v222 offset:9216
  v_mfma_f32_16x16x32_bf16 v[8:11], a[224:227], a[4:7], v[8:11]
  s_waitcnt lgkmcnt(6)
  s_add_u32 s42, s42, s49
  s_add_u32 m0, m0, s50
  ds_read_b64_tr_b16 a[244:245], v222 offset:8712
  ds_read_b64_tr_b16 a[246:247], v222 offset:9224
  v_mfma_f32_16x16x32_bf16 v[8:11], a[228:231], a[8:11], v[8:11]
  s_waitcnt lgkmcnt(6)
  buffer_load_dwordx4 v227, s[12:15], s42 offen lds
  ds_read_b64_tr_b16 a[248:249], v220 offset:64
  ds_read_b64_tr_b16 a[250:251], v220 offset:576
  v_mfma_f32_16x16x32_bf16 v[8:11], a[232:235], a[12:15], v[8:11]
  s_nop 0
  ds_read_b64_tr_b16 a[252:253], v220 offset:8768
  ds_read_b64_tr_b16 a[254:255], v220 offset:9280
  v_mfma_f32_16x16x32_bf16 v[12:15], v[176:179], a[64:67], 0
  s_add_u32 s42, s42, s49
  ds_read_b64_tr_b16 v[148:149], v220 offset:17472
  ds_read_b64_tr_b16 v[150:151], v220 offset:17984
  v_mfma_f32_16x16x32_bf16 v[12:15], a[224:227], a[68:71], v[12:15]
  s_add_u32 m0, m0, s50
  ds_read_b64_tr_b16 v[152:153], v220 offset:26176
  ds_read_b64_tr_b16 v[154:155], v220 offset:26688
  v_mfma_f32_16x16x32_bf16 v[12:15], a[228:231], a[72:75], v[12:15]
  buffer_load_dwordx4 v227, s[12:15], s42 offen lds
  v_mul_f32 v16, v251, v16
  v_mfma_f32_16x16x32_bf16 v[12:15], a[232:235], a[76:79], v[12:15]
  s_waitcnt lgkmcnt(10)
  v_mul_f32 v17, v251, v17
  v_mul_f32 v18, v251, v18
  v_mfma_f32_16x16x32_bf16 v[128:131], a[240:243], a[236:239], v[128:131]
  s_waitcnt lgkmcnt(8)
  v_mul_f32 v19, v251, v19
  v_cvt_pk_bf16_f32 v100, v16, v17
  v_mfma_f32_16x16x32_bf16 v[132:135], a[244:247], a[236:239], v[132:135]
  s_waitcnt lgkmcnt(6)
  s_add_u32 s42, s42, s49
  s_add_u32 m0, m0, s51
  v_cvt_pk_bf16_f32 v101, v18, v19
  v_mul_f32 v20, v252, v20
  v_mul_f32 v21, v252, v21
  v_mul_f32 v22, v252, v22
  v_mul_f32 v23, v252, v23
  v_cvt_pk_bf16_f32 v116, v20, v21
  v_cvt_pk_bf16_f32 v117, v22, v23
  v_mfma_f32_16x16x32_bf16 v[16:19], a[248:251], a[0:3], 0
  s_waitcnt lgkmcnt(4)
  buffer_load_dwordx4 v227, s[12:15], s42 offen lds
  ds_read_b64 v[156:157], v224 offset:128
  ds_read_b64 v[158:159], v224 offset:160
  ds_read_b64_tr_b16 v[160:161], v222 offset:17408
  ds_read_b64_tr_b16 v[162:163], v222 offset:17920
  v_mfma_f32_16x16x32_bf16 v[16:19], a[252:255], a[4:7], v[16:19]
  s_waitcnt lgkmcnt(6)
  ds_read_b64_tr_b16 v[164:165], v222 offset:17416
  ds_read_b64_tr_b16 v[166:167], v222 offset:17928
  v_mfma_f32_16x16x32_bf16 v[16:19], v[148:151], a[8:11], v[16:19]
  s_waitcnt lgkmcnt(6)
  ds_read_b64_tr_b16 v[168:169], v220 offset:72
  ds_read_b64_tr_b16 v[170:171], v220 offset:584
  v_mfma_f32_16x16x32_bf16 v[16:19], v[152:155], a[12:15], v[16:19]
  s_add_u32 s42, s42, s49
  s_add_u32 m0, m0, s50
  ds_read_b64_tr_b16 v[172:173], v220 offset:8776
  ds_read_b64_tr_b16 v[174:175], v220 offset:9288
  v_mfma_f32_16x16x32_bf16 v[20:23], a[248:251], a[64:67], 0
  s_nop 0
  buffer_load_dwordx4 v227, s[12:15], s42 offen lds
  ds_read_b64_tr_b16 v[176:177], v220 offset:17480
  ds_read_b64_tr_b16 v[178:179], v220 offset:17992
  v_mfma_f32_16x16x32_bf16 v[20:23], a[252:255], a[68:71], v[20:23]
  s_nop 0
  ds_read_b64_tr_b16 a[224:225], v220 offset:26184
  ds_read_b64_tr_b16 a[226:227], v220 offset:26696
  v_mfma_f32_16x16x32_bf16 v[20:23], v[148:151], a[72:75], v[20:23]
  s_add_u32 s42, s42, s49
  v_mul_f32 v24, v251, v24
  v_mul_f32 v25, v251, v25
  v_mfma_f32_16x16x32_bf16 v[20:23], v[152:155], a[76:79], v[20:23]
  s_waitcnt lgkmcnt(10)
  s_add_u32 m0, m0, s50
  v_mul_f32 v26, v251, v26
  v_mfma_f32_16x16x32_bf16 v[128:131], v[160:163], v[156:159], v[128:131]
  s_waitcnt lgkmcnt(8)
  buffer_load_dwordx4 v227, s[12:15], s42 offen lds
  ds_read_b128 v[180:183], v253 offset:0
  v_mfma_f32_16x16x32_bf16 v[132:135], v[164:167], v[156:159], v[132:135]
  s_waitcnt lgkmcnt(7)
  v_mul_f32 v27, v251, v27
  v_cvt_pk_bf16_f32 v102, v24, v25
  v_cvt_pk_bf16_f32 v103, v26, v27
  v_mul_f32 v28, v252, v28
  v_mul_f32 v29, v252, v29
  v_mul_f32 v30, v252, v30
  v_mul_f32 v31, v252, v31
  v_cvt_pk_bf16_f32 v118, v28, v29
  v_cvt_pk_bf16_f32 v119, v30, v31
  v_mfma_f32_16x16x32_bf16 v[24:27], v[168:171], a[0:3], 0
  s_waitcnt lgkmcnt(5)
  ds_read_b64 a[228:229], v224 offset:192
  ds_read_b64 a[230:231], v224 offset:224
  ds_read_b64_tr_b16 a[232:233], v222 offset:26112
  ds_read_b64_tr_b16 a[234:235], v222 offset:26624
  v_mfma_f32_16x16x32_bf16 v[24:27], v[172:175], a[4:7], v[24:27]
  s_waitcnt lgkmcnt(7)
  s_add_u32 s42, s42, s49
  s_add_u32 m0, m0, s50
  ds_read_b64_tr_b16 a[236:237], v222 offset:26120
  ds_read_b64_tr_b16 a[238:239], v222 offset:26632
  v_mfma_f32_16x16x32_bf16 v[24:27], v[176:179], a[8:11], v[24:27]
  s_waitcnt lgkmcnt(7)
  buffer_load_dwordx4 v227, s[12:15], s42 offen lds
  ds_read_b64_tr_b16 a[240:241], v220 offset:128
  ds_read_b64_tr_b16 a[242:243], v220 offset:640
  v_mfma_f32_16x16x32_bf16 v[24:27], a[224:227], a[12:15], v[24:27]
  s_nop 0
  ds_read_b64_tr_b16 a[244:245], v220 offset:8832
  ds_read_b64_tr_b16 a[246:247], v220 offset:9344
  v_mfma_f32_16x16x32_bf16 v[28:31], v[168:171], a[64:67], 0
  s_nop 0
  ds_read_b64_tr_b16 a[248:249], v220 offset:17536
  ds_read_b64_tr_b16 a[250:251], v220 offset:18048
  v_mfma_f32_16x16x32_bf16 v[28:31], v[172:175], a[68:71], v[28:31]
  s_nop 0
  ds_read_b64_tr_b16 a[252:253], v220 offset:26240
  ds_read_b64_tr_b16 a[254:255], v220 offset:26752
  v_mfma_f32_16x16x32_bf16 v[28:31], v[176:179], a[72:75], v[28:31]
  v_mul_f32 v32, v251, v32
  v_mul_f32 v33, v251, v33
  v_mfma_f32_16x16x32_bf16 v[28:31], a[224:227], a[76:79], v[28:31]
  s_waitcnt lgkmcnt(10)
  ds_read_b128 v[184:187], v253 offset:1024
  v_mul_f32 v34, v251, v34
  v_mfma_f32_16x16x32_bf16 v[128:131], a[232:235], a[228:231], v[128:131]
  s_waitcnt lgkmcnt(9)
  ds_read_b128 v[188:191], v253 offset:8192
  ds_read_b128 v[192:195], v253 offset:9216
  v_mfma_f32_16x16x32_bf16 v[132:135], a[236:239], a[228:231], v[132:135]
  s_waitcnt lgkmcnt(9)
  ds_read_b64_tr_b16 v[148:149], v220 offset:136
  ds_read_b64_tr_b16 v[150:151], v220 offset:648
  ds_read_b64_tr_b16 v[152:153], v220 offset:8840
  ds_read_b64_tr_b16 v[154:155], v220 offset:9352
  v_mul_f32 v35, v251, v35
  v_cvt_pk_bf16_f32 v104, v32, v33
  v_cvt_pk_bf16_f32 v105, v34, v35
  v_mul_f32 v36, v252, v36
  v_mul_f32 v37, v252, v37
  v_mul_f32 v38, v252, v38
  v_mul_f32 v39, v252, v39
  v_cvt_pk_bf16_f32 v120, v36, v37
  v_cvt_pk_bf16_f32 v121, v38, v39
  v_mfma_f32_16x16x32_bf16 v[32:35], a[240:243], a[0:3], 0
  s_waitcnt lgkmcnt(11)
  ds_read_b64_tr_b16 v[156:157], v220 offset:17544
  ds_read_b64_tr_b16 v[158:159], v220 offset:18056
  ds_read_b64_tr_b16 v[160:161], v220 offset:26248
  ds_read_b64_tr_b16 v[162:163], v220 offset:26760
  v_mfma_f32_16x16x32_bf16 v[32:35], a[244:247], a[4:7], v[32:35]
  s_waitcnt lgkmcnt(13)
  v_mul_f32 v40, v251, v40
  v_mul_f32 v41, v251, v41
  v_mfma_f32_16x16x32_bf16 v[32:35], a[248:251], a[8:11], v[32:35]
  s_waitcnt lgkmcnt(11)
  ds_read_b128 v[200:203], v253 offset:16384
  ds_read_b128 v[204:207], v253 offset:17408
  v_mfma_f32_16x16x32_bf16 v[32:35], a[252:255], a[12:15], v[32:35]
  s_nop 0
  ds_read_b32 v208, v254 offset:0
  ds_read_b32 v209, v254 offset:256
  ds_read_b32 v210, v254 offset:512
  ds_read_b32 v211, v254 offset:768
  v_mfma_f32_16x16x32_bf16 v[36:39], a[240:243], a[64:67], 0
  s_nop 0
  ds_read_b64_tr_b16 v[164:165], v220 offset:192
  ds_read_b64_tr_b16 v[166:167], v220 offset:704
  v_mfma_f32_16x16x32_bf16 v[36:39], a[244:247], a[68:71], v[36:39]
  s_nop 0
  ds_read_b64_tr_b16 v[168:169], v220 offset:8896
  ds_read_b64_tr_b16 v[170:171], v220 offset:9408
  ds_read_b64_tr_b16 v[172:173], v220 offset:17600
  ds_read_b64_tr_b16 v[174:175], v220 offset:18112
  ds_read_b64_tr_b16 v[176:177], v220 offset:26304
  ds_read_b64_tr_b16 v[178:179], v220 offset:26816
  v_mfma_f32_16x16x32_bf16 v[36:39], a[248:251], a[72:75], v[36:39]
  v_mul_f32 v42, v251, v42
  v_mul_f32 v43, v251, v43
  v_mfma_f32_16x16x32_bf16 v[36:39], a[252:255], a[76:79], v[36:39]
  s_waitcnt lgkmcnt(14)
  v_cvt_pk_bf16_f32 v106, v40, v41
  v_cvt_pk_bf16_f32 v107, v42, v43
  v_mul_f32 v44, v252, v44
  v_mul_f32 v45, v252, v45
  v_mul_f32 v46, v252, v46
  v_mul_f32 v47, v252, v47
  v_cvt_pk_bf16_f32 v122, v44, v45
  v_cvt_pk_bf16_f32 v123, v46, v47
  v_mfma_f32_16x16x32_bf16 v[40:43], v[148:151], a[0:3], 0
  v_mul_f32 v48, v251, v48
  v_mul_f32 v49, v251, v49
  v_mfma_f32_16x16x32_bf16 v[40:43], v[152:155], a[4:7], v[40:43]
  v_mul_f32 v50, v251, v50
  v_mul_f32 v51, v251, v51
  v_mfma_f32_16x16x32_bf16 v[40:43], v[156:159], a[8:11], v[40:43]
  s_nop 0
  ds_read_b64_tr_b16 a[224:225], v220 offset:200
  ds_read_b64_tr_b16 a[226:227], v220 offset:712
  ds_read_b64_tr_b16 a[228:229], v220 offset:8904
  ds_read_b64_tr_b16 a[230:231], v220 offset:9416
  ds_read_b64_tr_b16 a[232:233], v220 offset:17608
  ds_read_b64_tr_b16 a[234:235], v220 offset:18120
  v_mfma_f32_16x16x32_bf16 v[40:43], v[160:163], a[12:15], v[40:43]
  s_waitcnt lgkmcnt(14)
  ds_read_b64_tr_b16 a[236:237], v220 offset:26312
  ds_read_b64_tr_b16 a[238:239], v220 offset:26824
  v_mfma_f32_16x16x32_bf16 v[44:47], v[148:151], a[64:67], 0
  v_add_f32 v180, v180, v188
  v_add_f32 v181, v181, v189
  v_mfma_f32_16x16x32_bf16 v[44:47], v[152:155], a[68:71], v[44:47]
  v_add_f32 v182, v182, v190
  v_add_f32 v183, v183, v191
  v_mfma_f32_16x16x32_bf16 v[44:47], v[156:159], a[72:75], v[44:47]
  v_add_f32 v184, v184, v192
  v_add_f32 v185, v185, v193
  v_mfma_f32_16x16x32_bf16 v[44:47], v[160:163], a[76:79], v[44:47]
  s_waitcnt lgkmcnt(8)
  v_add_f32 v186, v186, v194
  v_add_f32 v187, v187, v195
  v_cvt_pk_bf16_f32 v108, v48, v49
  v_cvt_pk_bf16_f32 v109, v50, v51
  v_mul_f32 v52, v252, v52
  v_mul_f32 v53, v252, v53
  v_mul_f32 v54, v252, v54
  v_mul_f32 v55, v252, v55
  v_cvt_pk_bf16_f32 v124, v52, v53
  v_cvt_pk_bf16_f32 v125, v54, v55
  v_mfma_f32_16x16x32_bf16 v[48:51], v[164:167], a[0:3], 0
  s_cmp_eq_u32 s94, 0
  s_cselect_b32 s43, s95, 0x1000
  buffer_store_byte v196, off, s[4:7], s43 sc1
  ds_read_b128 v[188:191], v253 offset:24576
  ds_read_b128 v[192:195], v253 offset:25600
  v_mfma_f32_16x16x32_bf16 v[48:51], v[168:171], a[4:7], v[48:51]
  v_mul_f32 v56, v251, v56
  v_mul_f32 v57, v251, v57
  v_mfma_f32_16x16x32_bf16 v[48:51], v[172:175], a[8:11], v[48:51]
  v_mul_f32 v58, v251, v58
  v_mul_f32 v59, v251, v59
  v_mfma_f32_16x16x32_bf16 v[48:51], v[176:179], a[12:15], v[48:51]
  v_cvt_pk_bf16_f32 v110, v56, v57
  v_cvt_pk_bf16_f32 v111, v58, v59
  v_mfma_f32_16x16x32_bf16 v[52:55], v[164:167], a[64:67], 0
  v_mul_f32 v60, v252, v60
  v_mul_f32 v61, v252, v61
  v_mfma_f32_16x16x32_bf16 v[52:55], v[168:171], a[68:71], v[52:55]
  v_mul_f32 v62, v252, v62
  v_mul_f32 v63, v252, v63
  v_mfma_f32_16x16x32_bf16 v[52:55], v[172:175], a[72:75], v[52:55]
  s_waitcnt lgkmcnt(0)
  s_waitcnt vmcnt(1)
  s_barrier
  v_cvt_pk_bf16_f32 v126, v60, v61
  v_mfma_f32_16x16x32_bf16 v[52:55], v[176:179], a[76:79], v[52:55]
  ds_read_b64_tr_b16 a[240:241], v221 offset:0
  v_cvt_pk_bf16_f32 v127, v62, v63
  v_mfma_f32_16x16x32_bf16 v[56:59], a[224:227], a[0:3], 0
  s_nop 0
  ds_read_b64_tr_b16 a[242:243], v221 offset:512
  ds_read_b64_tr_b16 a[244:245], v221 offset:8704
  v_mfma_f32_16x16x32_bf16 v[56:59], a[228:231], a[4:7], v[56:59]
  s_add_u32 s42, s48, 2097408
  ds_read_b64_tr_b16 a[246:247], v221 offset:9216
  v_mfma_f32_16x16x32_bf16 v[56:59], a[232:235], a[8:11], v[56:59]
  s_nop 0
  ds_read_b64_tr_b16 a[248:249], v221 offset:17408
  ds_read_b64_tr_b16 a[250:251], v221 offset:17920
  v_mfma_f32_16x16x32_bf16 v[56:59], a[236:239], a[12:15], v[56:59]
  s_mov_b32 m0, s39
  ds_read_b64_tr_b16 a[252:253], v221 offset:26112
  ds_read_b64_tr_b16 a[254:255], v221 offset:26624
  v_mfma_f32_16x16x32_bf16 v[60:63], a[224:227], a[64:67], 0
  s_nop 0
  buffer_load_dwordx4 v227, s[12:15], s42 offen lds
  ds_read_b64 v[148:149], v224 offset:256
  v_mfma_f32_16x16x32_bf16 v[60:63], a[228:231], a[68:71], v[60:63]
  s_nop 0
  ds_read_b64 v[150:151], v224 offset:288
  ds_read_b64_tr_b16 v[152:153], v223 offset:0
  v_mfma_f32_16x16x32_bf16 v[60:63], a[232:235], a[72:75], v[60:63]
  s_add_u32 s42, s42, s49
  s_add_u32 m0, m0, s50
  ds_read_b64_tr_b16 v[154:155], v223 offset:512
  v_mfma_f32_16x16x32_bf16 v[60:63], a[236:239], a[76:79], v[60:63]
  s_waitcnt lgkmcnt(10)
  buffer_load_dwordx4 v227, s[12:15], s42 offen lds
  ds_read_b64_tr_b16 v[156:157], v223 offset:8
  v_mfma_f32_16x16x32_bf16 v[0:3], a[240:243], a[16:19], v[0:3]
  s_waitcnt lgkmcnt(9)
  ds_read_b64_tr_b16 v[158:159], v223 offset:520
  ds_read_b64_tr_b16 v[160:161], v221 offset:8
  v_mfma_f32_16x16x32_bf16 v[0:3], a[244:247], a[20:23], v[0:3]
  s_waitcnt lgkmcnt(9)
  s_add_u32 s42, s42, s49
  s_add_u32 m0, m0, s50
  v_mfma_f32_16x16x32_bf16 v[0:3], a[248:251], a[24:27], v[0:3]
  s_waitcnt lgkmcnt(7)
  ds_read_b64_tr_b16 v[162:163], v221 offset:520
  ds_read_b64_tr_b16 v[164:165], v221 offset:8712
  v_mfma_f32_16x16x32_bf16 v[0:3], a[252:255], a[28:31], v[0:3]
  s_nop 0
  ds_read_b64_tr_b16 v[166:167], v221 offset:9224
  buffer_load_dwordx4 v227, s[12:15], s42 offen lds
  v_mfma_f32_16x16x32_bf16 v[4:7], a[240:243], a[80:83], v[4:7]
  s_nop 0
  ds_read_b64_tr_b16 v[168:169], v221 offset:17416
  ds_read_b64_tr_b16 v[170:171], v221 offset:17928
  v_mfma_f32_16x16x32_bf16 v[4:7], a[244:247], a[84:87], v[4:7]
  s_add_u32 s42, s42, s49
  ds_read_b64_tr_b16 v[172:173], v221 offset:26120
  ds_read_b64_tr_b16 v[174:175], v221 offset:26632
  v_mfma_f32_16x16x32_bf16 v[4:7], a[248:251], a[88:91], v[4:7]
  s_add_u32 m0, m0, s50
  ds_read_b64 v[176:177], v224 offset:320
  ds_read_b64 v[178:179], v224 offset:352
  v_mfma_f32_16x16x32_bf16 v[4:7], a[252:255], a[92:95], v[4:7]
  s_waitcnt lgkmcnt(10)
  buffer_load_dwordx4 v227, s[12:15], s42 offen lds
  ds_read_b64_tr_b16 a[224:225], v223 offset:8704
  v_mfma_f32_16x16x32_bf16 v[128:131], v[152:155], v[148:151], v[128:131]
  s_nop 0
  ds_read_b64_tr_b16 a[226:227], v223 offset:9216
  ds_read_b64_tr_b16 a[228:229], v223 offset:8712
  v_mfma_f32_16x16x32_bf16 v[132:135], v[156:159], v[148:151], v[132:135]
  s_waitcnt lgkmcnt(11)
  s_add_u32 s42, s42, s49
  s_add_u32 m0, m0, s51
  v_mfma_f32_16x16x32_bf16 v[8:11], v[160:163], a[16:19], v[8:11]
  s_waitcnt lgkmcnt(9)
  ds_read_b64_tr_b16 a[230:231], v223 offset:9224
  buffer_load_dwordx4 v227, s[12:15], s42 offen lds
  v_mfma_f32_16x16x32_bf16 v[8:11], v[164:167], a[20:23], v[8:11]
  s_waitcnt lgkmcnt(8)
  ds_read_b64_tr_b16 a[232:233], v221 offset:64
  ds_read_b64_tr_b16 a[234:235], v221 offset:576
  v_mfma_f32_16x16x32_bf16 v[8:11], v[168:171], a[24:27], v[8:11]
  s_waitcnt lgkmcnt(8)
  ds_read_b64_tr_b16 a[236:237], v221 offset:8768
  ds_read_b64_tr_b16 a[238:239], v221 offset:9280
  v_mfma_f32_16x16x32_bf16 v[8:11], v[172:175], a[28:31], v[8:11]
  s_add_u32 s42, s42, s49
  s_add_u32 m0, m0, s50
  ds_read_b64_tr_b16 a[240:241], v221 offset:17472
  v_mfma_f32_16x16x32_bf16 v[12:15], v[160:163], a[80:83], v[12:15]
  ds_read_b64_tr_b16 a[242:243], v221 offset:17984
  v_add_f32 v208, v208, v209
  v_mfma_f32_16x16x32_bf16 v[12:15], v[164:167], a[84:87], v[12:15]
  s_nop 0
  ds_read_b64_tr_b16 a[244:245], v221 offset:26176
  ds_read_b64_tr_b16 a[246:247], v221 offset:26688
  v_mfma_f32_16x16x32_bf16 v[12:15], v[168:171], a[88:91], v[12:15]
  buffer_load_dwordx4 v227, s[12:15], s42 offen lds
  v_add_f32 v210, v210, v211
  v_mfma_f32_16x16x32_bf16 v[12:15], v[172:175], a[92:95], v[12:15]
  s_waitcnt lgkmcnt(8)
  v_add_f32 v180, v180, v200
  v_add_f32 v181, v181, v201
  v_mfma_f32_16x16x32_bf16 v[128:131], a[224:227], v[176:179], v[128:131]
  v_add_f32 v182, v182, v202
  v_add_f32 v183, v183, v203
  v_mfma_f32_16x16x32_bf16 v[132:135], a[228:231], v[176:179], v[132:135]
  s_waitcnt lgkmcnt(4)
  s_add_u32 s42, s42, s49
  s_add_u32 m0, m0, s50
  v_mfma_f32_16x16x32_bf16 v[16:19], a[232:235], a[16:19], v[16:19]
  s_nop 0
  buffer_load_dwordx4 v227, s[12:15], s42 offen lds
  ds_read_b64 a[248:249], v224 offset:384
  ds_read_b64 a[250:251], v224 offset:416
  ds_read_b64_tr_b16 a[252:253], v223 offset:17408
  ds_read_b64_tr_b16 a[254:255], v223 offset:17920
  v_mfma_f32_16x16x32_bf16 v[16:19], a[236:239], a[20:23], v[16:19]
  s_waitcnt lgkmcnt(6)
  ds_read_b64_tr_b16 v[148:149], v223 offset:17416
  ds_read_b64_tr_b16 v[150:151], v223 offset:17928
  v_mfma_f32_16x16x32_bf16 v[16:19], a[240:243], a[24:27], v[16:19]
  s_waitcnt lgkmcnt(6)
  ds_read_b64_tr_b16 v[152:153], v221 offset:72
  ds_read_b64_tr_b16 v[154:155], v221 offset:584
  v_mfma_f32_16x16x32_bf16 v[16:19], a[244:247], a[28:31], v[16:19]
  s_add_u32 s42, s42, s49
  s_add_u32 m0, m0, s50
  ds_read_b64_tr_b16 v[156:157], v221 offset:8776
  ds_read_b64_tr_b16 v[158:159], v221 offset:9288
  v_mfma_f32_16x16x32_bf16 v[20:23], a[232:235], a[80:83], v[20:23]
  s_nop 0
  buffer_load_dwordx4 v227, s[12:15], s42 offen lds
  ds_read_b64_tr_b16 v[160:161], v221 offset:17480
  ds_read_b64_tr_b16 v[162:163], v221 offset:17992
  v_mfma_f32_16x16x32_bf16 v[20:23], a[236:239], a[84:87], v[20:23]
  s_add_u32 s42, s0, 131072
  s_mov_b32 m0, s38
  ds_read_b64_tr_b16 v[164:165], v221 offset:26184
  ds_read_b64_tr_b16 v[166:167], v221 offset:26696
  v_mfma_f32_16x16x32_bf16 v[20:23], a[240:243], a[88:91], v[20:23]
  buffer_load_dwordx4 v225, s[20:23], s42 offen nt lds
  v_add_f32 v184, v184, v204
  v_mfma_f32_16x16x32_bf16 v[20:23], a[244:247], a[92:95], v[20:23]
  s_waitcnt lgkmcnt(10)
  v_add_f32 v185, v185, v205
  v_add_f32 v186, v186, v206
  v_mfma_f32_16x16x32_bf16 v[128:131], a[252:255], a[248:251], v[128:131]
  s_waitcnt lgkmcnt(8)
  v_add_f32 v187, v187, v207
  v_add_f32 v208, v208, v210
  v_mfma_f32_16x16x32_bf16 v[132:135], v[148:151], a[248:251], v[132:135]
  s_waitcnt lgkmcnt(6)
  s_add_u32 m0, m0, 32
  ds_read_b64 v[168:169], v224 offset:448
  v_mfma_f32_16x16x32_bf16 v[24:27], v[152:155], a[16:19], v[24:27]
  s_waitcnt lgkmcnt(5)
  buffer_load_dwordx4 v225, s[20:23], s42 offen offset:1024 nt lds
  ds_read_b64 v[170:171], v224 offset:480
  ds_read_b64_tr_b16 v[172:173], v223 offset:26112
  ds_read_b64_tr_b16 v[174:175], v223 offset:26624
  v_mfma_f32_16x16x32_bf16 v[24:27], v[156:159], a[20:23], v[24:27]
  s_waitcnt lgkmcnt(6)
  ds_read_b64_tr_b16 v[176:177], v223 offset:26120
  ds_read_b64_tr_b16 v[178:179], v223 offset:26632
  v_mfma_f32_16x16x32_bf16 v[24:27], v[160:163], a[24:27], v[24:27]
  s_waitcnt lgkmcnt(6)
  ds_read_b64_tr_b16 a[224:225], v221 offset:128
  ds_read_b64_tr_b16 a[226:227], v221 offset:640
  v_mfma_f32_16x16x32_bf16 v[24:27], v[164:167], a[28:31], v[24:27]
  s_add_u32 m0, m0, 32
  ds_read_b64_tr_b16 a[228:229], v221 offset:8832
  ds_read_b64_tr_b16 a[230:231], v221 offset:9344
  v_mfma_f32_16x16x32_bf16 v[28:31], v[152:155], a[80:83], v[28:31]
  s_nop 0
  buffer_load_dwordx4 v225, s[20:23], s42 offen offset:2048 nt lds
  ds_read_b64_tr_b16 a[232:233], v221 offset:17536
  ds_read_b64_tr_b16 a[234:235], v221 offset:18048
  v_mfma_f32_16x16x32_bf16 v[28:31], v[156:159], a[84:87], v[28:31]
  s_nop 0
  ds_read_b64_tr_b16 a[236:237], v221 offset:26240
  ds_read_b64_tr_b16 a[238:239], v221 offset:26752
  v_mfma_f32_16x16x32_bf16 v[28:31], v[160:163], a[88:91], v[28:31]
  s_add_u32 m0, m0, 32
  v_rcp_f32 v250, v208
  v_mfma_f32_16x16x32_bf16 v[28:31], v[164:167], a[92:95], v[28:31]
  s_waitcnt lgkmcnt(10)
  v_add_f32 v180, v180, v188
  v_mfma_f32_16x16x32_bf16 v[128:131], v[172:175], v[168:171], v[128:131]
  s_waitcnt lgkmcnt(8)
  buffer_load_dwordx4 v225, s[20:23], s42 offen offset:3072 nt lds
  v_add_f32 v181, v181, v189
  v_mfma_f32_16x16x32_bf16 v[132:135], v[176:179], v[168:171], v[132:135]
  s_waitcnt lgkmcnt(6)
  ds_read_b64_tr_b16 a[240:241], v221 offset:136
  ds_read_b64_tr_b16 a[242:243], v221 offset:648
  ds_read_b64_tr_b16 a[244:245], v221 offset:8840
  ds_read_b64_tr_b16 a[246:247], v221 offset:9352
  v_mfma_f32_16x16x32_bf16 v[32:35], a[224:227], a[16:19], v[32:35]
  s_waitcnt lgkmcnt(8)
  ds_read_b64_tr_b16 a[248:249], v221 offset:17544
  ds_read_b64_tr_b16 a[250:251], v221 offset:18056
  ds_read_b64_tr_b16 a[252:253], v221 offset:26248
  ds_read_b64_tr_b16 a[254:255], v221 offset:26760
  v_mfma_f32_16x16x32_bf16 v[32:35], a[228:231], a[20:23], v[32:35]
  s_waitcnt lgkmcnt(10)
  s_add_u32 s42, s42, s52
  s_add_u32 m0, m0, s53
  v_mfma_f32_16x16x32_bf16 v[32:35], a[232:235], a[24:27], v[32:35]
  s_waitcnt lgkmcnt(8)
  buffer_load_dwordx4 v225, s[20:23], s42 offen nt lds
  v_add_f32 v182, v182, v190
  v_mfma_f32_16x16x32_bf16 v[32:35], a[236:239], a[28:31], v[32:35]
  v_add_f32 v183, v183, v191
  v_add_f32 v184, v184, v192
  v_mfma_f32_16x16x32_bf16 v[36:39], a[224:227], a[80:83], v[36:39]
  s_add_u32 m0, m0, 32
  ds_read_b64_tr_b16 v[148:149], v221 offset:192
  ds_read_b64_tr_b16 v[150:151], v221 offset:704
  v_mfma_f32_16x16x32_bf16 v[36:39], a[228:231], a[84:87], v[36:39]
  s_nop 0
  ds_read_b64_tr_b16 v[152:153], v221 offset:8896
  ds_read_b64_tr_b16 v[154:155], v221 offset:9408
  ds_read_b64_tr_b16 v[156:157], v221 offset:17600
  ds_read_b64_tr_b16 v[158:159], v221 offset:18112
  ds_read_b64_tr_b16 v[160:161], v221 offset:26304
  ds_read_b64_tr_b16 v[162:163], v221 offset:26816
  v_mfma_f32_16x16x32_bf16 v[36:39], a[232:235], a[88:91], v[36:39]
  buffer_load_dwordx4 v225, s[20:23], s42 offen offset:1024 nt lds
  v_add_f32 v185, v185, v193
  v_mfma_f32_16x16x32_bf16 v[36:39], a[236:239], a[92:95], v[36:39]
  s_waitcnt lgkmcnt(8)
  v_add_f32 v186, v186, v194
  v_add_f32 v187, v187, v195
  v_mfma_f32_16x16x32_bf16 v[40:43], a[240:243], a[16:19], v[40:43]
  v_mul_f32 v180, v250, v180
  v_mul_f32 v181, v250, v181
  v_mfma_f32_16x16x32_bf16 v[40:43], a[244:247], a[20:23], v[40:43]
  s_add_u32 m0, m0, 32
  v_mul_f32 v182, v250, v182
  v_mfma_f32_16x16x32_bf16 v[40:43], a[248:251], a[24:27], v[40:43]
  s_nop 0
  buffer_load_dwordx4 v225, s[20:23], s42 offen offset:2048 nt lds
  ds_read_b64_tr_b16 v[164:165], v221 offset:200
  ds_read_b64_tr_b16 v[166:167], v221 offset:712
  ds_read_b64_tr_b16 v[168:169], v221 offset:8904
  ds_read_b64_tr_b16 v[170:171], v221 offset:9416
  ds_read_b64_tr_b16 v[172:173], v221 offset:17608
  ds_read_b64_tr_b16 v[174:175], v221 offset:18120
  v_mfma_f32_16x16x32_bf16 v[40:43], a[252:255], a[28:31], v[40:43]
  s_nop 0
  ds_read_b64_tr_b16 v[176:177], v221 offset:26312
  ds_read_b64_tr_b16 v[178:179], v221 offset:26824
  v_mfma_f32_16x16x32_bf16 v[44:47], a[240:243], a[80:83], v[44:47]
  s_add_u32 m0, m0, 32
  v_mul_f32 v183, v250, v183
  v_mul_f32 v184, v250, v184
  v_mfma_f32_16x16x32_bf16 v[44:47], a[244:247], a[84:87], v[44:47]
  v_mul_f32 v185, v250, v185
  v_mul_f32 v186, v250, v186
  v_mul_f32 v187, v250, v187
  v_cvt_pk_bf16_f32 v232, v180, v181
  v_cvt_pk_bf16_f32 v233, v182, v183
  v_cvt_pk_bf16_f32 v234, v184, v185
  v_cvt_pk_bf16_f32 v235, v186, v187
  v_mfma_f32_16x16x32_bf16 v[44:47], a[248:251], a[88:91], v[44:47]
  buffer_load_dwordx4 v225, s[20:23], s42 offen offset:3072 nt lds
  v_accvgpr_write_b32 a128, v96
  v_mfma_f32_16x16x32_bf16 v[44:47], a[252:255], a[92:95], v[44:47]
  s_waitcnt lgkmcnt(8)
  s_cmp_eq_u32 s94, 1
  s_cselect_b32 s43, s95, 0x1000
  buffer_store_byte v196, off, s[4:7], s43 sc1
  v_mfma_f32_16x16x32_bf16 v[48:51], v[148:151], a[16:19], v[48:51]
  s_nop 0
  ds_read_b32 v188, v254 offset:1024
  ds_read_b32 v189, v254 offset:1280
  v_mfma_f32_16x16x32_bf16 v[48:51], v[152:155], a[20:23], v[48:51]
  s_nop 0
  ds_read_b32 v190, v254 offset:1536
  ds_read_b32 v191, v254 offset:1792
  v_mfma_f32_16x16x32_bf16 v[48:51], v[156:159], a[24:27], v[48:51]
  s_waitcnt lgkmcnt(4)
  s_waitcnt vmcnt(9)
  s_barrier
  ds_read_b64_tr_b16 a[224:225], v220 offset:0
  v_mfma_f32_16x16x32_bf16 v[48:51], v[160:163], a[28:31], v[48:51]
  s_add_u32 s42, s48, 3145984
  ds_read_b64_tr_b16 a[226:227], v220 offset:512
  ds_read_b64_tr_b16 a[228:229], v220 offset:8704
  v_mfma_f32_16x16x32_bf16 v[52:55], v[148:151], a[80:83], v[52:55]
  s_mov_b32 m0, s40
  ds_read_b64_tr_b16 a[230:231], v220 offset:9216
  ds_read_b64_tr_b16 a[232:233], v220 offset:17408
  v_mfma_f32_16x16x32_bf16 v[52:55], v[152:155], a[84:87], v[52:55]
  s_nop 0
  ds_read_b64_tr_b16 a[234:235], v220 offset:17920
  ds_read_b64_tr_b16 a[236:237], v220 offset:26112
  v_mfma_f32_16x16x32_bf16 v[52:55], v[156:159], a[88:91], v[52:55]
  s_nop 0
  ds_read_b64_tr_b16 a[238:239], v220 offset:26624
  buffer_load_dwordx4 v227, s[12:15], s42 offen lds
  v_mfma_f32_16x16x32_bf16 v[52:55], v[160:163], a[92:95], v[52:55]
  ds_read_b64 a[240:241], v224 offset:512
  ds_read_b64 a[242:243], v224 offset:544
  v_mfma_f32_16x16x32_bf16 v[56:59], v[164:167], a[16:19], v[56:59]
  s_waitcnt lgkmcnt(10)
  s_add_u32 s42, s42, s49
  v_mfma_f32_16x16x32_bf16 v[56:59], v[168:171], a[20:23], v[56:59]
  s_add_u32 m0, m0, s50
  ds_read_b64_tr_b16 a[244:245], v222 offset:0
  v_mfma_f32_16x16x32_bf16 v[56:59], v[172:175], a[24:27], v[56:59]
  s_nop 0
  buffer_load_dwordx4 v227, s[12:15], s42 offen lds
  ds_read_b64_tr_b16 a[246:247], v222 offset:512
  v_mfma_f32_16x16x32_bf16 v[56:59], v[176:179], a[28:31], v[56:59]
  s_nop 0
  ds_read_b64_tr_b16 a[248:249], v222 offset:8
  ds_read_b64_tr_b16 a[250:251], v222 offset:520
  v_mfma_f32_16x16x32_bf16 v[60:63], v[164:167], a[80:83], v[60:63]
  s_add_u32 s42, s42, s49
  v_add_f32 v188, v188, v189
  v_add_f32 v190, v190, v191
  v_mfma_f32_16x16x32_bf16 v[60:63], v[168:171], a[84:87], v[60:63]
  s_add_u32 m0, m0, s50
  v_add_f32 v188, v188, v208
  v_add_f32 v188, v188, v190
  v_mfma_f32_16x16x32_bf16 v[60:63], v[172:175], a[88:91], v[60:63]
  v_cmp_lt_f32 vcc, s55, v188
  v_cmp_gt_f32 s[66:67], s56, v188
  v_mfma_f32_16x16x32_bf16 v[60:63], v[176:179], a[92:95], v[60:63]
  s_waitcnt lgkmcnt(6)
  ds_read_b64_tr_b16 a[252:253], v220 offset:8
  ds_read_b64_tr_b16 a[254:255], v220 offset:520
  v_mfma_f32_16x16x32_bf16 v[0:3], a[224:227], a[32:35], v[0:3]
  s_nop 0
  ds_read_b64_tr_b16 v[148:149], v220 offset:8712
  ds_read_b64_tr_b16 v[150:151], v220 offset:9224
  v_mfma_f32_16x16x32_bf16 v[0:3], a[228:231], a[36:39], v[0:3]
  s_nop 0
  buffer_load_dwordx4 v227, s[12:15], s42 offen lds
  ds_read_b64_tr_b16 v[152:153], v220 offset:17416
  v_mfma_f32_16x16x32_bf16 v[0:3], a[232:235], a[40:43], v[0:3]
  s_nop 0
  ds_read_b64_tr_b16 v[154:155], v220 offset:17928
  ds_read_b64_tr_b16 v[156:157], v220 offset:26120
  v_mfma_f32_16x16x32_bf16 v[0:3], a[236:239], a[44:47], v[0:3]
  s_add_u32 s42, s42, s49
  s_add_u32 m0, m0, s50
  ds_read_b64_tr_b16 v[158:159], v220 offset:26632
  v_mfma_f32_16x16x32_bf16 v[4:7], a[224:227], a[96:99], v[4:7]
  s_and_b64 vcc, vcc, s[66:67]
  s_cmp_eq_u64 vcc, exec
  s_cbranch_scc1 L_ok0
  s_cmp_eq_u32 s44, 0
  s_cbranch_scc1 L_retry
L_ok0:
  s_mov_b32 s44, 0
  v_mfma_f32_16x16x32_bf16 v[4:7], a[228:231], a[100:103], v[4:7]
  buffer_load_dwordx4 v227, s[12:15], s42 offen lds
  v_accvgpr_write_b32 a129, v97
  v_mfma_f32_16x16x32_bf16 v[4:7], a[232:235], a[104:107], v[4:7]
  ds_read_b64 v[160:161], v224 offset:576
  v_accvgpr_write_b32 a130, v98
  v_mfma_f32_16x16x32_bf16 v[4:7], a[236:239], a[108:111], v[4:7]
  s_waitcnt lgkmcnt(5)
  s_add_u32 s42, s42, s49
  s_add_u32 m0, m0, s51
  v_mfma_f32_16x16x32_bf16 v[128:131], a[244:247], a[240:243], v[128:131]
  s_nop 0
  ds_read_b64 v[162:163], v224 offset:608
  ds_read_b64_tr_b16 v[164:165], v222 offset:8704
  v_mfma_f32_16x16x32_bf16 v[132:135], a[248:251], a[240:243], v[132:135]
  ds_read_b64_tr_b16 v[166:167], v222 offset:9216
  v_accvgpr_write_b32 a131, v99
  v_mfma_f32_16x16x32_bf16 v[8:11], a[252:255], a[32:35], v[8:11]
  s_nop 0
  ds_read_b64_tr_b16 v[168:169], v222 offset:8712
  ds_read_b64_tr_b16 v[170:171], v222 offset:9224
  v_mfma_f32_16x16x32_bf16 v[8:11], v[148:151], a[36:39], v[8:11]
  s_waitcnt lgkmcnt(6)
  buffer_load_dwordx4 v227, s[12:15], s42 offen lds
  v_accvgpr_write_b32 a132, v100
  v_mfma_f32_16x16x32_bf16 v[8:11], v[152:155], a[40:43], v[8:11]
  s_nop 0
  ds_read_b64_tr_b16 v[172:173], v220 offset:64
  ds_read_b64_tr_b16 v[174:175], v220 offset:576
  v_mfma_f32_16x16x32_bf16 v[8:11], v[156:159], a[44:47], v[8:11]
  s_add_u32 s42, s42, s49
  ds_read_b64_tr_b16 v[176:177], v220 offset:8768
  ds_read_b64_tr_b16 v[178:179], v220 offset:9280
  v_mfma_f32_16x16x32_bf16 v[12:15], a[252:255], a[96:99], v[12:15]
  s_add_u32 m0, m0, s50
  ds_read_b64_tr_b16 a[224:225], v220 offset:17472
  ds_read_b64_tr_b16 a[226:227], v220 offset:17984
  v_mfma_f32_16x16x32_bf16 v[12:15], v[148:151], a[100:103], v[12:15]
  s_nop 0
  ds_read_b64_tr_b16 a[228:229], v220 offset:26176
  ds_read_b64_tr_b16 a[230:231], v220 offset:26688
  v_mfma_f32_16x16x32_bf16 v[12:15], v[152:155], a[104:107], v[12:15]
  buffer_load_dwordx4 v227, s[12:15], s42 offen lds
  v_accvgpr_write_b32 a133, v101
  v_mfma_f32_16x16x32_bf16 v[12:15], v[156:159], a[108:111], v[12:15]
  s_waitcnt lgkmcnt(8)
  v_accvgpr_write_b32 a134, v102
  v_accvgpr_write_b32 a135, v103
  v_mfma_f32_16x16x32_bf16 v[128:131], v[164:167], v[160:163], v[128:131]
  v_accvgpr_write_b32 a136, v104
  v_accvgpr_write_b32 a137, v105
  v_mfma_f32_16x16x32_bf16 v[132:135], v[168:171], v[160:163], v[132:135]
  s_waitcnt lgkmcnt(6)
  s_add_u32 s42, s42, s49
  s_add_u32 m0, m0, s50
  v_mfma_f32_16x16x32_bf16 v[16:19], v[172:175], a[32:35], v[16:19]
  s_waitcnt lgkmcnt(4)
  buffer_load_dwordx4 v227, s[12:15], s42 offen lds
  ds_read_b64 a[232:233], v224 offset:640
  ds_read_b64 a[234:235], v224 offset:672
  ds_read_b64_tr_b16 a[236:237], v222 offset:17408
  ds_read_b64_tr_b16 a[238:239], v222 offset:17920
  v_mfma_f32_16x16x32_bf16 v[16:19], v[176:179], a[36:39], v[16:19]
  s_waitcnt lgkmcnt(6)
  ds_read_b64_tr_b16 a[240:241], v222 offset:17416
  ds_read_b64_tr_b16 a[242:243], v222 offset:17928
  v_mfma_f32_16x16x32_bf16 v[16:19], a[224:227], a[40:43], v[16:19]
  s_waitcnt lgkmcnt(6)
  ds_read_b64_tr_b16 a[244:245], v220 offset:72
  ds_read_b64_tr_b16 a[246:247], v220 offset:584
  v_mfma_f32_16x16x32_bf16 v[16:19], a[228:231], a[44:47], v[16:19]
  s_add_u32 s42, s42, s49
  s_add_u32 m0, m0, s50
  ds_read_b64_tr_b16 a[248:249], v220 offset:8776
  ds_read_b64_tr_b16 a[250:251], v220 offset:9288
  v_mfma_f32_16x16x32_bf16 v[20:23], v[172:175], a[96:99], v[20:23]
  s_nop 0
  buffer_load_dwordx4 v227, s[12:15], s42 offen lds
  ds_read_b64_tr_b16 a[252:253], v220 offset:17480
  ds_read_b64_tr_b16 a[254:255], v220 offset:17992
  v_mfma_f32_16x16x32_bf16 v[20:23], v[176:179], a[100:103], v[20:23]
  s_nop 0
  ds_read_b64_tr_b16 v[148:149], v220 offset:26184
  ds_read_b64_tr_b16 v[150:151], v220 offset:26696
  v_mfma_f32_16x16x32_bf16 v[20:23], a[224:227], a[104:107], v[20:23]
  v_accvgpr_write_b32 a138, v106
  v_accvgpr_write_b32 a139, v107
  v_mfma_f32_16x16x32_bf16 v[20:23], a[228:231], a[108:111], v[20:23]
  s_waitcnt lgkmcnt(10)
  v_accvgpr_write_b32 a140, v108
  v_accvgpr_write_b32 a141, v109
  v_mfma_f32_16x16x32_bf16 v[128:131], a[236:239], a[232:235], v[128:131]
  s_waitcnt lgkmcnt(8)
  v_accvgpr_write_b32 a142, v110
  v_accvgpr_write_b32 a143, v111
  v_mfma_f32_16x16x32_bf16 v[132:135], a[240:243], a[232:235], v[132:135]
  s_waitcnt lgkmcnt(6)
  v_accvgpr_write_b32 a144, v112
  v_accvgpr_write_b32 a145, v113
  v_mfma_f32_16x16x32_bf16 v[24:27], a[244:247], a[32:35], v[24:27]
  s_waitcnt lgkmcnt(4)
  ds_read_b64 v[152:153], v224 offset:704
  ds_read_b64 v[154:155], v224 offset:736
  ds_read_b64_tr_b16 v[156:157], v222 offset:26112
  ds_read_b64_tr_b16 v[158:159], v222 offset:26624
  v_mfma_f32_16x16x32_bf16 v[24:27], a[248:251], a[36:39], v[24:27]
  s_waitcnt lgkmcnt(6)
  ds_read_b64_tr_b16 v[160:161], v222 offset:26120
  ds_read_b64_tr_b16 v[162:163], v222 offset:26632
  v_mfma_f32_16x16x32_bf16 v[24:27], a[252:255], a[40:43], v[24:27]
  s_waitcnt lgkmcnt(6)
  ds_read_b64_tr_b16 v[164:165], v220 offset:128
  ds_read_b64_tr_b16 v[166:167], v220 offset:640
  v_mfma_f32_16x16x32_bf16 v[24:27], v[148:151], a[44:47], v[24:27]
  s_nop 0
  ds_read_b64_tr_b16 v[168:169], v220 offset:8832
  ds_read_b64_tr_b16 v[170:171], v220 offset:9344
  v_mfma_f32_16x16x32_bf16 v[28:31], a[244:247], a[96:99], v[28:31]
  s_nop 0
  ds_read_b64_tr_b16 v[172:173], v220 offset:17536
  ds_read_b64_tr_b16 v[174:175], v220 offset:18048
  v_mfma_f32_16x16x32_bf16 v[28:31], a[248:251], a[100:103], v[28:31]
  s_nop 0
  ds_read_b64_tr_b16 v[176:177], v220 offset:26240
  ds_read_b64_tr_b16 v[178:179], v220 offset:26752
  v_mfma_f32_16x16x32_bf16 v[28:31], a[252:255], a[104:107], v[28:31]
  v_accvgpr_write_b32 a146, v114
  v_accvgpr_write_b32 a147, v115
  v_mfma_f32_16x16x32_bf16 v[28:31], v[148:151], a[108:111], v[28:31]
  s_waitcnt lgkmcnt(10)
  v_accvgpr_write_b32 a148, v116
  v_accvgpr_write_b32 a149, v117
  v_mfma_f32_16x16x32_bf16 v[128:131], v[156:159], v[152:155], v[128:131]
  s_waitcnt lgkmcnt(8)
  v_accvgpr_write_b32 a150, v118
  v_accvgpr_write_b32 a151, v119
  v_mfma_f32_16x16x32_bf16 v[132:135], v[160:163], v[152:155], v[132:135]
  s_waitcnt lgkmcnt(6)
  ds_read_b64_tr_b16 a[224:225], v220 offset:136
  ds_read_b64_tr_b16 a[226:227], v220 offset:648
  ds_read_b64_tr_b16 a[228:229], v220 offset:8840
  ds_read_b64_tr_b16 a[230:231], v220 offset:9352
  v_mfma_f32_16x16x32_bf16 v[32:35], v[164:167], a[32:35], v[32:35]
  s_waitcnt lgkmcnt(8)
  ds_read_b64_tr_b16 a[232:233], v220 offset:17544
  ds_read_b64_tr_b16 a[234:235], v220 offset:18056
  ds_read_b64_tr_b16 a[236:237], v220 offset:26248
  ds_read_b64_tr_b16 a[238:239], v220 offset:26760
  v_mfma_f32_16x16x32_bf16 v[32:35], v[168:171], a[36:39], v[32:35]
  s_waitcnt lgkmcnt(10)
  v_accvgpr_write_b32 a152, v120
  v_mfma_f32_16x16x32_bf16 v[32:35], v[172:175], a[40:43], v[32:35]
  s_waitcnt lgkmcnt(8)
  v_accvgpr_write_b32 a153, v121
  v_mov_b32 v136, 0
  v_mfma_f32_16x16x32_bf16 v[32:35], v[176:179], a[44:47], v[32:35]
  v_accvgpr_write_b32 a154, v122
  v_accvgpr_write_b32 a155, v123
  v_mfma_f32_16x16x32_bf16 v[36:39], v[164:167], a[96:99], v[36:39]
  s_nop 0
  ds_read_b64_tr_b16 a[240:241], v220 offset:192
  ds_read_b64_tr_b16 a[242:243], v220 offset:704
  v_mfma_f32_16x16x32_bf16 v[36:39], v[168:171], a[100:103], v[36:39]
  s_nop 0
  ds_read_b64_tr_b16 a[244:245], v220 offset:8896
  ds_read_b64_tr_b16 a[246:247], v220 offset:9408
  ds_read_b64_tr_b16 a[248:249], v220 offset:17600
  ds_read_b64_tr_b16 a[250:251], v220 offset:18112
  ds_read_b64_tr_b16 a[252:253], v220 offset:26304
  ds_read_b64_tr_b16 a[254:255], v220 offset:26816
  v_mfma_f32_16x16x32_bf16 v[36:39], v[172:175], a[104:107], v[36:39]
  v_accvgpr_write_b32 a156, v124
  v_accvgpr_write_b32 a157, v125
  v_mfma_f32_16x16x32_bf16 v[36:39], v[176:179], a[108:111], v[36:39]
  s_waitcnt lgkmcnt(8)
  v_accvgpr_write_b32 a158, v126
  v_mov_b32 v137, 0
  v_mfma_f32_16x16x32_bf16 v[40:43], a[224:227], a[32:35], v[40:43]
  v_accvgpr_write_b32 a159, v127
  v_mov_b32 v138, 0
  v_mfma_f32_16x16x32_bf16 v[40:43], a[228:231], a[36:39], v[40:43]
  v_mov_b32 v139, 0
  v_mov_b32 v140, 0
  v_mfma_f32_16x16x32_bf16 v[40:43], a[232:235], a[40:43], v[40:43]
  s_nop 0
  ds_read_b64_tr_b16 v[148:149], v220 offset:200
  ds_read_b64_tr_b16 v[150:151], v220 offset:712
  ds_read_b64_tr_b16 v[152:153], v220 offset:8904
  ds_read_b64_tr_b16 v[154:155], v220 offset:9416
  ds_read_b64_tr_b16 v[156:157], v220 offset:17608
  ds_read_b64_tr_b16 v[158:159], v220 offset:18120
  v_mfma_f32_16x16x32_bf16 v[40:43], a[236:239], a[44:47], v[40:43]
  s_nop 0
  ds_read_b64_tr_b16 v[160:161], v220 offset:26312
  ds_read_b64_tr_b16 v[162:163], v220 offset:26824
  v_mfma_f32_16x16x32_bf16 v[44:47], a[224:227], a[96:99], v[44:47]
  v_mov_b32 v141, 0
  v_mov_b32 v142, 0
  v_mfma_f32_16x16x32_bf16 v[44:47], a[228:231], a[100:103], v[44:47]
  v_mov_b32 v143, 0
  v_mov_b32 v144, 0
  v_mfma_f32_16x16x32_bf16 v[44:47], a[232:235], a[104:107], v[44:47]
  v_mov_b32 v145, 0
  v_mov_b32 v146, 0
  v_mfma_f32_16x16x32_bf16 v[44:47], a[236:239], a[108:111], v[44:47]
  s_waitcnt lgkmcnt(8)
  v_mov_b32 v147, 0
  v_mfma_f32_16x16x32_bf16 v[48:51], a[240:243], a[32:35], v[48:51]
  s_cmp_eq_u32 s94, 2
  s_cselect_b32 s43, s95, 0x1000
  buffer_store_byte v196, off, s[4:7], s43 sc1
  v_mfma_f32_16x16x32_bf16 v[48:51], a[244:247], a[36:39], v[48:51]
  s_waitcnt lgkmcnt(0)
  s_waitcnt vmcnt(1)
  s_barrier
  ds_read_b64_tr_b16 v[164:165], v221 offset:0
  v_mfma_f32_16x16x32_bf16 v[48:51], a[248:251], a[40:43], v[48:51]
  s_nop 0
  ds_read_b64_tr_b16 v[166:167], v221 offset:512
  ds_read_b64_tr_b16 v[168:169], v221 offset:8704
  v_mfma_f32_16x16x32_bf16 v[48:51], a[252:255], a[44:47], v[48:51]
  s_add_u32 s42, s1, 131072
  ds_read_b64_tr_b16 v[170:171], v221 offset:9216
  ds_read_b64_tr_b16 v[172:173], v221 offset:17408
  v_mfma_f32_16x16x32_bf16 v[52:55], a[240:243], a[96:99], v[52:55]
  s_mov_b32 m0, s39
  ds_read_b64_tr_b16 v[174:175], v221 offset:17920
  ds_read_b64_tr_b16 v[176:177], v221 offset:26112
  v_mfma_f32_16x16x32_bf16 v[52:55], a[244:247], a[100:103], v[52:55]
  s_nop 0
  ds_read_b64_tr_b16 v[178:179], v221 offset:26624
  buffer_load_dwordx4 v225, s[16:19], s42 offen nt lds
  v_mfma_f32_16x16x32_bf16 v[52:55], a[248:251], a[104:107], v[52:55]
  ds_read_b64 a[224:225], v224 offset:768
  v_mfma_f32_16x16x32_bf16 v[52:55], a[252:255], a[108:111], v[52:55]
  ds_read_b64 a[226:227], v224 offset:800
  ds_read_b64_tr_b16 a[228:229], v223 offset:0
  v_mfma_f32_16x16x32_bf16 v[56:59], v[148:151], a[32:35], v[56:59]
  s_add_u32 m0, m0, 32
  ds_read_b64_tr_b16 a[230:231], v223 offset:512
  v_mfma_f32_16x16x32_bf16 v[56:59], v[152:155], a[36:39], v[56:59]
  s_nop 0
  ds_read_b64_tr_b16 a[232:233], v223 offset:8
  ds_read_b64_tr_b16 a[234:235], v223 offset:520
  v_mfma_f32_16x16x32_bf16 v[56:59], v[156:159], a[40:43], v[56:59]
  s_nop 0
  buffer_load_dwordx4 v225, s[16:19], s42 offen offset:1024 nt lds
  ds_read_b64_tr_b16 a[236:237], v221 offset:8
  v_mfma_f32_16x16x32_bf16 v[56:59], v[160:163], a[44:47], v[56:59]
  s_nop 0
  ds_read_b64_tr_b16 a[238:239], v221 offset:520
  ds_read_b64_tr_b16 a[240:241], v221 offset:8712
  v_mfma_f32_16x16x32_bf16 v[60:63], v[148:151], a[96:99], v[60:63]
  s_nop 0
  ds_read_b64_tr_b16 a[242:243], v221 offset:9224
  ds_read_b64_tr_b16 a[244:245], v221 offset:17416
  v_mfma_f32_16x16x32_bf16 v[60:63], v[152:155], a[100:103], v[60:63]
  s_add_u32 m0, m0, 32
  ds_read_b64_tr_b16 a[246:247], v221 offset:17928
  ds_read_b64_tr_b16 a[248:249], v221 offset:26120
  v_mfma_f32_16x16x32_bf16 v[60:63], v[156:159], a[104:107], v[60:63]
  s_nop 0
  ds_read_b64_tr_b16 a[250:251], v221 offset:26632
  buffer_load_dwordx4 v225, s[16:19], s42 offen offset:2048 nt lds
  v_mfma_f32_16x16x32_bf16 v[60:63], v[160:163], a[108:111], v[60:63]
  s_waitcnt lgkmcnt(14)
  ds_read_b64 a[252:253], v224 offset:832
  v_mfma_f32_16x16x32_bf16 v[0:3], v[164:167], a[48:51], v[0:3]
  ds_read_b64 a[254:255], v224 offset:864
  v_mfma_f32_16x16x32_bf16 v[0:3], v[168:171], a[52:55], v[0:3]
  s_add_u32 m0, m0, 32
  ds_read_b64_tr_b16 v[148:149], v223 offset:8704
  v_mfma_f32_16x16x32_bf16 v[0:3], v[172:175], a[56:59], v[0:3]
  s_nop 0
  ds_read_b64_tr_b16 v[150:151], v223 offset:9216
  ds_read_b64_tr_b16 v[152:153], v223 offset:8712
  v_mfma_f32_16x16x32_bf16 v[0:3], v[176:179], a[60:63], v[0:3]
  s_nop 0
  ds_read_b64_tr_b16 v[154:155], v223 offset:9224
  buffer_load_dwordx4 v225, s[16:19], s42 offen offset:3072 nt lds
  v_mfma_f32_16x16x32_bf16 v[4:7], v[164:167], a[112:115], v[4:7]
  s_nop 0
  ds_read_b64_tr_b16 v[156:157], v221 offset:64
  ds_read_b64_tr_b16 v[158:159], v221 offset:576
  v_mfma_f32_16x16x32_bf16 v[4:7], v[168:171], a[116:119], v[4:7]
  s_nop 0
  ds_read_b64_tr_b16 v[160:161], v221 offset:8768
  ds_read_b64_tr_b16 v[162:163], v221 offset:9280
  v_mfma_f32_16x16x32_bf16 v[4:7], v[172:175], a[120:123], v[4:7]
  s_add_u32 s42, s42, s52
  ds_read_b64_tr_b16 v[164:165], v221 offset:17472
  ds_read_b64_tr_b16 v[166:167], v221 offset:17984
  v_mfma_f32_16x16x32_bf16 v[4:7], v[176:179], a[124:127], v[4:7]
  s_waitcnt lgkmcnt(12)
  s_add_u32 m0, m0, s53
  ds_read_b64_tr_b16 v[168:169], v221 offset:26176
  v_mfma_f32_16x16x32_bf16 v[128:131], a[228:231], a[224:227], v[128:131]
  s_nop 0
  ds_read_b64_tr_b16 v[170:171], v221 offset:26688
  buffer_load_dwordx4 v225, s[16:19], s42 offen nt lds
  v_mfma_f32_16x16x32_bf16 v[132:135], a[232:235], a[224:227], v[132:135]
  ds_read_b64 v[172:173], v224 offset:896
  v_mfma_f32_16x16x32_bf16 v[8:11], a[236:239], a[48:51], v[8:11]
  ds_read_b64 v[174:175], v224 offset:928
  v_mfma_f32_16x16x32_bf16 v[8:11], a[240:243], a[52:55], v[8:11]
  v_mul_f32 v0, s54, v0
  v_mul_f32 v1, s54, v1
  v_mfma_f32_16x16x32_bf16 v[8:11], a[244:247], a[56:59], v[8:11]
  v_mul_f32 v2, s54, v2
  v_mul_f32 v3, s54, v3
  v_mfma_f32_16x16x32_bf16 v[8:11], a[248:251], a[60:63], v[8:11]
  s_add_u32 m0, m0, 32
  v_cvt_pk_bf16_f32 v64, v0, v1
  v_cvt_pk_bf16_f32 v65, v2, v3
  v_mfma_f32_16x16x32_bf16 v[12:15], a[236:239], a[112:115], v[12:15]
  v_mul_f32 v4, s54, v4
  v_mul_f32 v5, s54, v5
  v_mfma_f32_16x16x32_bf16 v[12:15], a[240:243], a[116:119], v[12:15]
  v_mul_f32 v6, s54, v6
  v_mul_f32 v7, s54, v7
  v_mfma_f32_16x16x32_bf16 v[12:15], a[244:247], a[120:123], v[12:15]
  v_cvt_pk_bf16_f32 v80, v4, v5
  v_cvt_pk_bf16_f32 v81, v6, v7
  v_mfma_f32_16x16x32_bf16 v[12:15], a[248:251], a[124:127], v[12:15]
  s_waitcnt lgkmcnt(2)
  ds_read_b64_tr_b16 v[176:177], v223 offset:17408
  ds_read_b64_tr_b16 v[178:179], v223 offset:17920
  v_mfma_f32_16x16x32_bf16 v[128:131], v[148:151], a[252:255], v[128:131]
  s_nop 0
  ds_read_b64_tr_b16 a[224:225], v223 offset:17416
  ds_read_b64_tr_b16 a[226:227], v223 offset:17928
  v_mfma_f32_16x16x32_bf16 v[132:135], v[152:155], a[252:255], v[132:135]
  s_nop 0
  buffer_load_dwordx4 v225, s[16:19], s42 offen offset:1024 nt lds
  ds_read_b64_tr_b16 a[228:229], v221 offset:72
  v_mfma_f32_16x16x32_bf16 v[16:19], v[156:159], a[48:51], v[16:19]
  s_nop 0
  ds_read_b64_tr_b16 a[230:231], v221 offset:584
  ds_read_b64_tr_b16 a[232:233], v221 offset:8776
  v_mfma_f32_16x16x32_bf16 v[16:19], v[160:163], a[52:55], v[16:19]
  s_nop 0
  ds_read_b64_tr_b16 a[234:235], v221 offset:9288
  ds_read_b64_tr_b16 a[236:237], v221 offset:17480
  v_mfma_f32_16x16x32_bf16 v[16:19], v[164:167], a[56:59], v[16:19]
  s_add_u32 m0, m0, 32
  ds_read_b64_tr_b16 a[238:239], v221 offset:17992
  v_mfma_f32_16x16x32_bf16 v[16:19], v[168:171], a[60:63], v[16:19]
  s_nop 0
  ds_read_b64_tr_b16 a[240:241], v221 offset:26184
  ds_read_b64_tr_b16 a[242:243], v221 offset:26696
  v_mfma_f32_16x16x32_bf16 v[20:23], v[156:159], a[112:115], v[20:23]
  buffer_load_dwordx4 v225, s[16:19], s42 offen offset:2048 nt lds
  v_mul_f32 v8, s54, v8
  v_mfma_f32_16x16x32_bf16 v[20:23], v[160:163], a[116:119], v[20:23]
  v_mul_f32 v9, s54, v9
  v_mul_f32 v10, s54, v10
  v_mfma_f32_16x16x32_bf16 v[20:23], v[164:167], a[120:123], v[20:23]
  v_mul_f32 v11, s54, v11
  v_cvt_pk_bf16_f32 v66, v8, v9
  v_mfma_f32_16x16x32_bf16 v[20:23], v[168:171], a[124:127], v[20:23]
  s_waitcnt lgkmcnt(6)
  v_cvt_pk_bf16_f32 v67, v10, v11
  v_mul_f32 v12, s54, v12
  v_mfma_f32_16x16x32_bf16 v[128:131], v[176:179], v[172:175], v[128:131]
  v_mul_f32 v13, s54, v13
  v_mul_f32 v14, s54, v14
  v_mfma_f32_16x16x32_bf16 v[132:135], a[224:227], v[172:175], v[132:135]
  v_mul_f32 v15, s54, v15
  v_cvt_pk_bf16_f32 v82, v12, v13
  v_mfma_f32_16x16x32_bf16 v[24:27], a[228:231], a[48:51], v[24:27]
  s_waitcnt lgkmcnt(0)
  ds_read_b64 a[244:245], v224 offset:960
  ds_read_b64 a[246:247], v224 offset:992
  ds_read_b64_tr_b16 a[248:249], v223 offset:26112
  ds_read_b64_tr_b16 a[250:251], v223 offset:26624
  v_mfma_f32_16x16x32_bf16 v[24:27], a[232:235], a[52:55], v[24:27]
  s_add_u32 m0, m0, 32
  ds_read_b64_tr_b16 a[252:253], v223 offset:26120
  ds_read_b64_tr_b16 a[254:255], v223 offset:26632
  v_mfma_f32_16x16x32_bf16 v[24:27], a[236:239], a[56:59], v[24:27]
  s_nop 0
  buffer_load_dwordx4 v225, s[16:19], s42 offen offset:3072 nt lds
  ds_read_b64_tr_b16 v[148:149], v221 offset:128
  ds_read_b64_tr_b16 v[150:151], v221 offset:640
  v_mfma_f32_16x16x32_bf16 v[24:27], a[240:243], a[60:63], v[24:27]
  s_nop 0
  ds_read_b64_tr_b16 v[152:153], v221 offset:8832
  ds_read_b64_tr_b16 v[154:155], v221 offset:9344
  v_mfma_f32_16x16x32_bf16 v[28:31], a[228:231], a[112:115], v[28:31]
  s_nop 0
  ds_read_b64_tr_b16 v[156:157], v221 offset:17536
  ds_read_b64_tr_b16 v[158:159], v221 offset:18048
  v_mfma_f32_16x16x32_bf16 v[28:31], a[232:235], a[116:119], v[28:31]
  s_nop 0
  ds_read_b64_tr_b16 v[160:161], v221 offset:26240
  ds_read_b64_tr_b16 v[162:163], v221 offset:26752
  v_mfma_f32_16x16x32_bf16 v[28:31], a[236:239], a[120:123], v[28:31]
  v_cvt_pk_bf16_f32 v83, v14, v15
  v_mul_f32 v16, s54, v16
  v_mfma_f32_16x16x32_bf16 v[28:31], a[240:243], a[124:127], v[28:31]
  s_waitcnt lgkmcnt(10)
  v_mul_f32 v17, s54, v17
  v_mul_f32 v18, s54, v18
  v_mfma_f32_16x16x32_bf16 v[128:131], a[248:251], a[244:247], v[128:131]
  s_waitcnt lgkmcnt(8)
  v_mul_f32 v19, s54, v19
  v_cvt_pk_bf16_f32 v68, v16, v17
  v_mfma_f32_16x16x32_bf16 v[132:135], a[252:255], a[244:247], v[132:135]
  s_waitcnt lgkmcnt(6)
  ds_read_b64_tr_b16 v[164:165], v221 offset:136
  ds_read_b64_tr_b16 v[166:167], v221 offset:648
  ds_read_b64_tr_b16 v[168:169], v221 offset:8840
  ds_read_b64_tr_b16 v[170:171], v221 offset:9352
  v_mfma_f32_16x16x32_bf16 v[32:35], v[148:151], a[48:51], v[32:35]
  s_waitcnt lgkmcnt(8)
  ds_read_b64_tr_b16 v[172:173], v221 offset:17544
  ds_read_b64_tr_b16 v[174:175], v221 offset:18056
  ds_read_b64_tr_b16 v[176:177], v221 offset:26248
  ds_read_b64_tr_b16 v[178:179], v221 offset:26760
  v_mfma_f32_16x16x32_bf16 v[32:35], v[152:155], a[52:55], v[32:35]
  s_waitcnt lgkmcnt(10)
  v_cvt_pk_bf16_f32 v69, v18, v19
  v_mul_f32 v20, s54, v20
  v_mfma_f32_16x16x32_bf16 v[32:35], v[156:159], a[56:59], v[32:35]
  s_waitcnt lgkmcnt(8)
  v_mul_f32 v21, s54, v21
  v_mul_f32 v22, s54, v22
  v_mfma_f32_16x16x32_bf16 v[32:35], v[160:163], a[60:63], v[32:35]
  v_mul_f32 v23, s54, v23
  v_cvt_pk_bf16_f32 v84, v20, v21
  v_mfma_f32_16x16x32_bf16 v[36:39], v[148:151], a[112:115], v[36:39]
  s_nop 0
  ds_read_b64_tr_b16 a[224:225], v221 offset:192
  ds_read_b64_tr_b16 a[226:227], v221 offset:704
  v_mfma_f32_16x16x32_bf16 v[36:39], v[152:155], a[116:119], v[36:39]
  s_nop 0
  ds_read_b64_tr_b16 a[228:229], v221 offset:8896
  ds_read_b64_tr_b16 a[230:231], v221 offset:9408
  ds_read_b64_tr_b16 a[232:233], v221 offset:17600
  ds_read_b64_tr_b16 a[234:235], v221 offset:18112
  ds_read_b64_tr_b16 a[236:237], v221 offset:26304
  ds_read_b64_tr_b16 a[238:239], v221 offset:26816
  v_mfma_f32_16x16x32_bf16 v[36:39], v[156:159], a[120:123], v[36:39]
  v_cvt_pk_bf16_f32 v85, v22, v23
  v_mul_f32 v128, s54, v128
  v_mfma_f32_16x16x32_bf16 v[36:39], v[160:163], a[124:127], v[36:39]
  s_waitcnt lgkmcnt(8)
  v_mul_f32 v129, s54, v129
  v_mul_f32 v130, s54, v130
  v_mfma_f32_16x16x32_bf16 v[40:43], v[164:167], a[48:51], v[40:43]
  v_mul_f32 v131, s54, v131
  v_mul_f32 v132, s54, v132
  v_mfma_f32_16x16x32_bf16 v[40:43], v[168:171], a[52:55], v[40:43]
  v_mul_f32 v133, s54, v133
  v_mul_f32 v134, s54, v134
  v_mfma_f32_16x16x32_bf16 v[40:43], v[172:175], a[56:59], v[40:43]
  s_nop 0
  ds_read_b64_tr_b16 a[240:241], v221 offset:200
  ds_read_b64_tr_b16 a[242:243], v221 offset:712
  ds_read_b64_tr_b16 a[244:245], v221 offset:8904
  ds_read_b64_tr_b16 a[246:247], v221 offset:9416
  ds_read_b64_tr_b16 a[248:249], v221 offset:17608
  ds_read_b64_tr_b16 a[250:251], v221 offset:18120
  v_mfma_f32_16x16x32_bf16 v[40:43], v[176:179], a[60:63], v[40:43]
  s_nop 0
  ds_read_b64_tr_b16 a[252:253], v221 offset:26312
  ds_read_b64_tr_b16 a[254:255], v221 offset:26824
  v_mul_f32 v135, s54, v135
  v_mfma_f32_16x16x32_bf16 v[44:47], v[164:167], a[112:115], v[44:47]
  v_cvt_pk_bf16_f32 v128, v128, v129
  v_cvt_pk_bf16_f32 v129, v130, v131
  v_mfma_f32_16x16x32_bf16 v[44:47], v[168:171], a[116:119], v[44:47]
  v_cvt_pk_bf16_f32 v130, v132, v133
  v_cvt_pk_bf16_f32 v131, v134, v135
  v_mfma_f32_16x16x32_bf16 v[44:47], v[172:175], a[120:123], v[44:47]
  ds_write_b128 v230, v[128:131]
  v_mfma_f32_16x16x32_bf16 v[44:47], v[176:179], a[124:127], v[44:47]
  s_waitcnt lgkmcnt(9)
  v_mul_f32 v24, s54, v24
  v_mul_f32 v25, s54, v25
  v_mfma_f32_16x16x32_bf16 v[48:51], a[224:227], a[48:51], v[48:51]
  s_cmp_eq_u32 s94, 3
  s_cselect_b32 s43, s95, 0x1000
  buffer_store_byte v196, off, s[4:7], s43 sc1
  v_mfma_f32_16x16x32_bf16 v[48:51], a[228:231], a[52:55], v[48:51]
  v_mul_f32 v26, s54, v26
  v_mul_f32 v27, s54, v27
  v_mfma_f32_16x16x32_bf16 v[48:51], a[232:235], a[56:59], v[48:51]
  v_cvt_pk_bf16_f32 v70, v24, v25
  v_cvt_pk_bf16_f32 v71, v26, v27
  v_mfma_f32_16x16x32_bf16 v[48:51], a[236:239], a[60:63], v[48:51]
  v_mul_f32 v28, s54, v28
  v_mul_f32 v29, s54, v29
  v_mfma_f32_16x16x32_bf16 v[52:55], a[224:227], a[112:115], v[52:55]
  v_mul_f32 v30, s54, v30
  v_mul_f32 v31, s54, v31
  v_mfma_f32_16x16x32_bf16 v[52:55], a[228:231], a[116:119], v[52:55]
  v_cvt_pk_bf16_f32 v86, v28, v29
  v_cvt_pk_bf16_f32 v87, v30, v31
  v_mfma_f32_16x16x32_bf16 v[52:55], a[232:235], a[120:123], v[52:55]
  v_mul_f32 v32, s54, v32
  v_mul_f32 v33, s54, v33
  v_mfma_f32_16x16x32_bf16 v[52:55], a[236:239], a[124:127], v[52:55]
  s_waitcnt lgkmcnt(1)
  v_mul_f32 v34, s54, v34
  v_mul_f32 v35, s54, v35
  v_mfma_f32_16x16x32_bf16 v[56:59], a[240:243], a[48:51], v[56:59]
  s_waitcnt lgkmcnt(0)
  s_barrier
  v_cvt_pk_bf16_f32 v72, v32, v33
  v_mfma_f32_16x16x32_bf16 v[56:59], a[244:247], a[52:55], v[56:59]
  v_cvt_pk_bf16_f32 v73, v34, v35
  v_mul_f32 v36, s54, v36
  v_mfma_f32_16x16x32_bf16 v[56:59], a[248:251], a[56:59], v[56:59]
  v_mul_f32 v37, s54, v37
  v_mul_f32 v38, s54, v38
  v_mfma_f32_16x16x32_bf16 v[56:59], a[252:255], a[60:63], v[56:59]
  v_mul_f32 v39, s54, v39
  v_cvt_pk_bf16_f32 v88, v36, v37
  v_mfma_f32_16x16x32_bf16 v[60:63], a[240:243], a[112:115], v[60:63]
  ds_read_b128 v[148:151], v212 offset:0
  v_cvt_pk_bf16_f32 v89, v38, v39
  v_mfma_f32_16x16x32_bf16 v[60:63], a[244:247], a[116:119], v[60:63]
  s_nop 0
  ds_read_b128 v[180:183], v248 offset:0
  ds_read_b128 v[184:187], v248 offset:1024
  v_mfma_f32_16x16x32_bf16 v[60:63], a[248:251], a[120:123], v[60:63]
  s_nop 0
  ds_read_b128 v[188:191], v248 offset:2048
  ds_read_b128 v[192:195], v248 offset:3072
  v_mfma_f32_16x16x32_bf16 v[60:63], a[252:255], a[124:127], v[60:63]
  s_nop 5
  s_nop 0
  ds_read_b128 v[152:155], v212 offset:64
  ds_read_b128 v[156:159], v212 offset:128
  ds_read_b128 v[160:163], v212 offset:192
  v_mul_f32 v40, s54, v40
  v_mul_f32 v41, s54, v41
  v_mul_f32 v42, s54, v42
  v_mul_f32 v43, s54, v43
  v_cvt_pk_bf16_f32 v74, v40, v41
  v_cvt_pk_bf16_f32 v75, v42, v43
  v_mul_f32 v44, s54, v44
  v_mul_f32 v45, s54, v45
  v_mul_f32 v46, s54, v46
  v_mul_f32 v47, s54, v47
  v_cvt_pk_bf16_f32 v90, v44, v45
  v_cvt_pk_bf16_f32 v91, v46, v47
  v_mul_f32 v48, s54, v48
  v_mul_f32 v49, s54, v49
  v_mul_f32 v50, s54, v50
  v_mul_f32 v51, s54, v51
  v_cvt_pk_bf16_f32 v76, v48, v49
  v_cvt_pk_bf16_f32 v77, v50, v51
  v_mul_f32 v52, s54, v52
  v_mul_f32 v53, s54, v53
  v_mul_f32 v54, s54, v54
  v_mul_f32 v55, s54, v55
  v_cvt_pk_bf16_f32 v92, v52, v53
  v_cvt_pk_bf16_f32 v93, v54, v55
  v_mul_f32 v56, s54, v56
  v_mul_f32 v57, s54, v57
  v_mul_f32 v58, s54, v58
  v_mul_f32 v59, s54, v59
  v_cvt_pk_bf16_f32 v78, v56, v57
  v_cvt_pk_bf16_f32 v79, v58, v59
  v_mul_f32 v60, s54, v60
  v_mul_f32 v61, s54, v61
  v_mul_f32 v62, s54, v62
  v_mul_f32 v63, s54, v63
  v_cvt_pk_bf16_f32 v94, v60, v61
  v_cvt_pk_bf16_f32 v95, v62, v63
  s_add_u32 s0, s0, 131072
  s_add_u32 s1, s1, 131072
  s_add_u32 s2, s2, 131072
  s_add_u32 s3, s3, 131072
  s_mov_b32 s41, 1
  s_add_u32 s45, s0, 131072
  s_add_u32 s46, s47, 512
  s_mov_b32 s42, 512
  buffer_load_dword v229, v228, s[12:15], s42 offen
  s_lshl_b32 s65, s58, 2
  s_add_u32 s65, s65, s36
  s_lshl_b32 s65, s65, 11
  s_add_u32 s65, s65, 131072
  v_lshlrev_b32 v250, 1, v225
  buffer_load_dword v229, v250, s[24:27], s65 offen
  s_branch L_attn
L_q2:
  s_waitcnt vmcnt(0)
  s_barrier
  ds_read_b64_tr_b16 v[148:149], v220 offset:0
  ds_read_b64_tr_b16 v[150:151], v220 offset:512
  ds_read_b64_tr_b16 v[152:153], v220 offset:8704
  ds_read_b64_tr_b16 v[154:155], v220 offset:9216
  ds_read_b64_tr_b16 v[156:157], v220 offset:17408
  ds_read_b64_tr_b16 v[158:159], v220 offset:17920
  ds_read_b64_tr_b16 v[160:161], v220 offset:26112
  ds_read_b64_tr_b16 v[162:163], v220 offset:26624
  ds_read_b64 v[164:165], v224 offset:0
  ds_read_b64 v[166:167], v224 offset:32
  ds_read_b64_tr_b16 v[168:169], v222 offset:0
  ds_read_b64_tr_b16 v[170:171], v222 offset:512
  ds_read_b64_tr_b16 v[172:173], v222 offset:8
  ds_read_b64_tr_b16 v[174:175], v222 offset:520
  v_rcp_f32 v251, v200
  v_rcp_f32 v252, v204
  v_cmp_lt_f32 vcc, s55, v200
  v_cmp_gt_f32 s[66:67], s56, v200
  s_and_b64 s[68:69], vcc, s[66:67]
  v_cmp_lt_f32 vcc, s55, v204
  v_cmp_gt_f32 s[66:67], s56, v204
  s_and_b64 s[68:69], s[68:69], vcc
  v_mov_b32 v250, s57
  s_and_b64 vcc, s[68:69], s[66:67]
  v_mul_f32 v0, v251, v0
  v_mul_f32 v1, v251, v1
  v_mul_f32 v2, v251, v2
  v_mul_f32 v3, v251, v3
  v_cvt_pk_bf16_f32 v96, v0, v1
  v_cvt_pk_bf16_f32 v97, v2, v3
  v_mul_f32 v4, v252, v4
  v_mul_f32 v5, v252, v5
  v_mul_f32 v6, v252, v6
  v_mul_f32 v7, v252, v7
  v_cvt_pk_bf16_f32 v112, v4, v5
  v_cvt_pk_bf16_f32 v113, v6, v7
  v_cndmask_b32 v250, v250, 0, vcc
  ds_write_b32 v231, v250 offset:1024
  s_add_u32 s42, s47, 1049088
  s_mov_b32 m0, s40
  s_waitcnt lgkmcnt(13)
  v_mfma_f32_16x16x32_bf16 v[0:3], v[148:151], a[0:3], 0
  s_waitcnt lgkmcnt(11)
  v_mul_f32 v8, v251, v8
  v_mul_f32 v9, v251, v9
  v_mfma_f32_16x16x32_bf16 v[0:3], v[152:155], a[4:7], v[0:3]
  s_waitcnt lgkmcnt(9)
  v_mul_f32 v10, v251, v10
  v_mul_f32 v11, v251, v11
  v_mfma_f32_16x16x32_bf16 v[0:3], v[156:159], a[8:11], v[0:3]
  s_waitcnt lgkmcnt(7)
  ds_read_b64_tr_b16 v[176:177], v220 offset:8
  ds_read_b64_tr_b16 v[178:179], v220 offset:520
  v_mfma_f32_16x16x32_bf16 v[0:3], v[160:163], a[12:15], v[0:3]
  s_nop 0
  ds_read_b64_tr_b16 a[224:225], v220 offset:8712
  ds_read_b64_tr_b16 a[226:227], v220 offset:9224
  v_mfma_f32_16x16x32_bf16 v[4:7], v[148:151], a[64:67], 0
  s_nop 0
  buffer_load_dwordx4 v227, s[12:15], s42 offen lds
  ds_read_b64_tr_b16 a[228:229], v220 offset:17416
  ds_read_b64_tr_b16 a[230:231], v220 offset:17928
  v_mfma_f32_16x16x32_bf16 v[4:7], v[152:155], a[68:71], v[4:7]
  s_nop 0
  ds_read_b64_tr_b16 a[232:233], v220 offset:26120
  ds_read_b64_tr_b16 a[234:235], v220 offset:26632
  v_mfma_f32_16x16x32_bf16 v[4:7], v[156:159], a[72:75], v[4:7]
  s_add_u32 s42, s42, s49
  s_add_u32 m0, m0, s50
  v_cvt_pk_bf16_f32 v98, v8, v9
  v_mfma_f32_16x16x32_bf16 v[4:7], v[160:163], a[76:79], v[4:7]
  s_waitcnt lgkmcnt(9)
  v_cvt_pk_bf16_f32 v99, v10, v11
  v_mul_f32 v12, v252, v12
  v_mfma_f32_16x16x32_bf16 v[128:131], v[168:171], v[164:167], 0
  buffer_load_dwordx4 v227, s[12:15], s42 offen lds
  v_mul_f32 v13, v252, v13
  v_mfma_f32_16x16x32_bf16 v[132:135], v[172:175], v[164:167], 0
  s_waitcnt lgkmcnt(6)
  v_mul_f32 v14, v252, v14
  v_mul_f32 v15, v252, v15
  v_cvt_pk_bf16_f32 v114, v12, v13
  v_cvt_pk_bf16_f32 v115, v14, v15
  v_mfma_f32_16x16x32_bf16 v[8:11], v[176:179], a[0:3], 0
  s_waitcnt lgkmcnt(4)
  ds_read_b64 a[236:237], v224 offset:64
  ds_read_b64 a[238:239], v224 offset:96
  ds_read_b64_tr_b16 a[240:241], v222 offset:8704
  ds_read_b64_tr_b16 a[242:243], v222 offset:9216
  v_mfma_f32_16x16x32_bf16 v[8:11], a[224:227], a[4:7], v[8:11]
  s_waitcnt lgkmcnt(6)
  s_add_u32 s42, s42, s49
  s_add_u32 m0, m0, s50
  ds_read_b64_tr_b16 a[244:245], v222 offset:8712
  ds_read_b64_tr_b16 a[246:247], v222 offset:9224
  v_mfma_f32_16x16x32_bf16 v[8:11], a[228:231], a[8:11], v[8:11]
  s_waitcnt lgkmcnt(6)
  buffer_load_dwordx4 v227, s[12:15], s42 offen lds
  ds_read_b64_tr_b16 a[248:249], v220 offset:64
  ds_read_b64_tr_b16 a[250:251], v220 offset:576
  v_mfma_f32_16x16x32_bf16 v[8:11], a[232:235], a[12:15], v[8:11]
  s_nop 0
  ds_read_b64_tr_b16 a[252:253], v220 offset:8768
  ds_read_b64_tr_b16 a[254:255], v220 offset:9280
  v_mfma_f32_16x16x32_bf16 v[12:15], v[176:179], a[64:67], 0
  s_add_u32 s42, s42, s49
  ds_read_b64_tr_b16 v[148:149], v220 offset:17472
  ds_read_b64_tr_b16 v[150:151], v220 offset:17984
  v_mfma_f32_16x16x32_bf16 v[12:15], a[224:227], a[68:71], v[12:15]
  s_add_u32 m0, m0, s50
  ds_read_b64_tr_b16 v[152:153], v220 offset:26176
  ds_read_b64_tr_b16 v[154:155], v220 offset:26688
  v_mfma_f32_16x16x32_bf16 v[12:15], a[228:231], a[72:75], v[12:15]
  buffer_load_dwordx4 v227, s[12:15], s42 offen lds
  v_mul_f32 v16, v251, v16
  v_mfma_f32_16x16x32_bf16 v[12:15], a[232:235], a[76:79], v[12:15]
  s_waitcnt lgkmcnt(10)
  v_mul_f32 v17, v251, v17
  v_mul_f32 v18, v251, v18
  v_mfma_f32_16x16x32_bf16 v[128:131], a[240:243], a[236:239], v[128:131]
  s_waitcnt lgkmcnt(8)
  v_mul_f32 v19, v251, v19
  v_cvt_pk_bf16_f32 v100, v16, v17
  v_mfma_f32_16x16x32_bf16 v[132:135], a[244:247], a[236:239], v[132:135]
  s_waitcnt lgkmcnt(6)
  s_add_u32 s42, s42, s49
  s_add_u32 m0, m0, s51
  v_cvt_pk_bf16_f32 v101, v18, v19
  v_mul_f32 v20, v252, v20
  v_mul_f32 v21, v252, v21
  v_mul_f32 v22, v252, v22
  v_mul_f32 v23, v252, v23
  v_cvt_pk_bf16_f32 v116, v20, v21
  v_cvt_pk_bf16_f32 v117, v22, v23
  v_mfma_f32_16x16x32_bf16 v[16:19], a[248:251], a[0:3], 0
  s_waitcnt lgkmcnt(4)
  buffer_load_dwordx4 v227, s[12:15], s42 offen lds
  ds_read_b64 v[156:157], v224 offset:128
  ds_read_b64 v[158:159], v224 offset:160
  ds_read_b64_tr_b16 v[160:161], v222 offset:17408
  ds_read_b64_tr_b16 v[162:163], v222 offset:17920
  v_mfma_f32_16x16x32_bf16 v[16:19], a[252:255], a[4:7], v[16:19]
  s_waitcnt lgkmcnt(6)
  ds_read_b64_tr_b16 v[164:165], v222 offset:17416
  ds_read_b64_tr_b16 v[166:167], v222 offset:17928
  v_mfma_f32_16x16x32_bf16 v[16:19], v[148:151], a[8:11], v[16:19]
  s_waitcnt lgkmcnt(6)
  ds_read_b64_tr_b16 v[168:169], v220 offset:72
  ds_read_b64_tr_b16 v[170:171], v220 offset:584
  v_mfma_f32_16x16x32_bf16 v[16:19], v[152:155], a[12:15], v[16:19]
  s_add_u32 s42, s42, s49
  s_add_u32 m0, m0, s50
  ds_read_b64_tr_b16 v[172:173], v220 offset:8776
  ds_read_b64_tr_b16 v[174:175], v220 offset:9288
  v_mfma_f32_16x16x32_bf16 v[20:23], a[248:251], a[64:67], 0
  s_nop 0
  buffer_load_dwordx4 v227, s[12:15], s42 offen lds
  ds_read_b64_tr_b16 v[176:177], v220 offset:17480
  ds_read_b64_tr_b16 v[178:179], v220 offset:17992
  v_mfma_f32_16x16x32_bf16 v[20:23], a[252:255], a[68:71], v[20:23]
  s_nop 0
  ds_read_b64_tr_b16 a[224:225], v220 offset:26184
  ds_read_b64_tr_b16 a[226:227], v220 offset:26696
  v_mfma_f32_16x16x32_bf16 v[20:23], v[148:151], a[72:75], v[20:23]
  s_add_u32 s42, s42, s49
  v_mul_f32 v24, v251, v24
  v_mul_f32 v25, v251, v25
  v_mfma_f32_16x16x32_bf16 v[20:23], v[152:155], a[76:79], v[20:23]
  s_waitcnt lgkmcnt(10)
  s_add_u32 m0, m0, s50
  v_mul_f32 v26, v251, v26
  v_mfma_f32_16x16x32_bf16 v[128:131], v[160:163], v[156:159], v[128:131]
  s_waitcnt lgkmcnt(8)
  buffer_load_dwordx4 v227, s[12:15], s42 offen lds
  ds_read_b128 v[180:183], v253 offset:0
  v_mfma_f32_16x16x32_bf16 v[132:135], v[164:167], v[156:159], v[132:135]
  s_waitcnt lgkmcnt(7)
  v_mul_f32 v27, v251, v27
  v_cvt_pk_bf16_f32 v102, v24, v25
  v_cvt_pk_bf16_f32 v103, v26, v27
  v_mul_f32 v28, v252, v28
  v_mul_f32 v29, v252, v29
  v_mul_f32 v30, v252, v30
  v_mul_f32 v31, v252, v31
  v_cvt_pk_bf16_f32 v118, v28, v29
  v_cvt_pk_bf16_f32 v119, v30, v31
  v_mfma_f32_16x16x32_bf16 v[24:27], v[168:171], a[0:3], 0
  s_waitcnt lgkmcnt(5)
  ds_read_b64 a[228:229], v224 offset:192
  ds_read_b64 a[230:231], v224 offset:224
  ds_read_b64_tr_b16 a[232:233], v222 offset:26112
  ds_read_b64_tr_b16 a[234:235], v222 offset:26624
  v_mfma_f32_16x16x32_bf16 v[24:27], v[172:175], a[4:7], v[24:27]
  s_waitcnt lgkmcnt(7)
  s_add_u32 s42, s42, s49
  s_add_u32 m0, m0, s50
  ds_read_b64_tr_b16 a[236:237], v222 offset:26120
  ds_read_b64_tr_b16 a[238:239], v222 offset:26632
  v_mfma_f32_16x16x32_bf16 v[24:27], v[176:179], a[8:11], v[24:27]
  s_waitcnt lgkmcnt(7)
  buffer_load_dwordx4 v227, s[12:15], s42 offen lds
  ds_read_b64_tr_b16 a[240:241], v220 offset:128
  ds_read_b64_tr_b16 a[242:243], v220 offset:640
  v_mfma_f32_16x16x32_bf16 v[24:27], a[224:227], a[12:15], v[24:27]
  s_nop 0
  ds_read_b64_tr_b16 a[244:245], v220 offset:8832
  ds_read_b64_tr_b16 a[246:247], v220 offset:9344
  v_mfma_f32_16x16x32_bf16 v[28:31], v[168:171], a[64:67], 0
  s_nop 0
  ds_read_b64_tr_b16 a[248:249], v220 offset:17536
  ds_read_b64_tr_b16 a[250:251], v220 offset:18048
  v_mfma_f32_16x16x32_bf16 v[28:31], v[172:175], a[68:71], v[28:31]
  s_nop 0
  ds_read_b64_tr_b16 a[252:253], v220 offset:26240
  ds_read_b64_tr_b16 a[254:255], v220 offset:26752
  v_mfma_f32_16x16x32_bf16 v[28:31], v[176:179], a[72:75], v[28:31]
  v_mul_f32 v32, v251, v32
  v_mul_f32 v33, v251, v33
  v_mfma_f32_16x16x32_bf16 v[28:31], a[224:227], a[76:79], v[28:31]
  s_waitcnt lgkmcnt(10)
  ds_read_b128 v[184:187], v253 offset:1024
  v_mul_f32 v34, v251, v34
  v_mfma_f32_16x16x32_bf16 v[128:131], a[232:235], a[228:231], v[128:131]
  s_waitcnt lgkmcnt(9)
  ds_read_b128 v[188:191], v253 offset:8192
  ds_read_b128 v[192:195], v253 offset:9216
  v_mfma_f32_16x16x32_bf16 v[132:135], a[236:239], a[228:231], v[132:135]
  s_waitcnt lgkmcnt(9)
  ds_read_b64_tr_b16 v[148:149], v220 offset:136
  ds_read_b64_tr_b16 v[150:151], v220 offset:648
  ds_read_b64_tr_b16 v[152:153], v220 offset:8840
  ds_read_b64_tr_b16 v[154:155], v220 offset:9352
  v_mul_f32 v35, v251, v35
  v_cvt_pk_bf16_f32 v104, v32, v33
  v_cvt_pk_bf16_f32 v105, v34, v35
  v_mul_f32 v36, v252, v36
  v_mul_f32 v37, v252, v37
  v_mul_f32 v38, v252, v38
  v_mul_f32 v39, v252, v39
  v_cvt_pk_bf16_f32 v120, v36, v37
  v_cvt_pk_bf16_f32 v121, v38, v39
  v_mfma_f32_16x16x32_bf16 v[32:35], a[240:243], a[0:3], 0
  s_waitcnt lgkmcnt(11)
  ds_read_b64_tr_b16 v[156:157], v220 offset:17544
  ds_read_b64_tr_b16 v[158:159], v220 offset:18056
  ds_read_b64_tr_b16 v[160:161], v220 offset:26248
  ds_read_b64_tr_b16 v[162:163], v220 offset:26760
  v_mfma_f32_16x16x32_bf16 v[32:35], a[244:247], a[4:7], v[32:35]
  s_waitcnt lgkmcnt(13)
  v_mul_f32 v40, v251, v40
  v_mul_f32 v41, v251, v41
  v_mfma_f32_16x16x32_bf16 v[32:35], a[248:251], a[8:11], v[32:35]
  s_waitcnt lgkmcnt(11)
  ds_read_b128 v[200:203], v253 offset:16384
  ds_read_b128 v[204:207], v253 offset:17408
  v_mfma_f32_16x16x32_bf16 v[32:35], a[252:255], a[12:15], v[32:35]
  s_nop 0
  ds_read_b32 v208, v254 offset:0
  ds_read_b32 v209, v254 offset:256
  ds_read_b32 v210, v254 offset:512
  ds_read_b32 v211, v254 offset:768
  v_mfma_f32_16x16x32_bf16 v[36:39], a[240:243], a[64:67], 0
  s_nop 0
  ds_read_b64_tr_b16 v[164:165], v220 offset:192
  ds_read_b64_tr_b16 v[166:167], v220 offset:704
  v_mfma_f32_16x16x32_bf16 v[36:39], a[244:247], a[68:71], v[36:39]
  s_nop 0
  ds_read_b64_tr_b16 v[168:169], v220 offset:8896
  ds_read_b64_tr_b16 v[170:171], v220 offset:9408
  ds_read_b64_tr_b16 v[172:173], v220 offset:17600
  ds_read_b64_tr_b16 v[174:175], v220 offset:18112
  ds_read_b64_tr_b16 v[176:177], v220 offset:26304
  ds_read_b64_tr_b16 v[178:179], v220 offset:26816
  v_mfma_f32_16x16x32_bf16 v[36:39], a[248:251], a[72:75], v[36:39]
  v_mul_f32 v42, v251, v42
  v_mul_f32 v43, v251, v43
  v_mfma_f32_16x16x32_bf16 v[36:39], a[252:255], a[76:79], v[36:39]
  s_waitcnt lgkmcnt(14)
  v_cvt_pk_bf16_f32 v106, v40, v41
  v_cvt_pk_bf16_f32 v107, v42, v43
  v_mul_f32 v44, v252, v44
  v_mul_f32 v45, v252, v45
  v_mul_f32 v46, v252, v46
  v_mul_f32 v47, v252, v47
  v_cvt_pk_bf16_f32 v122, v44, v45
  v_cvt_pk_bf16_f32 v123, v46, v47
  v_mfma_f32_16x16x32_bf16 v[40:43], v[148:151], a[0:3], 0
  v_mul_f32 v48, v251, v48
  v_mul_f32 v49, v251, v49
  v_mfma_f32_16x16x32_bf16 v[40:43], v[152:155], a[4:7], v[40:43]
  v_mul_f32 v50, v251, v50
  v_mul_f32 v51, v251, v51
  v_mfma_f32_16x16x32_bf16 v[40:43], v[156:159], a[8:11], v[40:43]
  s_nop 0
  ds_read_b64_tr_b16 a[224:225], v220 offset:200
  ds_read_b64_tr_b16 a[226:227], v220 offset:712
  ds_read_b64_tr_b16 a[228:229], v220 offset:8904
  ds_read_b64_tr_b16 a[230:231], v220 offset:9416
  ds_read_b64_tr_b16 a[232:233], v220 offset:17608
  ds_read_b64_tr_b16 a[234:235], v220 offset:18120
  v_mfma_f32_16x16x32_bf16 v[40:43], v[160:163], a[12:15], v[40:43]
  s_waitcnt lgkmcnt(14)
  ds_read_b64_tr_b16 a[236:237], v220 offset:26312
  ds_read_b64_tr_b16 a[238:239], v220 offset:26824
  v_mfma_f32_16x16x32_bf16 v[44:47], v[148:151], a[64:67], 0
  v_add_f32 v180, v180, v188
  v_add_f32 v181, v181, v189
  v_mfma_f32_16x16x32_bf16 v[44:47], v[152:155], a[68:71], v[44:47]
  v_add_f32 v182, v182, v190
  v_add_f32 v183, v183, v191
  v_mfma_f32_16x16x32_bf16 v[44:47], v[156:159], a[72:75], v[44:47]
  v_add_f32 v184, v184, v192
  v_add_f32 v185, v185, v193
  v_mfma_f32_16x16x32_bf16 v[44:47], v[160:163], a[76:79], v[44:47]
  s_waitcnt lgkmcnt(8)
  v_add_f32 v186, v186, v194
  v_add_f32 v187, v187, v195
  v_cvt_pk_bf16_f32 v108, v48, v49
  v_cvt_pk_bf16_f32 v109, v50, v51
  v_mul_f32 v52, v252, v52
  v_mul_f32 v53, v252, v53
  v_mul_f32 v54, v252, v54
  v_mul_f32 v55, v252, v55
  v_cvt_pk_bf16_f32 v124, v52, v53
  v_cvt_pk_bf16_f32 v125, v54, v55
  v_mfma_f32_16x16x32_bf16 v[48:51], v[164:167], a[0:3], 0
  s_cmp_eq_u32 s94, 4
  s_cselect_b32 s43, s95, 0x1000
  buffer_store_byte v196, off, s[4:7], s43 sc1
  ds_read_b128 v[188:191], v253 offset:24576
  ds_read_b128 v[192:195], v253 offset:25600
  v_mfma_f32_16x16x32_bf16 v[48:51], v[168:171], a[4:7], v[48:51]
  v_mul_f32 v56, v251, v56
  v_mul_f32 v57, v251, v57
  v_mfma_f32_16x16x32_bf16 v[48:51], v[172:175], a[8:11], v[48:51]
  v_mul_f32 v58, v251, v58
  v_mul_f32 v59, v251, v59
  v_mfma_f32_16x16x32_bf16 v[48:51], v[176:179], a[12:15], v[48:51]
  v_cvt_pk_bf16_f32 v110, v56, v57
  v_cvt_pk_bf16_f32 v111, v58, v59
  v_mfma_f32_16x16x32_bf16 v[52:55], v[164:167], a[64:67], 0
  v_mul_f32 v60, v252, v60
  v_mul_f32 v61, v252, v61
  v_mfma_f32_16x16x32_bf16 v[52:55], v[168:171], a[68:71], v[52:55]
  v_mul_f32 v62, v252, v62
  v_mul_f32 v63, v252, v63
  v_mfma_f32_16x16x32_bf16 v[52:55], v[172:175], a[72:75], v[52:55]
  s_waitcnt lgkmcnt(0)
  s_waitcnt vmcnt(1)
  s_barrier
  v_cvt_pk_bf16_f32 v126, v60, v61
  v_mfma_f32_16x16x32_bf16 v[52:55], v[176:179], a[76:79], v[52:55]
  ds_read_b64_tr_b16 a[240:241], v221 offset:0
  v_cvt_pk_bf16_f32 v127, v62, v63
  v_mfma_f32_16x16x32_bf16 v[56:59], a[224:227], a[0:3], 0
  s_nop 0
  ds_read_b64_tr_b16 a[242:243], v221 offset:512
  ds_read_b64_tr_b16 a[244:245], v221 offset:8704
  v_mfma_f32_16x16x32_bf16 v[56:59], a[228:231], a[4:7], v[56:59]
  s_add_u32 s42, s48, 2097664
  ds_read_b64_tr_b16 a[246:247], v221 offset:9216
  v_mfma_f32_16x16x32_bf16 v[56:59], a[232:235], a[8:11], v[56:59]
  s_nop 0
  ds_read_b64_tr_b16 a[248:249], v221 offset:17408
  ds_read_b64_tr_b16 a[250:251], v221 offset:17920
  v_mfma_f32_16x16x32_bf16 v[56:59], a[236:239], a[12:15], v[56:59]
  s_mov_b32 m0, s39
  ds_read_b64_tr_b16 a[252:253], v221 offset:26112
  ds_read_b64_tr_b16 a[254:255], v221 offset:26624
  v_mfma_f32_16x16x32_bf16 v[60:63], a[224:227], a[64:67], 0
  s_nop 0
  buffer_load_dwordx4 v227, s[12:15], s42 offen lds
  ds_read_b64 v[148:149], v224 offset:256
  v_mfma_f32_16x16x32_bf16 v[60:63], a[228:231], a[68:71], v[60:63]
  s_nop 0
  ds_read_b64 v[150:151], v224 offset:288
  ds_read_b64_tr_b16 v[152:153], v223 offset:0
  v_mfma_f32_16x16x32_bf16 v[60:63], a[232:235], a[72:75], v[60:63]
  s_add_u32 s42, s42, s49
  s_add_u32 m0, m0, s50
  ds_read_b64_tr_b16 v[154:155], v223 offset:512
  v_mfma_f32_16x16x32_bf16 v[60:63], a[236:239], a[76:79], v[60:63]
  s_waitcnt lgkmcnt(10)
  buffer_load_dwordx4 v227, s[12:15], s42 offen lds
  ds_read_b64_tr_b16 v[156:157], v223 offset:8
  v_mfma_f32_16x16x32_bf16 v[0:3], a[240:243], a[16:19], v[0:3]
  s_waitcnt lgkmcnt(9)
  ds_read_b64_tr_b16 v[158:159], v223 offset:520
  ds_read_b64_tr_b16 v[160:161], v221 offset:8
  v_mfma_f32_16x16x32_bf16 v[0:3], a[244:247], a[20:23], v[0:3]
  s_waitcnt lgkmcnt(9)
  s_add_u32 s42, s42, s49
  s_add_u32 m0, m0, s50
  v_mfma_f32_16x16x32_bf16 v[0:3], a[248:251], a[24:27], v[0:3]
  s_waitcnt lgkmcnt(7)
  ds_read_b64_tr_b16 v[162:163], v221 offset:520
  ds_read_b64_tr_b16 v[164:165], v221 offset:8712
  v_mfma_f32_16x16x32_bf16 v[0:3], a[252:255], a[28:31], v[0:3]
  s_nop 0
  ds_read_b64_tr_b16 v[166:167], v221 offset:9224
  buffer_load_dwordx4 v227, s[12:15], s42 offen lds
  v_mfma_f32_16x16x32_bf16 v[4:7], a[240:243], a[80:83], v[4:7]
  s_nop 0
  ds_read_b64_tr_b16 v[168:169], v221 offset:17416
  ds_read_b64_tr_b16 v[170:171], v221 offset:17928
  v_mfma_f32_16x16x32_bf16 v[4:7], a[244:247], a[84:87], v[4:7]
  s_add_u32 s42, s42, s49
  ds_read_b64_tr_b16 v[172:173], v221 offset:26120
  ds_read_b64_tr_b16 v[174:175], v221 offset:26632
  v_mfma_f32_16x16x32_bf16 v[4:7], a[248:251], a[88:91], v[4:7]
  s_add_u32 m0, m0, s50
  ds_read_b64 v[176:177], v224 offset:320
  ds_read_b64 v[178:179], v224 offset:352
  v_mfma_f32_16x16x32_bf16 v[4:7], a[252:255], a[92:95], v[4:7]
  s_waitcnt lgkmcnt(10)
  buffer_load_dwordx4 v227, s[12:15], s42 offen lds
  ds_read_b64_tr_b16 a[224:225], v223 offset:8704
  v_mfma_f32_16x16x32_bf16 v[128:131], v[152:155], v[148:151], v[128:131]
  s_nop 0
  ds_read_b64_tr_b16 a[226:227], v223 offset:9216
  ds_read_b64_tr_b16 a[228:229], v223 offset:8712
  v_mfma_f32_16x16x32_bf16 v[132:135], v[156:159], v[148:151], v[132:135]
  s_waitcnt lgkmcnt(11)
  s_add_u32 s42, s42, s49
  s_add_u32 m0, m0, s51
  v_mfma_f32_16x16x32_bf16 v[8:11], v[160:163], a[16:19], v[8:11]
  s_waitcnt lgkmcnt(9)
  ds_read_b64_tr_b16 a[230:231], v223 offset:9224
  buffer_load_dwordx4 v227, s[12:15], s42 offen lds
  v_mfma_f32_16x16x32_bf16 v[8:11], v[164:167], a[20:23], v[8:11]
  s_waitcnt lgkmcnt(8)
  ds_read_b64_tr_b16 a[232:233], v221 offset:64
  ds_read_b64_tr_b16 a[234:235], v221 offset:576
  v_mfma_f32_16x16x32_bf16 v[8:11], v[168:171], a[24:27], v[8:11]
  s_waitcnt lgkmcnt(8)
  ds_read_b64_tr_b16 a[236:237], v221 offset:8768
  ds_read_b64_tr_b16 a[238:239], v221 offset:9280
  v_mfma_f32_16x16x32_bf16 v[8:11], v[172:175], a[28:31], v[8:11]
  s_add_u32 s42, s42, s49
  s_add_u32 m0, m0, s50
  ds_read_b64_tr_b16 a[240:241], v221 offset:17472
  v_mfma_f32_16x16x32_bf16 v[12:15], v[160:163], a[80:83], v[12:15]
  ds_read_b64_tr_b16 a[242:243], v221 offset:17984
  v_add_f32 v208, v208, v209
  v_mfma_f32_16x16x32_bf16 v[12:15], v[164:167], a[84:87], v[12:15]
  s_nop 0
  ds_read_b64_tr_b16 a[244:245], v221 offset:26176
  ds_read_b64_tr_b16 a[246:247], v221 offset:26688
  v_mfma_f32_16x16x32_bf16 v[12:15], v[168:171], a[88:91], v[12:15]
  buffer_load_dwordx4 v227, s[12:15], s42 offen lds
  v_add_f32 v210, v210, v211
  v_mfma_f32_16x16x32_bf16 v[12:15], v[172:175], a[92:95], v[12:15]
  s_waitcnt lgkmcnt(8)
  v_add_f32 v180, v180, v200
  v_add_f32 v181, v181, v201
  v_mfma_f32_16x16x32_bf16 v[128:131], a[224:227], v[176:179], v[128:131]
  v_add_f32 v182, v182, v202
  v_add_f32 v183, v183, v203
  v_mfma_f32_16x16x32_bf16 v[132:135], a[228:231], v[176:179], v[132:135]
  s_waitcnt lgkmcnt(4)
  s_add_u32 s42, s42, s49
  s_add_u32 m0, m0, s50
  v_mfma_f32_16x16x32_bf16 v[16:19], a[232:235], a[16:19], v[16:19]
  s_nop 0
  buffer_load_dwordx4 v227, s[12:15], s42 offen lds
  ds_read_b64 a[248:249], v224 offset:384
  ds_read_b64 a[250:251], v224 offset:416
  ds_read_b64_tr_b16 a[252:253], v223 offset:17408
  ds_read_b64_tr_b16 a[254:255], v223 offset:17920
  v_mfma_f32_16x16x32_bf16 v[16:19], a[236:239], a[20:23], v[16:19]
  s_waitcnt lgkmcnt(6)
  ds_read_b64_tr_b16 v[148:149], v223 offset:17416
  ds_read_b64_tr_b16 v[150:151], v223 offset:17928
  v_mfma_f32_16x16x32_bf16 v[16:19], a[240:243], a[24:27], v[16:19]
  s_waitcnt lgkmcnt(6)
  ds_read_b64_tr_b16 v[152:153], v221 offset:72
  ds_read_b64_tr_b16 v[154:155], v221 offset:584
  v_mfma_f32_16x16x32_bf16 v[16:19], a[244:247], a[28:31], v[16:19]
  s_add_u32 s42, s42, s49
  s_add_u32 m0, m0, s50
  ds_read_b64_tr_b16 v[156:157], v221 offset:8776
  ds_read_b64_tr_b16 v[158:159], v221 offset:9288
  v_mfma_f32_16x16x32_bf16 v[20:23], a[232:235], a[80:83], v[20:23]
  s_nop 0
  buffer_load_dwordx4 v227, s[12:15], s42 offen lds
  ds_read_b64_tr_b16 v[160:161], v221 offset:17480
  ds_read_b64_tr_b16 v[162:163], v221 offset:17992
  v_mfma_f32_16x16x32_bf16 v[20:23], a[236:239], a[84:87], v[20:23]
  s_add_u32 s42, s0, 131072
  s_mov_b32 m0, s38
  ds_read_b64_tr_b16 v[164:165], v221 offset:26184
  ds_read_b64_tr_b16 v[166:167], v221 offset:26696
  v_mfma_f32_16x16x32_bf16 v[20:23], a[240:243], a[88:91], v[20:23]
  buffer_load_dwordx4 v225, s[20:23], s42 offen nt lds
  v_add_f32 v184, v184, v204
  v_mfma_f32_16x16x32_bf16 v[20:23], a[244:247], a[92:95], v[20:23]
  s_waitcnt lgkmcnt(10)
  v_add_f32 v185, v185, v205
  v_add_f32 v186, v186, v206
  v_mfma_f32_16x16x32_bf16 v[128:131], a[252:255], a[248:251], v[128:131]
  s_waitcnt lgkmcnt(8)
  v_add_f32 v187, v187, v207
  v_add_f32 v208, v208, v210
  v_mfma_f32_16x16x32_bf16 v[132:135], v[148:151], a[248:251], v[132:135]
  s_waitcnt lgkmcnt(6)
  s_add_u32 m0, m0, 32
  ds_read_b64 v[168:169], v224 offset:448
  v_mfma_f32_16x16x32_bf16 v[24:27], v[152:155], a[16:19], v[24:27]
  s_waitcnt lgkmcnt(5)
  buffer_load_dwordx4 v225, s[20:23], s42 offen offset:1024 nt lds
  ds_read_b64 v[170:171], v224 offset:480
  ds_read_b64_tr_b16 v[172:173], v223 offset:26112
  ds_read_b64_tr_b16 v[174:175], v223 offset:26624
  v_mfma_f32_16x16x32_bf16 v[24:27], v[156:159], a[20:23], v[24:27]
  s_waitcnt lgkmcnt(6)
  ds_read_b64_tr_b16 v[176:177], v223 offset:26120
  ds_read_b64_tr_b16 v[178:179], v223 offset:26632
  v_mfma_f32_16x16x32_bf16 v[24:27], v[160:163], a[24:27], v[24:27]
  s_waitcnt lgkmcnt(6)
  ds_read_b64_tr_b16 a[224:225], v221 offset:128
  ds_read_b64_tr_b16 a[226:227], v221 offset:640
  v_mfma_f32_16x16x32_bf16 v[24:27], v[164:167], a[28:31], v[24:27]
  s_add_u32 m0, m0, 32
  ds_read_b64_tr_b16 a[228:229], v221 offset:8832
  ds_read_b64_tr_b16 a[230:231], v221 offset:9344
  v_mfma_f32_16x16x32_bf16 v[28:31], v[152:155], a[80:83], v[28:31]
  s_nop 0
  buffer_load_dwordx4 v225, s[20:23], s42 offen offset:2048 nt lds
  ds_read_b64_tr_b16 a[232:233], v221 offset:17536
  ds_read_b64_tr_b16 a[234:235], v221 offset:18048
  v_mfma_f32_16x16x32_bf16 v[28:31], v[156:159], a[84:87], v[28:31]
  s_nop 0
  ds_read_b64_tr_b16 a[236:237], v221 offset:26240
  ds_read_b64_tr_b16 a[238:239], v221 offset:26752
  v_mfma_f32_16x16x32_bf16 v[28:31], v[160:163], a[88:91], v[28:31]
  s_add_u32 m0, m0, 32
  v_rcp_f32 v250, v208
  v_mfma_f32_16x16x32_bf16 v[28:31], v[164:167], a[92:95], v[28:31]
  s_waitcnt lgkmcnt(10)
  v_add_f32 v180, v180, v188
  v_mfma_f32_16x16x32_bf16 v[128:131], v[172:175], v[168:171], v[128:131]
  s_waitcnt lgkmcnt(8)
  buffer_load_dwordx4 v225, s[20:23], s42 offen offset:3072 nt lds
  v_add_f32 v181, v181, v189
  v_mfma_f32_16x16x32_bf16 v[132:135], v[176:179], v[168:171], v[132:135]
  s_waitcnt lgkmcnt(6)
  ds_read_b64_tr_b16 a[240:241], v221 offset:136
  ds_read_b64_tr_b16 a[242:243], v221 offset:648
  ds_read_b64_tr_b16 a[244:245], v221 offset:8840
  ds_read_b64_tr_b16 a[246:247], v221 offset:9352
  v_mfma_f32_16x16x32_bf16 v[32:35], a[224:227], a[16:19], v[32:35]
  s_waitcnt lgkmcnt(8)
  ds_read_b64_tr_b16 a[248:249], v221 offset:17544
  ds_read_b64_tr_b16 a[250:251], v221 offset:18056
  ds_read_b64_tr_b16 a[252:253], v221 offset:26248
  ds_read_b64_tr_b16 a[254:255], v221 offset:26760
  v_mfma_f32_16x16x32_bf16 v[32:35], a[228:231], a[20:23], v[32:35]
  s_waitcnt lgkmcnt(10)
  s_add_u32 s42, s42, s52
  s_add_u32 m0, m0, s53
  v_mfma_f32_16x16x32_bf16 v[32:35], a[232:235], a[24:27], v[32:35]
  s_waitcnt lgkmcnt(8)
  buffer_load_dwordx4 v225, s[20:23], s42 offen nt lds
  v_add_f32 v182, v182, v190
  v_mfma_f32_16x16x32_bf16 v[32:35], a[236:239], a[28:31], v[32:35]
  v_add_f32 v183, v183, v191
  v_add_f32 v184, v184, v192
  v_mfma_f32_16x16x32_bf16 v[36:39], a[224:227], a[80:83], v[36:39]
  s_add_u32 m0, m0, 32
  ds_read_b64_tr_b16 v[148:149], v221 offset:192
  ds_read_b64_tr_b16 v[150:151], v221 offset:704
  v_mfma_f32_16x16x32_bf16 v[36:39], a[228:231], a[84:87], v[36:39]
  s_nop 0
  ds_read_b64_tr_b16 v[152:153], v221 offset:8896
  ds_read_b64_tr_b16 v[154:155], v221 offset:9408
  ds_read_b64_tr_b16 v[156:157], v221 offset:17600
  ds_read_b64_tr_b16 v[158:159], v221 offset:18112
  ds_read_b64_tr_b16 v[160:161], v221 offset:26304
  ds_read_b64_tr_b16 v[162:163], v221 offset:26816
  v_mfma_f32_16x16x32_bf16 v[36:39], a[232:235], a[88:91], v[36:39]
  buffer_load_dwordx4 v225, s[20:23], s42 offen offset:1024 nt lds
  v_add_f32 v185, v185, v193
  v_mfma_f32_16x16x32_bf16 v[36:39], a[236:239], a[92:95], v[36:39]
  s_waitcnt lgkmcnt(8)
  v_add_f32 v186, v186, v194
  v_add_f32 v187, v187, v195
  v_mfma_f32_16x16x32_bf16 v[40:43], a[240:243], a[16:19], v[40:43]
  v_mul_f32 v180, v250, v180
  v_mul_f32 v181, v250, v181
  v_mfma_f32_16x16x32_bf16 v[40:43], a[244:247], a[20:23], v[40:43]
  s_add_u32 m0, m0, 32
  v_mul_f32 v182, v250, v182
  v_mfma_f32_16x16x32_bf16 v[40:43], a[248:251], a[24:27], v[40:43]
  s_nop 0
  buffer_load_dwordx4 v225, s[20:23], s42 offen offset:2048 nt lds
  ds_read_b64_tr_b16 v[164:165], v221 offset:200
  ds_read_b64_tr_b16 v[166:167], v221 offset:712
  ds_read_b64_tr_b16 v[168:169], v221 offset:8904
  ds_read_b64_tr_b16 v[170:171], v221 offset:9416
  ds_read_b64_tr_b16 v[172:173], v221 offset:17608
  ds_read_b64_tr_b16 v[174:175], v221 offset:18120
  v_mfma_f32_16x16x32_bf16 v[40:43], a[252:255], a[28:31], v[40:43]
  s_nop 0
  ds_read_b64_tr_b16 v[176:177], v221 offset:26312
  ds_read_b64_tr_b16 v[178:179], v221 offset:26824
  v_mfma_f32_16x16x32_bf16 v[44:47], a[240:243], a[80:83], v[44:47]
  s_add_u32 m0, m0, 32
  v_mul_f32 v183, v250, v183
  v_mul_f32 v184, v250, v184
  v_mfma_f32_16x16x32_bf16 v[44:47], a[244:247], a[84:87], v[44:47]
  v_mul_f32 v185, v250, v185
  v_mul_f32 v186, v250, v186
  v_mul_f32 v187, v250, v187
  v_cvt_pk_bf16_f32 v236, v180, v181
  v_cvt_pk_bf16_f32 v237, v182, v183
  v_cvt_pk_bf16_f32 v238, v184, v185
  v_cvt_pk_bf16_f32 v239, v186, v187
  v_mfma_f32_16x16x32_bf16 v[44:47], a[248:251], a[88:91], v[44:47]
  buffer_load_dwordx4 v225, s[20:23], s42 offen offset:3072 nt lds
  v_accvgpr_write_b32 a160, v96
  v_mfma_f32_16x16x32_bf16 v[44:47], a[252:255], a[92:95], v[44:47]
  s_waitcnt lgkmcnt(8)
  s_cmp_eq_u32 s94, 5
  s_cselect_b32 s43, s95, 0x1000
  buffer_store_byte v196, off, s[4:7], s43 sc1
  v_mfma_f32_16x16x32_bf16 v[48:51], v[148:151], a[16:19], v[48:51]
  s_nop 0
  ds_read_b32 v188, v254 offset:1024
  ds_read_b32 v189, v254 offset:1280
  v_mfma_f32_16x16x32_bf16 v[48:51], v[152:155], a[20:23], v[48:51]
  s_nop 0
  ds_read_b32 v190, v254 offset:1536
  ds_read_b32 v191, v254 offset:1792
  v_mfma_f32_16x16x32_bf16 v[48:51], v[156:159], a[24:27], v[48:51]
  s_waitcnt lgkmcnt(4)
  s_waitcnt vmcnt(9)
  s_barrier
  ds_read_b64_tr_b16 a[224:225], v220 offset:0
  v_mfma_f32_16x16x32_bf16 v[48:51], v[160:163], a[28:31], v[48:51]
  s_add_u32 s42, s48, 3146240
  ds_read_b64_tr_b16 a[226:227], v220 offset:512
  ds_read_b64_tr_b16 a[228:229], v220 offset:8704
  v_mfma_f32_16x16x32_bf16 v[52:55], v[148:151], a[80:83], v[52:55]
  s_mov_b32 m0, s40
  ds_read_b64_tr_b16 a[230:231], v220 offset:9216
  ds_read_b64_tr_b16 a[232:233], v220 offset:17408
  v_mfma_f32_16x16x32_bf16 v[52:55], v[152:155], a[84:87], v[52:55]
  s_nop 0
  ds_read_b64_tr_b16 a[234:235], v220 offset:17920
  ds_read_b64_tr_b16 a[236:237], v220 offset:26112
  v_mfma_f32_16x16x32_bf16 v[52:55], v[156:159], a[88:91], v[52:55]
  s_nop 0
  ds_read_b64_tr_b16 a[238:239], v220 offset:26624
  buffer_load_dwordx4 v227, s[12:15], s42 offen lds
  v_mfma_f32_16x16x32_bf16 v[52:55], v[160:163], a[92:95], v[52:55]
  ds_read_b64 a[240:241], v224 offset:512
  ds_read_b64 a[242:243], v224 offset:544
  v_mfma_f32_16x16x32_bf16 v[56:59], v[164:167], a[16:19], v[56:59]
  s_waitcnt lgkmcnt(10)
  s_add_u32 s42, s42, s49
  v_mfma_f32_16x16x32_bf16 v[56:59], v[168:171], a[20:23], v[56:59]
  s_add_u32 m0, m0, s50
  ds_read_b64_tr_b16 a[244:245], v222 offset:0
  v_mfma_f32_16x16x32_bf16 v[56:59], v[172:175], a[24:27], v[56:59]
  s_nop 0
  buffer_load_dwordx4 v227, s[12:15], s42 offen lds
  ds_read_b64_tr_b16 a[246:247], v222 offset:512
  v_mfma_f32_16x16x32_bf16 v[56:59], v[176:179], a[28:31], v[56:59]
  s_nop 0
  ds_read_b64_tr_b16 a[248:249], v222 offset:8
  ds_read_b64_tr_b16 a[250:251], v222 offset:520
  v_mfma_f32_16x16x32_bf16 v[60:63], v[164:167], a[80:83], v[60:63]
  s_add_u32 s42, s42, s49
  v_add_f32 v188, v188, v189
  v_add_f32 v190, v190, v191
  v_mfma_f32_16x16x32_bf16 v[60:63], v[168:171], a[84:87], v[60:63]
  s_add_u32 m0, m0, s50
  v_add_f32 v188, v188, v208
  v_add_f32 v188, v188, v190
  v_mfma_f32_16x16x32_bf16 v[60:63], v[172:175], a[88:91], v[60:63]
  v_cmp_lt_f32 vcc, s55, v188
  v_cmp_gt_f32 s[66:67], s56, v188
  v_mfma_f32_16x16x32_bf16 v[60:63], v[176:179], a[92:95], v[60:63]
  s_waitcnt lgkmcnt(6)
  ds_read_b64_tr_b16 a[252:253], v220 offset:8
  ds_read_b64_tr_b16 a[254:255], v220 offset:520
  v_mfma_f32_16x16x32_bf16 v[0:3], a[224:227], a[32:35], v[0:3]
  s_nop 0
  ds_read_b64_tr_b16 v[148:149], v220 offset:8712
  ds_read_b64_tr_b16 v[150:151], v220 offset:9224
  v_mfma_f32_16x16x32_bf16 v[0:3], a[228:231], a[36:39], v[0:3]
  s_nop 0
  buffer_load_dwordx4 v227, s[12:15], s42 offen lds
  ds_read_b64_tr_b16 v[152:153], v220 offset:17416
  v_mfma_f32_16x16x32_bf16 v[0:3], a[232:235], a[40:43], v[0:3]
  s_nop 0
  ds_read_b64_tr_b16 v[154:155], v220 offset:17928
  ds_read_b64_tr_b16 v[156:157], v220 offset:26120
  v_mfma_f32_16x16x32_bf16 v[0:3], a[236:239], a[44:47], v[0:3]
  s_add_u32 s42, s42, s49
  s_add_u32 m0, m0, s50
  ds_read_b64_tr_b16 v[158:159], v220 offset:26632
  v_mfma_f32_16x16x32_bf16 v[4:7], a[224:227], a[96:99], v[4:7]
  s_and_b64 vcc, vcc, s[66:67]
  s_cmp_eq_u64 vcc, exec
  s_cbranch_scc1 L_ok1
  s_cmp_eq_u32 s44, 0
  s_cbranch_scc1 L_retry
L_ok1:
  s_mov_b32 s44, 0
  v_mfma_f32_16x16x32_bf16 v[4:7], a[228:231], a[100:103], v[4:7]
  buffer_load_dwordx4 v227, s[12:15], s42 offen lds
  v_accvgpr_write_b32 a161, v97
  v_mfma_f32_16x16x32_bf16 v[4:7], a[232:235], a[104:107], v[4:7]
  ds_read_b64 v[160:161], v224 offset:576
  v_accvgpr_write_b32 a162, v98
  v_mfma_f32_16x16x32_bf16 v[4:7], a[236:239], a[108:111], v[4:7]
  s_waitcnt lgkmcnt(5)
  s_add_u32 s42, s42, s49
  s_add_u32 m0, m0, s51
  v_mfma_f32_16x16x32_bf16 v[128:131], a[244:247], a[240:243], v[128:131]
  s_nop 0
  ds_read_b64 v[162:163], v224 offset:608
  ds_read_b64_tr_b16 v[164:165], v222 offset:8704
  v_mfma_f32_16x16x32_bf16 v[132:135], a[248:251], a[240:243], v[132:135]
  ds_read_b64_tr_b16 v[166:167], v222 offset:9216
  v_accvgpr_write_b32 a163, v99
  v_mfma_f32_16x16x32_bf16 v[8:11], a[252:255], a[32:35], v[8:11]
  s_nop 0
  ds_read_b64_tr_b16 v[168:169], v222 offset:8712
  ds_read_b64_tr_b16 v[170:171], v222 offset:9224
  v_mfma_f32_16x16x32_bf16 v[8:11], v[148:151], a[36:39], v[8:11]
  s_waitcnt lgkmcnt(6)
  buffer_load_dwordx4 v227, s[12:15], s42 offen lds
  v_accvgpr_write_b32 a164, v100
  v_mfma_f32_16x16x32_bf16 v[8:11], v[152:155], a[40:43], v[8:11]
  s_nop 0
  ds_read_b64_tr_b16 v[172:173], v220 offset:64
  ds_read_b64_tr_b16 v[174:175], v220 offset:576
  v_mfma_f32_16x16x32_bf16 v[8:11], v[156:159], a[44:47], v[8:11]
  s_add_u32 s42, s42, s49
  ds_read_b64_tr_b16 v[176:177], v220 offset:8768
  ds_read_b64_tr_b16 v[178:179], v220 offset:9280
  v_mfma_f32_16x16x32_bf16 v[12:15], a[252:255], a[96:99], v[12:15]
  s_add_u32 m0, m0, s50
  ds_read_b64_tr_b16 a[224:225], v220 offset:17472
  ds_read_b64_tr_b16 a[226:227], v220 offset:17984
  v_mfma_f32_16x16x32_bf16 v[12:15], v[148:151], a[100:103], v[12:15]
  s_nop 0
  ds_read_b64_tr_b16 a[228:229], v220 offset:26176
  ds_read_b64_tr_b16 a[230:231], v220 offset:26688
  v_mfma_f32_16x16x32_bf16 v[12:15], v[152:155], a[104:107], v[12:15]
  buffer_load_dwordx4 v227, s[12:15], s42 offen lds
  v_accvgpr_write_b32 a165, v101
  v_mfma_f32_16x16x32_bf16 v[12:15], v[156:159], a[108:111], v[12:15]
  s_waitcnt lgkmcnt(8)
  v_accvgpr_write_b32 a166, v102
  v_accvgpr_write_b32 a167, v103
  v_mfma_f32_16x16x32_bf16 v[128:131], v[164:167], v[160:163], v[128:131]
  v_accvgpr_write_b32 a168, v104
  v_accvgpr_write_b32 a169, v105
  v_mfma_f32_16x16x32_bf16 v[132:135], v[168:171], v[160:163], v[132:135]
  s_waitcnt lgkmcnt(6)
  s_add_u32 s42, s42, s49
  s_add_u32 m0, m0, s50
  v_mfma_f32_16x16x32_bf16 v[16:19], v[172:175], a[32:35], v[16:19]
  s_waitcnt lgkmcnt(4)
  buffer_load_dwordx4 v227, s[12:15], s42 offen lds
  ds_read_b64 a[232:233], v224 offset:640
  ds_read_b64 a[234:235], v224 offset:672
  ds_read_b64_tr_b16 a[236:237], v222 offset:17408
  ds_read_b64_tr_b16 a[238:239], v222 offset:17920
  v_mfma_f32_16x16x32_bf16 v[16:19], v[176:179], a[36:39], v[16:19]
  s_waitcnt lgkmcnt(6)
  ds_read_b64_tr_b16 a[240:241], v222 offset:17416
  ds_read_b64_tr_b16 a[242:243], v222 offset:17928
  v_mfma_f32_16x16x32_bf16 v[16:19], a[224:227], a[40:43], v[16:19]
  s_waitcnt lgkmcnt(6)
  ds_read_b64_tr_b16 a[244:245], v220 offset:72
  ds_read_b64_tr_b16 a[246:247], v220 offset:584
  v_mfma_f32_16x16x32_bf16 v[16:19], a[228:231], a[44:47], v[16:19]
  s_add_u32 s42, s42, s49
  s_add_u32 m0, m0, s50
  ds_read_b64_tr_b16 a[248:249], v220 offset:8776
  ds_read_b64_tr_b16 a[250:251], v220 offset:9288
  v_mfma_f32_16x16x32_bf16 v[20:23], v[172:175], a[96:99], v[20:23]
  s_nop 0
  buffer_load_dwordx4 v227, s[12:15], s42 offen lds
  ds_read_b64_tr_b16 a[252:253], v220 offset:17480
  ds_read_b64_tr_b16 a[254:255], v220 offset:17992
  v_mfma_f32_16x16x32_bf16 v[20:23], v[176:179], a[100:103], v[20:23]
  s_nop 0
  ds_read_b64_tr_b16 v[148:149], v220 offset:26184
  ds_read_b64_tr_b16 v[150:151], v220 offset:26696
  v_mfma_f32_16x16x32_bf16 v[20:23], a[224:227], a[104:107], v[20:23]
  v_accvgpr_write_b32 a170, v106
  v_accvgpr_write_b32 a171, v107
  v_mfma_f32_16x16x32_bf16 v[20:23], a[228:231], a[108:111], v[20:23]
  s_waitcnt lgkmcnt(10)
  v_accvgpr_write_b32 a172, v108
  v_accvgpr_write_b32 a173, v109
  v_mfma_f32_16x16x32_bf16 v[128:131], a[236:239], a[232:235], v[128:131]
  s_waitcnt lgkmcnt(8)
  v_accvgpr_write_b32 a174, v110
  v_accvgpr_write_b32 a175, v111
  v_mfma_f32_16x16x32_bf16 v[132:135], a[240:243], a[232:235], v[132:135]
  s_waitcnt lgkmcnt(6)
  v_accvgpr_write_b32 a176, v112
  v_accvgpr_write_b32 a177, v113
  v_mfma_f32_16x16x32_bf16 v[24:27], a[244:247], a[32:35], v[24:27]
  s_waitcnt lgkmcnt(4)
  ds_read_b64 v[152:153], v224 offset:704
  ds_read_b64 v[154:155], v224 offset:736
  ds_read_b64_tr_b16 v[156:157], v222 offset:26112
  ds_read_b64_tr_b16 v[158:159], v222 offset:26624
  v_mfma_f32_16x16x32_bf16 v[24:27], a[248:251], a[36:39], v[24:27]
  s_waitcnt lgkmcnt(6)
  ds_read_b64_tr_b16 v[160:161], v222 offset:26120
  ds_read_b64_tr_b16 v[162:163], v222 offset:26632
  v_mfma_f32_16x16x32_bf16 v[24:27], a[252:255], a[40:43], v[24:27]
  s_waitcnt lgkmcnt(6)
  ds_read_b64_tr_b16 v[164:165], v220 offset:128
  ds_read_b64_tr_b16 v[166:167], v220 offset:640
  v_mfma_f32_16x16x32_bf16 v[24:27], v[148:151], a[44:47], v[24:27]
  s_nop 0
  ds_read_b64_tr_b16 v[168:169], v220 offset:8832
  ds_read_b64_tr_b16 v[170:171], v220 offset:9344
  v_mfma_f32_16x16x32_bf16 v[28:31], a[244:247], a[96:99], v[28:31]
  s_nop 0
  ds_read_b64_tr_b16 v[172:173], v220 offset:17536
  ds_read_b64_tr_b16 v[174:175], v220 offset:18048
  v_mfma_f32_16x16x32_bf16 v[28:31], a[248:251], a[100:103], v[28:31]
  s_nop 0
  ds_read_b64_tr_b16 v[176:177], v220 offset:26240
  ds_read_b64_tr_b16 v[178:179], v220 offset:26752
  v_mfma_f32_16x16x32_bf16 v[28:31], a[252:255], a[104:107], v[28:31]
  v_accvgpr_write_b32 a178, v114
  v_accvgpr_write_b32 a179, v115
  v_mfma_f32_16x16x32_bf16 v[28:31], v[148:151], a[108:111], v[28:31]
  s_waitcnt lgkmcnt(10)
  v_accvgpr_write_b32 a180, v116
  v_accvgpr_write_b32 a181, v117
  v_mfma_f32_16x16x32_bf16 v[128:131], v[156:159], v[152:155], v[128:131]
  s_waitcnt lgkmcnt(8)
  v_accvgpr_write_b32 a182, v118
  v_accvgpr_write_b32 a183, v119
  v_mfma_f32_16x16x32_bf16 v[132:135], v[160:163], v[152:155], v[132:135]
  s_waitcnt lgkmcnt(6)
  ds_read_b64_tr_b16 a[224:225], v220 offset:136
  ds_read_b64_tr_b16 a[226:227], v220 offset:648
  ds_read_b64_tr_b16 a[228:229], v220 offset:8840
  ds_read_b64_tr_b16 a[230:231], v220 offset:9352
  v_mfma_f32_16x16x32_bf16 v[32:35], v[164:167], a[32:35], v[32:35]
  s_waitcnt lgkmcnt(8)
  ds_read_b64_tr_b16 a[232:233], v220 offset:17544
  ds_read_b64_tr_b16 a[234:235], v220 offset:18056
  ds_read_b64_tr_b16 a[236:237], v220 offset:26248
  ds_read_b64_tr_b16 a[238:239], v220 offset:26760
  v_mfma_f32_16x16x32_bf16 v[32:35], v[168:171], a[36:39], v[32:35]
  s_waitcnt lgkmcnt(10)
  v_accvgpr_write_b32 a184, v120
  v_mfma_f32_16x16x32_bf16 v[32:35], v[172:175], a[40:43], v[32:35]
  s_waitcnt lgkmcnt(8)
  v_accvgpr_write_b32 a185, v121
  v_mov_b32 v136, 0
  v_mfma_f32_16x16x32_bf16 v[32:35], v[176:179], a[44:47], v[32:35]
  v_accvgpr_write_b32 a186, v122
  v_accvgpr_write_b32 a187, v123
  v_mfma_f32_16x16x32_bf16 v[36:39], v[164:167], a[96:99], v[36:39]
  s_nop 0
  ds_read_b64_tr_b16 a[240:241], v220 offset:192
  ds_read_b64_tr_b16 a[242:243], v220 offset:704
  v_mfma_f32_16x16x32_bf16 v[36:39], v[168:171], a[100:103], v[36:39]
  s_nop 0
  ds_read_b64_tr_b16 a[244:245], v220 offset:8896
  ds_read_b64_tr_b16 a[246:247], v220 offset:9408
  ds_read_b64_tr_b16 a[248:249], v220 offset:17600
  ds_read_b64_tr_b16 a[250:251], v220 offset:18112
  ds_read_b64_tr_b16 a[252:253], v220 offset:26304
  ds_read_b64_tr_b16 a[254:255], v220 offset:26816
  v_mfma_f32_16x16x32_bf16 v[36:39], v[172:175], a[104:107], v[36:39]
  v_accvgpr_write_b32 a188, v124
  v_accvgpr_write_b32 a189, v125
  v_mfma_f32_16x16x32_bf16 v[36:39], v[176:179], a[108:111], v[36:39]
  s_waitcnt lgkmcnt(8)
  v_accvgpr_write_b32 a190, v126
  v_mov_b32 v137, 0
  v_mfma_f32_16x16x32_bf16 v[40:43], a[224:227], a[32:35], v[40:43]
  v_accvgpr_write_b32 a191, v127
  v_mov_b32 v138, 0
  v_mfma_f32_16x16x32_bf16 v[40:43], a[228:231], a[36:39], v[40:43]
  v_mov_b32 v139, 0
  v_mov_b32 v140, 0
  v_mfma_f32_16x16x32_bf16 v[40:43], a[232:235], a[40:43], v[40:43]
  s_nop 0
  ds_read_b64_tr_b16 v[148:149], v220 offset:200
  ds_read_b64_tr_b16 v[150:151], v220 offset:712
  ds_read_b64_tr_b16 v[152:153], v220 offset:8904
  ds_read_b64_tr_b16 v[154:155], v220 offset:9416
  ds_read_b64_tr_b16 v[156:157], v220 offset:17608
  ds_read_b64_tr_b16 v[158:159], v220 offset:18120
  v_mfma_f32_16x16x32_bf16 v[40:43], a[236:239], a[44:47], v[40:43]
  s_nop 0
  ds_read_b64_tr_b16 v[160:161], v220 offset:26312
  ds_read_b64_tr_b16 v[162:163], v220 offset:26824
  v_mfma_f32_16x16x32_bf16 v[44:47], a[224:227], a[96:99], v[44:47]
  v_mov_b32 v141, 0
  v_mov_b32 v142, 0
  v_mfma_f32_16x16x32_bf16 v[44:47], a[228:231], a[100:103], v[44:47]
  v_mov_b32 v143, 0
  v_mov_b32 v144, 0
  v_mfma_f32_16x16x32_bf16 v[44:47], a[232:235], a[104:107], v[44:47]
  v_mov_b32 v145, 0
  v_mov_b32 v146, 0
  v_mfma_f32_16x16x32_bf16 v[44:47], a[236:239], a[108:111], v[44:47]
  s_waitcnt lgkmcnt(8)
  v_mov_b32 v147, 0
  v_mfma_f32_16x16x32_bf16 v[48:51], a[240:243], a[32:35], v[48:51]
  s_cmp_eq_u32 s94, 6
  s_cselect_b32 s43, s95, 0x1000
  buffer_store_byte v196, off, s[4:7], s43 sc1
  v_mfma_f32_16x16x32_bf16 v[48:51], a[244:247], a[36:39], v[48:51]
  s_waitcnt lgkmcnt(0)
  s_waitcnt vmcnt(1)
  s_barrier
  ds_read_b64_tr_b16 v[164:165], v221 offset:0
  v_mfma_f32_16x16x32_bf16 v[48:51], a[248:251], a[40:43], v[48:51]
  s_nop 0
  ds_read_b64_tr_b16 v[166:167], v221 offset:512
  ds_read_b64_tr_b16 v[168:169], v221 offset:8704
  v_mfma_f32_16x16x32_bf16 v[48:51], a[252:255], a[44:47], v[48:51]
  s_add_u32 s42, s1, 131072
  ds_read_b64_tr_b16 v[170:171], v221 offset:9216
  ds_read_b64_tr_b16 v[172:173], v221 offset:17408
  v_mfma_f32_16x16x32_bf16 v[52:55], a[240:243], a[96:99], v[52:55]
  s_mov_b32 m0, s39
  ds_read_b64_tr_b16 v[174:175], v221 offset:17920
  ds_read_b64_tr_b16 v[176:177], v221 offset:26112
  v_mfma_f32_16x16x32_bf16 v[52:55], a[244:247], a[100:103], v[52:55]
  s_nop 0
  ds_read_b64_tr_b16 v[178:179], v221 offset:26624
  buffer_load_dwordx4 v225, s[16:19], s42 offen nt lds
  v_mfma_f32_16x16x32_bf16 v[52:55], a[248:251], a[104:107], v[52:55]
  ds_read_b64 a[224:225], v224 offset:768
  v_mfma_f32_16x16x32_bf16 v[52:55], a[252:255], a[108:111], v[52:55]
  ds_read_b64 a[226:227], v224 offset:800
  ds_read_b64_tr_b16 a[228:229], v223 offset:0
  v_mfma_f32_16x16x32_bf16 v[56:59], v[148:151], a[32:35], v[56:59]
  s_add_u32 m0, m0, 32
  ds_read_b64_tr_b16 a[230:231], v223 offset:512
  v_mfma_f32_16x16x32_bf16 v[56:59], v[152:155], a[36:39], v[56:59]
  s_nop 0
  ds_read_b64_tr_b16 a[232:233], v223 offset:8
  ds_read_b64_tr_b16 a[234:235], v223 offset:520
  v_mfma_f32_16x16x32_bf16 v[56:59], v[156:159], a[40:43], v[56:59]
  s_nop 0
  buffer_load_dwordx4 v225, s[16:19], s42 offen offset:1024 nt lds
  ds_read_b64_tr_b16 a[236:237], v221 offset:8
  v_mfma_f32_16x16x32_bf16 v[56:59], v[160:163], a[44:47], v[56:59]
  s_nop 0
  ds_read_b64_tr_b16 a[238:239], v221 offset:520
  ds_read_b64_tr_b16 a[240:241], v221 offset:8712
  v_mfma_f32_16x16x32_bf16 v[60:63], v[148:151], a[96:99], v[60:63]
  s_nop 0
  ds_read_b64_tr_b16 a[242:243], v221 offset:9224
  ds_read_b64_tr_b16 a[244:245], v221 offset:17416
  v_mfma_f32_16x16x32_bf16 v[60:63], v[152:155], a[100:103], v[60:63]
  s_add_u32 m0, m0, 32
  ds_read_b64_tr_b16 a[246:247], v221 offset:17928
  ds_read_b64_tr_b16 a[248:249], v221 offset:26120
  v_mfma_f32_16x16x32_bf16 v[60:63], v[156:159], a[104:107], v[60:63]
  s_nop 0
  ds_read_b64_tr_b16 a[250:251], v221 offset:26632
  buffer_load_dwordx4 v225, s[16:19], s42 offen offset:2048 nt lds
  v_mfma_f32_16x16x32_bf16 v[60:63], v[160:163], a[108:111], v[60:63]
  s_waitcnt lgkmcnt(14)
  ds_read_b64 a[252:253], v224 offset:832
  v_mfma_f32_16x16x32_bf16 v[0:3], v[164:167], a[48:51], v[0:3]
  ds_read_b64 a[254:255], v224 offset:864
  v_mfma_f32_16x16x32_bf16 v[0:3], v[168:171], a[52:55], v[0:3]
  s_add_u32 m0, m0, 32
  ds_read_b64_tr_b16 v[148:149], v223 offset:8704
  v_mfma_f32_16x16x32_bf16 v[0:3], v[172:175], a[56:59], v[0:3]
  s_nop 0
  ds_read_b64_tr_b16 v[150:151], v223 offset:9216
  ds_read_b64_tr_b16 v[152:153], v223 offset:8712
  v_mfma_f32_16x16x32_bf16 v[0:3], v[176:179], a[60:63], v[0:3]
  s_nop 0
  ds_read_b64_tr_b16 v[154:155], v223 offset:9224
  buffer_load_dwordx4 v225, s[16:19], s42 offen offset:3072 nt lds
  v_mfma_f32_16x16x32_bf16 v[4:7], v[164:167], a[112:115], v[4:7]
  s_nop 0
  ds_read_b64_tr_b16 v[156:157], v221 offset:64
  ds_read_b64_tr_b16 v[158:159], v221 offset:576
  v_mfma_f32_16x16x32_bf16 v[4:7], v[168:171], a[116:119], v[4:7]
  s_nop 0
  ds_read_b64_tr_b16 v[160:161], v221 offset:8768
  ds_read_b64_tr_b16 v[162:163], v221 offset:9280
  v_mfma_f32_16x16x32_bf16 v[4:7], v[172:175], a[120:123], v[4:7]
  s_add_u32 s42, s42, s52
  ds_read_b64_tr_b16 v[164:165], v221 offset:17472
  ds_read_b64_tr_b16 v[166:167], v221 offset:17984
  v_mfma_f32_16x16x32_bf16 v[4:7], v[176:179], a[124:127], v[4:7]
  s_waitcnt lgkmcnt(12)
  s_add_u32 m0, m0, s53
  ds_read_b64_tr_b16 v[168:169], v221 offset:26176
  v_mfma_f32_16x16x32_bf16 v[128:131], a[228:231], a[224:227], v[128:131]
  s_nop 0
  ds_read_b64_tr_b16 v[170:171], v221 offset:26688
  buffer_load_dwordx4 v225, s[16:19], s42 offen nt lds
  v_mfma_f32_16x16x32_bf16 v[132:135], a[232:235], a[224:227], v[132:135]
  ds_read_b64 v[172:173], v224 offset:896
  v_mfma_f32_16x16x32_bf16 v[8:11], a[236:239], a[48:51], v[8:11]
  ds_read_b64 v[174:175], v224 offset:928
  v_mfma_f32_16x16x32_bf16 v[8:11], a[240:243], a[52:55], v[8:11]
  v_mul_f32 v0, s54, v0
  v_mul_f32 v1, s54, v1
  v_mfma_f32_16x16x32_bf16 v[8:11], a[244:247], a[56:59], v[8:11]
  v_mul_f32 v2, s54, v2
  v_mul_f32 v3, s54, v3
  v_mfma_f32_16x16x32_bf16 v[8:11], a[248:251], a[60:63], v[8:11]
  s_add_u32 m0, m0, 32
  v_cvt_pk_bf16_f32 v64, v0, v1
  v_cvt_pk_bf16_f32 v65, v2, v3
  v_mfma_f32_16x16x32_bf16 v[12:15], a[236:239], a[112:115], v[12:15]
  v_mul_f32 v4, s54, v4
  v_mul_f32 v5, s54, v5
  v_mfma_f32_16x16x32_bf16 v[12:15], a[240:243], a[116:119], v[12:15]
  v_mul_f32 v6, s54, v6
  v_mul_f32 v7, s54, v7
  v_mfma_f32_16x16x32_bf16 v[12:15], a[244:247], a[120:123], v[12:15]
  v_cvt_pk_bf16_f32 v80, v4, v5
  v_cvt_pk_bf16_f32 v81, v6, v7
  v_mfma_f32_16x16x32_bf16 v[12:15], a[248:251], a[124:127], v[12:15]
  s_waitcnt lgkmcnt(2)
  ds_read_b64_tr_b16 v[176:177], v223 offset:17408
  ds_read_b64_tr_b16 v[178:179], v223 offset:17920
  v_mfma_f32_16x16x32_bf16 v[128:131], v[148:151], a[252:255], v[128:131]
  s_nop 0
  ds_read_b64_tr_b16 a[224:225], v223 offset:17416
  ds_read_b64_tr_b16 a[226:227], v223 offset:17928
  v_mfma_f32_16x16x32_bf16 v[132:135], v[152:155], a[252:255], v[132:135]
  s_nop 0
  buffer_load_dwordx4 v225, s[16:19], s42 offen offset:1024 nt lds
  ds_read_b64_tr_b16 a[228:229], v221 offset:72
  v_mfma_f32_16x16x32_bf16 v[16:19], v[156:159], a[48:51], v[16:19]
  s_nop 0
  ds_read_b64_tr_b16 a[230:231], v221 offset:584
  ds_read_b64_tr_b16 a[232:233], v221 offset:8776
  v_mfma_f32_16x16x32_bf16 v[16:19], v[160:163], a[52:55], v[16:19]
  s_nop 0
  ds_read_b64_tr_b16 a[234:235], v221 offset:9288
  ds_read_b64_tr_b16 a[236:237], v221 offset:17480
  v_mfma_f32_16x16x32_bf16 v[16:19], v[164:167], a[56:59], v[16:19]
  s_add_u32 m0, m0, 32
  ds_read_b64_tr_b16 a[238:239], v221 offset:17992
  v_mfma_f32_16x16x32_bf16 v[16:19], v[168:171], a[60:63], v[16:19]
  s_nop 0
  ds_read_b64_tr_b16 a[240:241], v221 offset:26184
  ds_read_b64_tr_b16 a[242:243], v221 offset:26696
  v_mfma_f32_16x16x32_bf16 v[20:23], v[156:159], a[112:115], v[20:23]
  buffer_load_dwordx4 v225, s[16:19], s42 offen offset:2048 nt lds
  v_mul_f32 v8, s54, v8
  v_mfma_f32_16x16x32_bf16 v[20:23], v[160:163], a[116:119], v[20:23]
  v_mul_f32 v9, s54, v9
  v_mul_f32 v10, s54, v10
  v_mfma_f32_16x16x32_bf16 v[20:23], v[164:167], a[120:123], v[20:23]
  v_mul_f32 v11, s54, v11
  v_cvt_pk_bf16_f32 v66, v8, v9
  v_mfma_f32_16x16x32_bf16 v[20:23], v[168:171], a[124:127], v[20:23]
  s_waitcnt lgkmcnt(6)
  v_cvt_pk_bf16_f32 v67, v10, v11
  v_mul_f32 v12, s54, v12
  v_mfma_f32_16x16x32_bf16 v[128:131], v[176:179], v[172:175], v[128:131]
  v_mul_f32 v13, s54, v13
  v_mul_f32 v14, s54, v14
  v_mfma_f32_16x16x32_bf16 v[132:135], a[224:227], v[172:175], v[132:135]
  v_mul_f32 v15, s54, v15
  v_cvt_pk_bf16_f32 v82, v12, v13
  v_mfma_f32_16x16x32_bf16 v[24:27], a[228:231], a[48:51], v[24:27]
  s_waitcnt lgkmcnt(0)
  ds_read_b64 a[244:245], v224 offset:960
  ds_read_b64 a[246:247], v224 offset:992
  ds_read_b64_tr_b16 a[248:249], v223 offset:26112
  ds_read_b64_tr_b16 a[250:251], v223 offset:26624
  v_mfma_f32_16x16x32_bf16 v[24:27], a[232:235], a[52:55], v[24:27]
  s_add_u32 m0, m0, 32
  ds_read_b64_tr_b16 a[252:253], v223 offset:26120
  ds_read_b64_tr_b16 a[254:255], v223 offset:26632
  v_mfma_f32_16x16x32_bf16 v[24:27], a[236:239], a[56:59], v[24:27]
  s_nop 0
  buffer_load_dwordx4 v225, s[16:19], s42 offen offset:3072 nt lds
  ds_read_b64_tr_b16 v[148:149], v221 offset:128
  ds_read_b64_tr_b16 v[150:151], v221 offset:640
  v_mfma_f32_16x16x32_bf16 v[24:27], a[240:243], a[60:63], v[24:27]
  s_nop 0
  ds_read_b64_tr_b16 v[152:153], v221 offset:8832
  ds_read_b64_tr_b16 v[154:155], v221 offset:9344
  v_mfma_f32_16x16x32_bf16 v[28:31], a[228:231], a[112:115], v[28:31]
  s_nop 0
  ds_read_b64_tr_b16 v[156:157], v221 offset:17536
  ds_read_b64_tr_b16 v[158:159], v221 offset:18048
  v_mfma_f32_16x16x32_bf16 v[28:31], a[232:235], a[116:119], v[28:31]
  s_nop 0
  ds_read_b64_tr_b16 v[160:161], v221 offset:26240
  ds_read_b64_tr_b16 v[162:163], v221 offset:26752
  v_mfma_f32_16x16x32_bf16 v[28:31], a[236:239], a[120:123], v[28:31]
  v_cvt_pk_bf16_f32 v83, v14, v15
  v_mul_f32 v16, s54, v16
  v_mfma_f32_16x16x32_bf16 v[28:31], a[240:243], a[124:127], v[28:31]
  s_waitcnt lgkmcnt(10)
  v_mul_f32 v17, s54, v17
  v_mul_f32 v18, s54, v18
  v_mfma_f32_16x16x32_bf16 v[128:131], a[248:251], a[244:247], v[128:131]
  s_waitcnt lgkmcnt(8)
  v_mul_f32 v19, s54, v19
  v_cvt_pk_bf16_f32 v68, v16, v17
  v_mfma_f32_16x16x32_bf16 v[132:135], a[252:255], a[244:247], v[132:135]
  s_waitcnt lgkmcnt(6)
  ds_read_b64_tr_b16 v[164:165], v221 offset:136
  ds_read_b64_tr_b16 v[166:167], v221 offset:648
  ds_read_b64_tr_b16 v[168:169], v221 offset:8840
  ds_read_b64_tr_b16 v[170:171], v221 offset:9352
  v_mfma_f32_16x16x32_bf16 v[32:35], v[148:151], a[48:51], v[32:35]
  s_waitcnt lgkmcnt(8)
  ds_read_b64_tr_b16 v[172:173], v221 offset:17544
  ds_read_b64_tr_b16 v[174:175], v221 offset:18056
  ds_read_b64_tr_b16 v[176:177], v221 offset:26248
  ds_read_b64_tr_b16 v[178:179], v221 offset:26760
  v_mfma_f32_16x16x32_bf16 v[32:35], v[152:155], a[52:55], v[32:35]
  s_waitcnt lgkmcnt(10)
  v_cvt_pk_bf16_f32 v69, v18, v19
  v_mul_f32 v20, s54, v20
  v_mfma_f32_16x16x32_bf16 v[32:35], v[156:159], a[56:59], v[32:35]
  s_waitcnt lgkmcnt(8)
  v_mul_f32 v21, s54, v21
  v_mul_f32 v22, s54, v22
  v_mfma_f32_16x16x32_bf16 v[32:35], v[160:163], a[60:63], v[32:35]
  v_mul_f32 v23, s54, v23
  v_cvt_pk_bf16_f32 v84, v20, v21
  v_mfma_f32_16x16x32_bf16 v[36:39], v[148:151], a[112:115], v[36:39]
  s_nop 0
  ds_read_b64_tr_b16 a[224:225], v221 offset:192
  ds_read_b64_tr_b16 a[226:227], v221 offset:704
  v_mfma_f32_16x16x32_bf16 v[36:39], v[152:155], a[116:119], v[36:39]
  s_nop 0
  ds_read_b64_tr_b16 a[228:229], v221 offset:8896
  ds_read_b64_tr_b16 a[230:231], v221 offset:9408
  ds_read_b64_tr_b16 a[232:233], v221 offset:17600
  ds_read_b64_tr_b16 a[234:235], v221 offset:18112
  ds_read_b64_tr_b16 a[236:237], v221 offset:26304
  ds_read_b64_tr_b16 a[238:239], v221 offset:26816
  v_mfma_f32_16x16x32_bf16 v[36:39], v[156:159], a[120:123], v[36:39]
  v_cvt_pk_bf16_f32 v85, v22, v23
  v_mul_f32 v128, s54, v128
  v_mfma_f32_16x16x32_bf16 v[36:39], v[160:163], a[124:127], v[36:39]
  s_waitcnt lgkmcnt(8)
  v_mul_f32 v129, s54, v129
  v_mul_f32 v130, s54, v130
  v_mfma_f32_16x16x32_bf16 v[40:43], v[164:167], a[48:51], v[40:43]
  v_mul_f32 v131, s54, v131
  v_mul_f32 v132, s54, v132
  v_mfma_f32_16x16x32_bf16 v[40:43], v[168:171], a[52:55], v[40:43]
  v_mul_f32 v133, s54, v133
  v_mul_f32 v134, s54, v134
  v_mfma_f32_16x16x32_bf16 v[40:43], v[172:175], a[56:59], v[40:43]
  s_nop 0
  ds_read_b64_tr_b16 a[240:241], v221 offset:200
  ds_read_b64_tr_b16 a[242:243], v221 offset:712
  ds_read_b64_tr_b16 a[244:245], v221 offset:8904
  ds_read_b64_tr_b16 a[246:247], v221 offset:9416
  ds_read_b64_tr_b16 a[248:249], v221 offset:17608
  ds_read_b64_tr_b16 a[250:251], v221 offset:18120
  v_mfma_f32_16x16x32_bf16 v[40:43], v[176:179], a[60:63], v[40:43]
  s_nop 0
  ds_read_b64_tr_b16 a[252:253], v221 offset:26312
  ds_read_b64_tr_b16 a[254:255], v221 offset:26824
  v_mul_f32 v135, s54, v135
  v_mfma_f32_16x16x32_bf16 v[44:47], v[164:167], a[112:115], v[44:47]
  v_cvt_pk_bf16_f32 v128, v128, v129
  v_cvt_pk_bf16_f32 v129, v130, v131
  v_mfma_f32_16x16x32_bf16 v[44:47], v[168:171], a[116:119], v[44:47]
  v_cvt_pk_bf16_f32 v130, v132, v133
  v_cvt_pk_bf16_f32 v131, v134, v135
  v_mfma_f32_16x16x32_bf16 v[44:47], v[172:175], a[120:123], v[44:47]
  ds_write_b128 v230, v[128:131]
  v_mfma_f32_16x16x32_bf16 v[44:47], v[176:179], a[124:127], v[44:47]
  s_waitcnt lgkmcnt(9)
  v_mul_f32 v24, s54, v24
  v_mul_f32 v25, s54, v25
  v_mfma_f32_16x16x32_bf16 v[48:51], a[224:227], a[48:51], v[48:51]
  s_cmp_eq_u32 s94, 7
  s_cselect_b32 s43, s95, 0x1000
  buffer_store_byte v196, off, s[4:7], s43 sc1
  v_mfma_f32_16x16x32_bf16 v[48:51], a[228:231], a[52:55], v[48:51]
  v_mul_f32 v26, s54, v26
  v_mul_f32 v27, s54, v27
  v_mfma_f32_16x16x32_bf16 v[48:51], a[232:235], a[56:59], v[48:51]
  v_cvt_pk_bf16_f32 v70, v24, v25
  v_cvt_pk_bf16_f32 v71, v26, v27
  v_mfma_f32_16x16x32_bf16 v[48:51], a[236:239], a[60:63], v[48:51]
  v_mul_f32 v28, s54, v28
  v_mul_f32 v29, s54, v29
  v_mfma_f32_16x16x32_bf16 v[52:55], a[224:227], a[112:115], v[52:55]
  v_mul_f32 v30, s54, v30
  v_mul_f32 v31, s54, v31
  v_mfma_f32_16x16x32_bf16 v[52:55], a[228:231], a[116:119], v[52:55]
  v_cvt_pk_bf16_f32 v86, v28, v29
  v_cvt_pk_bf16_f32 v87, v30, v31
  v_mfma_f32_16x16x32_bf16 v[52:55], a[232:235], a[120:123], v[52:55]
  v_mul_f32 v32, s54, v32
  v_mul_f32 v33, s54, v33
  v_mfma_f32_16x16x32_bf16 v[52:55], a[236:239], a[124:127], v[52:55]
  s_waitcnt lgkmcnt(1)
  v_mul_f32 v34, s54, v34
  v_mul_f32 v35, s54, v35
  v_mfma_f32_16x16x32_bf16 v[56:59], a[240:243], a[48:51], v[56:59]
  s_waitcnt lgkmcnt(0)
  s_barrier
  v_cvt_pk_bf16_f32 v72, v32, v33
  v_mfma_f32_16x16x32_bf16 v[56:59], a[244:247], a[52:55], v[56:59]
  v_cvt_pk_bf16_f32 v73, v34, v35
  v_mul_f32 v36, s54, v36
  v_mfma_f32_16x16x32_bf16 v[56:59], a[248:251], a[56:59], v[56:59]
  v_mul_f32 v37, s54, v37
  v_mul_f32 v38, s54, v38
  v_mfma_f32_16x16x32_bf16 v[56:59], a[252:255], a[60:63], v[56:59]
  v_mul_f32 v39, s54, v39
  v_cvt_pk_bf16_f32 v88, v36, v37
  v_mfma_f32_16x16x32_bf16 v[60:63], a[240:243], a[112:115], v[60:63]
  ds_read_b128 v[148:151], v212 offset:0
  v_cvt_pk_bf16_f32 v89, v38, v39
  v_mfma_f32_16x16x32_bf16 v[60:63], a[244:247], a[116:119], v[60:63]
  s_nop 0
  ds_read_b128 v[180:183], v248 offset:0
  ds_read_b128 v[184:187], v248 offset:1024
  v_mfma_f32_16x16x32_bf16 v[60:63], a[248:251], a[120:123], v[60:63]
  s_nop 0
  ds_read_b128 v[188:191], v248 offset:2048
  ds_read_b128 v[192:195], v248 offset:3072
  v_mfma_f32_16x16x32_bf16 v[60:63], a[252:255], a[124:127], v[60:63]
  s_nop 5
  s_nop 0
  ds_read_b128 v[152:155], v212 offset:64
  ds_read_b128 v[156:159], v212 offset:128
  ds_read_b128 v[160:163], v212 offset:192
  v_mul_f32 v40, s54, v40
  v_mul_f32 v41, s54, v41
  v_mul_f32 v42, s54, v42
  v_mul_f32 v43, s54, v43
  v_cvt_pk_bf16_f32 v74, v40, v41
  v_cvt_pk_bf16_f32 v75, v42, v43
  v_mul_f32 v44, s54, v44
  v_mul_f32 v45, s54, v45
  v_mul_f32 v46, s54, v46
  v_mul_f32 v47, s54, v47
  v_cvt_pk_bf16_f32 v90, v44, v45
  v_cvt_pk_bf16_f32 v91, v46, v47
  v_mul_f32 v48, s54, v48
  v_mul_f32 v49, s54, v49
  v_mul_f32 v50, s54, v50
  v_mul_f32 v51, s54, v51
  v_cvt_pk_bf16_f32 v76, v48, v49
  v_cvt_pk_bf16_f32 v77, v50, v51
  v_mul_f32 v52, s54, v52
  v_mul_f32 v53, s54, v53
  v_mul_f32 v54, s54, v54
  v_mul_f32 v55, s54, v55
  v_cvt_pk_bf16_f32 v92, v52, v53
  v_cvt_pk_bf16_f32 v93, v54, v55
  v_mul_f32 v56, s54, v56
  v_mul_f32 v57, s54, v57
  v_mul_f32 v58, s54, v58
  v_mul_f32 v59, s54, v59
  v_cvt_pk_bf16_f32 v78, v56, v57
  v_cvt_pk_bf16_f32 v79, v58, v59
  v_mul_f32 v60, s54, v60
  v_mul_f32 v61, s54, v61
  v_mul_f32 v62, s54, v62
  v_mul_f32 v63, s54, v63
  v_cvt_pk_bf16_f32 v94, v60, v61
  v_cvt_pk_bf16_f32 v95, v62, v63
  s_add_u32 s0, s0, 131072
  s_add_u32 s1, s1, 131072
  s_add_u32 s2, s2, 131072
  s_add_u32 s3, s3, 131072
  s_mov_b32 s41, 2
  s_add_u32 s45, s0, 131072
  s_add_u32 s46, s47, 768
  s_mov_b32 s42, 768
  buffer_load_dword v229, v228, s[12:15], s42 offen
  s_lshl_b32 s65, s58, 2
  s_add_u32 s65, s65, s36
  s_lshl_b32 s65, s65, 11
  s_add_u32 s65, s65, 262144
  v_lshlrev_b32 v250, 1, v225
  buffer_load_dword v229, v250, s[24:27], s65 offen
  s_branch L_attn
L_q3:
  s_waitcnt vmcnt(0)
  s_barrier
  ds_read_b64_tr_b16 v[148:149], v220 offset:0
  ds_read_b64_tr_b16 v[150:151], v220 offset:512
  ds_read_b64_tr_b16 v[152:153], v220 offset:8704
  ds_read_b64_tr_b16 v[154:155], v220 offset:9216
  ds_read_b64_tr_b16 v[156:157], v220 offset:17408
  ds_read_b64_tr_b16 v[158:159], v220 offset:17920
  ds_read_b64_tr_b16 v[160:161], v220 offset:26112
  ds_read_b64_tr_b16 v[162:163], v220 offset:26624
  ds_read_b64 v[164:165], v224 offset:0
  ds_read_b64 v[166:167], v224 offset:32
  ds_read_b64_tr_b16 v[168:169], v222 offset:0
  ds_read_b64_tr_b16 v[170:171], v222 offset:512
  ds_read_b64_tr_b16 v[172:173], v222 offset:8
  ds_read_b64_tr_b16 v[174:175], v222 offset:520
  v_rcp_f32 v251, v200
  v_rcp_f32 v252, v204
  v_cmp_lt_f32 vcc, s55, v200
  v_cmp_gt_f32 s[66:67], s56, v200
  s_and_b64 s[68:69], vcc, s[66:67]
  v_cmp_lt_f32 vcc, s55, v204
  v_cmp_gt_f32 s[66:67], s56, v204
  s_and_b64 s[68:69], s[68:69], vcc
  v_mov_b32 v250, s57
  s_and_b64 vcc, s[68:69], s[66:67]
  v_mul_f32 v0, v251, v0
  v_mul_f32 v1, v251, v1
  v_mul_f32 v2, v251, v2
  v_mul_f32 v3, v251, v3
  v_cvt_pk_bf16_f32 v96, v0, v1
  v_cvt_pk_bf16_f32 v97, v2, v3
  v_mul_f32 v4, v252, v4
  v_mul_f32 v5, v252, v5
  v_mul_f32 v6, v252, v6
  v_mul_f32 v7, v252, v7
  v_cvt_pk_bf16_f32 v112, v4, v5
  v_cvt_pk_bf16_f32 v113, v6, v7
  v_cndmask_b32 v250, v250, 0, vcc
  ds_write_b32 v231, v250 offset:1024
  s_add_u32 s42, s47, 1049344
  s_mov_b32 m0, s40
  s_waitcnt lgkmcnt(13)
  v_mfma_f32_16x16x32_bf16 v[0:3], v[148:151], a[0:3], 0
  s_waitcnt lgkmcnt(11)
  v_mul_f32 v8, v251, v8
  v_mul_f32 v9, v251, v9
  v_mfma_f32_16x16x32_bf16 v[0:3], v[152:155], a[4:7], v[0:3]
  s_waitcnt lgkmcnt(9)
  v_mul_f32 v10, v251, v10
  v_mul_f32 v11, v251, v11
  v_mfma_f32_16x16x32_bf16 v[0:3], v[156:159], a[8:11], v[0:3]
  s_waitcnt lgkmcnt(7)
  ds_read_b64_tr_b16 v[176:177], v220 offset:8
  ds_read_b64_tr_b16 v[178:179], v220 offset:520
  v_mfma_f32_16x16x32_bf16 v[0:3], v[160:163], a[12:15], v[0:3]
  s_nop 0
  ds_read_b64_tr_b16 a[224:225], v220 offset:8712
  ds_read_b64_tr_b16 a[226:227], v220 offset:9224
  v_mfma_f32_16x16x32_bf16 v[4:7], v[148:151], a[64:67], 0
  s_nop 0
  buffer_load_dwordx4 v227, s[12:15], s42 offen lds
  ds_read_b64_tr_b16 a[228:229], v220 offset:17416
  ds_read_b64_tr_b16 a[230:231], v220 offset:17928
  v_mfma_f32_16x16x32_bf16 v[4:7], v[152:155], a[68:71], v[4:7]
  s_nop 0
  ds_read_b64_tr_b16 a[232:233], v220 offset:26120
  ds_read_b64_tr_b16 a[234:235], v220 offset:26632
  v_mfma_f32_16x16x32_bf16 v[4:7], v[156:159], a[72:75], v[4:7]
  s_add_u32 s42, s42, s49
  s_add_u32 m0, m0, s50
  v_cvt_pk_bf16_f32 v98, v8, v9
  v_mfma_f32_16x16x32_bf16 v[4:7], v[160:163], a[76:79], v[4:7]
  s_waitcnt lgkmcnt(9)
  v_cvt_pk_bf16_f32 v99, v10, v11
  v_mul_f32 v12, v252, v12
  v_mfma_f32_16x16x32_bf16 v[128:131], v[168:171], v[164:167], 0
  buffer_load_dwordx4 v227, s[12:15], s42 offen lds
  v_mul_f32 v13, v252, v13
  v_mfma_f32_16x16x32_bf16 v[132:135], v[172:175], v[164:167], 0
  s_waitcnt lgkmcnt(6)
  v_mul_f32 v14, v252, v14
  v_mul_f32 v15, v252, v15
  v_cvt_pk_bf16_f32 v114, v12, v13
  v_cvt_pk_bf16_f32 v115, v14, v15
  v_mfma_f32_16x16x32_bf16 v[8:11], v[176:179], a[0:3], 0
  s_waitcnt lgkmcnt(4)
  ds_read_b64 a[236:237], v224 offset:64
  ds_read_b64 a[238:239], v224 offset:96
  ds_read_b64_tr_b16 a[240:241], v222 offset:8704
  ds_read_b64_tr_b16 a[242:243], v222 offset:9216
  v_mfma_f32_16x16x32_bf16 v[8:11], a[224:227], a[4:7], v[8:11]
  s_waitcnt lgkmcnt(6)
  s_add_u32 s42, s42, s49
  s_add_u32 m0, m0, s50
  ds_read_b64_tr_b16 a[244:245], v222 offset:8712
  ds_read_b64_tr_b16 a[246:247], v222 offset:9224
  v_mfma_f32_16x16x32_bf16 v[8:11], a[228:231], a[8:11], v[8:11]
  s_waitcnt lgkmcnt(6)
  buffer_load_dwordx4 v227, s[12:15], s42 offen lds
  ds_read_b64_tr_b16 a[248:249], v220 offset:64
  ds_read_b64_tr_b16 a[250:251], v220 offset:576
  v_mfma_f32_16x16x32_bf16 v[8:11], a[232:235], a[12:15], v[8:11]
  s_nop 0
  ds_read_b64_tr_b16 a[252:253], v220 offset:8768
  ds_read_b64_tr_b16 a[254:255], v220 offset:9280
  v_mfma_f32_16x16x32_bf16 v[12:15], v[176:179], a[64:67], 0
  s_add_u32 s42, s42, s49
  ds_read_b64_tr_b16 v[148:149], v220 offset:17472
  ds_read_b64_tr_b16 v[150:151], v220 offset:17984
  v_mfma_f32_16x16x32_bf16 v[12:15], a[224:227], a[68:71], v[12:15]
  s_add_u32 m0, m0, s50
  ds_read_b64_tr_b16 v[152:153], v220 offset:26176
  ds_read_b64_tr_b16 v[154:155], v220 offset:26688
  v_mfma_f32_16x16x32_bf16 v[12:15], a[228:231], a[72:75], v[12:15]
  buffer_load_dwordx4 v227, s[12:15], s42 offen lds
  v_mul_f32 v16, v251, v16
  v_mfma_f32_16x16x32_bf16 v[12:15], a[232:235], a[76:79], v[12:15]
  s_waitcnt lgkmcnt(10)
  v_mul_f32 v17, v251, v17
  v_mul_f32 v18, v251, v18
  v_mfma_f32_16x16x32_bf16 v[128:131], a[240:243], a[236:239], v[128:131]
  s_waitcnt lgkmcnt(8)
  v_mul_f32 v19, v251, v19
  v_cvt_pk_bf16_f32 v100, v16, v17
  v_mfma_f32_16x16x32_bf16 v[132:135], a[244:247], a[236:239], v[132:135]
  s_waitcnt lgkmcnt(6)
  s_add_u32 s42, s42, s49
  s_add_u32 m0, m0, s51
  v_cvt_pk_bf16_f32 v101, v18, v19
  v_mul_f32 v20, v252, v20
  v_mul_f32 v21, v252, v21
  v_mul_f32 v22, v252, v22
  v_mul_f32 v23, v252, v23
  v_cvt_pk_bf16_f32 v116, v20, v21
  v_cvt_pk_bf16_f32 v117, v22, v23
  v_mfma_f32_16x16x32_bf16 v[16:19], a[248:251], a[0:3], 0
  s_waitcnt lgkmcnt(4)
  buffer_load_dwordx4 v227, s[12:15], s42 offen lds
  ds_read_b64 v[156:157], v224 offset:128
  ds_read_b64 v[158:159], v224 offset:160
  ds_read_b64_tr_b16 v[160:161], v222 offset:17408
  ds_read_b64_tr_b16 v[162:163], v222 offset:17920
  v_mfma_f32_16x16x32_bf16 v[16:19], a[252:255], a[4:7], v[16:19]
  s_waitcnt lgkmcnt(6)
  ds_read_b64_tr_b16 v[164:165], v222 offset:17416
  ds_read_b64_tr_b16 v[166:167], v222 offset:17928
  v_mfma_f32_16x16x32_bf16 v[16:19], v[148:151], a[8:11], v[16:19]
  s_waitcnt lgkmcnt(6)
  ds_read_b64_tr_b16 v[168:169], v220 offset:72
  ds_read_b64_tr_b16 v[170:171], v220 offset:584
  v_mfma_f32_16x16x32_bf16 v[16:19], v[152:155], a[12:15], v[16:19]
  s_add_u32 s42, s42, s49
  s_add_u32 m0, m0, s50
  ds_read_b64_tr_b16 v[172:173], v220 offset:8776
  ds_read_b64_tr_b16 v[174:175], v220 offset:9288
  v_mfma_f32_16x16x32_bf16 v[20:23], a[248:251], a[64:67], 0
  s_nop 0
  buffer_load_dwordx4 v227, s[12:15], s42 offen lds
  ds_read_b64_tr_b16 v[176:177], v220 offset:17480
  ds_read_b64_tr_b16 v[178:179], v220 offset:17992
  v_mfma_f32_16x16x32_bf16 v[20:23], a[252:255], a[68:71], v[20:23]
  s_nop 0
  ds_read_b64_tr_b16 a[224:225], v220 offset:26184
  ds_read_b64_tr_b16 a[226:227], v220 offset:26696
  v_mfma_f32_16x16x32_bf16 v[20:23], v[148:151], a[72:75], v[20:23]
  s_add_u32 s42, s42, s49
  v_mul_f32 v24, v251, v24
  v_mul_f32 v25, v251, v25
  v_mfma_f32_16x16x32_bf16 v[20:23], v[152:155], a[76:79], v[20:23]
  s_waitcnt lgkmcnt(10)
  s_add_u32 m0, m0, s50
  v_mul_f32 v26, v251, v26
  v_mfma_f32_16x16x32_bf16 v[128:131], v[160:163], v[156:159], v[128:131]
  s_waitcnt lgkmcnt(8)
  buffer_load_dwordx4 v227, s[12:15], s42 offen lds
  ds_read_b128 v[180:183], v253 offset:0
  v_mfma_f32_16x16x32_bf16 v[132:135], v[164:167], v[156:159], v[132:135]
  s_waitcnt lgkmcnt(7)
  v_mul_f32 v27, v251, v27
  v_cvt_pk_bf16_f32 v102, v24, v25
  v_cvt_pk_bf16_f32 v103, v26, v27
  v_mul_f32 v28, v252, v28
  v_mul_f32 v29, v252, v29
  v_mul_f32 v30, v252, v30
  v_mul_f32 v31, v252, v31
  v_cvt_pk_bf16_f32 v118, v28, v29
  v_cvt_pk_bf16_f32 v119, v30, v31
  v_mfma_f32_16x16x32_bf16 v[24:27], v[168:171], a[0:3], 0
  s_waitcnt lgkmcnt(5)
  ds_read_b64 a[228:229], v224 offset:192
  ds_read_b64 a[230:231], v224 offset:224
  ds_read_b64_tr_b16 a[232:233], v222 offset:26112
  ds_read_b64_tr_b16 a[234:235], v222 offset:26624
  v_mfma_f32_16x16x32_bf16 v[24:27], v[172:175], a[4:7], v[24:27]
  s_waitcnt lgkmcnt(7)
  s_add_u32 s42, s42, s49
  s_add_u32 m0, m0, s50
  ds_read_b64_tr_b16 a[236:237], v222 offset:26120
  ds_read_b64_tr_b16 a[238:239], v222 offset:26632
  v_mfma_f32_16x16x32_bf16 v[24:27], v[176:179], a[8:11], v[24:27]
  s_waitcnt lgkmcnt(7)
  buffer_load_dwordx4 v227, s[12:15], s42 offen lds
  ds_read_b64_tr_b16 a[240:241], v220 offset:128
  ds_read_b64_tr_b16 a[242:243], v220 offset:640
  v_mfma_f32_16x16x32_bf16 v[24:27], a[224:227], a[12:15], v[24:27]
  s_nop 0
  ds_read_b64_tr_b16 a[244:245], v220 offset:8832
  ds_read_b64_tr_b16 a[246:247], v220 offset:9344
  v_mfma_f32_16x16x32_bf16 v[28:31], v[168:171], a[64:67], 0
  s_nop 0
  ds_read_b64_tr_b16 a[248:249], v220 offset:17536
  ds_read_b64_tr_b16 a[250:251], v220 offset:18048
  v_mfma_f32_16x16x32_bf16 v[28:31], v[172:175], a[68:71], v[28:31]
  s_nop 0
  ds_read_b64_tr_b16 a[252:253], v220 offset:26240
  ds_read_b64_tr_b16 a[254:255], v220 offset:26752
  v_mfma_f32_16x16x32_bf16 v[28:31], v[176:179], a[72:75], v[28:31]
  v_mul_f32 v32, v251, v32
  v_mul_f32 v33, v251, v33
  v_mfma_f32_16x16x32_bf16 v[28:31], a[224:227], a[76:79], v[28:31]
  s_waitcnt lgkmcnt(10)
  ds_read_b128 v[184:187], v253 offset:1024
  v_mul_f32 v34, v251, v34
  v_mfma_f32_16x16x32_bf16 v[128:131], a[232:235], a[228:231], v[128:131]
  s_waitcnt lgkmcnt(9)
  ds_read_b128 v[188:191], v253 offset:8192
  ds_read_b128 v[192:195], v253 offset:9216
  v_mfma_f32_16x16x32_bf16 v[132:135], a[236:239], a[228:231], v[132:135]
  s_waitcnt lgkmcnt(9)
  ds_read_b64_tr_b16 v[148:149], v220 offset:136
  ds_read_b64_tr_b16 v[150:151], v220 offset:648
  ds_read_b64_tr_b16 v[152:153], v220 offset:8840
  ds_read_b64_tr_b16 v[154:155], v220 offset:9352
  v_mul_f32 v35, v251, v35
  v_cvt_pk_bf16_f32 v104, v32, v33
  v_cvt_pk_bf16_f32 v105, v34, v35
  v_mul_f32 v36, v252, v36
  v_mul_f32 v37, v252, v37
  v_mul_f32 v38, v252, v38
  v_mul_f32 v39, v252, v39
  v_cvt_pk_bf16_f32 v120, v36, v37
  v_cvt_pk_bf16_f32 v121, v38, v39
  v_mfma_f32_16x16x32_bf16 v[32:35], a[240:243], a[0:3], 0
  s_waitcnt lgkmcnt(11)
  ds_read_b64_tr_b16 v[156:157], v220 offset:17544
  ds_read_b64_tr_b16 v[158:159], v220 offset:18056
  ds_read_b64_tr_b16 v[160:161], v220 offset:26248
  ds_read_b64_tr_b16 v[162:163], v220 offset:26760
  v_mfma_f32_16x16x32_bf16 v[32:35], a[244:247], a[4:7], v[32:35]
  s_waitcnt lgkmcnt(13)
  v_mul_f32 v40, v251, v40
  v_mul_f32 v41, v251, v41
  v_mfma_f32_16x16x32_bf16 v[32:35], a[248:251], a[8:11], v[32:35]
  s_waitcnt lgkmcnt(11)
  ds_read_b128 v[200:203], v253 offset:16384
  ds_read_b128 v[204:207], v253 offset:17408
  v_mfma_f32_16x16x32_bf16 v[32:35], a[252:255], a[12:15], v[32:35]
  s_nop 0
  ds_read_b32 v208, v254 offset:0
  ds_read_b32 v209, v254 offset:256
  ds_read_b32 v210, v254 offset:512
  ds_read_b32 v211, v254 offset:768
  v_mfma_f32_16x16x32_bf16 v[36:39], a[240:243], a[64:67], 0
  s_nop 0
  ds_read_b64_tr_b16 v[164:165], v220 offset:192
  ds_read_b64_tr_b16 v[166:167], v220 offset:704
  v_mfma_f32_16x16x32_bf16 v[36:39], a[244:247], a[68:71], v[36:39]
  s_nop 0
  ds_read_b64_tr_b16 v[168:169], v220 offset:8896
  ds_read_b64_tr_b16 v[170:171], v220 offset:9408
  ds_read_b64_tr_b16 v[172:173], v220 offset:17600
  ds_read_b64_tr_b16 v[174:175], v220 offset:18112
  ds_read_b64_tr_b16 v[176:177], v220 offset:26304
  ds_read_b64_tr_b16 v[178:179], v220 offset:26816
  v_mfma_f32_16x16x32_bf16 v[36:39], a[248:251], a[72:75], v[36:39]
  v_mul_f32 v42, v251, v42
  v_mul_f32 v43, v251, v43
  v_mfma_f32_16x16x32_bf16 v[36:39], a[252:255], a[76:79], v[36:39]
  s_waitcnt lgkmcnt(14)
  v_cvt_pk_bf16_f32 v106, v40, v41
  v_cvt_pk_bf16_f32 v107, v42, v43
  v_mul_f32 v44, v252, v44
  v_mul_f32 v45, v252, v45
  v_mul_f32 v46, v252, v46
  v_mul_f32 v47, v252, v47
  v_cvt_pk_bf16_f32 v122, v44, v45
  v_cvt_pk_bf16_f32 v123, v46, v47
  v_mfma_f32_16x16x32_bf16 v[40:43], v[148:151], a[0:3], 0
  v_mul_f32 v48, v251, v48
  v_mul_f32 v49, v251, v49
  v_mfma_f32_16x16x32_bf16 v[40:43], v[152:155], a[4:7], v[40:43]
  v_mul_f32 v50, v251, v50
  v_mul_f32 v51, v251, v51
  v_mfma_f32_16x16x32_bf16 v[40:43], v[156:159], a[8:11], v[40:43]
  s_nop 0
  ds_read_b64_tr_b16 a[224:225], v220 offset:200
  ds_read_b64_tr_b16 a[226:227], v220 offset:712
  ds_read_b64_tr_b16 a[228:229], v220 offset:8904
  ds_read_b64_tr_b16 a[230:231], v220 offset:9416
  ds_read_b64_tr_b16 a[232:233], v220 offset:17608
  ds_read_b64_tr_b16 a[234:235], v220 offset:18120
  v_mfma_f32_16x16x32_bf16 v[40:43], v[160:163], a[12:15], v[40:43]
  s_waitcnt lgkmcnt(14)
  ds_read_b64_tr_b16 a[236:237], v220 offset:26312
  ds_read_b64_tr_b16 a[238:239], v220 offset:26824
  v_mfma_f32_16x16x32_bf16 v[44:47], v[148:151], a[64:67], 0
  v_add_f32 v180, v180, v188
  v_add_f32 v181, v181, v189
  v_mfma_f32_16x16x32_bf16 v[44:47], v[152:155], a[68:71], v[44:47]
  v_add_f32 v182, v182, v190
  v_add_f32 v183, v183, v191
  v_mfma_f32_16x16x32_bf16 v[44:47], v[156:159], a[72:75], v[44:47]
  v_add_f32 v184, v184, v192
  v_add_f32 v185, v185, v193
  v_mfma_f32_16x16x32_bf16 v[44:47], v[160:163], a[76:79], v[44:47]
  s_waitcnt lgkmcnt(8)
  v_add_f32 v186, v186, v194
  v_add_f32 v187, v187, v195
  v_cvt_pk_bf16_f32 v108, v48, v49
  v_cvt_pk_bf16_f32 v109, v50, v51
  v_mul_f32 v52, v252, v52
  v_mul_f32 v53, v252, v53
  v_mul_f32 v54, v252, v54
  v_mul_f32 v55, v252, v55
  v_cvt_pk_bf16_f32 v124, v52, v53
  v_cvt_pk_bf16_f32 v125, v54, v55
  v_mfma_f32_16x16x32_bf16 v[48:51], v[164:167], a[0:3], 0
  s_cmp_eq_u32 s94, 8
  s_cselect_b32 s43, s95, 0x1000
  buffer_store_byte v196, off, s[4:7], s43 sc1
  ds_read_b128 v[188:191], v253 offset:24576
  ds_read_b128 v[192:195], v253 offset:25600
  v_mfma_f32_16x16x32_bf16 v[48:51], v[168:171], a[4:7], v[48:51]
  v_mul_f32 v56, v251, v56
  v_mul_f32 v57, v251, v57
  v_mfma_f32_16x16x32_bf16 v[48:51], v[172:175], a[8:11], v[48:51]
  v_mul_f32 v58, v251, v58
  v_mul_f32 v59, v251, v59
  v_mfma_f32_16x16x32_bf16 v[48:51], v[176:179], a[12:15], v[48:51]
  v_cvt_pk_bf16_f32 v110, v56, v57
  v_cvt_pk_bf16_f32 v111, v58, v59
  v_mfma_f32_16x16x32_bf16 v[52:55], v[164:167], a[64:67], 0
  v_mul_f32 v60, v252, v60
  v_mul_f32 v61, v252, v61
  v_mfma_f32_16x16x32_bf16 v[52:55], v[168:171], a[68:71], v[52:55]
  v_mul_f32 v62, v252, v62
  v_mul_f32 v63, v252, v63
  v_mfma_f32_16x16x32_bf16 v[52:55], v[172:175], a[72:75], v[52:55]
  s_waitcnt lgkmcnt(0)
  s_waitcnt vmcnt(1)
  s_barrier
  v_cvt_pk_bf16_f32 v126, v60, v61
  v_mfma_f32_16x16x32_bf16 v[52:55], v[176:179], a[76:79], v[52:55]
  ds_read_b64_tr_b16 a[240:241], v221 offset:0
  v_cvt_pk_bf16_f32 v127, v62, v63
  v_mfma_f32_16x16x32_bf16 v[56:59], a[224:227], a[0:3], 0
  s_nop 0
  ds_read_b64_tr_b16 a[242:243], v221 offset:512
  ds_read_b64_tr_b16 a[244:245], v221 offset:8704
  v_mfma_f32_16x16x32_bf16 v[56:59], a[228:231], a[4:7], v[56:59]
  s_add_u32 s42, s48, 2097920
  ds_read_b64_tr_b16 a[246:247], v221 offset:9216
  v_mfma_f32_16x16x32_bf16 v[56:59], a[232:235], a[8:11], v[56:59]
  s_nop 0
  ds_read_b64_tr_b16 a[248:249], v221 offset:17408
  ds_read_b64_tr_b16 a[250:251], v221 offset:17920
  v_mfma_f32_16x16x32_bf16 v[56:59], a[236:239], a[12:15], v[56:59]
  s_mov_b32 m0, s39
  ds_read_b64_tr_b16 a[252:253], v221 offset:26112
  ds_read_b64_tr_b16 a[254:255], v221 offset:26624
  v_mfma_f32_16x16x32_bf16 v[60:63], a[224:227], a[64:67], 0
  s_nop 0
  buffer_load_dwordx4 v227, s[12:15], s42 offen lds
  ds_read_b64 v[148:149], v224 offset:256
  v_mfma_f32_16x16x32_bf16 v[60:63], a[228:231], a[68:71], v[60:63]
  s_nop 0
  ds_read_b64 v[150:151], v224 offset:288
  ds_read_b64_tr_b16 v[152:153], v223 offset:0
  v_mfma_f32_16x16x32_bf16 v[60:63], a[232:235], a[72:75], v[60:63]
  s_add_u32 s42, s42, s49
  s_add_u32 m0, m0, s50
  ds_read_b64_tr_b16 v[154:155], v223 offset:512
  v_mfma_f32_16x16x32_bf16 v[60:63], a[236:239], a[76:79], v[60:63]
  s_waitcnt lgkmcnt(10)
  buffer_load_dwordx4 v227, s[12:15], s42 offen lds
  ds_read_b64_tr_b16 v[156:157], v223 offset:8
  v_mfma_f32_16x16x32_bf16 v[0:3], a[240:243], a[16:19], v[0:3]
  s_waitcnt lgkmcnt(9)
  ds_read_b64_tr_b16 v[158:159], v223 offset:520
  ds_read_b64_tr_b16 v[160:161], v221 offset:8
  v_mfma_f32_16x16x32_bf16 v[0:3], a[244:247], a[20:23], v[0:3]
  s_waitcnt lgkmcnt(9)
  s_add_u32 s42, s42, s49
  s_add_u32 m0, m0, s50
  v_mfma_f32_16x16x32_bf16 v[0:3], a[248:251], a[24:27], v[0:3]
  s_waitcnt lgkmcnt(7)
  ds_read_b64_tr_b16 v[162:163], v221 offset:520
  ds_read_b64_tr_b16 v[164:165], v221 offset:8712
  v_mfma_f32_16x16x32_bf16 v[0:3], a[252:255], a[28:31], v[0:3]
  s_nop 0
  ds_read_b64_tr_b16 v[166:167], v221 offset:9224
  buffer_load_dwordx4 v227, s[12:15], s42 offen lds
  v_mfma_f32_16x16x32_bf16 v[4:7], a[240:243], a[80:83], v[4:7]
  s_nop 0
  ds_read_b64_tr_b16 v[168:169], v221 offset:17416
  ds_read_b64_tr_b16 v[170:171], v221 offset:17928
  v_mfma_f32_16x16x32_bf16 v[4:7], a[244:247], a[84:87], v[4:7]
  s_add_u32 s42, s42, s49
  ds_read_b64_tr_b16 v[172:173], v221 offset:26120
  ds_read_b64_tr_b16 v[174:175], v221 offset:26632
  v_mfma_f32_16x16x32_bf16 v[4:7], a[248:251], a[88:91], v[4:7]
  s_add_u32 m0, m0, s50
  ds_read_b64 v[176:177], v224 offset:320
  ds_read_b64 v[178:179], v224 offset:352
  v_mfma_f32_16x16x32_bf16 v[4:7], a[252:255], a[92:95], v[4:7]
  s_waitcnt lgkmcnt(10)
  buffer_load_dwordx4 v227, s[12:15], s42 offen lds
  ds_read_b64_tr_b16 a[224:225], v223 offset:8704
  v_mfma_f32_16x16x32_bf16 v[128:131], v[152:155], v[148:151], v[128:131]
  s_nop 0
  ds_read_b64_tr_b16 a[226:227], v223 offset:9216
  ds_read_b64_tr_b16 a[228:229], v223 offset:8712
  v_mfma_f32_16x16x32_bf16 v[132:135], v[156:159], v[148:151], v[132:135]
  s_waitcnt lgkmcnt(11)
  s_add_u32 s42, s42, s49
  s_add_u32 m0, m0, s51
  v_mfma_f32_16x16x32_bf16 v[8:11], v[160:163], a[16:19], v[8:11]
  s_waitcnt lgkmcnt(9)
  ds_read_b64_tr_b16 a[230:231], v223 offset:9224
  buffer_load_dwordx4 v227, s[12:15], s42 offen lds
  v_mfma_f32_16x16x32_bf16 v[8:11], v[164:167], a[20:23], v[8:11]
  s_waitcnt lgkmcnt(8)
  ds_read_b64_tr_b16 a[232:233], v221 offset:64
  ds_read_b64_tr_b16 a[234:235], v221 offset:576
  v_mfma_f32_16x16x32_bf16 v[8:11], v[168:171], a[24:27], v[8:11]
  s_waitcnt lgkmcnt(8)
  ds_read_b64_tr_b16 a[236:237], v221 offset:8768
  ds_read_b64_tr_b16 a[238:239], v221 offset:9280
  v_mfma_f32_16x16x32_bf16 v[8:11], v[172:175], a[28:31], v[8:11]
  s_add_u32 s42, s42, s49
  s_add_u32 m0, m0, s50
  ds_read_b64_tr_b16 a[240:241], v221 offset:17472
  v_mfma_f32_16x16x32_bf16 v[12:15], v[160:163], a[80:83], v[12:15]
  ds_read_b64_tr_b16 a[242:243], v221 offset:17984
  v_add_f32 v208, v208, v209
  v_mfma_f32_16x16x32_bf16 v[12:15], v[164:167], a[84:87], v[12:15]
  s_nop 0
  ds_read_b64_tr_b16 a[244:245], v221 offset:26176
  ds_read_b64_tr_b16 a[246:247], v221 offset:26688
  v_mfma_f32_16x16x32_bf16 v[12:15], v[168:171], a[88:91], v[12:15]
  buffer_load_dwordx4 v227, s[12:15], s42 offen lds
  v_add_f32 v210, v210, v211
  v_mfma_f32_16x16x32_bf16 v[12:15], v[172:175], a[92:95], v[12:15]
  s_waitcnt lgkmcnt(8)
  v_add_f32 v180, v180, v200
  v_add_f32 v181, v181, v201
  v_mfma_f32_16x16x32_bf16 v[128:131], a[224:227], v[176:179], v[128:131]
  v_add_f32 v182, v182, v202
  v_add_f32 v183, v183, v203
  v_mfma_f32_16x16x32_bf16 v[132:135], a[228:231], v[176:179], v[132:135]
  s_waitcnt lgkmcnt(4)
  s_add_u32 s42, s42, s49
  s_add_u32 m0, m0, s50
  v_mfma_f32_16x16x32_bf16 v[16:19], a[232:235], a[16:19], v[16:19]
  s_nop 0
  buffer_load_dwordx4 v227, s[12:15], s42 offen lds
  ds_read_b64 a[248:249], v224 offset:384
  ds_read_b64 a[250:251], v224 offset:416
  ds_read_b64_tr_b16 a[252:253], v223 offset:17408
  ds_read_b64_tr_b16 a[254:255], v223 offset:17920
  v_mfma_f32_16x16x32_bf16 v[16:19], a[236:239], a[20:23], v[16:19]
  s_waitcnt lgkmcnt(6)
  ds_read_b64_tr_b16 v[148:149], v223 offset:17416
  ds_read_b64_tr_b16 v[150:151], v223 offset:17928
  v_mfma_f32_16x16x32_bf16 v[16:19], a[240:243], a[24:27], v[16:19]
  s_waitcnt lgkmcnt(6)
  ds_read_b64_tr_b16 v[152:153], v221 offset:72
  ds_read_b64_tr_b16 v[154:155], v221 offset:584
  v_mfma_f32_16x16x32_bf16 v[16:19], a[244:247], a[28:31], v[16:19]
  s_add_u32 s42, s42, s49
  s_add_u32 m0, m0, s50
  ds_read_b64_tr_b16 v[156:157], v221 offset:8776
  ds_read_b64_tr_b16 v[158:159], v221 offset:9288
  v_mfma_f32_16x16x32_bf16 v[20:23], a[232:235], a[80:83], v[20:23]
  s_nop 0
  buffer_load_dwordx4 v227, s[12:15], s42 offen lds
  ds_read_b64_tr_b16 v[160:161], v221 offset:17480
  ds_read_b64_tr_b16 v[162:163], v221 offset:17992
  v_mfma_f32_16x16x32_bf16 v[20:23], a[236:239], a[84:87], v[20:23]
  s_add_u32 s42, s0, 131072
  s_mov_b32 m0, s38
  ds_read_b64_tr_b16 v[164:165], v221 offset:26184
  ds_read_b64_tr_b16 v[166:167], v221 offset:26696
  v_mfma_f32_16x16x32_bf16 v[20:23], a[240:243], a[88:91], v[20:23]
  buffer_load_dwordx4 v225, s[20:23], s42 offen nt lds
  v_add_f32 v184, v184, v204
  v_mfma_f32_16x16x32_bf16 v[20:23], a[244:247], a[92:95], v[20:23]
  s_waitcnt lgkmcnt(10)
  v_add_f32 v185, v185, v205
  v_add_f32 v186, v186, v206
  v_mfma_f32_16x16x32_bf16 v[128:131], a[252:255], a[248:251], v[128:131]
  s_waitcnt lgkmcnt(8)
  v_add_f32 v187, v187, v207
  v_add_f32 v208, v208, v210
  v_mfma_f32_16x16x32_bf16 v[132:135], v[148:151], a[248:251], v[132:135]
  s_waitcnt lgkmcnt(6)
  s_add_u32 m0, m0, 32
  ds_read_b64 v[168:169], v224 offset:448
  v_mfma_f32_16x16x32_bf16 v[24:27], v[152:155], a[16:19], v[24:27]
  s_waitcnt lgkmcnt(5)
  buffer_load_dwordx4 v225, s[20:23], s42 offen offset:1024 nt lds
  ds_read_b64 v[170:171], v224 offset:480
  ds_read_b64_tr_b16 v[172:173], v223 offset:26112
  ds_read_b64_tr_b16 v[174:175], v223 offset:26624
  v_mfma_f32_16x16x32_bf16 v[24:27], v[156:159], a[20:23], v[24:27]
  s_waitcnt lgkmcnt(6)
  ds_read_b64_tr_b16 v[176:177], v223 offset:26120
  ds_read_b64_tr_b16 v[178:179], v223 offset:26632
  v_mfma_f32_16x16x32_bf16 v[24:27], v[160:163], a[24:27], v[24:27]
  s_waitcnt lgkmcnt(6)
  ds_read_b64_tr_b16 a[224:225], v221 offset:128
  ds_read_b64_tr_b16 a[226:227], v221 offset:640
  v_mfma_f32_16x16x32_bf16 v[24:27], v[164:167], a[28:31], v[24:27]
  s_add_u32 m0, m0, 32
  ds_read_b64_tr_b16 a[228:229], v221 offset:8832
  ds_read_b64_tr_b16 a[230:231], v221 offset:9344
  v_mfma_f32_16x16x32_bf16 v[28:31], v[152:155], a[80:83], v[28:31]
  s_nop 0
  buffer_load_dwordx4 v225, s[20:23], s42 offen offset:2048 nt lds
  ds_read_b64_tr_b16 a[232:233], v221 offset:17536
  ds_read_b64_tr_b16 a[234:235], v221 offset:18048
  v_mfma_f32_16x16x32_bf16 v[28:31], v[156:159], a[84:87], v[28:31]
  s_nop 0
  ds_read_b64_tr_b16 a[236:237], v221 offset:26240
  ds_read_b64_tr_b16 a[238:239], v221 offset:26752
  v_mfma_f32_16x16x32_bf16 v[28:31], v[160:163], a[88:91], v[28:31]
  s_add_u32 m0, m0, 32
  v_rcp_f32 v250, v208
  v_mfma_f32_16x16x32_bf16 v[28:31], v[164:167], a[92:95], v[28:31]
  s_waitcnt lgkmcnt(10)
  v_add_f32 v180, v180, v188
  v_mfma_f32_16x16x32_bf16 v[128:131], v[172:175], v[168:171], v[128:131]
  s_waitcnt lgkmcnt(8)
  buffer_load_dwordx4 v225, s[20:23], s42 offen offset:3072 nt lds
  v_add_f32 v181, v181, v189
  v_mfma_f32_16x16x32_bf16 v[132:135], v[176:179], v[168:171], v[132:135]
  s_waitcnt lgkmcnt(6)
  ds_read_b64_tr_b16 a[240:241], v221 offset:136
  ds_read_b64_tr_b16 a[242:243], v221 offset:648
  ds_read_b64_tr_b16 a[244:245], v221 offset:8840
  ds_read_b64_tr_b16 a[246:247], v221 offset:9352
  v_mfma_f32_16x16x32_bf16 v[32:35], a[224:227], a[16:19], v[32:35]
  s_waitcnt lgkmcnt(8)
  ds_read_b64_tr_b16 a[248:249], v221 offset:17544
  ds_read_b64_tr_b16 a[250:251], v221 offset:18056
  ds_read_b64_tr_b16 a[252:253], v221 offset:26248
  ds_read_b64_tr_b16 a[254:255], v221 offset:26760
  v_mfma_f32_16x16x32_bf16 v[32:35], a[228:231], a[20:23], v[32:35]
  s_waitcnt lgkmcnt(10)
  s_add_u32 s42, s42, s52
  s_add_u32 m0, m0, s53
  v_mfma_f32_16x16x32_bf16 v[32:35], a[232:235], a[24:27], v[32:35]
  s_waitcnt lgkmcnt(8)
  buffer_load_dwordx4 v225, s[20:23], s42 offen nt lds
  v_add_f32 v182, v182, v190
  v_mfma_f32_16x16x32_bf16 v[32:35], a[236:239], a[28:31], v[32:35]
  v_add_f32 v183, v183, v191
  v_add_f32 v184, v184, v192
  v_mfma_f32_16x16x32_bf16 v[36:39], a[224:227], a[80:83], v[36:39]
  s_add_u32 m0, m0, 32
  ds_read_b64_tr_b16 v[148:149], v221 offset:192
  ds_read_b64_tr_b16 v[150:151], v221 offset:704
  v_mfma_f32_16x16x32_bf16 v[36:39], a[228:231], a[84:87], v[36:39]
  s_nop 0
  ds_read_b64_tr_b16 v[152:153], v221 offset:8896
  ds_read_b64_tr_b16 v[154:155], v221 offset:9408
  ds_read_b64_tr_b16 v[156:157], v221 offset:17600
  ds_read_b64_tr_b16 v[158:159], v221 offset:18112
  ds_read_b64_tr_b16 v[160:161], v221 offset:26304
  ds_read_b64_tr_b16 v[162:163], v221 offset:26816
  v_mfma_f32_16x16x32_bf16 v[36:39], a[232:235], a[88:91], v[36:39]
  buffer_load_dwordx4 v225, s[20:23], s42 offen offset:1024 nt lds
  v_add_f32 v185, v185, v193
  v_mfma_f32_16x16x32_bf16 v[36:39], a[236:239], a[92:95], v[36:39]
  s_waitcnt lgkmcnt(8)
  v_add_f32 v186, v186, v194
  v_add_f32 v187, v187, v195
  v_mfma_f32_16x16x32_bf16 v[40:43], a[240:243], a[16:19], v[40:43]
  v_mul_f32 v180, v250, v180
  v_mul_f32 v181, v250, v181
  v_mfma_f32_16x16x32_bf16 v[40:43], a[244:247], a[20:23], v[40:43]
  s_add_u32 m0, m0, 32
  v_mul_f32 v182, v250, v182
  v_mfma_f32_16x16x32_bf16 v[40:43], a[248:251], a[24:27], v[40:43]
  s_nop 0
  buffer_load_dwordx4 v225, s[20:23], s42 offen offset:2048 nt lds
  ds_read_b64_tr_b16 v[164:165], v221 offset:200
  ds_read_b64_tr_b16 v[166:167], v221 offset:712
  ds_read_b64_tr_b16 v[168:169], v221 offset:8904
  ds_read_b64_tr_b16 v[170:171], v221 offset:9416
  ds_read_b64_tr_b16 v[172:173], v221 offset:17608
  ds_read_b64_tr_b16 v[174:175], v221 offset:18120
  v_mfma_f32_16x16x32_bf16 v[40:43], a[252:255], a[28:31], v[40:43]
  s_nop 0
  ds_read_b64_tr_b16 v[176:177], v221 offset:26312
  ds_read_b64_tr_b16 v[178:179], v221 offset:26824
  v_mfma_f32_16x16x32_bf16 v[44:47], a[240:243], a[80:83], v[44:47]
  s_add_u32 m0, m0, 32
  v_mul_f32 v183, v250, v183
  v_mul_f32 v184, v250, v184
  v_mfma_f32_16x16x32_bf16 v[44:47], a[244:247], a[84:87], v[44:47]
  v_mul_f32 v185, v250, v185
  v_mul_f32 v186, v250, v186
  v_mul_f32 v187, v250, v187
  v_cvt_pk_bf16_f32 v240, v180, v181
  v_cvt_pk_bf16_f32 v241, v182, v183
  v_cvt_pk_bf16_f32 v242, v184, v185
  v_cvt_pk_bf16_f32 v243, v186, v187
  v_mfma_f32_16x16x32_bf16 v[44:47], a[248:251], a[88:91], v[44:47]
  buffer_load_dwordx4 v225, s[20:23], s42 offen offset:3072 nt lds
  v_accvgpr_write_b32 a192, v96
  v_mfma_f32_16x16x32_bf16 v[44:47], a[252:255], a[92:95], v[44:47]
  s_waitcnt lgkmcnt(8)
  s_cmp_eq_u32 s94, 9
  s_cselect_b32 s43, s95, 0x1000
  buffer_store_byte v196, off, s[4:7], s43 sc1
  v_mfma_f32_16x16x32_bf16 v[48:51], v[148:151], a[16:19], v[48:51]
  s_nop 0
  ds_read_b32 v188, v254 offset:1024
  ds_read_b32 v189, v254 offset:1280
  v_mfma_f32_16x16x32_bf16 v[48:51], v[152:155], a[20:23], v[48:51]
  s_nop 0
  ds_read_b32 v190, v254 offset:1536
  ds_read_b32 v191, v254 offset:1792
  v_mfma_f32_16x16x32_bf16 v[48:51], v[156:159], a[24:27], v[48:51]
  s_waitcnt lgkmcnt(4)
  s_waitcnt vmcnt(9)
  s_barrier
  ds_read_b64_tr_b16 a[224:225], v220 offset:0
  v_mfma_f32_16x16x32_bf16 v[48:51], v[160:163], a[28:31], v[48:51]
  s_add_u32 s42, s48, 3146496
  ds_read_b64_tr_b16 a[226:227], v220 offset:512
  ds_read_b64_tr_b16 a[228:229], v220 offset:8704
  v_mfma_f32_16x16x32_bf16 v[52:55], v[148:151], a[80:83], v[52:55]
  s_mov_b32 m0, s40
  ds_read_b64_tr_b16 a[230:231], v220 offset:9216
  ds_read_b64_tr_b16 a[232:233], v220 offset:17408
  v_mfma_f32_16x16x32_bf16 v[52:55], v[152:155], a[84:87], v[52:55]
  s_nop 0
  ds_read_b64_tr_b16 a[234:235], v220 offset:17920
  ds_read_b64_tr_b16 a[236:237], v220 offset:26112
  v_mfma_f32_16x16x32_bf16 v[52:55], v[156:159], a[88:91], v[52:55]
  s_nop 0
  ds_read_b64_tr_b16 a[238:239], v220 offset:26624
  buffer_load_dwordx4 v227, s[12:15], s42 offen lds
  v_mfma_f32_16x16x32_bf16 v[52:55], v[160:163], a[92:95], v[52:55]
  ds_read_b64 a[240:241], v224 offset:512
  ds_read_b64 a[242:243], v224 offset:544
  v_mfma_f32_16x16x32_bf16 v[56:59], v[164:167], a[16:19], v[56:59]
  s_waitcnt lgkmcnt(10)
  s_add_u32 s42, s42, s49
  v_mfma_f32_16x16x32_bf16 v[56:59], v[168:171], a[20:23], v[56:59]
  s_add_u32 m0, m0, s50
  ds_read_b64_tr_b16 a[244:245], v222 offset:0
  v_mfma_f32_16x16x32_bf16 v[56:59], v[172:175], a[24:27], v[56:59]
  s_nop 0
  buffer_load_dwordx4 v227, s[12:15], s42 offen lds
  ds_read_b64_tr_b16 a[246:247], v222 offset:512
  v_mfma_f32_16x16x32_bf16 v[56:59], v[176:179], a[28:31], v[56:59]
  s_nop 0
  ds_read_b64_tr_b16 a[248:249], v222 offset:8
  ds_read_b64_tr_b16 a[250:251], v222 offset:520
  v_mfma_f32_16x16x32_bf16 v[60:63], v[164:167], a[80:83], v[60:63]
  s_add_u32 s42, s42, s49
  v_add_f32 v188, v188, v189
  v_add_f32 v190, v190, v191
  v_mfma_f32_16x16x32_bf16 v[60:63], v[168:171], a[84:87], v[60:63]
  s_add_u32 m0, m0, s50
  v_add_f32 v188, v188, v208
  v_add_f32 v188, v188, v190
  v_mfma_f32_16x16x32_bf16 v[60:63], v[172:175], a[88:91], v[60:63]
  v_cmp_lt_f32 vcc, s55, v188
  v_cmp_gt_f32 s[66:67], s56, v188
  v_mfma_f32_16x16x32_bf16 v[60:63], v[176:179], a[92:95], v[60:63]
  s_waitcnt lgkmcnt(6)
  ds_read_b64_tr_b16 a[252:253], v220 offset:8
  ds_read_b64_tr_b16 a[254:255], v220 offset:520
  v_mfma_f32_16x16x32_bf16 v[0:3], a[224:227], a[32:35], v[0:3]
  s_nop 0
  ds_read_b64_tr_b16 v[148:149], v220 offset:8712
  ds_read_b64_tr_b16 v[150:151], v220 offset:9224
  v_mfma_f32_16x16x32_bf16 v[0:3], a[228:231], a[36:39], v[0:3]
  s_nop 0
  buffer_load_dwordx4 v227, s[12:15], s42 offen lds
  ds_read_b64_tr_b16 v[152:153], v220 offset:17416
  v_mfma_f32_16x16x32_bf16 v[0:3], a[232:235], a[40:43], v[0:3]
  s_nop 0
  ds_read_b64_tr_b16 v[154:155], v220 offset:17928
  ds_read_b64_tr_b16 v[156:157], v220 offset:26120
  v_mfma_f32_16x16x32_bf16 v[0:3], a[236:239], a[44:47], v[0:3]
  s_add_u32 s42, s42, s49
  s_add_u32 m0, m0, s50
  ds_read_b64_tr_b16 v[158:159], v220 offset:26632
  v_mfma_f32_16x16x32_bf16 v[4:7], a[224:227], a[96:99], v[4:7]
  s_and_b64 vcc, vcc, s[66:67]
  s_cmp_eq_u64 vcc, exec
  s_cbranch_scc1 L_ok2
  s_cmp_eq_u32 s44, 0
  s_cbranch_scc1 L_retry
L_ok2:
  s_mov_b32 s44, 0
  v_mfma_f32_16x16x32_bf16 v[4:7], a[228:231], a[100:103], v[4:7]
  buffer_load_dwordx4 v227, s[12:15], s42 offen lds
  v_accvgpr_write_b32 a193, v97
  v_mfma_f32_16x16x32_bf16 v[4:7], a[232:235], a[104:107], v[4:7]
  ds_read_b64 v[160:161], v224 offset:576
  v_accvgpr_write_b32 a194, v98
  v_mfma_f32_16x16x32_bf16 v[4:7], a[236:239], a[108:111], v[4:7]
  s_waitcnt lgkmcnt(5)
  s_add_u32 s42, s42, s49
  s_add_u32 m0, m0, s51
  v_mfma_f32_16x16x32_bf16 v[128:131], a[244:247], a[240:243], v[128:131]
  s_nop 0
  ds_read_b64 v[162:163], v224 offset:608
  ds_read_b64_tr_b16 v[164:165], v222 offset:8704
  v_mfma_f32_16x16x32_bf16 v[132:135], a[248:251], a[240:243], v[132:135]
  ds_read_b64_tr_b16 v[166:167], v222 offset:9216
  v_accvgpr_write_b32 a195, v99
  v_mfma_f32_16x16x32_bf16 v[8:11], a[252:255], a[32:35], v[8:11]
  s_nop 0
  ds_read_b64_tr_b16 v[168:169], v222 offset:8712
  ds_read_b64_tr_b16 v[170:171], v222 offset:9224
  v_mfma_f32_16x16x32_bf16 v[8:11], v[148:151], a[36:39], v[8:11]
  s_waitcnt lgkmcnt(6)
  buffer_load_dwordx4 v227, s[12:15], s42 offen lds
  v_accvgpr_write_b32 a196, v100
  v_mfma_f32_16x16x32_bf16 v[8:11], v[152:155], a[40:43], v[8:11]
  s_nop 0
  ds_read_b64_tr_b16 v[172:173], v220 offset:64
  ds_read_b64_tr_b16 v[174:175], v220 offset:576
  v_mfma_f32_16x16x32_bf16 v[8:11], v[156:159], a[44:47], v[8:11]
  s_add_u32 s42, s42, s49
  ds_read_b64_tr_b16 v[176:177], v220 offset:8768
  ds_read_b64_tr_b16 v[178:179], v220 offset:9280
  v_mfma_f32_16x16x32_bf16 v[12:15], a[252:255], a[96:99], v[12:15]
  s_add_u32 m0, m0, s50
  ds_read_b64_tr_b16 a[224:225], v220 offset:17472
  ds_read_b64_tr_b16 a[226:227], v220 offset:17984
  v_mfma_f32_16x16x32_bf16 v[12:15], v[148:151], a[100:103], v[12:15]
  s_nop 0
  ds_read_b64_tr_b16 a[228:229], v220 offset:26176
  ds_read_b64_tr_b16 a[230:231], v220 offset:26688
  v_mfma_f32_16x16x32_bf16 v[12:15], v[152:155], a[104:107], v[12:15]
  buffer_load_dwordx4 v227, s[12:15], s42 offen lds
  v_accvgpr_write_b32 a197, v101
  v_mfma_f32_16x16x32_bf16 v[12:15], v[156:159], a[108:111], v[12:15]
  s_waitcnt lgkmcnt(8)
  v_accvgpr_write_b32 a198, v102
  v_accvgpr_write_b32 a199, v103
  v_mfma_f32_16x16x32_bf16 v[128:131], v[164:167], v[160:163], v[128:131]
  v_accvgpr_write_b32 a200, v104
  v_accvgpr_write_b32 a201, v105
  v_mfma_f32_16x16x32_bf16 v[132:135], v[168:171], v[160:163], v[132:135]
  s_waitcnt lgkmcnt(6)
  s_add_u32 s42, s42, s49
  s_add_u32 m0, m0, s50
  v_mfma_f32_16x16x32_bf16 v[16:19], v[172:175], a[32:35], v[16:19]
  s_waitcnt lgkmcnt(4)
  buffer_load_dwordx4 v227, s[12:15], s42 offen lds
  ds_read_b64 a[232:233], v224 offset:640
  ds_read_b64 a[234:235], v224 offset:672
  ds_read_b64_tr_b16 a[236:237], v222 offset:17408
  ds_read_b64_tr_b16 a[238:239], v222 offset:17920
  v_mfma_f32_16x16x32_bf16 v[16:19], v[176:179], a[36:39], v[16:19]
  s_waitcnt lgkmcnt(6)
  ds_read_b64_tr_b16 a[240:241], v222 offset:17416
  ds_read_b64_tr_b16 a[242:243], v222 offset:17928
  v_mfma_f32_16x16x32_bf16 v[16:19], a[224:227], a[40:43], v[16:19]
  s_waitcnt lgkmcnt(6)
  ds_read_b64_tr_b16 a[244:245], v220 offset:72
  ds_read_b64_tr_b16 a[246:247], v220 offset:584
  v_mfma_f32_16x16x32_bf16 v[16:19], a[228:231], a[44:47], v[16:19]
  s_add_u32 s42, s42, s49
  s_add_u32 m0, m0, s50
  ds_read_b64_tr_b16 a[248:249], v220 offset:8776
  ds_read_b64_tr_b16 a[250:251], v220 offset:9288
  v_mfma_f32_16x16x32_bf16 v[20:23], v[172:175], a[96:99], v[20:23]
  s_nop 0
  buffer_load_dwordx4 v227, s[12:15], s42 offen lds
  ds_read_b64_tr_b16 a[252:253], v220 offset:17480
  ds_read_b64_tr_b16 a[254:255], v220 offset:17992
  v_mfma_f32_16x16x32_bf16 v[20:23], v[176:179], a[100:103], v[20:23]
  s_nop 0
  ds_read_b64_tr_b16 v[148:149], v220 offset:26184
  ds_read_b64_tr_b16 v[150:151], v220 offset:26696
  v_mfma_f32_16x16x32_bf16 v[20:23], a[224:227], a[104:107], v[20:23]
  v_accvgpr_write_b32 a202, v106
  v_accvgpr_write_b32 a203, v107
  v_mfma_f32_16x16x32_bf16 v[20:23], a[228:231], a[108:111], v[20:23]
  s_waitcnt lgkmcnt(10)
  v_accvgpr_write_b32 a204, v108
  v_accvgpr_write_b32 a205, v109
  v_mfma_f32_16x16x32_bf16 v[128:131], a[236:239], a[232:235], v[128:131]
  s_waitcnt lgkmcnt(8)
  v_accvgpr_write_b32 a206, v110
  v_accvgpr_write_b32 a207, v111
  v_mfma_f32_16x16x32_bf16 v[132:135], a[240:243], a[232:235], v[132:135]
  s_waitcnt lgkmcnt(6)
  v_accvgpr_write_b32 a208, v112
  v_accvgpr_write_b32 a209, v113
  v_mfma_f32_16x16x32_bf16 v[24:27], a[244:247], a[32:35], v[24:27]
  s_waitcnt lgkmcnt(4)
  ds_read_b64 v[152:153], v224 offset:704
  ds_read_b64 v[154:155], v224 offset:736
  ds_read_b64_tr_b16 v[156:157], v222 offset:26112
  ds_read_b64_tr_b16 v[158:159], v222 offset:26624
  v_mfma_f32_16x16x32_bf16 v[24:27], a[248:251], a[36:39], v[24:27]
  s_waitcnt lgkmcnt(6)
  ds_read_b64_tr_b16 v[160:161], v222 offset:26120
  ds_read_b64_tr_b16 v[162:163], v222 offset:26632
  v_mfma_f32_16x16x32_bf16 v[24:27], a[252:255], a[40:43], v[24:27]
  s_waitcnt lgkmcnt(6)
  ds_read_b64_tr_b16 v[164:165], v220 offset:128
  ds_read_b64_tr_b16 v[166:167], v220 offset:640
  v_mfma_f32_16x16x32_bf16 v[24:27], v[148:151], a[44:47], v[24:27]
  s_nop 0
  ds_read_b64_tr_b16 v[168:169], v220 offset:8832
  ds_read_b64_tr_b16 v[170:171], v220 offset:9344
  v_mfma_f32_16x16x32_bf16 v[28:31], a[244:247], a[96:99], v[28:31]
  s_nop 0
  ds_read_b64_tr_b16 v[172:173], v220 offset:17536
  ds_read_b64_tr_b16 v[174:175], v220 offset:18048
  v_mfma_f32_16x16x32_bf16 v[28:31], a[248:251], a[100:103], v[28:31]
  s_nop 0
  ds_read_b64_tr_b16 v[176:177], v220 offset:26240
  ds_read_b64_tr_b16 v[178:179], v220 offset:26752
  v_mfma_f32_16x16x32_bf16 v[28:31], a[252:255], a[104:107], v[28:31]
  v_accvgpr_write_b32 a210, v114
  v_accvgpr_write_b32 a211, v115
  v_mfma_f32_16x16x32_bf16 v[28:31], v[148:151], a[108:111], v[28:31]
  s_waitcnt lgkmcnt(10)
  v_accvgpr_write_b32 a212, v116
  v_accvgpr_write_b32 a213, v117
  v_mfma_f32_16x16x32_bf16 v[128:131], v[156:159], v[152:155], v[128:131]
  s_waitcnt lgkmcnt(8)
  v_accvgpr_write_b32 a214, v118
  v_accvgpr_write_b32 a215, v119
  v_mfma_f32_16x16x32_bf16 v[132:135], v[160:163], v[152:155], v[132:135]
  s_waitcnt lgkmcnt(6)
  ds_read_b64_tr_b16 a[224:225], v220 offset:136
  ds_read_b64_tr_b16 a[226:227], v220 offset:648
  ds_read_b64_tr_b16 a[228:229], v220 offset:8840
  ds_read_b64_tr_b16 a[230:231], v220 offset:9352
  v_mfma_f32_16x16x32_bf16 v[32:35], v[164:167], a[32:35], v[32:35]
  s_waitcnt lgkmcnt(8)
  ds_read_b64_tr_b16 a[232:233], v220 offset:17544
  ds_read_b64_tr_b16 a[234:235], v220 offset:18056
  ds_read_b64_tr_b16 a[236:237], v220 offset:26248
  ds_read_b64_tr_b16 a[238:239], v220 offset:26760
  v_mfma_f32_16x16x32_bf16 v[32:35], v[168:171], a[36:39], v[32:35]
  s_waitcnt lgkmcnt(10)
  v_accvgpr_write_b32 a216, v120
  v_mfma_f32_16x16x32_bf16 v[32:35], v[172:175], a[40:43], v[32:35]
  s_waitcnt lgkmcnt(8)
  v_accvgpr_write_b32 a217, v121
  v_mov_b32 v136, 0
  v_mfma_f32_16x16x32_bf16 v[32:35], v[176:179], a[44:47], v[32:35]
  v_accvgpr_write_b32 a218, v122
  v_accvgpr_write_b32 a219, v123
  v_mfma_f32_16x16x32_bf16 v[36:39], v[164:167], a[96:99], v[36:39]
  s_nop 0
  ds_read_b64_tr_b16 a[240:241], v220 offset:192
  ds_read_b64_tr_b16 a[242:243], v220 offset:704
  v_mfma_f32_16x16x32_bf16 v[36:39], v[168:171], a[100:103], v[36:39]
  s_nop 0
  ds_read_b64_tr_b16 a[244:245], v220 offset:8896
  ds_read_b64_tr_b16 a[246:247], v220 offset:9408
  ds_read_b64_tr_b16 a[248:249], v220 offset:17600
  ds_read_b64_tr_b16 a[250:251], v220 offset:18112
  ds_read_b64_tr_b16 a[252:253], v220 offset:26304
  ds_read_b64_tr_b16 a[254:255], v220 offset:26816
  v_mfma_f32_16x16x32_bf16 v[36:39], v[172:175], a[104:107], v[36:39]
  v_accvgpr_write_b32 a220, v124
  v_accvgpr_write_b32 a221, v125
  v_mfma_f32_16x16x32_bf16 v[36:39], v[176:179], a[108:111], v[36:39]
  s_waitcnt lgkmcnt(8)
  v_accvgpr_write_b32 a222, v126
  v_mov_b32 v137, 0
  v_mfma_f32_16x16x32_bf16 v[40:43], a[224:227], a[32:35], v[40:43]
  v_accvgpr_write_b32 a223, v127
  v_mov_b32 v138, 0
  v_mfma_f32_16x16x32_bf16 v[40:43], a[228:231], a[36:39], v[40:43]
  v_mov_b32 v139, 0
  v_mov_b32 v140, 0
  v_mfma_f32_16x16x32_bf16 v[40:43], a[232:235], a[40:43], v[40:43]
  s_nop 0
  ds_read_b64_tr_b16 v[148:149], v220 offset:200
  ds_read_b64_tr_b16 v[150:151], v220 offset:712
  ds_read_b64_tr_b16 v[152:153], v220 offset:8904
  ds_read_b64_tr_b16 v[154:155], v220 offset:9416
  ds_read_b64_tr_b16 v[156:157], v220 offset:17608
  ds_read_b64_tr_b16 v[158:159], v220 offset:18120
  v_mfma_f32_16x16x32_bf16 v[40:43], a[236:239], a[44:47], v[40:43]
  s_nop 0
  ds_read_b64_tr_b16 v[160:161], v220 offset:26312
  ds_read_b64_tr_b16 v[162:163], v220 offset:26824
  v_mfma_f32_16x16x32_bf16 v[44:47], a[224:227], a[96:99], v[44:47]
  v_mov_b32 v141, 0
  v_mov_b32 v142, 0
  v_mfma_f32_16x16x32_bf16 v[44:47], a[228:231], a[100:103], v[44:47]
  v_mov_b32 v143, 0
  v_mov_b32 v144, 0
  v_mfma_f32_16x16x32_bf16 v[44:47], a[232:235], a[104:107], v[44:47]
  v_mov_b32 v145, 0
  v_mov_b32 v146, 0
  v_mfma_f32_16x16x32_bf16 v[44:47], a[236:239], a[108:111], v[44:47]
  s_waitcnt lgkmcnt(8)
  v_mov_b32 v147, 0
  v_mfma_f32_16x16x32_bf16 v[48:51], a[240:243], a[32:35], v[48:51]
  s_cmp_eq_u32 s94, 10
  s_cselect_b32 s43, s95, 0x1000
  buffer_store_byte v196, off, s[4:7], s43 sc1
  v_mfma_f32_16x16x32_bf16 v[48:51], a[244:247], a[36:39], v[48:51]
  s_waitcnt lgkmcnt(0)
  s_waitcnt vmcnt(1)
  s_barrier
  ds_read_b64_tr_b16 v[164:165], v221 offset:0
  v_mfma_f32_16x16x32_bf16 v[48:51], a[248:251], a[40:43], v[48:51]
  s_nop 0
  ds_read_b64_tr_b16 v[166:167], v221 offset:512
  ds_read_b64_tr_b16 v[168:169], v221 offset:8704
  v_mfma_f32_16x16x32_bf16 v[48:51], a[252:255], a[44:47], v[48:51]
  s_add_u32 s42, s1, 131072
  ds_read_b64_tr_b16 v[170:171], v221 offset:9216
  ds_read_b64_tr_b16 v[172:173], v221 offset:17408
  v_mfma_f32_16x16x32_bf16 v[52:55], a[240:243], a[96:99], v[52:55]
  s_mov_b32 m0, s39
  ds_read_b64_tr_b16 v[174:175], v221 offset:17920
  ds_read_b64_tr_b16 v[176:177], v221 offset:26112
  v_mfma_f32_16x16x32_bf16 v[52:55], a[244:247], a[100:103], v[52:55]
  s_nop 0
  ds_read_b64_tr_b16 v[178:179], v221 offset:26624
  buffer_load_dwordx4 v225, s[16:19], s42 offen nt lds
  v_mfma_f32_16x16x32_bf16 v[52:55], a[248:251], a[104:107], v[52:55]
  ds_read_b64 a[224:225], v224 offset:768
  v_mfma_f32_16x16x32_bf16 v[52:55], a[252:255], a[108:111], v[52:55]
  ds_read_b64 a[226:227], v224 offset:800
  ds_read_b64_tr_b16 a[228:229], v223 offset:0
  v_mfma_f32_16x16x32_bf16 v[56:59], v[148:151], a[32:35], v[56:59]
  s_add_u32 m0, m0, 32
  ds_read_b64_tr_b16 a[230:231], v223 offset:512
  v_mfma_f32_16x16x32_bf16 v[56:59], v[152:155], a[36:39], v[56:59]
  s_nop 0
  ds_read_b64_tr_b16 a[232:233], v223 offset:8
  ds_read_b64_tr_b16 a[234:235], v223 offset:520
  v_mfma_f32_16x16x32_bf16 v[56:59], v[156:159], a[40:43], v[56:59]
  s_nop 0
  buffer_load_dwordx4 v225, s[16:19], s42 offen offset:1024 nt lds
  ds_read_b64_tr_b16 a[236:237], v221 offset:8
  v_mfma_f32_16x16x32_bf16 v[56:59], v[160:163], a[44:47], v[56:59]
  s_nop 0
  ds_read_b64_tr_b16 a[238:239], v221 offset:520
  ds_read_b64_tr_b16 a[240:241], v221 offset:8712
  v_mfma_f32_16x16x32_bf16 v[60:63], v[148:151], a[96:99], v[60:63]
  s_nop 0
  ds_read_b64_tr_b16 a[242:243], v221 offset:9224
  ds_read_b64_tr_b16 a[244:245], v221 offset:17416
  v_mfma_f32_16x16x32_bf16 v[60:63], v[152:155], a[100:103], v[60:63]
  s_add_u32 m0, m0, 32
  ds_read_b64_tr_b16 a[246:247], v221 offset:17928
  ds_read_b64_tr_b16 a[248:249], v221 offset:26120
  v_mfma_f32_16x16x32_bf16 v[60:63], v[156:159], a[104:107], v[60:63]
  s_nop 0
  ds_read_b64_tr_b16 a[250:251], v221 offset:26632
  buffer_load_dwordx4 v225, s[16:19], s42 offen offset:2048 nt lds
  v_mfma_f32_16x16x32_bf16 v[60:63], v[160:163], a[108:111], v[60:63]
  s_waitcnt lgkmcnt(14)
  ds_read_b64 a[252:253], v224 offset:832
  v_mfma_f32_16x16x32_bf16 v[0:3], v[164:167], a[48:51], v[0:3]
  ds_read_b64 a[254:255], v224 offset:864
  v_mfma_f32_16x16x32_bf16 v[0:3], v[168:171], a[52:55], v[0:3]
  s_add_u32 m0, m0, 32
  ds_read_b64_tr_b16 v[148:149], v223 offset:8704
  v_mfma_f32_16x16x32_bf16 v[0:3], v[172:175], a[56:59], v[0:3]
  s_nop 0
  ds_read_b64_tr_b16 v[150:151], v223 offset:9216
  ds_read_b64_tr_b16 v[152:153], v223 offset:8712
  v_mfma_f32_16x16x32_bf16 v[0:3], v[176:179], a[60:63], v[0:3]
  s_nop 0
  ds_read_b64_tr_b16 v[154:155], v223 offset:9224
  buffer_load_dwordx4 v225, s[16:19], s42 offen offset:3072 nt lds
  v_mfma_f32_16x16x32_bf16 v[4:7], v[164:167], a[112:115], v[4:7]
  s_nop 0
  ds_read_b64_tr_b16 v[156:157], v221 offset:64
  ds_read_b64_tr_b16 v[158:159], v221 offset:576
  v_mfma_f32_16x16x32_bf16 v[4:7], v[168:171], a[116:119], v[4:7]
  s_nop 0
  ds_read_b64_tr_b16 v[160:161], v221 offset:8768
  ds_read_b64_tr_b16 v[162:163], v221 offset:9280
  v_mfma_f32_16x16x32_bf16 v[4:7], v[172:175], a[120:123], v[4:7]
  s_add_u32 s42, s42, s52
  ds_read_b64_tr_b16 v[164:165], v221 offset:17472
  ds_read_b64_tr_b16 v[166:167], v221 offset:17984
  v_mfma_f32_16x16x32_bf16 v[4:7], v[176:179], a[124:127], v[4:7]
  s_waitcnt lgkmcnt(12)
  s_add_u32 m0, m0, s53
  ds_read_b64_tr_b16 v[168:169], v221 offset:26176
  v_mfma_f32_16x16x32_bf16 v[128:131], a[228:231], a[224:227], v[128:131]
  s_nop 0
  ds_read_b64_tr_b16 v[170:171], v221 offset:26688
  buffer_load_dwordx4 v225, s[16:19], s42 offen nt lds
  v_mfma_f32_16x16x32_bf16 v[132:135], a[232:235], a[224:227], v[132:135]
  ds_read_b64 v[172:173], v224 offset:896
  v_mfma_f32_16x16x32_bf16 v[8:11], a[236:239], a[48:51], v[8:11]
  ds_read_b64 v[174:175], v224 offset:928
  v_mfma_f32_16x16x32_bf16 v[8:11], a[240:243], a[52:55], v[8:11]
  v_mul_f32 v0, s54, v0
  v_mul_f32 v1, s54, v1
  v_mfma_f32_16x16x32_bf16 v[8:11], a[244:247], a[56:59], v[8:11]
  v_mul_f32 v2, s54, v2
  v_mul_f32 v3, s54, v3
  v_mfma_f32_16x16x32_bf16 v[8:11], a[248:251], a[60:63], v[8:11]
  s_add_u32 m0, m0, 32
  v_cvt_pk_bf16_f32 v64, v0, v1
  v_cvt_pk_bf16_f32 v65, v2, v3
  v_mfma_f32_16x16x32_bf16 v[12:15], a[236:239], a[112:115], v[12:15]
  v_mul_f32 v4, s54, v4
  v_mul_f32 v5, s54, v5
  v_mfma_f32_16x16x32_bf16 v[12:15], a[240:243], a[116:119], v[12:15]
  v_mul_f32 v6, s54, v6
  v_mul_f32 v7, s54, v7
  v_mfma_f32_16x16x32_bf16 v[12:15], a[244:247], a[120:123], v[12:15]
  v_cvt_pk_bf16_f32 v80, v4, v5
  v_cvt_pk_bf16_f32 v81, v6, v7
  v_mfma_f32_16x16x32_bf16 v[12:15], a[248:251], a[124:127], v[12:15]
  s_waitcnt lgkmcnt(2)
  ds_read_b64_tr_b16 v[176:177], v223 offset:17408
  ds_read_b64_tr_b16 v[178:179], v223 offset:17920
  v_mfma_f32_16x16x32_bf16 v[128:131], v[148:151], a[252:255], v[128:131]
  s_nop 0
  ds_read_b64_tr_b16 a[224:225], v223 offset:17416
  ds_read_b64_tr_b16 a[226:227], v223 offset:17928
  v_mfma_f32_16x16x32_bf16 v[132:135], v[152:155], a[252:255], v[132:135]
  s_nop 0
  buffer_load_dwordx4 v225, s[16:19], s42 offen offset:1024 nt lds
  ds_read_b64_tr_b16 a[228:229], v221 offset:72
  v_mfma_f32_16x16x32_bf16 v[16:19], v[156:159], a[48:51], v[16:19]
  s_nop 0
  ds_read_b64_tr_b16 a[230:231], v221 offset:584
  ds_read_b64_tr_b16 a[232:233], v221 offset:8776
  v_mfma_f32_16x16x32_bf16 v[16:19], v[160:163], a[52:55], v[16:19]
  s_nop 0
  ds_read_b64_tr_b16 a[234:235], v221 offset:9288
  ds_read_b64_tr_b16 a[236:237], v221 offset:17480
  v_mfma_f32_16x16x32_bf16 v[16:19], v[164:167], a[56:59], v[16:19]
  s_add_u32 m0, m0, 32
  ds_read_b64_tr_b16 a[238:239], v221 offset:17992
  v_mfma_f32_16x16x32_bf16 v[16:19], v[168:171], a[60:63], v[16:19]
  s_nop 0
  ds_read_b64_tr_b16 a[240:241], v221 offset:26184
  ds_read_b64_tr_b16 a[242:243], v221 offset:26696
  v_mfma_f32_16x16x32_bf16 v[20:23], v[156:159], a[112:115], v[20:23]
  buffer_load_dwordx4 v225, s[16:19], s42 offen offset:2048 nt lds
  v_mul_f32 v8, s54, v8
  v_mfma_f32_16x16x32_bf16 v[20:23], v[160:163], a[116:119], v[20:23]
  v_mul_f32 v9, s54, v9
  v_mul_f32 v10, s54, v10
  v_mfma_f32_16x16x32_bf16 v[20:23], v[164:167], a[120:123], v[20:23]
  v_mul_f32 v11, s54, v11
  v_cvt_pk_bf16_f32 v66, v8, v9
  v_mfma_f32_16x16x32_bf16 v[20:23], v[168:171], a[124:127], v[20:23]
  s_waitcnt lgkmcnt(6)
  v_cvt_pk_bf16_f32 v67, v10, v11
  v_mul_f32 v12, s54, v12
  v_mfma_f32_16x16x32_bf16 v[128:131], v[176:179], v[172:175], v[128:131]
  v_mul_f32 v13, s54, v13
  v_mul_f32 v14, s54, v14
  v_mfma_f32_16x16x32_bf16 v[132:135], a[224:227], v[172:175], v[132:135]
  v_mul_f32 v15, s54, v15
  v_cvt_pk_bf16_f32 v82, v12, v13
  v_mfma_f32_16x16x32_bf16 v[24:27], a[228:231], a[48:51], v[24:27]
  s_waitcnt lgkmcnt(0)
  ds_read_b64 a[244:245], v224 offset:960
  ds_read_b64 a[246:247], v224 offset:992
  ds_read_b64_tr_b16 a[248:249], v223 offset:26112
  ds_read_b64_tr_b16 a[250:251], v223 offset:26624
  v_mfma_f32_16x16x32_bf16 v[24:27], a[232:235], a[52:55], v[24:27]
  s_add_u32 m0, m0, 32
  ds_read_b64_tr_b16 a[252:253], v223 offset:26120
  ds_read_b64_tr_b16 a[254:255], v223 offset:26632
  v_mfma_f32_16x16x32_bf16 v[24:27], a[236:239], a[56:59], v[24:27]
  s_nop 0
  buffer_load_dwordx4 v225, s[16:19], s42 offen offset:3072 nt lds
  ds_read_b64_tr_b16 v[148:149], v221 offset:128
  ds_read_b64_tr_b16 v[150:151], v221 offset:640
  v_mfma_f32_16x16x32_bf16 v[24:27], a[240:243], a[60:63], v[24:27]
  s_nop 0
  ds_read_b64_tr_b16 v[152:153], v221 offset:8832
  ds_read_b64_tr_b16 v[154:155], v221 offset:9344
  v_mfma_f32_16x16x32_bf16 v[28:31], a[228:231], a[112:115], v[28:31]
  s_nop 0
  ds_read_b64_tr_b16 v[156:157], v221 offset:17536
  ds_read_b64_tr_b16 v[158:159], v221 offset:18048
  v_mfma_f32_16x16x32_bf16 v[28:31], a[232:235], a[116:119], v[28:31]
  s_nop 0
  ds_read_b64_tr_b16 v[160:161], v221 offset:26240
  ds_read_b64_tr_b16 v[162:163], v221 offset:26752
  v_mfma_f32_16x16x32_bf16 v[28:31], a[236:239], a[120:123], v[28:31]
  v_cvt_pk_bf16_f32 v83, v14, v15
  v_mul_f32 v16, s54, v16
  v_mfma_f32_16x16x32_bf16 v[28:31], a[240:243], a[124:127], v[28:31]
  s_waitcnt lgkmcnt(10)
  v_mul_f32 v17, s54, v17
  v_mul_f32 v18, s54, v18
  v_mfma_f32_16x16x32_bf16 v[128:131], a[248:251], a[244:247], v[128:131]
  s_waitcnt lgkmcnt(8)
  v_mul_f32 v19, s54, v19
  v_cvt_pk_bf16_f32 v68, v16, v17
  v_mfma_f32_16x16x32_bf16 v[132:135], a[252:255], a[244:247], v[132:135]
  s_waitcnt lgkmcnt(6)
  ds_read_b64_tr_b16 v[164:165], v221 offset:136
  ds_read_b64_tr_b16 v[166:167], v221 offset:648
  ds_read_b64_tr_b16 v[168:169], v221 offset:8840
  ds_read_b64_tr_b16 v[170:171], v221 offset:9352
  v_mfma_f32_16x16x32_bf16 v[32:35], v[148:151], a[48:51], v[32:35]
  s_waitcnt lgkmcnt(8)
  ds_read_b64_tr_b16 v[172:173], v221 offset:17544
  ds_read_b64_tr_b16 v[174:175], v221 offset:18056
  ds_read_b64_tr_b16 v[176:177], v221 offset:26248
  ds_read_b64_tr_b16 v[178:179], v221 offset:26760
  v_mfma_f32_16x16x32_bf16 v[32:35], v[152:155], a[52:55], v[32:35]
  s_waitcnt lgkmcnt(10)
  v_cvt_pk_bf16_f32 v69, v18, v19
  v_mul_f32 v20, s54, v20
  v_mfma_f32_16x16x32_bf16 v[32:35], v[156:159], a[56:59], v[32:35]
  s_waitcnt lgkmcnt(8)
  v_mul_f32 v21, s54, v21
  v_mul_f32 v22, s54, v22
  v_mfma_f32_16x16x32_bf16 v[32:35], v[160:163], a[60:63], v[32:35]
  v_mul_f32 v23, s54, v23
  v_cvt_pk_bf16_f32 v84, v20, v21
  v_mfma_f32_16x16x32_bf16 v[36:39], v[148:151], a[112:115], v[36:39]
  s_nop 0
  ds_read_b64_tr_b16 a[224:225], v221 offset:192
  ds_read_b64_tr_b16 a[226:227], v221 offset:704
  v_mfma_f32_16x16x32_bf16 v[36:39], v[152:155], a[116:119], v[36:39]
  s_nop 0
  ds_read_b64_tr_b16 a[228:229], v221 offset:8896
  ds_read_b64_tr_b16 a[230:231], v221 offset:9408
  ds_read_b64_tr_b16 a[232:233], v221 offset:17600
  ds_read_b64_tr_b16 a[234:235], v221 offset:18112
  ds_read_b64_tr_b16 a[236:237], v221 offset:26304
  ds_read_b64_tr_b16 a[238:239], v221 offset:26816
  v_mfma_f32_16x16x32_bf16 v[36:39], v[156:159], a[120:123], v[36:39]
  v_cvt_pk_bf16_f32 v85, v22, v23
  v_mul_f32 v128, s54, v128
  v_mfma_f32_16x16x32_bf16 v[36:39], v[160:163], a[124:127], v[36:39]
  s_waitcnt lgkmcnt(8)
  v_mul_f32 v129, s54, v129
  v_mul_f32 v130, s54, v130
  v_mfma_f32_16x16x32_bf16 v[40:43], v[164:167], a[48:51], v[40:43]
  v_mul_f32 v131, s54, v131
  v_mul_f32 v132, s54, v132
  v_mfma_f32_16x16x32_bf16 v[40:43], v[168:171], a[52:55], v[40:43]
  v_mul_f32 v133, s54, v133
  v_mul_f32 v134, s54, v134
  v_mfma_f32_16x16x32_bf16 v[40:43], v[172:175], a[56:59], v[40:43]
  s_nop 0
  ds_read_b64_tr_b16 a[240:241], v221 offset:200
  ds_read_b64_tr_b16 a[242:243], v221 offset:712
  ds_read_b64_tr_b16 a[244:245], v221 offset:8904
  ds_read_b64_tr_b16 a[246:247], v221 offset:9416
  ds_read_b64_tr_b16 a[248:249], v221 offset:17608
  ds_read_b64_tr_b16 a[250:251], v221 offset:18120
  v_mfma_f32_16x16x32_bf16 v[40:43], v[176:179], a[60:63], v[40:43]
  s_nop 0
  ds_read_b64_tr_b16 a[252:253], v221 offset:26312
  ds_read_b64_tr_b16 a[254:255], v221 offset:26824
  v_mul_f32 v135, s54, v135
  v_mfma_f32_16x16x32_bf16 v[44:47], v[164:167], a[112:115], v[44:47]
  v_cvt_pk_bf16_f32 v128, v128, v129
  v_cvt_pk_bf16_f32 v129, v130, v131
  v_mfma_f32_16x16x32_bf16 v[44:47], v[168:171], a[116:119], v[44:47]
  v_cvt_pk_bf16_f32 v130, v132, v133
  v_cvt_pk_bf16_f32 v131, v134, v135
  v_mfma_f32_16x16x32_bf16 v[44:47], v[172:175], a[120:123], v[44:47]
  ds_write_b128 v230, v[128:131]
  v_mfma_f32_16x16x32_bf16 v[44:47], v[176:179], a[124:127], v[44:47]
  s_waitcnt lgkmcnt(9)
  v_mul_f32 v24, s54, v24
  v_mul_f32 v25, s54, v25
  v_mfma_f32_16x16x32_bf16 v[48:51], a[224:227], a[48:51], v[48:51]
  s_cmp_eq_u32 s94, 11
  s_cselect_b32 s43, s95, 0x1000
  buffer_store_byte v196, off, s[4:7], s43 sc1
  v_mfma_f32_16x16x32_bf16 v[48:51], a[228:231], a[52:55], v[48:51]
  v_mul_f32 v26, s54, v26
  v_mul_f32 v27, s54, v27
  v_mfma_f32_16x16x32_bf16 v[48:51], a[232:235], a[56:59], v[48:51]
  v_cvt_pk_bf16_f32 v70, v24, v25
  v_cvt_pk_bf16_f32 v71, v26, v27
  v_mfma_f32_16x16x32_bf16 v[48:51], a[236:239], a[60:63], v[48:51]
  v_mul_f32 v28, s54, v28
  v_mul_f32 v29, s54, v29
  v_mfma_f32_16x16x32_bf16 v[52:55], a[224:227], a[112:115], v[52:55]
  v_mul_f32 v30, s54, v30
  v_mul_f32 v31, s54, v31
  v_mfma_f32_16x16x32_bf16 v[52:55], a[228:231], a[116:119], v[52:55]
  v_cvt_pk_bf16_f32 v86, v28, v29
  v_cvt_pk_bf16_f32 v87, v30, v31
  v_mfma_f32_16x16x32_bf16 v[52:55], a[232:235], a[120:123], v[52:55]
  v_mul_f32 v32, s54, v32
  v_mul_f32 v33, s54, v33
  v_mfma_f32_16x16x32_bf16 v[52:55], a[236:239], a[124:127], v[52:55]
  s_waitcnt lgkmcnt(1)
  v_mul_f32 v34, s54, v34
  v_mul_f32 v35, s54, v35
  v_mfma_f32_16x16x32_bf16 v[56:59], a[240:243], a[48:51], v[56:59]
  s_waitcnt lgkmcnt(0)
  s_barrier
  v_cvt_pk_bf16_f32 v72, v32, v33
  v_mfma_f32_16x16x32_bf16 v[56:59], a[244:247], a[52:55], v[56:59]
  v_cvt_pk_bf16_f32 v73, v34, v35
  v_mul_f32 v36, s54, v36
  v_mfma_f32_16x16x32_bf16 v[56:59], a[248:251], a[56:59], v[56:59]
  v_mul_f32 v37, s54, v37
  v_mul_f32 v38, s54, v38
  v_mfma_f32_16x16x32_bf16 v[56:59], a[252:255], a[60:63], v[56:59]
  v_mul_f32 v39, s54, v39
  v_cvt_pk_bf16_f32 v88, v36, v37
  v_mfma_f32_16x16x32_bf16 v[60:63], a[240:243], a[112:115], v[60:63]
  ds_read_b128 v[148:151], v212 offset:0
  v_cvt_pk_bf16_f32 v89, v38, v39
  v_mfma_f32_16x16x32_bf16 v[60:63], a[244:247], a[116:119], v[60:63]
  s_nop 0
  ds_read_b128 v[180:183], v248 offset:0
  ds_read_b128 v[184:187], v248 offset:1024
  v_mfma_f32_16x16x32_bf16 v[60:63], a[248:251], a[120:123], v[60:63]
  s_nop 0
  ds_read_b128 v[188:191], v248 offset:2048
  ds_read_b128 v[192:195], v248 offset:3072
  v_mfma_f32_16x16x32_bf16 v[60:63], a[252:255], a[124:127], v[60:63]
  s_nop 5
  s_nop 0
  ds_read_b128 v[152:155], v212 offset:64
  ds_read_b128 v[156:159], v212 offset:128
  ds_read_b128 v[160:163], v212 offset:192
  v_mul_f32 v40, s54, v40
  v_mul_f32 v41, s54, v41
  v_mul_f32 v42, s54, v42
  v_mul_f32 v43, s54, v43
  v_cvt_pk_bf16_f32 v74, v40, v41
  v_cvt_pk_bf16_f32 v75, v42, v43
  v_mul_f32 v44, s54, v44
  v_mul_f32 v45, s54, v45
  v_mul_f32 v46, s54, v46
  v_mul_f32 v47, s54, v47
  v_cvt_pk_bf16_f32 v90, v44, v45
  v_cvt_pk_bf16_f32 v91, v46, v47
  v_mul_f32 v48, s54, v48
  v_mul_f32 v49, s54, v49
  v_mul_f32 v50, s54, v50
  v_mul_f32 v51, s54, v51
  v_cvt_pk_bf16_f32 v76, v48, v49
  v_cvt_pk_bf16_f32 v77, v50, v51
  v_mul_f32 v52, s54, v52
  v_mul_f32 v53, s54, v53
  v_mul_f32 v54, s54, v54
  v_mul_f32 v55, s54, v55
  v_cvt_pk_bf16_f32 v92, v52, v53
  v_cvt_pk_bf16_f32 v93, v54, v55
  v_mul_f32 v56, s54, v56
  v_mul_f32 v57, s54, v57
  v_mul_f32 v58, s54, v58
  v_mul_f32 v59, s54, v59
  v_cvt_pk_bf16_f32 v78, v56, v57
  v_cvt_pk_bf16_f32 v79, v58, v59
  v_mul_f32 v60, s54, v60
  v_mul_f32 v61, s54, v61
  v_mul_f32 v62, s54, v62
  v_mul_f32 v63, s54, v63
  v_cvt_pk_bf16_f32 v94, v60, v61
  v_cvt_pk_bf16_f32 v95, v62, v63
  s_add_u32 s0, s0, 131072
  s_add_u32 s1, s1, 131072
  s_add_u32 s2, s2, 131072
  s_add_u32 s3, s3, 131072
  s_mov_b32 s41, 3
  s_mov_b32 s12, s24
  s_mov_b32 s32, s24
  s_mov_b32 s13, s25
  s_mov_b32 s33, s25
  s_mov_b32 s14, s26
  s_mov_b32 s34, s26
  s_mov_b32 s49, 1024
  s_mov_b32 s50, 1056
  s_mov_b32 s51, 1056
  s_mov_b32 s45, s72
  s_add_u32 s46, s72, 262144
  s_mov_b32 s42, 0
  v_lshrrev_b32 v227, 7, v225
  v_lshlrev_b32 v227, 13, v227
  v_and_b32 v228, 0x70, v225
  v_or_b32 v227, v227, v228
  v_mov_b32 v226, v227
  s_lshl_b32 s65, s58, 2
  s_add_u32 s65, s65, s36
  s_lshl_b32 s65, s65, 11
  s_add_u32 s65, s65, 393216
  v_lshlrev_b32 v250, 1, v225
  buffer_load_dword v229, v250, s[24:27], s65 offen
  s_branch L_attn
L_final:
  s_lshl_b32 s42, s36, 10
  s_add_u32 s42, s42, 139264
  v_add_u32 v220, s42, v225
  v_add_u32 v221, 139264, v225
  ds_write_b128 v220, v[232:235] offset:0
  ds_write_b128 v220, v[236:239] offset:4096
  ds_write_b128 v220, v[240:243] offset:8192
  v_lshrrev_b32 v222, 1, v225
  v_bfe_u32 v212, v225, 6, 3
  v_mul_u32_u24 v212, 1056, v212
  v_lshrrev_b32 v213, 9, v225
  v_lshl_add_u32 v212, v213, 7, v212
  v_and_b32 v213, 24, v222
  v_add_u32 v216, v212, v213
  s_add_u32 s42, s36, 1
  s_and_b32 s42, s42, 3
  s_lshl_b32 s42, s42, 5
  v_add_u32 v212, s42, v216
  s_add_u32 s42, s36, 2
  s_and_b32 s42, s42, 3
  s_lshl_b32 s42, s42, 5
  v_add_u32 v213, s42, v216
  s_add_u32 s42, s36, 3
  s_and_b32 s42, s42, 3
  s_lshl_b32 s42, s42, 5
  v_add_u32 v214, s42, v216
  s_add_u32 s42, s36, 4
  s_and_b32 s42, s42, 3
  s_lshl_b32 s42, s42, 5
  v_add_u32 v215, s42, v216
  v_add_u32 v216, 69632, v212
  v_add_u32 v217, 69632, v213
  v_add_u32 v218, 69632, v214
  v_add_u32 v219, 69632, v215
  s_lshl_b32 s89, s60, 3
  v_bfe_u32 v250, v225, 4, 3
  buffer_load_ubyte v229, v250, s[4:7], s89 offen sc1
  s_waitcnt lgkmcnt(0)
  s_waitcnt vmcnt(9)
  s_barrier
  ds_read_b64_tr_b16 v[148:149], v212 offset:0
  ds_read_b64_tr_b16 v[150:151], v212 offset:256
  ds_read_b64_tr_b16 v[152:153], v212 offset:512
  ds_read_b64_tr_b16 v[154:155], v212 offset:768
  ds_read_b64_tr_b16 v[156:157], v212 offset:8704
  ds_read_b64_tr_b16 v[158:159], v212 offset:8960
  ds_read_b64_tr_b16 v[160:161], v212 offset:9216
  ds_read_b64_tr_b16 v[162:163], v212 offset:9472
  ds_read_b64_tr_b16 v[164:165], v212 offset:17408
  ds_read_b64_tr_b16 v[166:167], v212 offset:17664
  ds_read_b64_tr_b16 v[168:169], v212 offset:17920
  ds_read_b64_tr_b16 v[170:171], v212 offset:18176
  v_rcp_f32 v251, v200
  v_rcp_f32 v252, v204
  v_cmp_lt_f32 vcc, s55, v200
  v_cmp_gt_f32 s[66:67], s56, v200
  s_and_b64 s[68:69], vcc, s[66:67]
  v_cmp_lt_f32 vcc, s55, v204
  v_cmp_gt_f32 s[66:67], s56, v204
  s_and_b64 s[68:69], s[68:69], vcc
  v_mov_b32 v250, s57
  s_and_b64 vcc, s[68:69], s[66:67]
  v_mul_f32 v0, v251, v0
  v_mul_f32 v1, v251, v1
  v_mul_f32 v2, v251, v2
  v_mul_f32 v3, v251, v3
  v_cvt_pk_bf16_f32 v96, v0, v1
  v_cvt_pk_bf16_f32 v97, v2, v3
  v_mul_f32 v4, v252, v4
  v_mul_f32 v5, v252, v5
  v_mul_f32 v6, v252, v6
  v_mul_f32 v7, v252, v7
  v_cvt_pk_bf16_f32 v112, v4, v5
  v_cvt_pk_bf16_f32 v113, v6, v7
  v_cndmask_b32 v250, v250, 0, vcc
  ds_write_b32 v231, v250 offset:1024
  s_waitcnt lgkmcnt(11)
  v_mfma_f32_16x16x32_bf16 v[0:3], v[148:151], a[128:131], 0
  s_waitcnt lgkmcnt(9)
  s_add_u32 s42, s73, 0
  s_mov_b32 m0, s40
  v_mfma_f32_16x16x32_bf16 v[0:3], v[152:155], a[132:135], v[0:3]
  v_mul_f32 v8, v251, v8
  v_mul_f32 v9, v251, v9
  v_mfma_f32_16x16x32_bf16 v[4:7], v[148:151], a[144:147], 0
  v_mul_f32 v10, v251, v10
  v_mul_f32 v11, v251, v11
  v_mfma_f32_16x16x32_bf16 v[4:7], v[152:155], a[148:151], v[4:7]
  s_waitcnt lgkmcnt(7)
  v_cvt_pk_bf16_f32 v98, v8, v9
  v_cvt_pk_bf16_f32 v99, v10, v11
  v_mfma_f32_16x16x32_bf16 v[0:3], v[156:159], a[136:139], v[0:3]
  s_waitcnt lgkmcnt(5)
  ds_read_b64_tr_b16 v[172:173], v212 offset:26112
  ds_read_b64_tr_b16 v[174:175], v212 offset:26368
  v_mfma_f32_16x16x32_bf16 v[0:3], v[160:163], a[140:143], v[0:3]
  s_nop 0
  ds_read_b64_tr_b16 v[176:177], v212 offset:26624
  ds_read_b64_tr_b16 v[178:179], v212 offset:26880
  v_mfma_f32_16x16x32_bf16 v[4:7], v[156:159], a[152:155], v[4:7]
  v_mul_f32 v12, v252, v12
  v_mul_f32 v13, v252, v13
  v_mfma_f32_16x16x32_bf16 v[4:7], v[160:163], a[156:159], v[4:7]
  s_waitcnt lgkmcnt(5)
  ds_read_b128 v[180:183], v253 offset:0
  v_mul_f32 v14, v252, v14
  v_mfma_f32_16x16x32_bf16 v[0:3], v[164:167], a[160:163], v[0:3]
  s_nop 0
  buffer_load_dwordx4 v227, s[24:27], s42 offen lds
  ds_read_b64_tr_b16 a[224:225], v213 offset:0
  ds_read_b64_tr_b16 a[226:227], v213 offset:256
  v_mfma_f32_16x16x32_bf16 v[0:3], v[168:171], a[164:167], v[0:3]
  s_nop 0
  ds_read_b64_tr_b16 a[228:229], v213 offset:512
  ds_read_b64_tr_b16 a[230:231], v213 offset:768
  v_mfma_f32_16x16x32_bf16 v[4:7], v[164:167], a[176:179], v[4:7]
  ds_read_b128 v[184:187], v253 offset:1024
  v_mul_f32 v15, v252, v15
  v_mfma_f32_16x16x32_bf16 v[4:7], v[168:171], a[180:183], v[4:7]
  s_waitcnt lgkmcnt(8)
  ds_read_b128 v[188:191], v253 offset:8192
  ds_read_b128 v[192:195], v253 offset:9216
  v_mfma_f32_16x16x32_bf16 v[0:3], v[172:175], a[168:171], v[0:3]
  s_waitcnt lgkmcnt(8)
  ds_read_b64_tr_b16 a[232:233], v213 offset:8704
  ds_read_b64_tr_b16 a[234:235], v213 offset:8960
  v_mfma_f32_16x16x32_bf16 v[0:3], v[176:179], a[172:175], v[0:3]
  s_add_u32 m0, m0, 32
  ds_read_b64_tr_b16 a[236:237], v213 offset:9216
  ds_read_b64_tr_b16 a[238:239], v213 offset:9472
  v_mfma_f32_16x16x32_bf16 v[4:7], v[172:175], a[184:187], v[4:7]
  s_nop 0
  buffer_load_dwordx4 v227, s[24:27], s42 offen offset:1024 lds
  ds_read_b128 v[200:203], v253 offset:16384
  v_mfma_f32_16x16x32_bf16 v[4:7], v[176:179], a[188:191], v[4:7]
  s_waitcnt lgkmcnt(10)
  v_cvt_pk_bf16_f32 v114, v12, v13
  v_cvt_pk_bf16_f32 v115, v14, v15
  v_mfma_f32_16x16x32_bf16 v[8:11], a[224:227], a[128:131], 0
  s_waitcnt lgkmcnt(8)
  ds_read_b64_tr_b16 a[240:241], v213 offset:17408
  ds_read_b64_tr_b16 a[242:243], v213 offset:17664
  v_mfma_f32_16x16x32_bf16 v[8:11], a[228:231], a[132:135], v[8:11]
  s_nop 0
  ds_read_b64_tr_b16 a[244:245], v213 offset:17920
  ds_read_b64_tr_b16 a[246:247], v213 offset:18176
  v_mfma_f32_16x16x32_bf16 v[12:15], a[224:227], a[144:147], 0
  s_add_u32 m0, m0, 32
  ds_read_b128 v[204:207], v253 offset:17408
  ds_read_b32 v208, v254 offset:0
  v_mfma_f32_16x16x32_bf16 v[12:15], a[228:231], a[148:151], v[12:15]
  s_waitcnt lgkmcnt(9)
  ds_read_b32 v209, v254 offset:256
  ds_read_b32 v210, v254 offset:512
  v_mfma_f32_16x16x32_bf16 v[8:11], a[232:235], a[136:139], v[8:11]
  s_waitcnt lgkmcnt(9)
  buffer_load_dwordx4 v227, s[24:27], s42 offen offset:2048 lds
  ds_read_b64_tr_b16 a[248:249], v213 offset:26112
  ds_read_b64_tr_b16 a[250:251], v213 offset:26368
  v_mfma_f32_16x16x32_bf16 v[8:11], a[236:239], a[140:143], v[8:11]
  s_nop 0
  ds_read_b64_tr_b16 a[252:253], v213 offset:26624
  ds_read_b64_tr_b16 a[254:255], v213 offset:26880
  v_mfma_f32_16x16x32_bf16 v[12:15], a[232:235], a[152:155], v[12:15]
  ds_read_b32 v211, v254 offset:768
  v_mul_f32 v16, v251, v16
  v_mfma_f32_16x16x32_bf16 v[12:15], a[236:239], a[156:159], v[12:15]
  s_waitcnt lgkmcnt(11)
  ds_read_b128 a[0:3], v221 offset:0
  ds_read_b128 a[4:7], v221 offset:1024
  v_mfma_f32_16x16x32_bf16 v[8:11], a[240:243], a[160:163], v[8:11]
  s_waitcnt lgkmcnt(11)
  ds_read_b64_tr_b16 v[148:149], v214 offset:0
  ds_read_b64_tr_b16 v[150:151], v214 offset:256
  v_mfma_f32_16x16x32_bf16 v[8:11], a[244:247], a[164:167], v[8:11]
  s_add_u32 m0, m0, 32
  ds_read_b64_tr_b16 v[152:153], v214 offset:512
  ds_read_b64_tr_b16 v[154:155], v214 offset:768
  v_mfma_f32_16x16x32_bf16 v[12:15], a[240:243], a[176:179], v[12:15]
  s_nop 0
  buffer_load_dwordx4 v227, s[24:27], s42 offen offset:3072 lds
  ds_read_b128 a[8:11], v221 offset:2048
  v_mfma_f32_16x16x32_bf16 v[12:15], a[244:247], a[180:183], v[12:15]
  s_waitcnt lgkmcnt(10)
  ds_read_b128 a[12:15], v221 offset:3072
  ds_read_b128 a[16:19], v221 offset:4096
  v_mfma_f32_16x16x32_bf16 v[8:11], a[248:251], a[168:171], v[8:11]
  s_waitcnt lgkmcnt(10)
  ds_read_b64_tr_b16 v[156:157], v214 offset:8704
  ds_read_b64_tr_b16 v[158:159], v214 offset:8960
  v_mfma_f32_16x16x32_bf16 v[8:11], a[252:255], a[172:175], v[8:11]
  s_waitcnt lgkmcnt(11)
  ds_read_b64_tr_b16 v[160:161], v214 offset:9216
  ds_read_b64_tr_b16 v[162:163], v214 offset:9472
  v_mfma_f32_16x16x32_bf16 v[12:15], a[248:251], a[184:187], v[12:15]
  s_add_u32 s42, s42, s52
  v_add_f32 v180, v180, v188
  v_add_f32 v181, v181, v189
  v_mfma_f32_16x16x32_bf16 v[12:15], a[252:255], a[188:191], v[12:15]
  s_waitcnt lgkmcnt(9)
  s_add_u32 m0, m0, s53
  v_mul_f32 v17, v251, v17
  v_mul_f32 v18, v251, v18
  v_mul_f32 v19, v251, v19
  v_cvt_pk_bf16_f32 v100, v16, v17
  v_cvt_pk_bf16_f32 v101, v18, v19
  v_mul_f32 v20, v252, v20
  v_mul_f32 v21, v252, v21
  v_mul_f32 v22, v252, v22
  v_mul_f32 v23, v252, v23
  v_cvt_pk_bf16_f32 v116, v20, v21
  v_cvt_pk_bf16_f32 v117, v22, v23
  v_mfma_f32_16x16x32_bf16 v[16:19], v[148:151], a[128:131], 0
  s_waitcnt lgkmcnt(7)
  buffer_load_dwordx4 v227, s[24:27], s42 offen lds
  ds_read_b64_tr_b16 v[164:165], v214 offset:17408
  ds_read_b64_tr_b16 v[166:167], v214 offset:17664
  v_mfma_f32_16x16x32_bf16 v[16:19], v[152:155], a[132:135], v[16:19]
  s_nop 0
  ds_read_b64_tr_b16 v[168:169], v214 offset:17920
  ds_read_b64_tr_b16 v[170:171], v214 offset:18176
  v_mfma_f32_16x16x32_bf16 v[20:23], v[148:151], a[144:147], 0
  v_add_f32 v182, v182, v190
  v_add_f32 v183, v183, v191
  v_mfma_f32_16x16x32_bf16 v[20:23], v[152:155], a[148:151], v[20:23]
  s_waitcnt lgkmcnt(6)
  v_add_f32 v184, v184, v192
  v_add_f32 v185, v185, v193
  v_mfma_f32_16x16x32_bf16 v[16:19], v[156:159], a[136:139], v[16:19]
  s_waitcnt lgkmcnt(4)
  ds_read_b64_tr_b16 v[172:173], v214 offset:26112
  ds_read_b64_tr_b16 v[174:175], v214 offset:26368
  v_mfma_f32_16x16x32_bf16 v[16:19], v[160:163], a[140:143], v[16:19]
  s_add_u32 m0, m0, 32
  ds_read_b64_tr_b16 v[176:177], v214 offset:26624
  ds_read_b64_tr_b16 v[178:179], v214 offset:26880
  v_mfma_f32_16x16x32_bf16 v[20:23], v[156:159], a[152:155], v[20:23]
  buffer_load_dwordx4 v227, s[24:27], s42 offen offset:1024 lds
  v_add_f32 v186, v186, v194
  v_mfma_f32_16x16x32_bf16 v[20:23], v[160:163], a[156:159], v[20:23]
  s_waitcnt lgkmcnt(6)
  ds_read_b128 a[20:23], v221 offset:5120
  v_add_f32 v187, v187, v195
  v_mfma_f32_16x16x32_bf16 v[16:19], v[164:167], a[160:163], v[16:19]
  s_waitcnt lgkmcnt(5)
  ds_read_b128 v[188:191], v253 offset:24576
  ds_read_b128 v[192:195], v253 offset:25600
  ds_read_b128 a[24:27], v221 offset:6144
  ds_read_b128 a[28:31], v221 offset:7168
  ds_read_b64_tr_b16 a[224:225], v215 offset:0
  ds_read_b64_tr_b16 a[226:227], v215 offset:256
  v_mfma_f32_16x16x32_bf16 v[16:19], v[168:171], a[164:167], v[16:19]
  s_nop 0
  ds_read_b64_tr_b16 a[228:229], v215 offset:512
  ds_read_b64_tr_b16 a[230:231], v215 offset:768
  v_mfma_f32_16x16x32_bf16 v[20:23], v[164:167], a[176:179], v[20:23]
  s_add_u32 m0, m0, 32
  v_add_f32 v208, v208, v209
  v_add_f32 v210, v210, v211
  v_mfma_f32_16x16x32_bf16 v[20:23], v[168:171], a[180:183], v[20:23]
  s_waitcnt lgkmcnt(11)
  v_add_f32 v180, v180, v200
  v_add_f32 v181, v181, v201
  v_mfma_f32_16x16x32_bf16 v[16:19], v[172:175], a[168:171], v[16:19]
  s_waitcnt lgkmcnt(9)
  buffer_load_dwordx4 v227, s[24:27], s42 offen offset:2048 lds
  v_add_f32 v182, v182, v202
  v_mfma_f32_16x16x32_bf16 v[16:19], v[176:179], a[172:175], v[16:19]
  v_add_f32 v183, v183, v203
  v_add_f32 v184, v184, v204
  v_mfma_f32_16x16x32_bf16 v[20:23], v[172:175], a[184:187], v[20:23]
  s_nop 0
  ds_read_b64_tr_b16 a[232:233], v215 offset:8704
  ds_read_b64_tr_b16 a[234:235], v215 offset:8960
  v_mfma_f32_16x16x32_bf16 v[20:23], v[176:179], a[188:191], v[20:23]
  s_waitcnt lgkmcnt(4)
  ds_read_b64_tr_b16 a[236:237], v215 offset:9216
  ds_read_b64_tr_b16 a[238:239], v215 offset:9472
  v_mul_f32 v24, v251, v24
  v_mul_f32 v25, v251, v25
  v_mul_f32 v26, v251, v26
  v_mul_f32 v27, v251, v27
  v_cvt_pk_bf16_f32 v102, v24, v25
  v_cvt_pk_bf16_f32 v103, v26, v27
  v_mul_f32 v28, v252, v28
  v_mul_f32 v29, v252, v29
  v_mul_f32 v30, v252, v30
  v_mul_f32 v31, v252, v31
  v_cvt_pk_bf16_f32 v118, v28, v29
  v_cvt_pk_bf16_f32 v119, v30, v31
  v_mfma_f32_16x16x32_bf16 v[24:27], a[224:227], a[128:131], 0
  s_waitcnt lgkmcnt(4)
  v_add_f32 v185, v185, v205
  v_add_f32 v186, v186, v206
  v_mfma_f32_16x16x32_bf16 v[24:27], a[228:231], a[132:135], v[24:27]
  s_add_u32 m0, m0, 32
  v_add_f32 v187, v187, v207
  v_add_f32 v208, v208, v210
  v_mfma_f32_16x16x32_bf16 v[28:31], a[224:227], a[144:147], 0
  s_nop 0
  buffer_load_dwordx4 v227, s[24:27], s42 offen offset:3072 lds
  ds_read_b128 a[32:35], v221 offset:8192
  v_mfma_f32_16x16x32_bf16 v[28:31], a[228:231], a[148:151], v[28:31]
  v_rcp_f32 v250, v208
  v_mfma_f32_16x16x32_bf16 v[128:131], a[224:227], a[0:3], 0
  ds_read_b64_tr_b16 a[240:241], v215 offset:17408
  ds_read_b64_tr_b16 a[242:243], v215 offset:17664
  v_mfma_f32_16x16x32_bf16 v[128:131], a[228:231], a[4:7], v[128:131]
  s_waitcnt lgkmcnt(5)
  ds_read_b64_tr_b16 a[244:245], v215 offset:17920
  ds_read_b64_tr_b16 a[246:247], v215 offset:18176
  v_mfma_f32_16x16x32_bf16 v[24:27], a[232:235], a[136:139], v[24:27]
  s_waitcnt lgkmcnt(5)
  v_add_f32 v180, v180, v188
  v_add_f32 v181, v181, v189
  v_add_f32 v182, v182, v190
  v_add_f32 v183, v183, v191
  v_add_f32 v184, v184, v192
  v_add_f32 v185, v185, v193
  v_add_f32 v186, v186, v194
  v_add_f32 v187, v187, v195
  v_mul_f32 v180, v250, v180
  v_mul_f32 v181, v250, v181
  v_mul_f32 v182, v250, v182
  v_mul_f32 v183, v250, v183
  v_mul_f32 v184, v250, v184
  v_mul_f32 v185, v250, v185
  v_mul_f32 v186, v250, v186
  v_mul_f32 v187, v250, v187
  v_cvt_pk_bf16_f32 v244, v180, v181
  v_cvt_pk_bf16_f32 v245, v182, v183
  v_cvt_pk_bf16_f32 v246, v184, v185
  v_cvt_pk_bf16_f32 v247, v186, v187
  v_mfma_f32_16x16x32_bf16 v[24:27], a[236:239], a[140:143], v[24:27]
  s_nop 0
  ds_read_b128 a[36:39], v221 offset:9216
  ds_read_b128 a[40:43], v221 offset:10240
  v_mfma_f32_16x16x32_bf16 v[28:31], a[232:235], a[152:155], v[28:31]
  ds_write_b128 v220, v[244:247] offset:12288
  v_mfma_f32_16x16x32_bf16 v[28:31], a[236:239], a[156:159], v[28:31]
  ds_read_b128 a[44:47], v221 offset:11264
  v_mul_f32 v32, v251, v32
  v_mfma_f32_16x16x32_bf16 v[128:131], a[232:235], a[8:11], v[128:131]
  s_nop 0
  ds_read_b64_tr_b16 a[248:249], v215 offset:26112
  ds_read_b64_tr_b16 a[250:251], v215 offset:26368
  v_mfma_f32_16x16x32_bf16 v[128:131], a[236:239], a[12:15], v[128:131]
  s_waitcnt lgkmcnt(8)
  ds_read_b64_tr_b16 a[252:253], v215 offset:26624
  ds_read_b64_tr_b16 a[254:255], v215 offset:26880
  v_mfma_f32_16x16x32_bf16 v[24:27], a[240:243], a[160:163], v[24:27]
  s_waitcnt lgkmcnt(8)
  v_mul_f32 v33, v251, v33
  v_mul_f32 v34, v251, v34
  v_mfma_f32_16x16x32_bf16 v[24:27], a[244:247], a[164:167], v[24:27]
  v_mul_f32 v35, v251, v35
  v_cvt_pk_bf16_f32 v104, v32, v33
  v_mfma_f32_16x16x32_bf16 v[28:31], a[240:243], a[176:179], v[28:31]
  v_cvt_pk_bf16_f32 v105, v34, v35
  v_mul_f32 v36, v252, v36
  v_mfma_f32_16x16x32_bf16 v[28:31], a[244:247], a[180:183], v[28:31]
  s_waitcnt lgkmcnt(5)
  s_waitcnt vmcnt(9)
  s_barrier
  v_mul_f32 v37, v252, v37
  v_mfma_f32_16x16x32_bf16 v[128:131], a[240:243], a[16:19], v[128:131]
  s_add_u32 s42, s73, 262144
  ds_read_b64_tr_b16 v[148:149], v212 offset:34816
  ds_read_b64_tr_b16 v[150:151], v212 offset:35072
  v_mfma_f32_16x16x32_bf16 v[128:131], a[244:247], a[20:23], v[128:131]
  s_waitcnt lgkmcnt(4)
  ds_read_b64_tr_b16 v[152:153], v212 offset:35328
  ds_read_b64_tr_b16 v[154:155], v212 offset:35584
  v_mfma_f32_16x16x32_bf16 v[24:27], a[248:251], a[168:171], v[24:27]
  s_waitcnt lgkmcnt(4)
  v_mul_f32 v38, v252, v38
  v_mul_f32 v39, v252, v39
  v_mfma_f32_16x16x32_bf16 v[24:27], a[252:255], a[172:175], v[24:27]
  s_mov_b32 m0, s38
  v_cvt_pk_bf16_f32 v120, v36, v37
  v_cvt_pk_bf16_f32 v121, v38, v39
  v_mfma_f32_16x16x32_bf16 v[28:31], a[248:251], a[184:187], v[28:31]
  s_nop 0
  ds_read_b64_tr_b16 v[156:157], v212 offset:43520
  ds_read_b64_tr_b16 v[158:159], v212 offset:43776
  v_mfma_f32_16x16x32_bf16 v[28:31], a[252:255], a[188:191], v[28:31]
  s_nop 0
  ds_read_b64_tr_b16 v[160:161], v212 offset:44032
  ds_read_b64_tr_b16 v[162:163], v212 offset:44288
  v_mfma_f32_16x16x32_bf16 v[128:131], a[248:251], a[24:27], v[128:131]
  buffer_load_dwordx4 v227, s[24:27], s42 offen lds
  v_mul_f32 v40, v251, v40
  v_mfma_f32_16x16x32_bf16 v[128:131], a[252:255], a[28:31], v[128:131]
  s_waitcnt lgkmcnt(6)
  v_mul_f32 v41, v251, v41
  v_mul_f32 v42, v251, v42
  v_mfma_f32_16x16x32_bf16 v[0:3], v[148:151], a[192:195], v[0:3]
  s_waitcnt lgkmcnt(4)
  ds_read_b64_tr_b16 v[164:165], v212 offset:52224
  ds_read_b64_tr_b16 v[166:167], v212 offset:52480
  v_mul_f32 v43, v251, v43
  v_cvt_pk_bf16_f32 v106, v40, v41
  v_cvt_pk_bf16_f32 v107, v42, v43
  v_mul_f32 v44, v252, v44
  v_mul_f32 v45, v252, v45
  v_mul_f32 v46, v252, v46
  v_mul_f32 v47, v252, v47
  v_cvt_pk_bf16_f32 v122, v44, v45
  v_cvt_pk_bf16_f32 v123, v46, v47
  v_mfma_f32_16x16x32_bf16 v[0:3], v[152:155], a[196:199], v[0:3]
  s_nop 0
  ds_read_b64_tr_b16 v[168:169], v212 offset:52736
  ds_read_b64_tr_b16 v[170:171], v212 offset:52992
  v_mfma_f32_16x16x32_bf16 v[4:7], v[148:151], a[208:211], v[4:7]
  s_add_u32 m0, m0, 32
  v_mul_f32 v48, v251, v48
  v_mul_f32 v49, v251, v49
  v_mfma_f32_16x16x32_bf16 v[4:7], v[152:155], a[212:215], v[4:7]
  s_waitcnt lgkmcnt(6)
  v_mul_f32 v50, v251, v50
  v_mul_f32 v51, v251, v51
  v_cvt_pk_bf16_f32 v108, v48, v49
  v_cvt_pk_bf16_f32 v109, v50, v51
  v_mul_f32 v52, v252, v52
  v_mul_f32 v53, v252, v53
  v_mul_f32 v54, v252, v54
  v_mul_f32 v55, v252, v55
  v_cvt_pk_bf16_f32 v124, v52, v53
  v_cvt_pk_bf16_f32 v125, v54, v55
  v_mfma_f32_16x16x32_bf16 v[0:3], v[156:159], a[200:203], v[0:3]
  s_waitcnt lgkmcnt(4)
  buffer_load_dwordx4 v227, s[24:27], s42 offen offset:1024 lds
  ds_read_b64_tr_b16 v[172:173], v212 offset:60928
  ds_read_b64_tr_b16 v[174:175], v212 offset:61184
  v_mfma_f32_16x16x32_bf16 v[0:3], v[160:163], a[204:207], v[0:3]
  s_nop 0
  ds_read_b64_tr_b16 v[176:177], v212 offset:61440
  ds_read_b64_tr_b16 v[178:179], v212 offset:61696
  v_mfma_f32_16x16x32_bf16 v[4:7], v[156:159], a[216:219], v[4:7]
  v_mul_f32 v56, v251, v56
  v_mul_f32 v57, v251, v57
  v_mul_f32 v58, v251, v58
  v_mul_f32 v59, v251, v59
  v_cvt_pk_bf16_f32 v110, v56, v57
  v_cvt_pk_bf16_f32 v111, v58, v59
  v_mul_f32 v60, v252, v60
  v_mul_f32 v61, v252, v61
  v_mul_f32 v62, v252, v62
  v_mul_f32 v63, v252, v63
  v_cvt_pk_bf16_f32 v126, v60, v61
  v_cvt_pk_bf16_f32 v127, v62, v63
  v_mfma_f32_16x16x32_bf16 v[4:7], v[160:163], a[220:223], v[4:7]
  s_waitcnt lgkmcnt(6)
  ds_read_b32 v188, v254 offset:1024
  ds_read_b32 v189, v254 offset:1280
  v_mfma_f32_16x16x32_bf16 v[0:3], v[164:167], v[96:99], v[0:3]
  s_waitcnt lgkmcnt(6)
  ds_read_b64_tr_b16 a[224:225], v213 offset:34816
  ds_read_b64_tr_b16 a[226:227], v213 offset:35072
  v_mfma_f32_16x16x32_bf16 v[0:3], v[168:171], v[100:103], v[0:3]
  s_add_u32 m0, m0, 32
  ds_read_b64_tr_b16 a[228:229], v213 offset:35328
  ds_read_b64_tr_b16 a[230:231], v213 offset:35584
  v_mfma_f32_16x16x32_bf16 v[4:7], v[164:167], v[112:115], v[4:7]
  s_nop 0
  buffer_load_dwordx4 v227, s[24:27], s42 offen offset:2048 lds
  ds_read_b32 v190, v254 offset:1536
  v_mfma_f32_16x16x32_bf16 v[4:7], v[168:171], v[116:119], v[4:7]
  s_waitcnt lgkmcnt(9)
  ds_read_b32 v191, v254 offset:1792
  ds_read_b64_tr_b16 a[232:233], v213 offset:43520
  v_mfma_f32_16x16x32_bf16 v[0:3], v[172:175], v[104:107], v[0:3]
  s_waitcnt lgkmcnt(9)
  ds_read_b64_tr_b16 a[234:235], v213 offset:43776
  ds_read_b64_tr_b16 a[236:237], v213 offset:44032
  v_mfma_f32_16x16x32_bf16 v[0:3], v[176:179], v[108:111], v[0:3]
  s_nop 0
  ds_read_b64_tr_b16 a[238:239], v213 offset:44288
  ds_read_b64_tr_b16 a[240:241], v213 offset:52224
  v_mfma_f32_16x16x32_bf16 v[4:7], v[172:175], v[120:123], v[4:7]
  s_add_u32 m0, m0, 32
  ds_read_b64_tr_b16 a[242:243], v213 offset:52480
  ds_read_b64_tr_b16 a[244:245], v213 offset:52736
  v_mfma_f32_16x16x32_bf16 v[4:7], v[176:179], v[124:127], v[4:7]
  s_waitcnt lgkmcnt(11)
  buffer_load_dwordx4 v227, s[24:27], s42 offen offset:3072 lds
  ds_read_b64_tr_b16 a[246:247], v213 offset:52992
  v_mfma_f32_16x16x32_bf16 v[8:11], a[224:227], a[192:195], v[8:11]
  s_waitcnt lgkmcnt(10)
  ds_read_b64_tr_b16 a[248:249], v213 offset:60928
  ds_read_b64_tr_b16 a[250:251], v213 offset:61184
  v_mfma_f32_16x16x32_bf16 v[8:11], a[228:231], a[196:199], v[8:11]
  s_nop 0
  ds_read_b64_tr_b16 a[252:253], v213 offset:61440
  ds_read_b64_tr_b16 a[254:255], v213 offset:61696
  v_mfma_f32_16x16x32_bf16 v[12:15], a[224:227], a[208:211], v[12:15]
  s_waitcnt lgkmcnt(12)
  v_add_f32 v188, v188, v189
  v_add_f32 v190, v190, v191
  v_mfma_f32_16x16x32_bf16 v[12:15], a[228:231], a[212:215], v[12:15]
  s_waitcnt lgkmcnt(10)
  v_add_f32 v188, v188, v208
  v_add_f32 v188, v188, v190
  v_mfma_f32_16x16x32_bf16 v[8:11], a[232:235], a[200:203], v[8:11]
  s_waitcnt lgkmcnt(8)
  v_cmp_lt_f32 vcc, s55, v188
  v_cmp_gt_f32 s[66:67], s56, v188
  v_mfma_f32_16x16x32_bf16 v[8:11], a[236:239], a[204:207], v[8:11]
  s_add_u32 s42, s42, s52
  s_add_u32 m0, m0, s53
  ds_read_b128 a[48:51], v221 offset:12288
  v_mfma_f32_16x16x32_bf16 v[12:15], a[232:235], a[216:219], v[12:15]
  s_nop 0
  buffer_load_dwordx4 v227, s[24:27], s42 offen lds
  ds_read_b128 a[52:55], v221 offset:13312
  v_mfma_f32_16x16x32_bf16 v[12:15], a[236:239], a[220:223], v[12:15]
  s_waitcnt lgkmcnt(4)
  ds_read_b128 a[56:59], v221 offset:14336
  ds_read_b128 a[60:63], v221 offset:15360
  v_mfma_f32_16x16x32_bf16 v[8:11], a[240:243], v[96:99], v[8:11]
  s_nop 0
  ds_read_b64_tr_b16 v[148:149], v214 offset:34816
  ds_read_b64_tr_b16 v[150:151], v214 offset:35072
  v_mfma_f32_16x16x32_bf16 v[8:11], a[244:247], v[100:103], v[8:11]
  s_nop 0
  ds_read_b64_tr_b16 v[152:153], v214 offset:35328
  ds_read_b64_tr_b16 v[154:155], v214 offset:35584
  v_mfma_f32_16x16x32_bf16 v[12:15], a[240:243], v[112:115], v[12:15]
  s_and_b64 vcc, vcc, s[66:67]
  s_cmp_eq_u64 vcc, exec
  s_cbranch_scc1 L_ok3
  s_cmp_eq_u32 s44, 0
  s_cbranch_scc1 L_retry
L_ok3:
  s_mov_b32 s44, 0
  s_add_u32 m0, m0, 32
  v_mfma_f32_16x16x32_bf16 v[12:15], a[244:247], v[116:119], v[12:15]
  s_nop 0
  buffer_load_dwordx4 v227, s[24:27], s42 offen offset:1024 lds
  ds_read_b64_tr_b16 v[156:157], v214 offset:43520
  v_mfma_f32_16x16x32_bf16 v[8:11], a[248:251], v[104:107], v[8:11]
  s_waitcnt lgkmcnt(9)
  ds_read_b64_tr_b16 v[158:159], v214 offset:43776
  ds_read_b64_tr_b16 v[160:161], v214 offset:44032
  v_mfma_f32_16x16x32_bf16 v[8:11], a[252:255], v[108:111], v[8:11]
  s_nop 0
  ds_read_b64_tr_b16 v[162:163], v214 offset:44288
  ds_read_b64_tr_b16 v[164:165], v214 offset:52224
  v_mfma_f32_16x16x32_bf16 v[12:15], a[248:251], v[120:123], v[12:15]
  s_nop 0
  ds_read_b64_tr_b16 v[166:167], v214 offset:52480
  ds_read_b64_tr_b16 v[168:169], v214 offset:52736
  v_mfma_f32_16x16x32_bf16 v[12:15], a[252:255], v[124:127], v[12:15]
  s_waitcnt lgkmcnt(9)
  s_add_u32 m0, m0, 32
  ds_read_b64_tr_b16 v[170:171], v214 offset:52992
  v_mfma_f32_16x16x32_bf16 v[16:19], v[148:151], a[192:195], v[16:19]
  s_waitcnt lgkmcnt(8)
  buffer_load_dwordx4 v227, s[24:27], s42 offen offset:2048 lds
  ds_read_b64_tr_b16 v[172:173], v214 offset:60928
  v_mfma_f32_16x16x32_bf16 v[16:19], v[152:155], a[196:199], v[16:19]
  s_nop 0
  ds_read_b64_tr_b16 v[174:175], v214 offset:61184
  ds_read_b64_tr_b16 v[176:177], v214 offset:61440
  v_mfma_f32_16x16x32_bf16 v[20:23], v[148:151], a[208:211], v[20:23]
  s_nop 0
  ds_read_b64_tr_b16 v[178:179], v214 offset:61696
  ds_read_b64_tr_b16 a[224:225], v215 offset:34816
  v_mfma_f32_16x16x32_bf16 v[20:23], v[152:155], a[212:215], v[20:23]
  s_waitcnt lgkmcnt(11)
  ds_read_b64_tr_b16 a[226:227], v215 offset:35072
  ds_read_b64_tr_b16 a[228:229], v215 offset:35328
  v_mfma_f32_16x16x32_bf16 v[16:19], v[156:159], a[200:203], v[16:19]
  s_waitcnt lgkmcnt(11)
  s_add_u32 m0, m0, 32
  ds_read_b64_tr_b16 a[230:231], v215 offset:35584
  v_mfma_f32_16x16x32_bf16 v[16:19], v[160:163], a[204:207], v[16:19]
  s_nop 0
  buffer_load_dwordx4 v227, s[24:27], s42 offen offset:3072 lds
  ds_read_b64_tr_b16 a[232:233], v215 offset:43520
  v_mfma_f32_16x16x32_bf16 v[20:23], v[156:159], a[216:219], v[20:23]
  s_nop 0
  ds_read_b64_tr_b16 a[234:235], v215 offset:43776
  ds_read_b64_tr_b16 a[236:237], v215 offset:44032
  v_mfma_f32_16x16x32_bf16 v[20:23], v[160:163], a[220:223], v[20:23]
  s_waitcnt lgkmcnt(11)
  ds_read_b64_tr_b16 a[238:239], v215 offset:44288
  v_mfma_f32_16x16x32_bf16 v[16:19], v[164:167], v[96:99], v[16:19]
  s_waitcnt vmcnt(16)
  v_cmp_eq_u32 vcc, 0, v229
  s_nop 0
  s_cbranch_vccnz L_spin_r
L_spin_r_back:
  v_mfma_f32_16x16x32_bf16 v[16:19], v[168:171], v[100:103], v[16:19]
  v_cvt_pk_bf16_f32 v64, v0, v1
  v_cvt_pk_bf16_f32 v65, v2, v3
  v_mfma_f32_16x16x32_bf16 v[20:23], v[164:167], v[112:115], v[20:23]
  v_cvt_pk_bf16_f32 v66, v8, v9
  v_cvt_pk_bf16_f32 v67, v10, v11
  v_mfma_f32_16x16x32_bf16 v[20:23], v[168:171], v[116:119], v[20:23]
  s_waitcnt lgkmcnt(4)
  buffer_store_dwordx4 v[64:67], v225, s[28:31], s80 offen offset:0 sc1
  v_cvt_pk_bf16_f32 v72, v4, v5
  v_mfma_f32_16x16x32_bf16 v[16:19], v[172:175], v[104:107], v[16:19]
  v_cvt_pk_bf16_f32 v73, v6, v7
  v_cvt_pk_bf16_f32 v74, v12, v13
  v_mfma_f32_16x16x32_bf16 v[16:19], v[176:179], v[108:111], v[16:19]
  ds_read_b64_tr_b16 a[240:241], v215 offset:52224
  v_cvt_pk_bf16_f32 v75, v14, v15
  v_mfma_f32_16x16x32_bf16 v[20:23], v[172:175], v[120:123], v[20:23]
  s_nop 0
  buffer_store_dwordx4 v[72:75], v225, s[28:31], s80 offen offset:2048 sc1
  ds_read_b64_tr_b16 a[242:243], v215 offset:52480
  v_mfma_f32_16x16x32_bf16 v[20:23], v[176:179], v[124:127], v[20:23]
  s_nop 0
  ds_read_b64_tr_b16 a[244:245], v215 offset:52736
  ds_read_b64_tr_b16 a[246:247], v215 offset:52992
  v_mfma_f32_16x16x32_bf16 v[24:27], a[224:227], a[192:195], v[24:27]
  ds_read_b64_tr_b16 a[248:249], v215 offset:60928
  v_lshrrev_b32 v140, 4, v225
  v_mfma_f32_16x16x32_bf16 v[24:27], a[228:231], a[196:199], v[24:27]
  ds_read_b64_tr_b16 a[250:251], v215 offset:61184
  v_bfe_u32 v141, v140, 2, 2
  v_mfma_f32_16x16x32_bf16 v[28:31], a[224:227], a[208:211], v[28:31]
  s_nop 0
  ds_read_b64_tr_b16 a[252:253], v215 offset:61440
  ds_read_b64_tr_b16 a[254:255], v215 offset:61696
  v_mfma_f32_16x16x32_bf16 v[28:31], a[228:231], a[212:215], v[28:31]
  s_waitcnt lgkmcnt(8)
  v_cvt_pk_bf16_f32 v68, v16, v17
  v_cvt_pk_bf16_f32 v69, v18, v19
  v_mfma_f32_16x16x32_bf16 v[128:131], a[224:227], a[32:35], v[128:131]
  s_waitcnt vmcnt(10)
  s_barrier
  ds_read_b64_tr_b16 v[148:149], v216 offset:34816
  v_mfma_f32_16x16x32_bf16 v[128:131], a[228:231], a[36:39], v[128:131]
  s_add_u32 s42, s74, 0
  ds_read_b64_tr_b16 v[150:151], v216 offset:35072
  v_mfma_f32_16x16x32_bf16 v[24:27], a[232:235], a[200:203], v[24:27]
  s_mov_b32 m0, s37
  ds_read_b64_tr_b16 v[152:153], v216 offset:35328
  v_mfma_f32_16x16x32_bf16 v[24:27], a[236:239], a[204:207], v[24:27]
  ds_read_b64_tr_b16 v[154:155], v216 offset:35584
  v_lshrrev_b32 v144, 4, v140
  v_mfma_f32_16x16x32_bf16 v[28:31], a[232:235], a[216:219], v[28:31]
  ds_read_b64_tr_b16 v[156:157], v216 offset:43520
  v_and_b32 v145, 1, v140
  v_mfma_f32_16x16x32_bf16 v[28:31], a[236:239], a[220:223], v[28:31]
  ds_read_b64_tr_b16 v[158:159], v216 offset:43776
  v_lshlrev_b32 v145, 4, v145
  v_mfma_f32_16x16x32_bf16 v[128:131], a[232:235], a[40:43], v[128:131]
  ds_read_b64_tr_b16 v[160:161], v216 offset:44032
  v_mov_b32 v142, 0x3f80
  v_mfma_f32_16x16x32_bf16 v[128:131], a[236:239], a[44:47], v[128:131]
  s_waitcnt lgkmcnt(11)
  ds_read_b64_tr_b16 v[162:163], v216 offset:44288
  v_lshlrev_b32 v145, v145, v142
  v_mfma_f32_16x16x32_bf16 v[24:27], a[240:243], v[96:99], v[24:27]
  buffer_load_dwordx4 v227, s[24:27], s42 offen lds
  v_cmp_eq_u32 vcc, v141, v144
  v_mfma_f32_16x16x32_bf16 v[24:27], a[244:247], v[100:103], v[24:27]
  ds_read_b64_tr_b16 v[164:165], v216 offset:52224
  v_and_b32 v140, 2, v140
  v_mfma_f32_16x16x32_bf16 v[28:31], a[240:243], v[112:115], v[28:31]
  ds_read_b64_tr_b16 v[166:167], v216 offset:52480
  v_mov_b32 v141, 0
  v_mfma_f32_16x16x32_bf16 v[28:31], a[244:247], v[116:119], v[28:31]
  ds_read_b64_tr_b16 v[168:169], v216 offset:52736
  v_cndmask_b32 v145, 0, v145, vcc
  v_mfma_f32_16x16x32_bf16 v[128:131], a[240:243], a[48:51], v[128:131]
  s_add_u32 m0, m0, 32
  ds_read_b64_tr_b16 v[170:171], v216 offset:52992
  v_cmp_eq_u32 vcc, 0, v140
  v_mfma_f32_16x16x32_bf16 v[128:131], a[244:247], a[52:55], v[128:131]
  s_waitcnt lgkmcnt(12)
  buffer_load_dwordx4 v227, s[24:27], s42 offen offset:1024 lds
  v_mov_b32 v140, 0
  v_mfma_f32_16x16x32_bf16 v[24:27], a[248:251], v[104:107], v[24:27]
  ds_read_b64_tr_b16 v[172:173], v216 offset:60928
  v_mov_b32 v144, 0
  v_mfma_f32_16x16x32_bf16 v[24:27], a[252:255], v[108:111], v[24:27]
  ds_read_b64_tr_b16 v[174:175], v216 offset:61184
  v_cndmask_b32 v142, 0, v145, vcc
  v_mfma_f32_16x16x32_bf16 v[28:31], a[248:251], v[120:123], v[28:31]
  s_nop 0
  ds_read_b64_tr_b16 v[176:177], v216 offset:61440
  ds_read_b64_tr_b16 v[178:179], v216 offset:61696
  v_mfma_f32_16x16x32_bf16 v[28:31], a[252:255], v[124:127], v[28:31]
  s_add_u32 m0, m0, 32
  ds_read_b64_tr_b16 a[224:225], v217 offset:34816
  v_cndmask_b32 v143, v145, v144, vcc
  v_mfma_f32_16x16x32_bf16 v[128:131], a[248:251], a[56:59], v[128:131]
  ds_read_b64_tr_b16 a[226:227], v217 offset:35072
  v_mov_b32 v145, 0
  v_mfma_f32_16x16x32_bf16 v[128:131], a[252:255], a[60:63], v[128:131]
  s_waitcnt lgkmcnt(10)
  ds_read_b64_tr_b16 a[228:229], v217 offset:35328
  v_accvgpr_write_b32 a82, 0
  v_mfma_f32_16x16x32_bf16 v[32:35], v[148:151], a[128:131], 0
  s_nop 0
  ds_read_b64_tr_b16 a[230:231], v217 offset:35584
  buffer_load_dwordx4 v227, s[24:27], s42 offen offset:2048 lds
  v_mfma_f32_16x16x32_bf16 v[32:35], v[152:155], a[132:135], v[32:35]
  ds_read_b64_tr_b16 a[232:233], v217 offset:43520
  v_accvgpr_write_b32 a83, 0
  v_mfma_f32_16x16x32_bf16 v[36:39], v[148:151], a[144:147], 0
  ds_read_b64_tr_b16 a[234:235], v217 offset:43776
  v_accvgpr_write_b32 a102, 0
  v_mfma_f32_16x16x32_bf16 v[36:39], v[152:155], a[148:151], v[36:39]
  v_cvt_pk_bf16_f32 v70, v24, v25
  v_cvt_pk_bf16_f32 v71, v26, v27
  v_mfma_f32_16x16x32_bf16 v[32:35], v[156:159], a[136:139], v[32:35]
  s_nop 0
  ds_read_b64_tr_b16 a[236:237], v217 offset:44032
  ds_read_b64_tr_b16 a[238:239], v217 offset:44288
  v_mfma_f32_16x16x32_bf16 v[32:35], v[160:163], a[140:143], v[32:35]
  s_add_u32 m0, m0, 32
  buffer_store_dwordx4 v[68:71], v225, s[28:31], s80 offen offset:1024 sc1
  v_cvt_pk_bf16_f32 v76, v20, v21
  v_mfma_f32_16x16x32_bf16 v[36:39], v[156:159], a[152:155], v[36:39]
  v_cvt_pk_bf16_f32 v77, v22, v23
  v_cvt_pk_bf16_f32 v78, v28, v29
  v_mfma_f32_16x16x32_bf16 v[36:39], v[160:163], a[156:159], v[36:39]
  s_waitcnt lgkmcnt(8)
  buffer_load_dwordx4 v227, s[24:27], s42 offen offset:3072 lds
  v_cvt_pk_bf16_f32 v79, v30, v31
  v_mfma_f32_16x16x32_bf16 v[32:35], v[164:167], a[160:163], v[32:35]
  buffer_store_dwordx4 v[76:79], v225, s[28:31], s80 offen offset:3072 sc1
  v_cvt_pk_bf16_f32 v232, v128, v129
  v_mfma_f32_16x16x32_bf16 v[32:35], v[168:171], a[164:167], v[32:35]
  v_cvt_pk_bf16_f32 v233, v130, v131
  s_add_u32 s92, s80, s64
  ds_read_b64_tr_b16 a[240:241], v217 offset:52224
  v_mfma_f32_16x16x32_bf16 v[36:39], v[164:167], a[176:179], v[36:39]
  s_nop 0
  buffer_store_dwordx2 v[232:233], v222, s[28:31], s92 offen sc1
  ds_read_b64_tr_b16 a[242:243], v217 offset:52480
  v_mfma_f32_16x16x32_bf16 v[36:39], v[168:171], a[180:183], v[36:39]
  s_nop 0
  ds_read_b64_tr_b16 a[244:245], v217 offset:52736
  ds_read_b64_tr_b16 a[246:247], v217 offset:52992
  v_mfma_f32_16x16x32_bf16 v[32:35], v[172:175], a[168:171], v[32:35]
  v_accvgpr_write_b32 a103, 0
  v_accvgpr_write_b32 a122, 0
  v_mfma_f32_16x16x32_bf16 v[32:35], v[176:179], a[172:175], v[32:35]
  s_add_u32 s42, s42, s52
  v_accvgpr_write_b32 a123, 0
  v_mov_b32 v228, 1
  v_mfma_f32_16x16x32_bf16 v[36:39], v[172:175], a[184:187], v[36:39]
  s_add_u32 m0, m0, s53
  ds_read_b64_tr_b16 a[248:249], v217 offset:60928
  ds_read_b64_tr_b16 a[250:251], v217 offset:61184
  v_mfma_f32_16x16x32_bf16 v[36:39], v[176:179], a[188:191], v[36:39]
  s_waitcnt lgkmcnt(6)
  ds_read_b64_tr_b16 a[252:253], v217 offset:61440
  ds_read_b64_tr_b16 a[254:255], v217 offset:61696
  v_mfma_f32_16x16x32_bf16 v[40:43], a[224:227], a[128:131], 0
  s_nop 0
  buffer_load_dwordx4 v227, s[24:27], s42 offen lds
  ds_read_b64_tr_b16 v[148:149], v218 offset:34816
  v_mfma_f32_16x16x32_bf16 v[40:43], a[228:231], a[132:135], v[40:43]
  s_nop 0
  ds_read_b64_tr_b16 v[150:151], v218 offset:35072
  ds_read_b64_tr_b16 v[152:153], v218 offset:35328
  v_mfma_f32_16x16x32_bf16 v[44:47], a[224:227], a[144:147], 0
  ds_read_b64_tr_b16 v[154:155], v218 offset:35584
  v_mfma_f32_16x16x32_bf16 v[44:47], a[228:231], a[148:151], v[44:47]
  s_nop 0
  ds_read_b64_tr_b16 v[156:157], v218 offset:43520
  ds_read_b64_tr_b16 v[158:159], v218 offset:43776
  v_mfma_f32_16x16x32_bf16 v[40:43], a[232:235], a[136:139], v[40:43]
  s_add_u32 m0, m0, 32
  ds_read_b64_tr_b16 v[160:161], v218 offset:44032
  v_mfma_f32_16x16x32_bf16 v[40:43], a[236:239], a[140:143], v[40:43]
  s_nop 0
  buffer_load_dwordx4 v227, s[24:27], s42 offen offset:1024 lds
  ds_read_b64_tr_b16 v[162:163], v218 offset:44288
  v_mfma_f32_16x16x32_bf16 v[44:47], a[232:235], a[152:155], v[44:47]
  ds_read_b64_tr_b16 v[164:165], v218 offset:52224
  v_mfma_f32_16x16x32_bf16 v[44:47], a[236:239], a[156:159], v[44:47]
  s_waitcnt lgkmcnt(9)
  ds_read_b64_tr_b16 v[166:167], v218 offset:52480
  v_mfma_f32_16x16x32_bf16 v[40:43], a[240:243], a[160:163], v[40:43]
  s_nop 0
  ds_read_b64_tr_b16 v[168:169], v218 offset:52736
  ds_read_b64_tr_b16 v[170:171], v218 offset:52992
  v_mfma_f32_16x16x32_bf16 v[40:43], a[244:247], a[164:167], v[40:43]
  s_add_u32 m0, m0, 32
  s_add_u32 s43, s59, 1
  ds_read_b64_tr_b16 v[172:173], v218 offset:60928
  v_mfma_f32_16x16x32_bf16 v[44:47], a[240:243], a[176:179], v[44:47]
  s_and_b32 s43, s43, 7
  s_lshl_b32 s43, s43, 9
  buffer_load_dwordx4 v227, s[24:27], s42 offen offset:2048 lds
  v_mfma_f32_16x16x32_bf16 v[44:47], a[244:247], a[180:183], v[44:47]
  s_add_u32 s43, s43, s61
  ds_read_b64_tr_b16 v[174:175], v218 offset:61184
  v_mfma_f32_16x16x32_bf16 v[40:43], a[248:251], a[168:171], v[40:43]
  s_nop 0
  ds_read_b64_tr_b16 v[176:177], v218 offset:61440
  ds_read_b64_tr_b16 v[178:179], v218 offset:61696
  v_mfma_f32_16x16x32_bf16 v[40:43], a[252:255], a[172:175], v[40:43]
  ds_read_b64_tr_b16 a[224:225], v219 offset:34816
  v_mfma_f32_16x16x32_bf16 v[44:47], a[248:251], a[184:187], v[44:47]
  s_add_u32 m0, m0, 32
  ds_read_b64_tr_b16 a[226:227], v219 offset:35072
  v_mfma_f32_16x16x32_bf16 v[44:47], a[252:255], a[188:191], v[44:47]
  s_waitcnt lgkmcnt(10)
  buffer_load_dwordx4 v227, s[24:27], s42 offen offset:3072 lds
  v_mfma_f32_16x16x32_bf16 v[48:51], v[148:151], a[128:131], 0
  s_nop 0
  ds_read_b64_tr_b16 a[228:229], v219 offset:35328
  ds_read_b64_tr_b16 a[230:231], v219 offset:35584
  v_mfma_f32_16x16x32_bf16 v[48:51], v[152:155], a[132:135], v[48:51]
  ds_read_b64_tr_b16 a[232:233], v219 offset:43520
  v_mfma_f32_16x16x32_bf16 v[52:55], v[148:151], a[144:147], 0
  ds_read_b64_tr_b16 a[234:235], v219 offset:43776
  v_mfma_f32_16x16x32_bf16 v[52:55], v[152:155], a[148:151], v[52:55]
  ds_read_b64_tr_b16 a[236:237], v219 offset:44032
  v_mfma_f32_16x16x32_bf16 v[48:51], v[156:159], a[136:139], v[48:51]
  ds_read_b64_tr_b16 a[238:239], v219 offset:44288
  v_mfma_f32_16x16x32_bf16 v[48:51], v[160:163], a[140:143], v[48:51]
  ds_read_b64_tr_b16 a[240:241], v219 offset:52224
  v_mfma_f32_16x16x32_bf16 v[52:55], v[156:159], a[152:155], v[52:55]
  ds_read_b64_tr_b16 a[242:243], v219 offset:52480
  v_mfma_f32_16x16x32_bf16 v[52:55], v[160:163], a[156:159], v[52:55]
  s_waitcnt lgkmcnt(10)
  ds_read_b64_tr_b16 a[244:245], v219 offset:52736
  v_mfma_f32_16x16x32_bf16 v[48:51], v[164:167], a[160:163], v[48:51]
  ds_read_b64_tr_b16 a[246:247], v219 offset:52992
  v_mfma_f32_16x16x32_bf16 v[48:51], v[168:171], a[164:167], v[48:51]
  ds_read_b64_tr_b16 a[248:249], v219 offset:60928
  v_mfma_f32_16x16x32_bf16 v[52:55], v[164:167], a[176:179], v[52:55]
  ds_read_b64_tr_b16 a[250:251], v219 offset:61184
  v_mfma_f32_16x16x32_bf16 v[52:55], v[168:171], a[180:183], v[52:55]
  ds_read_b64_tr_b16 a[252:253], v219 offset:61440
  v_mfma_f32_16x16x32_bf16 v[48:51], v[172:175], a[168:171], v[48:51]
  ds_read_b64_tr_b16 a[254:255], v219 offset:61696
  s_waitcnt vmcnt(13)
  s_barrier
  v_mfma_f32_16x16x32_bf16 v[48:51], v[176:179], a[172:175], v[48:51]
  s_add_u32 s42, s74, 262144
  s_mov_b32 m0, s39
  ds_read_b64_tr_b16 v[148:149], v216 offset:0
  v_mfma_f32_16x16x32_bf16 v[52:55], v[172:175], a[184:187], v[52:55]
  ds_read_b64_tr_b16 v[150:151], v216 offset:256
  v_mfma_f32_16x16x32_bf16 v[52:55], v[176:179], a[188:191], v[52:55]
  s_waitcnt lgkmcnt(14)
  ds_read_b64_tr_b16 v[152:153], v216 offset:512
  v_mfma_f32_16x16x32_bf16 v[56:59], a[224:227], a[128:131], 0
  ds_read_b64_tr_b16 v[154:155], v216 offset:768
  v_mfma_f32_16x16x32_bf16 v[56:59], a[228:231], a[132:135], v[56:59]
  ds_read_b64_tr_b16 v[156:157], v216 offset:8704
  v_mfma_f32_16x16x32_bf16 v[60:63], a[224:227], a[144:147], 0
  ds_read_b64_tr_b16 v[158:159], v216 offset:8960
  v_mfma_f32_16x16x32_bf16 v[60:63], a[228:231], a[148:151], v[60:63]
  ds_read_b64_tr_b16 v[160:161], v216 offset:9216
  v_mfma_f32_16x16x32_bf16 v[132:135], a[224:227], a[0:3], 0
  ds_read_b64_tr_b16 v[162:163], v216 offset:9472
  v_mfma_f32_16x16x32_bf16 v[132:135], a[228:231], a[4:7], v[132:135]
  s_waitcnt lgkmcnt(15)
  buffer_load_dwordx4 v227, s[24:27], s42 offen lds
  v_mfma_f32_16x16x32_bf16 v[56:59], a[232:235], a[136:139], v[56:59]
  ds_read_b64_tr_b16 v[164:165], v216 offset:17408
  v_mfma_f32_16x16x32_bf16 v[56:59], a[236:239], a[140:143], v[56:59]
  ds_read_b64_tr_b16 v[166:167], v216 offset:17664
  v_mfma_f32_16x16x32_bf16 v[60:63], a[232:235], a[152:155], v[60:63]
  ds_read_b64_tr_b16 v[168:169], v216 offset:17920
  v_mfma_f32_16x16x32_bf16 v[60:63], a[236:239], a[156:159], v[60:63]
  s_add_u32 m0, m0, 32
  ds_read_b64_tr_b16 v[170:171], v216 offset:18176
  v_mfma_f32_16x16x32_bf16 v[132:135], a[232:235], a[8:11], v[132:135]
  buffer_load_dwordx4 v227, s[24:27], s42 offen offset:1024 lds
  v_mfma_f32_16x16x32_bf16 v[132:135], a[236:239], a[12:15], v[132:135]
  s_waitcnt lgkmcnt(15)
  ds_read_b64_tr_b16 v[172:173], v216 offset:26112
  v_mfma_f32_16x16x32_bf16 v[56:59], a[240:243], a[160:163], v[56:59]
  ds_read_b64_tr_b16 v[174:175], v216 offset:26368
  v_mfma_f32_16x16x32_bf16 v[56:59], a[244:247], a[164:167], v[56:59]
  ds_read_b64_tr_b16 v[176:177], v216 offset:26624
  v_mfma_f32_16x16x32_bf16 v[60:63], a[240:243], a[176:179], v[60:63]
  s_add_u32 m0, m0, 32
  ds_read_b64_tr_b16 v[178:179], v216 offset:26880
  v_mfma_f32_16x16x32_bf16 v[60:63], a[244:247], a[180:183], v[60:63]
  ds_read_b64_tr_b16 a[224:225], v217 offset:0
  v_mfma_f32_16x16x32_bf16 v[132:135], a[240:243], a[16:19], v[132:135]
  ds_read_b64_tr_b16 a[226:227], v217 offset:256
  v_mfma_f32_16x16x32_bf16 v[132:135], a[244:247], a[20:23], v[132:135]
  s_waitcnt lgkmcnt(15)
  ds_read_b64_tr_b16 a[228:229], v217 offset:512
  v_mfma_f32_16x16x32_bf16 v[56:59], a[248:251], a[168:171], v[56:59]
  ds_read_b64_tr_b16 a[230:231], v217 offset:768
  v_mfma_f32_16x16x32_bf16 v[56:59], a[252:255], a[172:175], v[56:59]
  buffer_load_dwordx4 v227, s[24:27], s42 offen offset:2048 lds
  v_mfma_f32_16x16x32_bf16 v[60:63], a[248:251], a[184:187], v[60:63]
  ds_read_b64_tr_b16 a[232:233], v217 offset:8704
  v_mfma_f32_16x16x32_bf16 v[60:63], a[252:255], a[188:191], v[60:63]
  ds_read_b64_tr_b16 a[234:235], v217 offset:8960
  v_mfma_f32_16x16x32_bf16 v[132:135], a[248:251], a[24:27], v[132:135]
  ds_read_b64_tr_b16 a[236:237], v217 offset:9216
  v_mfma_f32_16x16x32_bf16 v[132:135], a[252:255], a[28:31], v[132:135]
  s_waitcnt lgkmcnt(15)
  s_add_u32 m0, m0, 32
  ds_read_b64_tr_b16 a[238:239], v217 offset:9472
  v_mfma_f32_16x16x32_bf16 v[32:35], v[148:151], a[192:195], v[32:35]
  buffer_load_dwordx4 v227, s[24:27], s42 offen offset:3072 lds
  v_mfma_f32_16x16x32_bf16 v[32:35], v[152:155], a[196:199], v[32:35]
  ds_read_b64_tr_b16 a[240:241], v217 offset:17408
  v_mfma_f32_16x16x32_bf16 v[36:39], v[148:151], a[208:211], v[36:39]
  ds_read_b64_tr_b16 a[242:243], v217 offset:17664
  v_mfma_f32_16x16x32_bf16 v[36:39], v[152:155], a[212:215], v[36:39]
  ds_read_b64_tr_b16 a[244:245], v217 offset:17920
  v_mfma_f32_16x16x32_bf16 v[32:35], v[156:159], a[200:203], v[32:35]
  s_add_u32 s42, s42, s52
  ds_read_b64_tr_b16 a[246:247], v217 offset:18176
  v_mfma_f32_16x16x32_bf16 v[32:35], v[160:163], a[204:207], v[32:35]
  s_add_u32 m0, m0, s53
  ds_read_b64_tr_b16 a[248:249], v217 offset:26112
  v_mfma_f32_16x16x32_bf16 v[36:39], v[156:159], a[216:219], v[36:39]
  ds_read_b64_tr_b16 a[250:251], v217 offset:26368
  v_mfma_f32_16x16x32_bf16 v[36:39], v[160:163], a[220:223], v[36:39]
  s_waitcnt lgkmcnt(14)
  ds_read_b64_tr_b16 a[252:253], v217 offset:26624
  v_mfma_f32_16x16x32_bf16 v[32:35], v[164:167], v[96:99], v[32:35]
  ds_read_b64_tr_b16 a[254:255], v217 offset:26880
  v_mfma_f32_16x16x32_bf16 v[32:35], v[168:171], v[100:103], v[32:35]
  buffer_load_dwordx4 v227, s[24:27], s42 offen lds
  v_mfma_f32_16x16x32_bf16 v[36:39], v[164:167], v[112:115], v[36:39]
  ds_read_b64_tr_b16 v[148:149], v218 offset:0
  v_mfma_f32_16x16x32_bf16 v[36:39], v[168:171], v[116:119], v[36:39]
  ds_read_b64_tr_b16 v[150:151], v218 offset:256
  v_mfma_f32_16x16x32_bf16 v[32:35], v[172:175], v[104:107], v[32:35]
  ds_read_b64_tr_b16 v[152:153], v218 offset:512
  v_mfma_f32_16x16x32_bf16 v[32:35], v[176:179], v[108:111], v[32:35]
  s_add_u32 m0, m0, 32
  ds_read_b64_tr_b16 v[154:155], v218 offset:768
  v_mfma_f32_16x16x32_bf16 v[36:39], v[172:175], v[120:123], v[36:39]
  buffer_load_dwordx4 v227, s[24:27], s42 offen offset:1024 lds
  v_mfma_f32_16x16x32_bf16 v[36:39], v[176:179], v[124:127], v[36:39]
  s_waitcnt lgkmcnt(12)
  ds_read_b64_tr_b16 v[156:157], v218 offset:8704
  v_mfma_f32_16x16x32_bf16 v[40:43], a[224:227], a[192:195], v[40:43]
  ds_read_b64_tr_b16 v[158:159], v218 offset:8960
  v_mfma_f32_16x16x32_bf16 v[40:43], a[228:231], a[196:199], v[40:43]
  ds_read_b64_tr_b16 v[160:161], v218 offset:9216
  v_mfma_f32_16x16x32_bf16 v[44:47], a[224:227], a[208:211], v[44:47]
  s_add_u32 m0, m0, 32
  ds_read_b64_tr_b16 v[162:163], v218 offset:9472
  v_mfma_f32_16x16x32_bf16 v[44:47], a[228:231], a[212:215], v[44:47]
  v_cvt_pk_bf16_f32 v80, v32, v33
  v_cvt_pk_bf16_f32 v81, v34, v35
  v_mfma_f32_16x16x32_bf16 v[40:43], a[232:235], a[200:203], v[40:43]
  ds_read_b64_tr_b16 v[164:165], v218 offset:17408
  v_mfma_f32_16x16x32_bf16 v[40:43], a[236:239], a[204:207], v[40:43]
  ds_read_b64_tr_b16 v[166:167], v218 offset:17664
  v_mfma_f32_16x16x32_bf16 v[44:47], a[232:235], a[216:219], v[44:47]
  ds_read_b64_tr_b16 v[168:169], v218 offset:17920
  v_mfma_f32_16x16x32_bf16 v[44:47], a[236:239], a[220:223], v[44:47]
  s_waitcnt lgkmcnt(11)
  s_waitcnt vmcnt(10)
  buffer_store_dword v228, off, s[28:31], s43 sc1
  ds_read_b64_tr_b16 v[170:171], v218 offset:18176
  v_mfma_f32_16x16x32_bf16 v[40:43], a[240:243], v[96:99], v[40:43]
  buffer_load_dwordx4 v227, s[24:27], s42 offen offset:2048 lds
  v_mfma_f32_16x16x32_bf16 v[40:43], a[244:247], v[100:103], v[40:43]
  ds_read_b64_tr_b16 v[172:173], v218 offset:26112
  v_mfma_f32_16x16x32_bf16 v[44:47], a[240:243], v[112:115], v[44:47]
  ds_read_b64_tr_b16 v[174:175], v218 offset:26368
  v_mfma_f32_16x16x32_bf16 v[44:47], a[244:247], v[116:119], v[44:47]
  ds_read_b64_tr_b16 v[176:177], v218 offset:26624
  v_mfma_f32_16x16x32_bf16 v[40:43], a[248:251], v[104:107], v[40:43]
  s_add_u32 m0, m0, 32
  ds_read_b64_tr_b16 v[178:179], v218 offset:26880
  v_mfma_f32_16x16x32_bf16 v[40:43], a[252:255], v[108:111], v[40:43]
  buffer_load_dwordx4 v227, s[24:27], s42 offen offset:3072 lds
  v_mfma_f32_16x16x32_bf16 v[44:47], a[248:251], v[120:123], v[44:47]
  ds_read_b64_tr_b16 a[224:225], v219 offset:0
  v_mfma_f32_16x16x32_bf16 v[44:47], a[252:255], v[124:127], v[44:47]
  s_waitcnt lgkmcnt(9)
  ds_read_b64_tr_b16 a[226:227], v219 offset:256
  v_mfma_f32_16x16x32_bf16 v[48:51], v[148:151], a[192:195], v[48:51]
  s_nop 0
  ds_read_b64_tr_b16 a[228:229], v219 offset:512
  ds_read_b64_tr_b16 a[230:231], v219 offset:768
  v_mfma_f32_16x16x32_bf16 v[48:51], v[152:155], a[196:199], v[48:51]
  ds_read_b64_tr_b16 a[232:233], v219 offset:8704
  v_mfma_f32_16x16x32_bf16 v[52:55], v[148:151], a[208:211], v[52:55]
  ds_read_b64_tr_b16 a[234:235], v219 offset:8960
  v_mfma_f32_16x16x32_bf16 v[52:55], v[152:155], a[212:215], v[52:55]
  v_cvt_pk_bf16_f32 v82, v40, v41
  v_cvt_pk_bf16_f32 v83, v42, v43
  v_mfma_f32_16x16x32_bf16 v[48:51], v[156:159], a[200:203], v[48:51]
  buffer_store_dwordx4 v[80:83], v225, s[28:31], s81 offen offset:0 sc1
  v_cvt_pk_bf16_f32 v88, v36, v37
  v_mfma_f32_16x16x32_bf16 v[48:51], v[160:163], a[204:207], v[48:51]
  v_cvt_pk_bf16_f32 v89, v38, v39
  v_cvt_pk_bf16_f32 v90, v44, v45
  v_mfma_f32_16x16x32_bf16 v[52:55], v[156:159], a[216:219], v[52:55]
  ds_read_b64_tr_b16 a[236:237], v219 offset:9216
  v_cvt_pk_bf16_f32 v91, v46, v47
  v_mfma_f32_16x16x32_bf16 v[52:55], v[160:163], a[220:223], v[52:55]
  s_waitcnt lgkmcnt(7)
  buffer_store_dwordx4 v[88:91], v225, s[28:31], s81 offen offset:2048 sc1
  ds_read_b64_tr_b16 a[238:239], v219 offset:9472
  v_mfma_f32_16x16x32_bf16 v[48:51], v[164:167], v[96:99], v[48:51]
  ds_read_b64_tr_b16 a[240:241], v219 offset:17408
  v_mfma_f32_16x16x32_bf16 v[48:51], v[168:171], v[100:103], v[48:51]
  ds_read_b64_tr_b16 a[242:243], v219 offset:17664
  v_mfma_f32_16x16x32_bf16 v[52:55], v[164:167], v[112:115], v[52:55]
  ds_read_b64_tr_b16 a[244:245], v219 offset:17920
  v_mfma_f32_16x16x32_bf16 v[52:55], v[168:171], v[116:119], v[52:55]
  ds_read_b64_tr_b16 a[246:247], v219 offset:18176
  v_mfma_f32_16x16x32_bf16 v[48:51], v[172:175], v[104:107], v[48:51]
  ds_read_b64_tr_b16 a[248:249], v219 offset:26112
  v_mfma_f32_16x16x32_bf16 v[48:51], v[176:179], v[108:111], v[48:51]
  ds_read_b64_tr_b16 a[250:251], v219 offset:26368
  v_mfma_f32_16x16x32_bf16 v[52:55], v[172:175], v[120:123], v[52:55]
  ds_read_b64_tr_b16 a[252:253], v219 offset:26624
  v_mfma_f32_16x16x32_bf16 v[52:55], v[176:179], v[124:127], v[52:55]
  s_waitcnt lgkmcnt(11)
  ds_read_b64_tr_b16 a[254:255], v219 offset:26880
  s_waitcnt vmcnt(11)
  s_barrier
  v_mfma_f32_16x16x32_bf16 v[56:59], a[224:227], a[192:195], v[56:59]
  s_add_u32 s42, s75, 0
  ds_read_b64_tr_b16 v[148:149], v212 offset:0
  v_mfma_f32_16x16x32_bf16 v[56:59], a[228:231], a[196:199], v[56:59]
  s_mov_b32 m0, s40
  ds_read_b64_tr_b16 v[150:151], v212 offset:256
  v_mfma_f32_16x16x32_bf16 v[60:63], a[224:227], a[208:211], v[60:63]
  ds_read_b64_tr_b16 v[152:153], v212 offset:512
  v_mfma_f32_16x16x32_bf16 v[60:63], a[228:231], a[212:215], v[60:63]
  v_cvt_pk_bf16_f32 v84, v48, v49
  v_cvt_pk_bf16_f32 v85, v50, v51
  v_mfma_f32_16x16x32_bf16 v[132:135], a[224:227], a[32:35], v[132:135]
  ds_read_b64_tr_b16 v[154:155], v212 offset:768
  v_mfma_f32_16x16x32_bf16 v[132:135], a[228:231], a[36:39], v[132:135]
  s_waitcnt lgkmcnt(12)
  ds_read_b64_tr_b16 v[156:157], v212 offset:8704
  v_mfma_f32_16x16x32_bf16 v[56:59], a[232:235], a[200:203], v[56:59]
  ds_read_b64_tr_b16 v[158:159], v212 offset:8960
  v_mfma_f32_16x16x32_bf16 v[56:59], a[236:239], a[204:207], v[56:59]
  ds_read_b64_tr_b16 v[160:161], v212 offset:9216
  v_mfma_f32_16x16x32_bf16 v[60:63], a[232:235], a[216:219], v[60:63]
  ds_read_b64_tr_b16 v[162:163], v212 offset:9472
  v_mfma_f32_16x16x32_bf16 v[60:63], a[236:239], a[220:223], v[60:63]
  buffer_load_dwordx4 v227, s[24:27], s42 offen lds
  v_mfma_f32_16x16x32_bf16 v[132:135], a[232:235], a[40:43], v[132:135]
  ds_read_b64_tr_b16 v[164:165], v212 offset:17408
  v_mfma_f32_16x16x32_bf16 v[132:135], a[236:239], a[44:47], v[132:135]
  s_waitcnt lgkmcnt(13)
  ds_read_b64_tr_b16 v[166:167], v212 offset:17664
  v_mfma_f32_16x16x32_bf16 v[56:59], a[240:243], v[96:99], v[56:59]
  ds_read_b64_tr_b16 v[168:169], v212 offset:17920
  v_mfma_f32_16x16x32_bf16 v[56:59], a[244:247], v[100:103], v[56:59]
  s_add_u32 m0, m0, 32
  ds_read_b64_tr_b16 v[170:171], v212 offset:18176
  v_mfma_f32_16x16x32_bf16 v[60:63], a[240:243], v[112:115], v[60:63]
  buffer_load_dwordx4 v227, s[24:27], s42 offen offset:1024 lds
  v_mfma_f32_16x16x32_bf16 v[60:63], a[244:247], v[116:119], v[60:63]
  ds_read_b64_tr_b16 v[172:173], v212 offset:26112
  v_mfma_f32_16x16x32_bf16 v[132:135], a[240:243], a[48:51], v[132:135]
  ds_read_b64_tr_b16 v[174:175], v212 offset:26368
  v_mfma_f32_16x16x32_bf16 v[132:135], a[244:247], a[52:55], v[132:135]
  s_waitcnt lgkmcnt(14)
  ds_read_b64_tr_b16 v[176:177], v212 offset:26624
  v_mfma_f32_16x16x32_bf16 v[56:59], a[248:251], v[104:107], v[56:59]
  s_add_u32 m0, m0, 32
  ds_read_b64_tr_b16 v[178:179], v212 offset:26880
  v_mfma_f32_16x16x32_bf16 v[56:59], a[252:255], v[108:111], v[56:59]
  s_sub_u32 s89, s59, 1
  s_and_b32 s89, s89, 7
  ds_read_b64_tr_b16 a[224:225], v213 offset:0
  v_mfma_f32_16x16x32_bf16 v[60:63], a[248:251], v[120:123], v[60:63]
  s_mul_i32 s90, s89, 18432
  s_lshl_b32 s89, s89, 2
  ds_read_b64_tr_b16 a[226:227], v213 offset:256
  v_mfma_f32_16x16x32_bf16 v[60:63], a[252:255], v[124:127], v[60:63]
  s_add_u32 s89, s89, s62
  s_add_u32 s90, s90, s63
  ds_read_b64_tr_b16 a[228:229], v213 offset:512
  v_mfma_f32_16x16x32_bf16 v[132:135], a[248:251], a[56:59], v[132:135]
  s_add_u32 s91, s90, s64
  ds_read_b64_tr_b16 a[230:231], v213 offset:768
  v_mfma_f32_16x16x32_bf16 v[132:135], a[252:255], a[60:63], v[132:135]
  s_waitcnt lgkmcnt(12)
  buffer_load_dwordx4 v227, s[24:27], s42 offen offset:2048 lds
  v_mfma_f32_16x16x32_bf16 v[0:3], v[148:151], a[128:131], 0
  ds_read_b64_tr_b16 a[232:233], v213 offset:8704
  v_mfma_f32_16x16x32_bf16 v[0:3], v[152:155], a[132:135], v[0:3]
  ds_read_b64_tr_b16 a[234:235], v213 offset:8960
  v_mfma_f32_16x16x32_bf16 v[4:7], v[148:151], a[144:147], 0
  ds_read_b64_tr_b16 a[236:237], v213 offset:9216
  v_mfma_f32_16x16x32_bf16 v[4:7], v[152:155], a[148:151], v[4:7]
  v_cvt_pk_bf16_f32 v86, v56, v57
  v_cvt_pk_bf16_f32 v87, v58, v59
  v_mfma_f32_16x16x32_bf16 v[0:3], v[156:159], a[136:139], v[0:3]
  s_add_u32 m0, m0, 32
  ds_read_b64_tr_b16 a[238:239], v213 offset:9472
  v_mfma_f32_16x16x32_bf16 v[0:3], v[160:163], a[140:143], v[0:3]
  buffer_store_dwordx4 v[84:87], v225, s[28:31], s81 offen offset:1024 sc1
  v_cvt_pk_bf16_f32 v92, v52, v53
  v_mfma_f32_16x16x32_bf16 v[4:7], v[156:159], a[152:155], v[4:7]
  v_cvt_pk_bf16_f32 v93, v54, v55
  v_cvt_pk_bf16_f32 v94, v60, v61
  v_mfma_f32_16x16x32_bf16 v[4:7], v[160:163], a[156:159], v[4:7]
  s_waitcnt lgkmcnt(8)
  buffer_load_dwordx4 v227, s[24:27], s42 offen offset:3072 lds
  v_cvt_pk_bf16_f32 v95, v62, v63
  v_mfma_f32_16x16x32_bf16 v[0:3], v[164:167], a[160:163], v[0:3]
  buffer_store_dwordx4 v[92:95], v225, s[28:31], s81 offen offset:3072 sc1
  v_cvt_pk_bf16_f32 v236, v132, v133
  v_mfma_f32_16x16x32_bf16 v[0:3], v[168:171], a[164:167], v[0:3]
  v_cvt_pk_bf16_f32 v237, v134, v135
  s_add_u32 s92, s81, s64
  ds_read_b64_tr_b16 a[240:241], v213 offset:17408
  v_mfma_f32_16x16x32_bf16 v[4:7], v[164:167], a[176:179], v[4:7]
  s_nop 0
  buffer_store_dwordx2 v[236:237], v222, s[28:31], s92 offen sc1
  ds_read_b64_tr_b16 a[242:243], v213 offset:17664
  v_mfma_f32_16x16x32_bf16 v[4:7], v[168:171], a[180:183], v[4:7]
  s_nop 0
  ds_read_b64_tr_b16 a[244:245], v213 offset:17920
  ds_read_b64_tr_b16 a[246:247], v213 offset:18176
  v_mfma_f32_16x16x32_bf16 v[0:3], v[172:175], a[168:171], v[0:3]
  s_add_u32 s42, s42, s52
  s_add_u32 m0, m0, s53
  v_mfma_f32_16x16x32_bf16 v[0:3], v[176:179], a[172:175], v[0:3]
  s_nop 0
  ds_read_b64_tr_b16 a[248:249], v213 offset:26112
  ds_read_b64_tr_b16 a[250:251], v213 offset:26368
  v_mfma_f32_16x16x32_bf16 v[4:7], v[172:175], a[184:187], v[4:7]
  s_nop 0
  ds_read_b64_tr_b16 a[252:253], v213 offset:26624
  ds_read_b64_tr_b16 a[254:255], v213 offset:26880
  v_mfma_f32_16x16x32_bf16 v[4:7], v[176:179], a[188:191], v[4:7]
  s_waitcnt lgkmcnt(8)
  buffer_load_dwordx4 v227, s[24:27], s42 offen lds
  ds_read_b64_tr_b16 v[148:149], v214 offset:0
  v_mfma_f32_16x16x32_bf16 v[8:11], a[224:227], a[128:131], 0
  s_nop 0
  ds_read_b64_tr_b16 v[150:151], v214 offset:256
  ds_read_b64_tr_b16 v[152:153], v214 offset:512
  v_mfma_f32_16x16x32_bf16 v[8:11], a[228:231], a[132:135], v[8:11]
  ds_read_b64_tr_b16 v[154:155], v214 offset:768
  v_mfma_f32_16x16x32_bf16 v[12:15], a[224:227], a[144:147], 0
  ds_read_b64_tr_b16 v[156:157], v214 offset:8704
  v_mfma_f32_16x16x32_bf16 v[12:15], a[228:231], a[148:151], v[12:15]
  s_add_u32 m0, m0, 32
  ds_read_b64_tr_b16 v[158:159], v214 offset:8960
  v_mfma_f32_16x16x32_bf16 v[8:11], a[232:235], a[136:139], v[8:11]
  s_nop 0
  buffer_load_dwordx4 v227, s[24:27], s42 offen offset:1024 lds
  ds_read_b64_tr_b16 v[160:161], v214 offset:9216
  v_mfma_f32_16x16x32_bf16 v[8:11], a[236:239], a[140:143], v[8:11]
  ds_read_b64_tr_b16 v[162:163], v214 offset:9472
  v_mfma_f32_16x16x32_bf16 v[12:15], a[232:235], a[152:155], v[12:15]
  ds_read_b64_tr_b16 v[164:165], v214 offset:17408
  v_mfma_f32_16x16x32_bf16 v[12:15], a[236:239], a[156:159], v[12:15]
  s_waitcnt lgkmcnt(9)
  ds_read_b64_tr_b16 v[166:167], v214 offset:17664
  v_mfma_f32_16x16x32_bf16 v[8:11], a[240:243], a[160:163], v[8:11]
  s_add_u32 m0, m0, 32
  ds_read_b64_tr_b16 v[168:169], v214 offset:17920
  v_mfma_f32_16x16x32_bf16 v[8:11], a[244:247], a[164:167], v[8:11]
  buffer_load_dword v229, off, s[28:31], s89 sc1
  s_add_u32 s43, s59, 2
  ds_read_b64_tr_b16 v[170:171], v214 offset:18176
  v_mfma_f32_16x16x32_bf16 v[12:15], a[240:243], a[176:179], v[12:15]
  s_and_b32 s43, s43, 7
  s_lshl_b32 s43, s43, 9
  buffer_load_dwordx4 v227, s[24:27], s42 offen offset:2048 lds
  v_mfma_f32_16x16x32_bf16 v[12:15], a[244:247], a[180:183], v[12:15]
  s_nop 0
  ds_read_b64_tr_b16 v[172:173], v214 offset:26112
  ds_read_b64_tr_b16 v[174:175], v214 offset:26368
  v_mfma_f32_16x16x32_bf16 v[8:11], a[248:251], a[168:171], v[8:11]
  s_nop 0
  ds_read_b64_tr_b16 v[176:177], v214 offset:26624
  ds_read_b64_tr_b16 v[178:179], v214 offset:26880
  v_mfma_f32_16x16x32_bf16 v[8:11], a[252:255], a[172:175], v[8:11]
  s_add_u32 s43, s43, s61
  ds_read_b64_tr_b16 a[224:225], v215 offset:0
  v_mfma_f32_16x16x32_bf16 v[12:15], a[248:251], a[184:187], v[12:15]
  s_add_u32 m0, m0, 32
  ds_read_b64_tr_b16 a[226:227], v215 offset:256
  v_mfma_f32_16x16x32_bf16 v[12:15], a[252:255], a[188:191], v[12:15]
  s_waitcnt lgkmcnt(10)
  buffer_load_dwordx4 v227, s[24:27], s42 offen offset:3072 lds
  v_mfma_f32_16x16x32_bf16 v[16:19], v[148:151], a[128:131], 0
  s_nop 0
  ds_read_b64_tr_b16 a[228:229], v215 offset:512
  ds_read_b64_tr_b16 a[230:231], v215 offset:768
  v_mfma_f32_16x16x32_bf16 v[16:19], v[152:155], a[132:135], v[16:19]
  ds_read_b64_tr_b16 a[232:233], v215 offset:8704
  v_mfma_f32_16x16x32_bf16 v[20:23], v[148:151], a[144:147], 0
  ds_read_b64_tr_b16 a[234:235], v215 offset:8960
  v_mfma_f32_16x16x32_bf16 v[20:23], v[152:155], a[148:151], v[20:23]
  ds_read_b64_tr_b16 a[236:237], v215 offset:9216
  v_mfma_f32_16x16x32_bf16 v[16:19], v[156:159], a[136:139], v[16:19]
  ds_read_b64_tr_b16 a[238:239], v215 offset:9472
  v_mfma_f32_16x16x32_bf16 v[16:19], v[160:163], a[140:143], v[16:19]
  ds_read_b64_tr_b16 a[240:241], v215 offset:17408
  v_mfma_f32_16x16x32_bf16 v[20:23], v[156:159], a[152:155], v[20:23]
  ds_read_b64_tr_b16 a[242:243], v215 offset:17664
  v_mfma_f32_16x16x32_bf16 v[20:23], v[160:163], a[156:159], v[20:23]
  s_waitcnt lgkmcnt(10)
  ds_read_b64_tr_b16 a[244:245], v215 offset:17920
  v_mfma_f32_16x16x32_bf16 v[16:19], v[164:167], a[160:163], v[16:19]
  ds_read_b64_tr_b16 a[246:247], v215 offset:18176
  v_mfma_f32_16x16x32_bf16 v[16:19], v[168:171], a[164:167], v[16:19]
  ds_read_b64_tr_b16 a[248:249], v215 offset:26112
  v_mfma_f32_16x16x32_bf16 v[20:23], v[164:167], a[176:179], v[20:23]
  ds_read_b64_tr_b16 a[250:251], v215 offset:26368
  v_mfma_f32_16x16x32_bf16 v[20:23], v[168:171], a[180:183], v[20:23]
  ds_read_b64_tr_b16 a[252:253], v215 offset:26624
  v_mfma_f32_16x16x32_bf16 v[16:19], v[172:175], a[168:171], v[16:19]
  ds_read_b64_tr_b16 a[254:255], v215 offset:26880
  s_waitcnt vmcnt(14)
  s_barrier
  v_mfma_f32_16x16x32_bf16 v[16:19], v[176:179], a[172:175], v[16:19]
  s_add_u32 s42, s75, 262144
  s_mov_b32 m0, s38
  ds_read_b64_tr_b16 v[148:149], v212 offset:34816
  v_mfma_f32_16x16x32_bf16 v[20:23], v[172:175], a[184:187], v[20:23]
  ds_read_b64_tr_b16 v[150:151], v212 offset:35072
  v_mfma_f32_16x16x32_bf16 v[20:23], v[176:179], a[188:191], v[20:23]
  s_waitcnt lgkmcnt(14)
  ds_read_b64_tr_b16 v[152:153], v212 offset:35328
  v_mfma_f32_16x16x32_bf16 v[24:27], a[224:227], a[128:131], 0
  ds_read_b64_tr_b16 v[154:155], v212 offset:35584
  v_mfma_f32_16x16x32_bf16 v[24:27], a[228:231], a[132:135], v[24:27]
  ds_read_b64_tr_b16 v[156:157], v212 offset:43520
  v_mfma_f32_16x16x32_bf16 v[28:31], a[224:227], a[144:147], 0
  ds_read_b64_tr_b16 v[158:159], v212 offset:43776
  v_mfma_f32_16x16x32_bf16 v[28:31], a[228:231], a[148:151], v[28:31]
  ds_read_b64_tr_b16 v[160:161], v212 offset:44032
  v_mfma_f32_16x16x32_bf16 v[128:131], a[224:227], a[0:3], 0
  ds_read_b64_tr_b16 v[162:163], v212 offset:44288
  v_mfma_f32_16x16x32_bf16 v[128:131], a[228:231], a[4:7], v[128:131]
  s_waitcnt lgkmcnt(15)
  buffer_load_dwordx4 v227, s[24:27], s42 offen lds
  v_mfma_f32_16x16x32_bf16 v[24:27], a[232:235], a[136:139], v[24:27]
  ds_read_b64_tr_b16 v[164:165], v212 offset:52224
  v_mfma_f32_16x16x32_bf16 v[24:27], a[236:239], a[140:143], v[24:27]
  ds_read_b64_tr_b16 v[166:167], v212 offset:52480
  v_mfma_f32_16x16x32_bf16 v[28:31], a[232:235], a[152:155], v[28:31]
  ds_read_b64_tr_b16 v[168:169], v212 offset:52736
  v_mfma_f32_16x16x32_bf16 v[28:31], a[236:239], a[156:159], v[28:31]
  s_add_u32 m0, m0, 32
  ds_read_b64_tr_b16 v[170:171], v212 offset:52992
  v_mfma_f32_16x16x32_bf16 v[128:131], a[232:235], a[8:11], v[128:131]
  buffer_load_dwordx4 v227, s[24:27], s42 offen offset:1024 lds
  v_mfma_f32_16x16x32_bf16 v[128:131], a[236:239], a[12:15], v[128:131]
  s_waitcnt lgkmcnt(15)
  ds_read_b64_tr_b16 v[172:173], v212 offset:60928
  v_mfma_f32_16x16x32_bf16 v[24:27], a[240:243], a[160:163], v[24:27]
  ds_read_b64_tr_b16 v[174:175], v212 offset:61184
  v_mfma_f32_16x16x32_bf16 v[24:27], a[244:247], a[164:167], v[24:27]
  ds_read_b64_tr_b16 v[176:177], v212 offset:61440
  v_mfma_f32_16x16x32_bf16 v[28:31], a[240:243], a[176:179], v[28:31]
  s_add_u32 m0, m0, 32
  ds_read_b64_tr_b16 v[178:179], v212 offset:61696
  v_mfma_f32_16x16x32_bf16 v[28:31], a[244:247], a[180:183], v[28:31]
  ds_read_b64_tr_b16 a[224:225], v213 offset:34816
  v_mfma_f32_16x16x32_bf16 v[128:131], a[240:243], a[16:19], v[128:131]
  ds_read_b64_tr_b16 a[226:227], v213 offset:35072
  v_mfma_f32_16x16x32_bf16 v[128:131], a[244:247], a[20:23], v[128:131]
  s_waitcnt lgkmcnt(15)
  ds_read_b64_tr_b16 a[228:229], v213 offset:35328
  v_mfma_f32_16x16x32_bf16 v[24:27], a[248:251], a[168:171], v[24:27]
  ds_read_b64_tr_b16 a[230:231], v213 offset:35584
  v_mfma_f32_16x16x32_bf16 v[24:27], a[252:255], a[172:175], v[24:27]
  buffer_load_dwordx4 v227, s[24:27], s42 offen offset:2048 lds
  v_mfma_f32_16x16x32_bf16 v[28:31], a[248:251], a[184:187], v[28:31]
  ds_read_b64_tr_b16 a[232:233], v213 offset:43520
  v_mfma_f32_16x16x32_bf16 v[28:31], a[252:255], a[188:191], v[28:31]
  ds_read_b64_tr_b16 a[234:235], v213 offset:43776
  v_mfma_f32_16x16x32_bf16 v[128:131], a[248:251], a[24:27], v[128:131]
  ds_read_b64_tr_b16 a[236:237], v213 offset:44032
  v_mfma_f32_16x16x32_bf16 v[128:131], a[252:255], a[28:31], v[128:131]
  s_waitcnt lgkmcnt(15)
  s_add_u32 m0, m0, 32
  ds_read_b64_tr_b16 a[238:239], v213 offset:44288
  v_mfma_f32_16x16x32_bf16 v[0:3], v[148:151], a[192:195], v[0:3]
  buffer_load_dwordx4 v227, s[24:27], s42 offen offset:3072 lds
  v_mfma_f32_16x16x32_bf16 v[0:3], v[152:155], a[196:199], v[0:3]
  ds_read_b64_tr_b16 a[240:241], v213 offset:52224
  v_mfma_f32_16x16x32_bf16 v[4:7], v[148:151], a[208:211], v[4:7]
  ds_read_b64_tr_b16 a[242:243], v213 offset:52480
  v_mfma_f32_16x16x32_bf16 v[4:7], v[152:155], a[212:215], v[4:7]
  ds_read_b64_tr_b16 a[244:245], v213 offset:52736
  v_mfma_f32_16x16x32_bf16 v[0:3], v[156:159], a[200:203], v[0:3]
  s_add_u32 s42, s42, s52
  ds_read_b64_tr_b16 a[246:247], v213 offset:52992
  v_mfma_f32_16x16x32_bf16 v[0:3], v[160:163], a[204:207], v[0:3]
  s_add_u32 m0, m0, s53
  ds_read_b64_tr_b16 a[248:249], v213 offset:60928
  v_mfma_f32_16x16x32_bf16 v[4:7], v[156:159], a[216:219], v[4:7]
  ds_read_b64_tr_b16 a[250:251], v213 offset:61184
  v_mfma_f32_16x16x32_bf16 v[4:7], v[160:163], a[220:223], v[4:7]
  s_waitcnt lgkmcnt(14)
  ds_read_b64_tr_b16 a[252:253], v213 offset:61440
  v_mfma_f32_16x16x32_bf16 v[0:3], v[164:167], v[96:99], v[0:3]
  ds_read_b64_tr_b16 a[254:255], v213 offset:61696
  v_mfma_f32_16x16x32_bf16 v[0:3], v[168:171], v[100:103], v[0:3]
  buffer_load_dwordx4 v227, s[24:27], s42 offen lds
  v_mfma_f32_16x16x32_bf16 v[4:7], v[164:167], v[112:115], v[4:7]
  ds_read_b64_tr_b16 v[148:149], v214 offset:34816
  v_mfma_f32_16x16x32_bf16 v[4:7], v[168:171], v[116:119], v[4:7]
  ds_read_b64_tr_b16 v[150:151], v214 offset:35072
  v_mfma_f32_16x16x32_bf16 v[0:3], v[172:175], v[104:107], v[0:3]
  ds_read_b64_tr_b16 v[152:153], v214 offset:35328
  v_mfma_f32_16x16x32_bf16 v[0:3], v[176:179], v[108:111], v[0:3]
  s_add_u32 m0, m0, 32
  ds_read_b64_tr_b16 v[154:155], v214 offset:35584
  v_mfma_f32_16x16x32_bf16 v[4:7], v[172:175], v[120:123], v[4:7]
  buffer_load_dwordx4 v227, s[24:27], s42 offen offset:1024 lds
  v_mfma_f32_16x16x32_bf16 v[4:7], v[176:179], v[124:127], v[4:7]
  s_waitcnt lgkmcnt(12)
  ds_read_b64_tr_b16 v[156:157], v214 offset:43520
  v_mfma_f32_16x16x32_bf16 v[8:11], a[224:227], a[192:195], v[8:11]
  ds_read_b64_tr_b16 v[158:159], v214 offset:43776
  v_mfma_f32_16x16x32_bf16 v[8:11], a[228:231], a[196:199], v[8:11]
  ds_read_b64_tr_b16 v[160:161], v214 offset:44032
  v_mfma_f32_16x16x32_bf16 v[12:15], a[224:227], a[208:211], v[12:15]
  s_add_u32 m0, m0, 32
  ds_read_b64_tr_b16 v[162:163], v214 offset:44288
  v_mfma_f32_16x16x32_bf16 v[12:15], a[228:231], a[212:215], v[12:15]
  v_cvt_pk_bf16_f32 v64, v0, v1
  v_cvt_pk_bf16_f32 v65, v2, v3
  v_mfma_f32_16x16x32_bf16 v[8:11], a[232:235], a[200:203], v[8:11]
  ds_read_b64_tr_b16 v[164:165], v214 offset:52224
  v_mfma_f32_16x16x32_bf16 v[8:11], a[236:239], a[204:207], v[8:11]
  ds_read_b64_tr_b16 v[166:167], v214 offset:52480
  v_mfma_f32_16x16x32_bf16 v[12:15], a[232:235], a[216:219], v[12:15]
  ds_read_b64_tr_b16 v[168:169], v214 offset:52736
  v_mfma_f32_16x16x32_bf16 v[12:15], a[236:239], a[220:223], v[12:15]
  s_waitcnt lgkmcnt(11)
  s_waitcnt vmcnt(11)
  buffer_store_dword v228, off, s[28:31], s43 sc1
  ds_read_b64_tr_b16 v[170:171], v214 offset:52992
  v_mfma_f32_16x16x32_bf16 v[8:11], a[240:243], v[96:99], v[8:11]
  s_waitcnt vmcnt(9)
  v_readfirstlane_b32 s65, v229
  s_cmp_ge_u32 s65, 1
  s_cbranch_scc0 L_spin0
L_spin0_back:
  v_mfma_f32_16x16x32_bf16 v[8:11], a[244:247], v[100:103], v[8:11]
  buffer_load_dwordx4 v227, s[24:27], s42 offen offset:2048 lds
  v_mfma_f32_16x16x32_bf16 v[12:15], a[240:243], v[112:115], v[12:15]
  ds_read_b64_tr_b16 v[172:173], v214 offset:60928
  v_mfma_f32_16x16x32_bf16 v[12:15], a[244:247], v[116:119], v[12:15]
  s_nop 0
  buffer_load_dwordx4 a[64:67], v225, s[28:31], s90 offen offset:0 sc1
  ds_read_b64_tr_b16 v[174:175], v214 offset:61184
  v_mfma_f32_16x16x32_bf16 v[8:11], a[248:251], v[104:107], v[8:11]
  s_nop 0
  ds_read_b64_tr_b16 v[176:177], v214 offset:61440
  ds_read_b64_tr_b16 v[178:179], v214 offset:61696
  v_mfma_f32_16x16x32_bf16 v[8:11], a[252:255], v[108:111], v[8:11]
  s_add_u32 m0, m0, 32
  ds_read_b64_tr_b16 a[224:225], v215 offset:34816
  v_mfma_f32_16x16x32_bf16 v[12:15], a[248:251], v[120:123], v[12:15]
  s_nop 0
  buffer_load_dwordx4 a[68:71], v225, s[28:31], s90 offen offset:1024 sc1
  buffer_load_dwordx4 v227, s[24:27], s42 offen offset:3072 lds
  v_mfma_f32_16x16x32_bf16 v[12:15], a[252:255], v[124:127], v[12:15]
  s_waitcnt lgkmcnt(9)
  ds_read_b64_tr_b16 a[226:227], v215 offset:35072
  v_mfma_f32_16x16x32_bf16 v[16:19], v[148:151], a[192:195], v[16:19]
  s_nop 0
  ds_read_b64_tr_b16 a[228:229], v215 offset:35328
  ds_read_b64_tr_b16 a[230:231], v215 offset:35584
  v_mfma_f32_16x16x32_bf16 v[16:19], v[152:155], a[196:199], v[16:19]
  buffer_load_dwordx4 a[72:75], v225, s[28:31], s90 offen offset:2048 sc1
  v_mfma_f32_16x16x32_bf16 v[20:23], v[148:151], a[208:211], v[20:23]
  ds_read_b64_tr_b16 a[232:233], v215 offset:43520
  v_mfma_f32_16x16x32_bf16 v[20:23], v[152:155], a[212:215], v[20:23]
  v_cvt_pk_bf16_f32 v66, v8, v9
  v_cvt_pk_bf16_f32 v67, v10, v11
  v_mfma_f32_16x16x32_bf16 v[16:19], v[156:159], a[200:203], v[16:19]
  buffer_load_dwordx4 a[76:79], v225, s[28:31], s90 offen offset:3072 sc1
  v_mfma_f32_16x16x32_bf16 v[16:19], v[160:163], a[204:207], v[16:19]
  s_nop 0
  ds_read_b64_tr_b16 a[234:235], v215 offset:43776
  buffer_store_dwordx4 v[64:67], v225, s[28:31], s82 offen offset:0 sc1
  v_mfma_f32_16x16x32_bf16 v[20:23], v[156:159], a[216:219], v[20:23]
  v_cvt_pk_bf16_f32 v72, v4, v5
  v_cvt_pk_bf16_f32 v73, v6, v7
  v_mfma_f32_16x16x32_bf16 v[20:23], v[160:163], a[220:223], v[20:23]
  s_waitcnt lgkmcnt(6)
  buffer_load_dwordx2 a[80:81], v222, s[28:31], s91 offen sc1
  v_cvt_pk_bf16_f32 v74, v12, v13
  v_mfma_f32_16x16x32_bf16 v[16:19], v[164:167], v[96:99], v[16:19]
  ds_read_b64_tr_b16 a[236:237], v215 offset:44032
  v_cvt_pk_bf16_f32 v75, v14, v15
  v_mfma_f32_16x16x32_bf16 v[16:19], v[168:171], v[100:103], v[16:19]
  s_nop 0
  buffer_store_dwordx4 v[72:75], v225, s[28:31], s82 offen offset:2048 sc1
  ds_read_b64_tr_b16 a[238:239], v215 offset:44288
  v_mfma_f32_16x16x32_bf16 v[20:23], v[164:167], v[112:115], v[20:23]
  ds_read_b64_tr_b16 a[240:241], v215 offset:52224
  v_mfma_f32_16x16x32_bf16 v[20:23], v[168:171], v[116:119], v[20:23]
  ds_read_b64_tr_b16 a[242:243], v215 offset:52480
  v_mfma_f32_16x16x32_bf16 v[16:19], v[172:175], v[104:107], v[16:19]
  s_nop 0
  ds_read_b64_tr_b16 a[244:245], v215 offset:52736
  ds_read_b64_tr_b16 a[246:247], v215 offset:52992
  v_mfma_f32_16x16x32_bf16 v[16:19], v[176:179], v[108:111], v[16:19]
  ds_read_b64_tr_b16 a[248:249], v215 offset:60928
  v_mfma_f32_16x16x32_bf16 v[20:23], v[172:175], v[120:123], v[20:23]
  ds_read_b64_tr_b16 a[250:251], v215 offset:61184
  v_mfma_f32_16x16x32_bf16 v[20:23], v[176:179], v[124:127], v[20:23]
  s_waitcnt lgkmcnt(10)
  ds_read_b64_tr_b16 a[252:253], v215 offset:61440
  v_mfma_f32_16x16x32_bf16 v[24:27], a[224:227], a[192:195], v[24:27]
  ds_read_b64_tr_b16 a[254:255], v215 offset:61696
  s_waitcnt vmcnt(16)
  s_barrier
  v_mfma_f32_16x16x32_bf16 v[24:27], a[228:231], a[196:199], v[24:27]
  s_add_u32 s42, s76, 0
  s_mov_b32 m0, s37
  ds_read_b64_tr_b16 v[148:149], v216 offset:34816
  v_mfma_f32_16x16x32_bf16 v[28:31], a[224:227], a[208:211], v[28:31]
  ds_read_b64_tr_b16 v[150:151], v216 offset:35072
  v_mfma_f32_16x16x32_bf16 v[28:31], a[228:231], a[212:215], v[28:31]
  v_cvt_pk_bf16_f32 v68, v16, v17
  v_cvt_pk_bf16_f32 v69, v18, v19
  v_mfma_f32_16x16x32_bf16 v[128:131], a[224:227], a[32:35], v[128:131]
  ds_read_b64_tr_b16 v[152:153], v216 offset:35328
  v_mfma_f32_16x16x32_bf16 v[128:131], a[228:231], a[36:39], v[128:131]
  s_waitcnt lgkmcnt(11)
  ds_read_b64_tr_b16 v[154:155], v216 offset:35584
  v_mfma_f32_16x16x32_bf16 v[24:27], a[232:235], a[200:203], v[24:27]
  ds_read_b64_tr_b16 v[156:157], v216 offset:43520
  v_mfma_f32_16x16x32_bf16 v[24:27], a[236:239], a[204:207], v[24:27]
  ds_read_b64_tr_b16 v[158:159], v216 offset:43776
  v_mfma_f32_16x16x32_bf16 v[28:31], a[232:235], a[216:219], v[28:31]
  ds_read_b64_tr_b16 v[160:161], v216 offset:44032
  v_mfma_f32_16x16x32_bf16 v[28:31], a[236:239], a[220:223], v[28:31]
  ds_read_b64_tr_b16 v[162:163], v216 offset:44288
  v_mfma_f32_16x16x32_bf16 v[128:131], a[232:235], a[40:43], v[128:131]
  buffer_load_dwordx4 v227, s[24:27], s42 offen lds
  v_mfma_f32_16x16x32_bf16 v[128:131], a[236:239], a[44:47], v[128:131]
  s_waitcnt lgkmcnt(12)
  ds_read_b64_tr_b16 v[164:165], v216 offset:52224
  v_mfma_f32_16x16x32_bf16 v[24:27], a[240:243], v[96:99], v[24:27]
  ds_read_b64_tr_b16 v[166:167], v216 offset:52480
  v_mfma_f32_16x16x32_bf16 v[24:27], a[244:247], v[100:103], v[24:27]
  ds_read_b64_tr_b16 v[168:169], v216 offset:52736
  v_mfma_f32_16x16x32_bf16 v[28:31], a[240:243], v[112:115], v[28:31]
  s_add_u32 m0, m0, 32
  ds_read_b64_tr_b16 v[170:171], v216 offset:52992
  v_mfma_f32_16x16x32_bf16 v[28:31], a[244:247], v[116:119], v[28:31]
  buffer_load_dwordx4 v227, s[24:27], s42 offen offset:1024 lds
  v_mfma_f32_16x16x32_bf16 v[128:131], a[240:243], a[48:51], v[128:131]
  ds_read_b64_tr_b16 v[172:173], v216 offset:60928
  v_mfma_f32_16x16x32_bf16 v[128:131], a[244:247], a[52:55], v[128:131]
  s_waitcnt lgkmcnt(13)
  ds_read_b64_tr_b16 v[174:175], v216 offset:61184
  v_mfma_f32_16x16x32_bf16 v[24:27], a[248:251], v[104:107], v[24:27]
  ds_read_b64_tr_b16 v[176:177], v216 offset:61440
  v_mfma_f32_16x16x32_bf16 v[24:27], a[252:255], v[108:111], v[24:27]
  s_add_u32 m0, m0, 32
  s_sub_u32 s89, s59, 2
  ds_read_b64_tr_b16 v[178:179], v216 offset:61696
  v_mfma_f32_16x16x32_bf16 v[28:31], a[248:251], v[120:123], v[28:31]
  s_and_b32 s89, s89, 7
  s_mul_i32 s90, s89, 18432
  ds_read_b64_tr_b16 a[224:225], v217 offset:34816
  v_mfma_f32_16x16x32_bf16 v[28:31], a[252:255], v[124:127], v[28:31]
  s_lshl_b32 s89, s89, 2
  s_add_u32 s89, s89, s62
  ds_read_b64_tr_b16 a[226:227], v217 offset:35072
  v_mfma_f32_16x16x32_bf16 v[128:131], a[248:251], a[56:59], v[128:131]
  s_add_u32 s90, s90, s63
  s_add_u32 s91, s90, s64
  ds_read_b64_tr_b16 a[228:229], v217 offset:35328
  v_mfma_f32_16x16x32_bf16 v[128:131], a[252:255], a[60:63], v[128:131]
  s_waitcnt lgkmcnt(11)
  ds_read_b64_tr_b16 a[230:231], v217 offset:35584
  v_mfma_f32_16x16x32_bf16 v[32:35], v[148:151], a[128:131], 0
  buffer_load_dwordx4 v227, s[24:27], s42 offen offset:2048 lds
  v_mfma_f32_16x16x32_bf16 v[32:35], v[152:155], a[132:135], v[32:35]
  ds_read_b64_tr_b16 a[232:233], v217 offset:43520
  v_mfma_f32_16x16x32_bf16 v[36:39], v[148:151], a[144:147], 0
  ds_read_b64_tr_b16 a[234:235], v217 offset:43776
  v_mfma_f32_16x16x32_bf16 v[36:39], v[152:155], a[148:151], v[36:39]
  v_cvt_pk_bf16_f32 v70, v24, v25
  v_cvt_pk_bf16_f32 v71, v26, v27
  v_mfma_f32_16x16x32_bf16 v[32:35], v[156:159], a[136:139], v[32:35]
  s_nop 0
  ds_read_b64_tr_b16 a[236:237], v217 offset:44032
  ds_read_b64_tr_b16 a[238:239], v217 offset:44288
  v_mfma_f32_16x16x32_bf16 v[32:35], v[160:163], a[140:143], v[32:35]
  s_add_u32 m0, m0, 32
  buffer_store_dwordx4 v[68:71], v225, s[28:31], s82 offen offset:1024 sc1
  v_cvt_pk_bf16_f32 v76, v20, v21
  v_mfma_f32_16x16x32_bf16 v[36:39], v[156:159], a[152:155], v[36:39]
  v_cvt_pk_bf16_f32 v77, v22, v23
  v_cvt_pk_bf16_f32 v78, v28, v29
  v_mfma_f32_16x16x32_bf16 v[36:39], v[160:163], a[156:159], v[36:39]
  s_waitcnt lgkmcnt(8)
  buffer_load_dwordx4 v227, s[24:27], s42 offen offset:3072 lds
  v_cvt_pk_bf16_f32 v79, v30, v31
  v_mfma_f32_16x16x32_bf16 v[32:35], v[164:167], a[160:163], v[32:35]
  buffer_store_dwordx4 v[76:79], v225, s[28:31], s82 offen offset:3072 sc1
  v_cvt_pk_bf16_f32 v232, v128, v129
  v_mfma_f32_16x16x32_bf16 v[32:35], v[168:171], a[164:167], v[32:35]
  v_cvt_pk_bf16_f32 v233, v130, v131
  s_add_u32 s92, s82, s64
  ds_read_b64_tr_b16 a[240:241], v217 offset:52224
  v_mfma_f32_16x16x32_bf16 v[36:39], v[164:167], a[176:179], v[36:39]
  s_nop 0
  buffer_store_dwordx2 v[232:233], v222, s[28:31], s92 offen sc1
  ds_read_b64_tr_b16 a[242:243], v217 offset:52480
  v_mfma_f32_16x16x32_bf16 v[36:39], v[168:171], a[180:183], v[36:39]
  s_nop 0
  ds_read_b64_tr_b16 a[244:245], v217 offset:52736
  ds_read_b64_tr_b16 a[246:247], v217 offset:52992
  v_mfma_f32_16x16x32_bf16 v[32:35], v[172:175], a[168:171], v[32:35]
  s_add_u32 s42, s42, s52
  s_add_u32 m0, m0, s53
  v_mfma_f32_16x16x32_bf16 v[32:35], v[176:179], a[172:175], v[32:35]
  s_nop 0
  ds_read_b64_tr_b16 a[248:249], v217 offset:60928
  ds_read_b64_tr_b16 a[250:251], v217 offset:61184
  v_mfma_f32_16x16x32_bf16 v[36:39], v[172:175], a[184:187], v[36:39]
  s_nop 0
  ds_read_b64_tr_b16 a[252:253], v217 offset:61440
  ds_read_b64_tr_b16 a[254:255], v217 offset:61696
  v_mfma_f32_16x16x32_bf16 v[36:39], v[176:179], a[188:191], v[36:39]
  s_waitcnt lgkmcnt(8)
  buffer_load_dwordx4 v227, s[24:27], s42 offen lds
  ds_read_b64_tr_b16 v[148:149], v218 offset:34816
  v_mfma_f32_16x16x32_bf16 v[40:43], a[224:227], a[128:131], 0
  s_nop 0
  ds_read_b64_tr_b16 v[150:151], v218 offset:35072
  ds_read_b64_tr_b16 v[152:153], v218 offset:35328
  v_mfma_f32_16x16x32_bf16 v[40:43], a[228:231], a[132:135], v[40:43]
  ds_read_b64_tr_b16 v[154:155], v218 offset:35584
  v_mfma_f32_16x16x32_bf16 v[44:47], a[224:227], a[144:147], 0
  ds_read_b64_tr_b16 v[156:157], v218 offset:43520
  v_mfma_f32_16x16x32_bf16 v[44:47], a[228:231], a[148:151], v[44:47]
  s_add_u32 m0, m0, 32
  ds_read_b64_tr_b16 v[158:159], v218 offset:43776
  v_mfma_f32_16x16x32_bf16 v[40:43], a[232:235], a[136:139], v[40:43]
  s_nop 0
  buffer_load_dwordx4 v227, s[24:27], s42 offen offset:1024 lds
  ds_read_b64_tr_b16 v[160:161], v218 offset:44032
  v_mfma_f32_16x16x32_bf16 v[40:43], a[236:239], a[140:143], v[40:43]
  ds_read_b64_tr_b16 v[162:163], v218 offset:44288
  v_mfma_f32_16x16x32_bf16 v[44:47], a[232:235], a[152:155], v[44:47]
  ds_read_b64_tr_b16 v[164:165], v218 offset:52224
  v_mfma_f32_16x16x32_bf16 v[44:47], a[236:239], a[156:159], v[44:47]
  s_waitcnt lgkmcnt(9)
  ds_read_b64_tr_b16 v[166:167], v218 offset:52480
  v_mfma_f32_16x16x32_bf16 v[40:43], a[240:243], a[160:163], v[40:43]
  s_add_u32 m0, m0, 32
  ds_read_b64_tr_b16 v[168:169], v218 offset:52736
  v_mfma_f32_16x16x32_bf16 v[40:43], a[244:247], a[164:167], v[40:43]
  buffer_load_dword v229, off, s[28:31], s89 sc1
  s_add_u32 s43, s59, 3
  ds_read_b64_tr_b16 v[170:171], v218 offset:52992
  v_mfma_f32_16x16x32_bf16 v[44:47], a[240:243], a[176:179], v[44:47]
  s_and_b32 s43, s43, 7
  s_lshl_b32 s43, s43, 9
  buffer_load_dwordx4 v227, s[24:27], s42 offen offset:2048 lds
  v_mfma_f32_16x16x32_bf16 v[44:47], a[244:247], a[180:183], v[44:47]
  s_nop 0
  ds_read_b64_tr_b16 v[172:173], v218 offset:60928
  ds_read_b64_tr_b16 v[174:175], v218 offset:61184
  v_mfma_f32_16x16x32_bf16 v[40:43], a[248:251], a[168:171], v[40:43]
  s_nop 0
  ds_read_b64_tr_b16 v[176:177], v218 offset:61440
  ds_read_b64_tr_b16 v[178:179], v218 offset:61696
  v_mfma_f32_16x16x32_bf16 v[40:43], a[252:255], a[172:175], v[40:43]
  s_add_u32 s43, s43, s61
  ds_read_b64_tr_b16 a[224:225], v219 offset:34816
  v_mfma_f32_16x16x32_bf16 v[44:47], a[248:251], a[184:187], v[44:47]
  s_add_u32 m0, m0, 32
  ds_read_b64_tr_b16 a[226:227], v219 offset:35072
  v_mfma_f32_16x16x32_bf16 v[44:47], a[252:255], a[188:191], v[44:47]
  s_waitcnt lgkmcnt(10)
  buffer_load_dwordx4 v227, s[24:27], s42 offen offset:3072 lds
  v_mfma_f32_16x16x32_bf16 v[48:51], v[148:151], a[128:131], 0
  s_nop 0
  ds_read_b64_tr_b16 a[228:229], v219 offset:35328
  ds_read_b64_tr_b16 a[230:231], v219 offset:35584
  v_mfma_f32_16x16x32_bf16 v[48:51], v[152:155], a[132:135], v[48:51]
  ds_read_b64_tr_b16 a[232:233], v219 offset:43520
  v_mfma_f32_16x16x32_bf16 v[52:55], v[148:151], a[144:147], 0
  ds_read_b64_tr_b16 a[234:235], v219 offset:43776
  v_mfma_f32_16x16x32_bf16 v[52:55], v[152:155], a[148:151], v[52:55]
  ds_read_b64_tr_b16 a[236:237], v219 offset:44032
  v_mfma_f32_16x16x32_bf16 v[48:51], v[156:159], a[136:139], v[48:51]
  ds_read_b64_tr_b16 a[238:239], v219 offset:44288
  v_mfma_f32_16x16x32_bf16 v[48:51], v[160:163], a[140:143], v[48:51]
  ds_read_b64_tr_b16 a[240:241], v219 offset:52224
  v_mfma_f32_16x16x32_bf16 v[52:55], v[156:159], a[152:155], v[52:55]
  ds_read_b64_tr_b16 a[242:243], v219 offset:52480
  v_mfma_f32_16x16x32_bf16 v[52:55], v[160:163], a[156:159], v[52:55]
  s_waitcnt lgkmcnt(10)
  ds_read_b64_tr_b16 a[244:245], v219 offset:52736
  v_mfma_f32_16x16x32_bf16 v[48:51], v[164:167], a[160:163], v[48:51]
  ds_read_b64_tr_b16 a[246:247], v219 offset:52992
  v_mfma_f32_16x16x32_bf16 v[48:51], v[168:171], a[164:167], v[48:51]
  ds_read_b64_tr_b16 a[248:249], v219 offset:60928
  v_mfma_f32_16x16x32_bf16 v[52:55], v[164:167], a[176:179], v[52:55]
  ds_read_b64_tr_b16 a[250:251], v219 offset:61184
  v_mfma_f32_16x16x32_bf16 v[52:55], v[168:171], a[180:183], v[52:55]
  ds_read_b64_tr_b16 a[252:253], v219 offset:61440
  v_mfma_f32_16x16x32_bf16 v[48:51], v[172:175], a[168:171], v[48:51]
  ds_read_b64_tr_b16 a[254:255], v219 offset:61696
  s_waitcnt vmcnt(17)
  s_barrier
  v_mfma_f32_16x16x32_bf16 v[48:51], v[176:179], a[172:175], v[48:51]
  s_add_u32 s42, s76, 262144
  s_mov_b32 m0, s39
  ds_read_b64_tr_b16 v[148:149], v216 offset:0
  v_mfma_f32_16x16x32_bf16 v[52:55], v[172:175], a[184:187], v[52:55]
  buffer_load_dwordx4 v227, s[24:27], s42 offen lds
  v_mfma_f32_16x16x32_bf16 v[52:55], v[176:179], a[188:191], v[52:55]
  s_waitcnt lgkmcnt(13)
  ds_read_b64_tr_b16 v[150:151], v216 offset:256
  v_mfma_f32_16x16x32_bf16 v[56:59], a[224:227], a[128:131], 0
  ds_read_b64_tr_b16 v[152:153], v216 offset:512
  v_mfma_f32_16x16x32_bf16 v[56:59], a[228:231], a[132:135], v[56:59]
  ds_read_b64_tr_b16 v[154:155], v216 offset:768
  v_mfma_f32_16x16x32_bf16 v[60:63], a[224:227], a[144:147], 0
  s_add_u32 m0, m0, 32
  ds_read_b64_tr_b16 v[156:157], v216 offset:8704
  v_mfma_f32_16x16x32_bf16 v[60:63], a[228:231], a[148:151], v[60:63]
  buffer_load_dwordx4 v227, s[24:27], s42 offen offset:1024 lds
  v_mfma_f32_16x16x32_bf16 v[132:135], a[224:227], a[0:3], 0
  ds_read_b64_tr_b16 v[158:159], v216 offset:8960
  v_mfma_f32_16x16x32_bf16 v[132:135], a[228:231], a[4:7], v[132:135]
  s_waitcnt lgkmcnt(14)
  ds_read_b64_tr_b16 v[160:161], v216 offset:9216
  v_mfma_f32_16x16x32_bf16 v[56:59], a[232:235], a[136:139], v[56:59]
  ds_read_b64_tr_b16 v[162:163], v216 offset:9472
  v_mfma_f32_16x16x32_bf16 v[56:59], a[236:239], a[140:143], v[56:59]
  s_add_u32 m0, m0, 32
  ds_read_b64_tr_b16 v[164:165], v216 offset:17408
  v_mfma_f32_16x16x32_bf16 v[60:63], a[232:235], a[152:155], v[60:63]
  ds_read_b64_tr_b16 v[166:167], v216 offset:17664
  v_mfma_f32_16x16x32_bf16 v[60:63], a[236:239], a[156:159], v[60:63]
  buffer_load_dwordx4 v227, s[24:27], s42 offen offset:2048 lds
  v_mfma_f32_16x16x32_bf16 v[132:135], a[232:235], a[8:11], v[132:135]
  ds_read_b64_tr_b16 v[168:169], v216 offset:17920
  v_mfma_f32_16x16x32_bf16 v[132:135], a[236:239], a[12:15], v[132:135]
  s_waitcnt lgkmcnt(15)
  ds_read_b64_tr_b16 v[170:171], v216 offset:18176
  v_mfma_f32_16x16x32_bf16 v[56:59], a[240:243], a[160:163], v[56:59]
  ds_read_b64_tr_b16 v[172:173], v216 offset:26112
  v_mfma_f32_16x16x32_bf16 v[56:59], a[244:247], a[164:167], v[56:59]
  s_add_u32 m0, m0, 32
  ds_read_b64_tr_b16 v[174:175], v216 offset:26368
  v_mfma_f32_16x16x32_bf16 v[60:63], a[240:243], a[176:179], v[60:63]
  ds_read_b64_tr_b16 v[176:177], v216 offset:26624
  v_mfma_f32_16x16x32_bf16 v[60:63], a[244:247], a[180:183], v[60:63]
  ds_read_b64_tr_b16 v[178:179], v216 offset:26880
  v_mfma_f32_16x16x32_bf16 v[132:135], a[240:243], a[16:19], v[132:135]
  buffer_load_dwordx4 v227, s[24:27], s42 offen offset:3072 lds
  v_mfma_f32_16x16x32_bf16 v[132:135], a[244:247], a[20:23], v[132:135]
  s_waitcnt lgkmcnt(15)
  ds_read_b64_tr_b16 a[224:225], v217 offset:0
  v_mfma_f32_16x16x32_bf16 v[56:59], a[248:251], a[168:171], v[56:59]
  ds_read_b64_tr_b16 a[226:227], v217 offset:256
  v_mfma_f32_16x16x32_bf16 v[56:59], a[252:255], a[172:175], v[56:59]
  ds_read_b64_tr_b16 a[228:229], v217 offset:512
  v_mfma_f32_16x16x32_bf16 v[60:63], a[248:251], a[184:187], v[60:63]
  s_add_u32 s42, s42, s52
  s_add_u32 m0, m0, s53
  ds_read_b64_tr_b16 a[230:231], v217 offset:768
  v_mfma_f32_16x16x32_bf16 v[60:63], a[252:255], a[188:191], v[60:63]
  ds_read_b64_tr_b16 a[232:233], v217 offset:8704
  v_mfma_f32_16x16x32_bf16 v[132:135], a[248:251], a[24:27], v[132:135]
  s_waitcnt vmcnt(17)
  ds_read_b64_tr_b16 a[234:235], v217 offset:8960
  v_mfma_f32_16x16x32_bf16 v[132:135], a[252:255], a[28:31], v[132:135]
  buffer_load_dwordx4 v227, s[24:27], s42 offen lds
  v_mfma_f32_16x16x32_bf16 v[180:183], v[142:145], a[64:67], 0
  ds_read_b64_tr_b16 a[236:237], v217 offset:9216
  v_mfma_f32_16x16x32_bf16 v[188:191], v[140:143], a[64:67], 0
  ds_read_b64_tr_b16 a[238:239], v217 offset:9472
  v_mfma_f32_16x16x32_bf16 v[196:199], v[142:145], a[68:71], 0
  ds_read_b64_tr_b16 a[240:241], v217 offset:17408
  v_mfma_f32_16x16x32_bf16 v[204:207], v[140:143], a[68:71], 0
  s_add_u32 m0, m0, 32
  ds_read_b64_tr_b16 a[242:243], v217 offset:17664
  v_mfma_f32_16x16x32_bf16 v[184:187], v[142:145], a[72:75], 0
  ds_read_b64_tr_b16 a[244:245], v217 offset:17920
  v_mfma_f32_16x16x32_bf16 v[192:195], v[140:143], a[72:75], 0
  ds_read_b64_tr_b16 a[246:247], v217 offset:18176
  v_mfma_f32_16x16x32_bf16 v[200:203], v[142:145], a[76:79], 0
  buffer_load_dwordx4 v227, s[24:27], s42 offen offset:1024 lds
  v_mfma_f32_16x16x32_bf16 v[208:211], v[140:143], a[76:79], 0
  ds_read_b64_tr_b16 a[248:249], v217 offset:26112
  v_mfma_f32_16x16x32_bf16 v[136:139], v[142:145], a[80:83], 0
  s_waitcnt lgkmcnt(15)
  ds_read_b64_tr_b16 a[250:251], v217 offset:26368
  v_mfma_f32_16x16x32_bf16 v[32:35], v[148:151], a[192:195], v[32:35]
  ds_read_b64_tr_b16 a[252:253], v217 offset:26624
  v_mfma_f32_16x16x32_bf16 v[32:35], v[152:155], a[196:199], v[32:35]
  s_add_u32 m0, m0, 32
  ds_read_b64_tr_b16 a[254:255], v217 offset:26880
  v_mfma_f32_16x16x32_bf16 v[36:39], v[148:151], a[208:211], v[36:39]
  ds_read_b64_tr_b16 v[148:149], v218 offset:0
  v_mfma_f32_16x16x32_bf16 v[36:39], v[152:155], a[212:215], v[36:39]
  ds_read_b64_tr_b16 v[150:151], v218 offset:256
  v_mfma_f32_16x16x32_bf16 v[32:35], v[156:159], a[200:203], v[32:35]
  buffer_load_dwordx4 v227, s[24:27], s42 offen offset:2048 lds
  v_mfma_f32_16x16x32_bf16 v[32:35], v[160:163], a[204:207], v[32:35]
  ds_read_b64_tr_b16 v[152:153], v218 offset:512
  v_mfma_f32_16x16x32_bf16 v[36:39], v[156:159], a[216:219], v[36:39]
  ds_read_b64_tr_b16 v[154:155], v218 offset:768
  v_mfma_f32_16x16x32_bf16 v[36:39], v[160:163], a[220:223], v[36:39]
  s_waitcnt lgkmcnt(15)
  ds_read_b64_tr_b16 v[156:157], v218 offset:8704
  v_mfma_f32_16x16x32_bf16 v[32:35], v[164:167], v[96:99], v[32:35]
  s_add_u32 m0, m0, 32
  ds_read_b64_tr_b16 v[158:159], v218 offset:8960
  v_mfma_f32_16x16x32_bf16 v[32:35], v[168:171], v[100:103], v[32:35]
  ds_read_b64_tr_b16 v[160:161], v218 offset:9216
  v_mfma_f32_16x16x32_bf16 v[36:39], v[164:167], v[112:115], v[36:39]
  ds_read_b64_tr_b16 v[162:163], v218 offset:9472
  v_mfma_f32_16x16x32_bf16 v[36:39], v[168:171], v[116:119], v[36:39]
  buffer_load_dwordx4 v227, s[24:27], s42 offen offset:3072 lds
  v_mfma_f32_16x16x32_bf16 v[32:35], v[172:175], v[104:107], v[32:35]
  ds_read_b64_tr_b16 v[164:165], v218 offset:17408
  v_mfma_f32_16x16x32_bf16 v[32:35], v[176:179], v[108:111], v[32:35]
  ds_read_b64_tr_b16 v[166:167], v218 offset:17664
  v_mfma_f32_16x16x32_bf16 v[36:39], v[172:175], v[120:123], v[36:39]
  s_waitcnt vmcnt(13)
  buffer_store_dword v228, off, s[28:31], s43 sc1
  ds_read_b64_tr_b16 v[168:169], v218 offset:17920
  v_mfma_f32_16x16x32_bf16 v[36:39], v[176:179], v[124:127], v[36:39]
  s_waitcnt lgkmcnt(15)
  s_waitcnt vmcnt(11)
  v_readfirstlane_b32 s65, v229
  s_cmp_ge_u32 s65, 1
  s_cbranch_scc0 L_spin1
L_spin1_back:
  v_mfma_f32_16x16x32_bf16 v[40:43], a[224:227], a[192:195], v[40:43]
  ds_read_b64_tr_b16 v[170:171], v218 offset:18176
  v_mfma_f32_16x16x32_bf16 v[40:43], a[228:231], a[196:199], v[40:43]
  ds_read_b64_tr_b16 v[172:173], v218 offset:26112
  v_mfma_f32_16x16x32_bf16 v[44:47], a[224:227], a[208:211], v[44:47]
  buffer_load_dwordx4 a[84:87], v225, s[28:31], s90 offen offset:0 sc1
  v_mfma_f32_16x16x32_bf16 v[44:47], a[228:231], a[212:215], v[44:47]
  v_cvt_pk_bf16_f32 v80, v32, v33
  v_cvt_pk_bf16_f32 v81, v34, v35
  v_mfma_f32_16x16x32_bf16 v[40:43], a[232:235], a[200:203], v[40:43]
  ds_read_b64_tr_b16 v[174:175], v218 offset:26368
  v_mfma_f32_16x16x32_bf16 v[40:43], a[236:239], a[204:207], v[40:43]
  buffer_load_dwordx4 a[88:91], v225, s[28:31], s90 offen offset:1024 sc1
  v_mfma_f32_16x16x32_bf16 v[44:47], a[232:235], a[216:219], v[44:47]
  ds_read_b64_tr_b16 v[176:177], v218 offset:26624
  v_mfma_f32_16x16x32_bf16 v[44:47], a[236:239], a[220:223], v[44:47]
  s_waitcnt lgkmcnt(15)
  ds_read_b64_tr_b16 v[178:179], v218 offset:26880
  v_mfma_f32_16x16x32_bf16 v[40:43], a[240:243], v[96:99], v[40:43]
  buffer_load_dwordx4 a[92:95], v225, s[28:31], s90 offen offset:2048 sc1
  v_mfma_f32_16x16x32_bf16 v[40:43], a[244:247], v[100:103], v[40:43]
  ds_read_b64_tr_b16 a[224:225], v219 offset:0
  v_mfma_f32_16x16x32_bf16 v[44:47], a[240:243], v[112:115], v[44:47]
  ds_read_b64_tr_b16 a[226:227], v219 offset:256
  v_mfma_f32_16x16x32_bf16 v[44:47], a[244:247], v[116:119], v[44:47]
  buffer_load_dwordx4 a[96:99], v225, s[28:31], s90 offen offset:3072 sc1
  v_mfma_f32_16x16x32_bf16 v[40:43], a[248:251], v[104:107], v[40:43]
  ds_read_b64_tr_b16 a[228:229], v219 offset:512
  v_mfma_f32_16x16x32_bf16 v[40:43], a[252:255], v[108:111], v[40:43]
  ds_read_b64_tr_b16 a[230:231], v219 offset:768
  v_mfma_f32_16x16x32_bf16 v[44:47], a[248:251], v[120:123], v[44:47]
  buffer_load_dwordx2 a[100:101], v222, s[28:31], s91 offen sc1
  v_mfma_f32_16x16x32_bf16 v[44:47], a[252:255], v[124:127], v[44:47]
  s_waitcnt lgkmcnt(12)
  ds_read_b64_tr_b16 a[232:233], v219 offset:8704
  v_mfma_f32_16x16x32_bf16 v[48:51], v[148:151], a[192:195], v[48:51]
  ds_read_b64_tr_b16 a[234:235], v219 offset:8960
  v_mfma_f32_16x16x32_bf16 v[48:51], v[152:155], a[196:199], v[48:51]
  ds_read_b64_tr_b16 a[236:237], v219 offset:9216
  v_mfma_f32_16x16x32_bf16 v[52:55], v[148:151], a[208:211], v[52:55]
  ds_read_b64_tr_b16 a[238:239], v219 offset:9472
  v_mfma_f32_16x16x32_bf16 v[52:55], v[152:155], a[212:215], v[52:55]
  v_cvt_pk_bf16_f32 v82, v40, v41
  v_cvt_pk_bf16_f32 v83, v42, v43
  v_mfma_f32_16x16x32_bf16 v[48:51], v[156:159], a[200:203], v[48:51]
  buffer_store_dwordx4 v[80:83], v225, s[28:31], s83 offen offset:0 sc1
  v_cvt_pk_bf16_f32 v88, v36, v37
  v_mfma_f32_16x16x32_bf16 v[48:51], v[160:163], a[204:207], v[48:51]
  v_cvt_pk_bf16_f32 v89, v38, v39
  v_cvt_pk_bf16_f32 v90, v44, v45
  v_mfma_f32_16x16x32_bf16 v[52:55], v[156:159], a[216:219], v[52:55]
  ds_read_b64_tr_b16 a[240:241], v219 offset:17408
  v_cvt_pk_bf16_f32 v91, v46, v47
  v_mfma_f32_16x16x32_bf16 v[52:55], v[160:163], a[220:223], v[52:55]
  s_waitcnt lgkmcnt(9)
  buffer_store_dwordx4 v[88:91], v225, s[28:31], s83 offen offset:2048 sc1
  v_mfma_f32_16x16x32_bf16 v[48:51], v[164:167], v[96:99], v[48:51]
  ds_read_b64_tr_b16 a[242:243], v219 offset:17664
  v_mfma_f32_16x16x32_bf16 v[48:51], v[168:171], v[100:103], v[48:51]
  ds_read_b64_tr_b16 a[244:245], v219 offset:17920
  v_mfma_f32_16x16x32_bf16 v[52:55], v[164:167], v[112:115], v[52:55]
  ds_read_b64_tr_b16 a[246:247], v219 offset:18176
  v_mfma_f32_16x16x32_bf16 v[52:55], v[168:171], v[116:119], v[52:55]
  ds_read_b64_tr_b16 a[248:249], v219 offset:26112
  v_mfma_f32_16x16x32_bf16 v[48:51], v[172:175], v[104:107], v[48:51]
  ds_read_b64_tr_b16 a[250:251], v219 offset:26368
  v_mfma_f32_16x16x32_bf16 v[48:51], v[176:179], v[108:111], v[48:51]
  ds_read_b64_tr_b16 a[252:253], v219 offset:26624
  v_mfma_f32_16x16x32_bf16 v[52:55], v[172:175], v[120:123], v[52:55]
  ds_read_b64_tr_b16 a[254:255], v219 offset:26880
  s_waitcnt vmcnt(16)
  s_barrier
  v_mfma_f32_16x16x32_bf16 v[52:55], v[176:179], v[124:127], v[52:55]
  s_waitcnt lgkmcnt(12)
  s_add_u32 s42, s77, 0
  ds_read_b64_tr_b16 v[148:149], v212 offset:0
  v_mfma_f32_16x16x32_bf16 v[56:59], a[224:227], a[192:195], v[56:59]
  s_mov_b32 m0, s40
  ds_read_b64_tr_b16 v[150:151], v212 offset:256
  v_mfma_f32_16x16x32_bf16 v[56:59], a[228:231], a[196:199], v[56:59]
  ds_read_b64_tr_b16 v[152:153], v212 offset:512
  v_mfma_f32_16x16x32_bf16 v[60:63], a[224:227], a[208:211], v[60:63]
  ds_read_b64_tr_b16 v[154:155], v212 offset:768
  v_mfma_f32_16x16x32_bf16 v[60:63], a[228:231], a[212:215], v[60:63]
  v_cvt_pk_bf16_f32 v84, v48, v49
  v_cvt_pk_bf16_f32 v85, v50, v51
  v_mfma_f32_16x16x32_bf16 v[132:135], a[224:227], a[32:35], v[132:135]
  ds_read_b64_tr_b16 v[156:157], v212 offset:8704
  v_mfma_f32_16x16x32_bf16 v[132:135], a[228:231], a[36:39], v[132:135]
  s_waitcnt lgkmcnt(13)
  ds_read_b64_tr_b16 v[158:159], v212 offset:8960
  v_mfma_f32_16x16x32_bf16 v[56:59], a[232:235], a[200:203], v[56:59]
  ds_read_b64_tr_b16 v[160:161], v212 offset:9216
  v_mfma_f32_16x16x32_bf16 v[56:59], a[236:239], a[204:207], v[56:59]
  ds_read_b64_tr_b16 v[162:163], v212 offset:9472
  v_mfma_f32_16x16x32_bf16 v[60:63], a[232:235], a[216:219], v[60:63]
  buffer_load_dwordx4 v227, s[24:27], s42 offen lds
  v_mfma_f32_16x16x32_bf16 v[60:63], a[236:239], a[220:223], v[60:63]
  ds_read_b64_tr_b16 v[164:165], v212 offset:17408
  v_mfma_f32_16x16x32_bf16 v[132:135], a[232:235], a[40:43], v[132:135]
  ds_read_b64_tr_b16 v[166:167], v212 offset:17664
  v_mfma_f32_16x16x32_bf16 v[132:135], a[236:239], a[44:47], v[132:135]
  s_waitcnt lgkmcnt(14)
  ds_read_b64_tr_b16 v[168:169], v212 offset:17920
  v_mfma_f32_16x16x32_bf16 v[56:59], a[240:243], v[96:99], v[56:59]
  s_add_u32 m0, m0, 32
  ds_read_b64_tr_b16 v[170:171], v212 offset:18176
  v_mfma_f32_16x16x32_bf16 v[56:59], a[244:247], v[100:103], v[56:59]
  buffer_load_dwordx4 v227, s[24:27], s42 offen offset:1024 lds
  v_mfma_f32_16x16x32_bf16 v[60:63], a[240:243], v[112:115], v[60:63]
  ds_read_b64_tr_b16 v[172:173], v212 offset:26112
  v_mfma_f32_16x16x32_bf16 v[60:63], a[244:247], v[116:119], v[60:63]
  ds_read_b64_tr_b16 v[174:175], v212 offset:26368
  v_mfma_f32_16x16x32_bf16 v[132:135], a[240:243], a[48:51], v[132:135]
  ds_read_b64_tr_b16 v[176:177], v212 offset:26624
  v_mfma_f32_16x16x32_bf16 v[132:135], a[244:247], a[52:55], v[132:135]
  s_waitcnt lgkmcnt(15)
  s_add_u32 m0, m0, 32
  ds_read_b64_tr_b16 v[178:179], v212 offset:26880
  v_mfma_f32_16x16x32_bf16 v[56:59], a[248:251], v[104:107], v[56:59]
  ds_read_b64_tr_b16 a[224:225], v213 offset:0
  v_mfma_f32_16x16x32_bf16 v[56:59], a[252:255], v[108:111], v[56:59]
  s_sub_u32 s89, s59, 3
  s_and_b32 s89, s89, 7
  ds_read_b64_tr_b16 a[226:227], v213 offset:256
  v_mfma_f32_16x16x32_bf16 v[60:63], a[248:251], v[120:123], v[60:63]
  s_mul_i32 s90, s89, 18432
  s_lshl_b32 s89, s89, 2
  ds_read_b64_tr_b16 a[228:229], v213 offset:512
  v_mfma_f32_16x16x32_bf16 v[60:63], a[252:255], v[124:127], v[60:63]
  s_add_u32 s89, s89, s62
  s_add_u32 s90, s90, s63
  ds_read_b64_tr_b16 a[230:231], v213 offset:768
  v_mfma_f32_16x16x32_bf16 v[132:135], a[248:251], a[56:59], v[132:135]
  s_add_u32 s91, s90, s64
  buffer_load_dwordx4 v227, s[24:27], s42 offen offset:2048 lds
  v_mfma_f32_16x16x32_bf16 v[132:135], a[252:255], a[60:63], v[132:135]
  s_waitcnt lgkmcnt(12)
  ds_read_b64_tr_b16 a[232:233], v213 offset:8704
  v_mfma_f32_16x16x32_bf16 v[0:3], v[148:151], a[128:131], 0
  ds_read_b64_tr_b16 a[234:235], v213 offset:8960
  v_mfma_f32_16x16x32_bf16 v[0:3], v[152:155], a[132:135], v[0:3]
  ds_read_b64_tr_b16 a[236:237], v213 offset:9216
  v_mfma_f32_16x16x32_bf16 v[4:7], v[148:151], a[144:147], 0
  s_add_u32 m0, m0, 32
  ds_read_b64_tr_b16 a[238:239], v213 offset:9472
  v_mfma_f32_16x16x32_bf16 v[4:7], v[152:155], a[148:151], v[4:7]
  v_cvt_pk_bf16_f32 v86, v56, v57
  v_cvt_pk_bf16_f32 v87, v58, v59
  v_mfma_f32_16x16x32_bf16 v[0:3], v[156:159], a[136:139], v[0:3]
  buffer_store_dwordx4 v[84:87], v225, s[28:31], s83 offen offset:1024 sc1
  v_cvt_pk_bf16_f32 v92, v52, v53
  v_mfma_f32_16x16x32_bf16 v[0:3], v[160:163], a[140:143], v[0:3]
  v_cvt_pk_bf16_f32 v93, v54, v55
  v_cvt_pk_bf16_f32 v94, v60, v61
  v_mfma_f32_16x16x32_bf16 v[4:7], v[156:159], a[152:155], v[4:7]
  buffer_load_dwordx4 v227, s[24:27], s42 offen offset:3072 lds
  v_cvt_pk_bf16_f32 v95, v62, v63
  v_mfma_f32_16x16x32_bf16 v[4:7], v[160:163], a[156:159], v[4:7]
  s_waitcnt lgkmcnt(8)
  buffer_store_dwordx4 v[92:95], v225, s[28:31], s83 offen offset:3072 sc1
  v_cvt_pk_bf16_f32 v236, v132, v133
  v_mfma_f32_16x16x32_bf16 v[0:3], v[164:167], a[160:163], v[0:3]
  v_cvt_pk_bf16_f32 v237, v134, v135
  s_add_u32 s92, s83, s64
  v_mfma_f32_16x16x32_bf16 v[0:3], v[168:171], a[164:167], v[0:3]
  s_nop 0
  buffer_store_dwordx2 v[236:237], v222, s[28:31], s92 offen sc1
  ds_read_b64_tr_b16 a[240:241], v213 offset:17408
  v_mfma_f32_16x16x32_bf16 v[4:7], v[164:167], a[176:179], v[4:7]
  s_add_u32 s42, s42, s52
  ds_read_b64_tr_b16 a[242:243], v213 offset:17664
  ds_read_b64_tr_b16 a[244:245], v213 offset:17920
  v_mfma_f32_16x16x32_bf16 v[4:7], v[168:171], a[180:183], v[4:7]
  s_add_u32 m0, m0, s53
  ds_read_b64_tr_b16 a[246:247], v213 offset:18176
  v_mfma_f32_16x16x32_bf16 v[0:3], v[172:175], a[168:171], v[0:3]
  s_nop 0
  ds_read_b64_tr_b16 a[248:249], v213 offset:26112
  ds_read_b64_tr_b16 a[250:251], v213 offset:26368
  v_mfma_f32_16x16x32_bf16 v[0:3], v[176:179], a[172:175], v[0:3]
  s_nop 0
  ds_read_b64_tr_b16 a[252:253], v213 offset:26624
  ds_read_b64_tr_b16 a[254:255], v213 offset:26880
  v_mfma_f32_16x16x32_bf16 v[4:7], v[172:175], a[184:187], v[4:7]
  buffer_load_dwordx4 v227, s[24:27], s42 offen lds
  v_mfma_f32_16x16x32_bf16 v[4:7], v[176:179], a[188:191], v[4:7]
  s_waitcnt lgkmcnt(8)
  ds_read_b64_tr_b16 v[148:149], v214 offset:0
  ds_read_b64_tr_b16 v[150:151], v214 offset:256
  v_mfma_f32_16x16x32_bf16 v[8:11], a[224:227], a[128:131], 0
  s_nop 0
  ds_read_b64_tr_b16 v[152:153], v214 offset:512
  ds_read_b64_tr_b16 v[154:155], v214 offset:768
  v_mfma_f32_16x16x32_bf16 v[8:11], a[228:231], a[132:135], v[8:11]
  ds_read_b64_tr_b16 v[156:157], v214 offset:8704
  v_mfma_f32_16x16x32_bf16 v[12:15], a[224:227], a[144:147], 0
  s_add_u32 m0, m0, 32
  ds_read_b64_tr_b16 v[158:159], v214 offset:8960
  v_mfma_f32_16x16x32_bf16 v[12:15], a[228:231], a[148:151], v[12:15]
  buffer_load_dwordx4 v227, s[24:27], s42 offen offset:1024 lds
  v_mfma_f32_16x16x32_bf16 v[8:11], a[232:235], a[136:139], v[8:11]
  s_nop 0
  ds_read_b64_tr_b16 v[160:161], v214 offset:9216
  ds_read_b64_tr_b16 v[162:163], v214 offset:9472
  v_mfma_f32_16x16x32_bf16 v[8:11], a[236:239], a[140:143], v[8:11]
  ds_read_b64_tr_b16 v[164:165], v214 offset:17408
  v_mfma_f32_16x16x32_bf16 v[12:15], a[232:235], a[152:155], v[12:15]
  ds_read_b64_tr_b16 v[166:167], v214 offset:17664
  v_mfma_f32_16x16x32_bf16 v[12:15], a[236:239], a[156:159], v[12:15]
  s_waitcnt lgkmcnt(10)
  s_add_u32 m0, m0, 32
  ds_read_b64_tr_b16 v[168:169], v214 offset:17920
  v_mfma_f32_16x16x32_bf16 v[8:11], a[240:243], a[160:163], v[8:11]
  s_nop 0
  ds_read_b64_tr_b16 v[170:171], v214 offset:18176
  buffer_load_dwordx4 v227, s[24:27], s42 offen offset:2048 lds
  v_mfma_f32_16x16x32_bf16 v[8:11], a[244:247], a[164:167], v[8:11]
  buffer_load_dword v229, off, s[28:31], s89 sc1
  s_add_u32 s43, s59, 4
  s_and_b32 s43, s43, 7
  v_mfma_f32_16x16x32_bf16 v[12:15], a[240:243], a[176:179], v[12:15]
  s_lshl_b32 s43, s43, 9
  s_add_u32 s43, s43, s61
  ds_read_b64_tr_b16 v[172:173], v214 offset:26112
  v_mfma_f32_16x16x32_bf16 v[12:15], a[244:247], a[180:183], v[12:15]
  ds_read_b64_tr_b16 v[174:175], v214 offset:26368
  v_mfma_f32_16x16x32_bf16 v[8:11], a[248:251], a[168:171], v[8:11]
  s_nop 0
  ds_read_b64_tr_b16 v[176:177], v214 offset:26624
  ds_read_b64_tr_b16 v[178:179], v214 offset:26880
  v_mfma_f32_16x16x32_bf16 v[8:11], a[252:255], a[172:175], v[8:11]
  s_add_u32 m0, m0, 32
  ds_read_b64_tr_b16 a[224:225], v215 offset:0
  v_mfma_f32_16x16x32_bf16 v[12:15], a[248:251], a[184:187], v[12:15]
  buffer_load_dwordx4 v227, s[24:27], s42 offen offset:3072 lds
  v_mfma_f32_16x16x32_bf16 v[12:15], a[252:255], a[188:191], v[12:15]
  s_waitcnt lgkmcnt(9)
  ds_read_b64_tr_b16 a[226:227], v215 offset:256
  v_mfma_f32_16x16x32_bf16 v[16:19], v[148:151], a[128:131], 0
  s_nop 0
  ds_read_b64_tr_b16 a[228:229], v215 offset:512
  ds_read_b64_tr_b16 a[230:231], v215 offset:768
  v_mfma_f32_16x16x32_bf16 v[16:19], v[152:155], a[132:135], v[16:19]
  ds_read_b64_tr_b16 a[232:233], v215 offset:8704
  v_mfma_f32_16x16x32_bf16 v[20:23], v[148:151], a[144:147], 0
  ds_read_b64_tr_b16 a[234:235], v215 offset:8960
  v_mfma_f32_16x16x32_bf16 v[20:23], v[152:155], a[148:151], v[20:23]
  ds_read_b64_tr_b16 a[236:237], v215 offset:9216
  v_mfma_f32_16x16x32_bf16 v[16:19], v[156:159], a[136:139], v[16:19]
  ds_read_b64_tr_b16 a[238:239], v215 offset:9472
  v_mfma_f32_16x16x32_bf16 v[16:19], v[160:163], a[140:143], v[16:19]
  ds_read_b64_tr_b16 a[240:241], v215 offset:17408
  v_mfma_f32_16x16x32_bf16 v[20:23], v[156:159], a[152:155], v[20:23]
  ds_read_b64_tr_b16 a[242:243], v215 offset:17664
  v_mfma_f32_16x16x32_bf16 v[20:23], v[160:163], a[156:159], v[20:23]
  s_waitcnt lgkmcnt(10)
  ds_read_b64_tr_b16 a[244:245], v215 offset:17920
  v_mfma_f32_16x16x32_bf16 v[16:19], v[164:167], a[160:163], v[16:19]
  ds_read_b64_tr_b16 a[246:247], v215 offset:18176
  v_mfma_f32_16x16x32_bf16 v[16:19], v[168:171], a[164:167], v[16:19]
  ds_read_b64_tr_b16 a[248:249], v215 offset:26112
  v_mfma_f32_16x16x32_bf16 v[20:23], v[164:167], a[176:179], v[20:23]
  ds_read_b64_tr_b16 a[250:251], v215 offset:26368
  v_mfma_f32_16x16x32_bf16 v[20:23], v[168:171], a[180:183], v[20:23]
  ds_read_b64_tr_b16 a[252:253], v215 offset:26624
  v_mfma_f32_16x16x32_bf16 v[16:19], v[172:175], a[168:171], v[16:19]
  ds_read_b64_tr_b16 a[254:255], v215 offset:26880
  s_waitcnt vmcnt(20)
  s_barrier
  v_mfma_f32_16x16x32_bf16 v[16:19], v[176:179], a[172:175], v[16:19]
  s_add_u32 s42, s77, 262144
  s_mov_b32 m0, s38
  ds_read_b64_tr_b16 v[148:149], v212 offset:34816
  v_mfma_f32_16x16x32_bf16 v[20:23], v[172:175], a[184:187], v[20:23]
  buffer_load_dwordx4 v227, s[24:27], s42 offen lds
  v_mfma_f32_16x16x32_bf16 v[20:23], v[176:179], a[188:191], v[20:23]
  s_waitcnt lgkmcnt(13)
  ds_read_b64_tr_b16 v[150:151], v212 offset:35072
  v_mfma_f32_16x16x32_bf16 v[24:27], a[224:227], a[128:131], 0
  ds_read_b64_tr_b16 v[152:153], v212 offset:35328
  v_mfma_f32_16x16x32_bf16 v[24:27], a[228:231], a[132:135], v[24:27]
  ds_read_b64_tr_b16 v[154:155], v212 offset:35584
  v_mfma_f32_16x16x32_bf16 v[28:31], a[224:227], a[144:147], 0
  s_add_u32 m0, m0, 32
  ds_read_b64_tr_b16 v[156:157], v212 offset:43520
  v_mfma_f32_16x16x32_bf16 v[28:31], a[228:231], a[148:151], v[28:31]
  buffer_load_dwordx4 v227, s[24:27], s42 offen offset:1024 lds
  v_mfma_f32_16x16x32_bf16 v[128:131], a[224:227], a[0:3], 0
  ds_read_b64_tr_b16 v[158:159], v212 offset:43776
  v_mfma_f32_16x16x32_bf16 v[128:131], a[228:231], a[4:7], v[128:131]
  s_waitcnt lgkmcnt(14)
  ds_read_b64_tr_b16 v[160:161], v212 offset:44032
  v_mfma_f32_16x16x32_bf16 v[24:27], a[232:235], a[136:139], v[24:27]
  ds_read_b64_tr_b16 v[162:163], v212 offset:44288
  v_mfma_f32_16x16x32_bf16 v[24:27], a[236:239], a[140:143], v[24:27]
  s_add_u32 m0, m0, 32
  ds_read_b64_tr_b16 v[164:165], v212 offset:52224
  v_mfma_f32_16x16x32_bf16 v[28:31], a[232:235], a[152:155], v[28:31]
  ds_read_b64_tr_b16 v[166:167], v212 offset:52480
  v_mfma_f32_16x16x32_bf16 v[28:31], a[236:239], a[156:159], v[28:31]
  buffer_load_dwordx4 v227, s[24:27], s42 offen offset:2048 lds
  v_mfma_f32_16x16x32_bf16 v[128:131], a[232:235], a[8:11], v[128:131]
  ds_read_b64_tr_b16 v[168:169], v212 offset:52736
  v_mfma_f32_16x16x32_bf16 v[128:131], a[236:239], a[12:15], v[128:131]
  s_waitcnt lgkmcnt(15)
  ds_read_b64_tr_b16 v[170:171], v212 offset:52992
  v_mfma_f32_16x16x32_bf16 v[24:27], a[240:243], a[160:163], v[24:27]
  ds_read_b64_tr_b16 v[172:173], v212 offset:60928
  v_mfma_f32_16x16x32_bf16 v[24:27], a[244:247], a[164:167], v[24:27]
  s_add_u32 m0, m0, 32
  ds_read_b64_tr_b16 v[174:175], v212 offset:61184
  v_mfma_f32_16x16x32_bf16 v[28:31], a[240:243], a[176:179], v[28:31]
  ds_read_b64_tr_b16 v[176:177], v212 offset:61440
  v_mfma_f32_16x16x32_bf16 v[28:31], a[244:247], a[180:183], v[28:31]
  ds_read_b64_tr_b16 v[178:179], v212 offset:61696
  v_mfma_f32_16x16x32_bf16 v[128:131], a[240:243], a[16:19], v[128:131]
  buffer_load_dwordx4 v227, s[24:27], s42 offen offset:3072 lds
  v_mfma_f32_16x16x32_bf16 v[128:131], a[244:247], a[20:23], v[128:131]
  s_waitcnt lgkmcnt(15)
  ds_read_b64_tr_b16 a[224:225], v213 offset:34816
  v_mfma_f32_16x16x32_bf16 v[24:27], a[248:251], a[168:171], v[24:27]
  ds_read_b64_tr_b16 a[226:227], v213 offset:35072
  v_mfma_f32_16x16x32_bf16 v[24:27], a[252:255], a[172:175], v[24:27]
  ds_read_b64_tr_b16 a[228:229], v213 offset:35328
  v_mfma_f32_16x16x32_bf16 v[28:31], a[248:251], a[184:187], v[28:31]
  s_add_u32 s42, s42, s52
  s_add_u32 m0, m0, s53
  ds_read_b64_tr_b16 a[230:231], v213 offset:35584
  v_mfma_f32_16x16x32_bf16 v[28:31], a[252:255], a[188:191], v[28:31]
  ds_read_b64_tr_b16 a[232:233], v213 offset:43520
  v_mfma_f32_16x16x32_bf16 v[128:131], a[248:251], a[24:27], v[128:131]
  s_waitcnt vmcnt(18)
  ds_read_b64_tr_b16 a[234:235], v213 offset:43776
  v_mfma_f32_16x16x32_bf16 v[128:131], a[252:255], a[28:31], v[128:131]
  buffer_load_dwordx4 v227, s[24:27], s42 offen lds
  v_mfma_f32_16x16x32_bf16 v[180:183], v[142:145], a[84:87], v[180:183]
  ds_read_b64_tr_b16 a[236:237], v213 offset:44032
  v_mfma_f32_16x16x32_bf16 v[188:191], v[140:143], a[84:87], v[188:191]
  ds_read_b64_tr_b16 a[238:239], v213 offset:44288
  v_mfma_f32_16x16x32_bf16 v[196:199], v[142:145], a[88:91], v[196:199]
  ds_read_b64_tr_b16 a[240:241], v213 offset:52224
  v_mfma_f32_16x16x32_bf16 v[204:207], v[140:143], a[88:91], v[204:207]
  s_add_u32 m0, m0, 32
  ds_read_b64_tr_b16 a[242:243], v213 offset:52480
  v_mfma_f32_16x16x32_bf16 v[184:187], v[142:145], a[92:95], v[184:187]
  ds_read_b64_tr_b16 a[244:245], v213 offset:52736
  v_mfma_f32_16x16x32_bf16 v[192:195], v[140:143], a[92:95], v[192:195]
  ds_read_b64_tr_b16 a[246:247], v213 offset:52992
  v_mfma_f32_16x16x32_bf16 v[200:203], v[142:145], a[96:99], v[200:203]
  buffer_load_dwordx4 v227, s[24:27], s42 offen offset:1024 lds
  v_mfma_f32_16x16x32_bf16 v[208:211], v[140:143], a[96:99], v[208:211]
  ds_read_b64_tr_b16 a[248:249], v213 offset:60928
  v_mfma_f32_16x16x32_bf16 v[136:139], v[142:145], a[100:103], v[136:139]
  s_waitcnt lgkmcnt(15)
  ds_read_b64_tr_b16 a[250:251], v213 offset:61184
  v_mfma_f32_16x16x32_bf16 v[0:3], v[148:151], a[192:195], v[0:3]
  ds_read_b64_tr_b16 a[252:253], v213 offset:61440
  v_mfma_f32_16x16x32_bf16 v[0:3], v[152:155], a[196:199], v[0:3]
  s_add_u32 m0, m0, 32
  ds_read_b64_tr_b16 a[254:255], v213 offset:61696
  v_mfma_f32_16x16x32_bf16 v[4:7], v[148:151], a[208:211], v[4:7]
  ds_read_b64_tr_b16 v[148:149], v214 offset:34816
  v_mfma_f32_16x16x32_bf16 v[4:7], v[152:155], a[212:215], v[4:7]
  ds_read_b64_tr_b16 v[150:151], v214 offset:35072
  v_mfma_f32_16x16x32_bf16 v[0:3], v[156:159], a[200:203], v[0:3]
  buffer_load_dwordx4 v227, s[24:27], s42 offen offset:2048 lds
  v_mfma_f32_16x16x32_bf16 v[0:3], v[160:163], a[204:207], v[0:3]
  ds_read_b64_tr_b16 v[152:153], v214 offset:35328
  v_mfma_f32_16x16x32_bf16 v[4:7], v[156:159], a[216:219], v[4:7]
  ds_read_b64_tr_b16 v[154:155], v214 offset:35584
  v_mfma_f32_16x16x32_bf16 v[4:7], v[160:163], a[220:223], v[4:7]
  s_waitcnt lgkmcnt(15)
  ds_read_b64_tr_b16 v[156:157], v214 offset:43520
  v_mfma_f32_16x16x32_bf16 v[0:3], v[164:167], v[96:99], v[0:3]
  s_add_u32 m0, m0, 32
  ds_read_b64_tr_b16 v[158:159], v214 offset:43776
  v_mfma_f32_16x16x32_bf16 v[0:3], v[168:171], v[100:103], v[0:3]
  ds_read_b64_tr_b16 v[160:161], v214 offset:44032
  v_mfma_f32_16x16x32_bf16 v[4:7], v[164:167], v[112:115], v[4:7]
  ds_read_b64_tr_b16 v[162:163], v214 offset:44288
  v_mfma_f32_16x16x32_bf16 v[4:7], v[168:171], v[116:119], v[4:7]
  buffer_load_dwordx4 v227, s[24:27], s42 offen offset:3072 lds
  v_mfma_f32_16x16x32_bf16 v[0:3], v[172:175], v[104:107], v[0:3]
  ds_read_b64_tr_b16 v[164:165], v214 offset:52224
  v_mfma_f32_16x16x32_bf16 v[0:3], v[176:179], v[108:111], v[0:3]
  ds_read_b64_tr_b16 v[166:167], v214 offset:52480
  v_mfma_f32_16x16x32_bf16 v[4:7], v[172:175], v[120:123], v[4:7]
  s_waitcnt vmcnt(13)
  buffer_store_dword v228, off, s[28:31], s43 sc1
  ds_read_b64_tr_b16 v[168:169], v214 offset:52736
  v_mfma_f32_16x16x32_bf16 v[4:7], v[176:179], v[124:127], v[4:7]
  s_waitcnt lgkmcnt(15)
  s_waitcnt vmcnt(10)
  v_readfirstlane_b32 s65, v229
  s_cmp_ge_u32 s65, 1
  s_cbranch_scc0 L_spin2
L_spin2_back:
  v_mfma_f32_16x16x32_bf16 v[8:11], a[224:227], a[192:195], v[8:11]
  ds_read_b64_tr_b16 v[170:171], v214 offset:52992
  v_mfma_f32_16x16x32_bf16 v[8:11], a[228:231], a[196:199], v[8:11]
  ds_read_b64_tr_b16 v[172:173], v214 offset:60928
  v_mfma_f32_16x16x32_bf16 v[12:15], a[224:227], a[208:211], v[12:15]
  buffer_load_dwordx4 a[104:107], v225, s[28:31], s90 offen offset:0 sc1
  v_mfma_f32_16x16x32_bf16 v[12:15], a[228:231], a[212:215], v[12:15]
  v_cvt_pk_bf16_f32 v64, v0, v1
  v_cvt_pk_bf16_f32 v65, v2, v3
  v_mfma_f32_16x16x32_bf16 v[8:11], a[232:235], a[200:203], v[8:11]
  ds_read_b64_tr_b16 v[174:175], v214 offset:61184
  v_mfma_f32_16x16x32_bf16 v[8:11], a[236:239], a[204:207], v[8:11]
  buffer_load_dwordx4 a[108:111], v225, s[28:31], s90 offen offset:1024 sc1
  v_mfma_f32_16x16x32_bf16 v[12:15], a[232:235], a[216:219], v[12:15]
  ds_read_b64_tr_b16 v[176:177], v214 offset:61440
  v_mfma_f32_16x16x32_bf16 v[12:15], a[236:239], a[220:223], v[12:15]
  s_waitcnt lgkmcnt(15)
  ds_read_b64_tr_b16 v[178:179], v214 offset:61696
  v_mfma_f32_16x16x32_bf16 v[8:11], a[240:243], v[96:99], v[8:11]
  buffer_load_dwordx4 a[112:115], v225, s[28:31], s90 offen offset:2048 sc1
  v_mfma_f32_16x16x32_bf16 v[8:11], a[244:247], v[100:103], v[8:11]
  ds_read_b64_tr_b16 a[224:225], v215 offset:34816
  v_mfma_f32_16x16x32_bf16 v[12:15], a[240:243], v[112:115], v[12:15]
  ds_read_b64_tr_b16 a[226:227], v215 offset:35072
  v_mfma_f32_16x16x32_bf16 v[12:15], a[244:247], v[116:119], v[12:15]
  buffer_load_dwordx4 a[116:119], v225, s[28:31], s90 offen offset:3072 sc1
  v_mfma_f32_16x16x32_bf16 v[8:11], a[248:251], v[104:107], v[8:11]
  ds_read_b64_tr_b16 a[228:229], v215 offset:35328
  v_mfma_f32_16x16x32_bf16 v[8:11], a[252:255], v[108:111], v[8:11]
  ds_read_b64_tr_b16 a[230:231], v215 offset:35584
  v_mfma_f32_16x16x32_bf16 v[12:15], a[248:251], v[120:123], v[12:15]
  buffer_load_dwordx2 a[120:121], v222, s[28:31], s91 offen sc1
  v_mfma_f32_16x16x32_bf16 v[12:15], a[252:255], v[124:127], v[12:15]
  s_waitcnt lgkmcnt(12)
  ds_read_b64_tr_b16 a[232:233], v215 offset:43520
  v_mfma_f32_16x16x32_bf16 v[16:19], v[148:151], a[192:195], v[16:19]
  ds_read_b64_tr_b16 a[234:235], v215 offset:43776
  v_mfma_f32_16x16x32_bf16 v[16:19], v[152:155], a[196:199], v[16:19]
  ds_read_b64_tr_b16 a[236:237], v215 offset:44032
  v_mfma_f32_16x16x32_bf16 v[20:23], v[148:151], a[208:211], v[20:23]
  ds_read_b64_tr_b16 a[238:239], v215 offset:44288
  v_mfma_f32_16x16x32_bf16 v[20:23], v[152:155], a[212:215], v[20:23]
  v_cvt_pk_bf16_f32 v66, v8, v9
  v_cvt_pk_bf16_f32 v67, v10, v11
  v_mfma_f32_16x16x32_bf16 v[16:19], v[156:159], a[200:203], v[16:19]
  buffer_store_dwordx4 v[64:67], v225, s[28:31], s84 offen offset:0 sc1
  v_cvt_pk_bf16_f32 v72, v4, v5
  v_mfma_f32_16x16x32_bf16 v[16:19], v[160:163], a[204:207], v[16:19]
  v_cvt_pk_bf16_f32 v73, v6, v7
  v_cvt_pk_bf16_f32 v74, v12, v13
  v_mfma_f32_16x16x32_bf16 v[20:23], v[156:159], a[216:219], v[20:23]
  ds_read_b64_tr_b16 a[240:241], v215 offset:52224
  v_cvt_pk_bf16_f32 v75, v14, v15
  v_mfma_f32_16x16x32_bf16 v[20:23], v[160:163], a[220:223], v[20:23]
  s_waitcnt lgkmcnt(9)
  buffer_store_dwordx4 v[72:75], v225, s[28:31], s84 offen offset:2048 sc1
  v_mfma_f32_16x16x32_bf16 v[16:19], v[164:167], v[96:99], v[16:19]
  ds_read_b64_tr_b16 a[242:243], v215 offset:52480
  v_mfma_f32_16x16x32_bf16 v[16:19], v[168:171], v[100:103], v[16:19]
  ds_read_b64_tr_b16 a[244:245], v215 offset:52736
  v_mfma_f32_16x16x32_bf16 v[20:23], v[164:167], v[112:115], v[20:23]
  ds_read_b64_tr_b16 a[246:247], v215 offset:52992
  v_mfma_f32_16x16x32_bf16 v[20:23], v[168:171], v[116:119], v[20:23]
  ds_read_b64_tr_b16 a[248:249], v215 offset:60928
  v_mfma_f32_16x16x32_bf16 v[16:19], v[172:175], v[104:107], v[16:19]
  ds_read_b64_tr_b16 a[250:251], v215 offset:61184
  v_mfma_f32_16x16x32_bf16 v[16:19], v[176:179], v[108:111], v[16:19]
  ds_read_b64_tr_b16 a[252:253], v215 offset:61440
  v_mfma_f32_16x16x32_bf16 v[20:23], v[172:175], v[120:123], v[20:23]
  ds_read_b64_tr_b16 a[254:255], v215 offset:61696
  s_waitcnt vmcnt(16)
  s_barrier
  v_mfma_f32_16x16x32_bf16 v[20:23], v[176:179], v[124:127], v[20:23]
  s_waitcnt lgkmcnt(12)
  s_add_u32 s42, s78, 0
  ds_read_b64_tr_b16 v[148:149], v216 offset:34816
  v_mfma_f32_16x16x32_bf16 v[24:27], a[224:227], a[192:195], v[24:27]
  s_mov_b32 m0, s37
  ds_read_b64_tr_b16 v[150:151], v216 offset:35072
  v_mfma_f32_16x16x32_bf16 v[24:27], a[228:231], a[196:199], v[24:27]
  ds_read_b64_tr_b16 v[152:153], v216 offset:35328
  v_mfma_f32_16x16x32_bf16 v[28:31], a[224:227], a[208:211], v[28:31]
  ds_read_b64_tr_b16 v[154:155], v216 offset:35584
  v_mfma_f32_16x16x32_bf16 v[28:31], a[228:231], a[212:215], v[28:31]
  v_cvt_pk_bf16_f32 v68, v16, v17
  v_cvt_pk_bf16_f32 v69, v18, v19
  v_mfma_f32_16x16x32_bf16 v[128:131], a[224:227], a[32:35], v[128:131]
  ds_read_b64_tr_b16 v[156:157], v216 offset:43520
  v_mfma_f32_16x16x32_bf16 v[128:131], a[228:231], a[36:39], v[128:131]
  s_waitcnt lgkmcnt(13)
  ds_read_b64_tr_b16 v[158:159], v216 offset:43776
  v_mfma_f32_16x16x32_bf16 v[24:27], a[232:235], a[200:203], v[24:27]
  ds_read_b64_tr_b16 v[160:161], v216 offset:44032
  v_mfma_f32_16x16x32_bf16 v[24:27], a[236:239], a[204:207], v[24:27]
  ds_read_b64_tr_b16 v[162:163], v216 offset:44288
  v_mfma_f32_16x16x32_bf16 v[28:31], a[232:235], a[216:219], v[28:31]
  buffer_load_dwordx4 v227, s[24:27], s42 offen lds
  v_mfma_f32_16x16x32_bf16 v[28:31], a[236:239], a[220:223], v[28:31]
  ds_read_b64_tr_b16 v[164:165], v216 offset:52224
  v_mfma_f32_16x16x32_bf16 v[128:131], a[232:235], a[40:43], v[128:131]
  ds_read_b64_tr_b16 v[166:167], v216 offset:52480
  v_mfma_f32_16x16x32_bf16 v[128:131], a[236:239], a[44:47], v[128:131]
  s_waitcnt lgkmcnt(14)
  ds_read_b64_tr_b16 v[168:169], v216 offset:52736
  v_mfma_f32_16x16x32_bf16 v[24:27], a[240:243], v[96:99], v[24:27]
  s_add_u32 m0, m0, 32
  ds_read_b64_tr_b16 v[170:171], v216 offset:52992
  v_mfma_f32_16x16x32_bf16 v[24:27], a[244:247], v[100:103], v[24:27]
  buffer_load_dwordx4 v227, s[24:27], s42 offen offset:1024 lds
  v_mfma_f32_16x16x32_bf16 v[28:31], a[240:243], v[112:115], v[28:31]
  ds_read_b64_tr_b16 v[172:173], v216 offset:60928
  v_mfma_f32_16x16x32_bf16 v[28:31], a[244:247], v[116:119], v[28:31]
  ds_read_b64_tr_b16 v[174:175], v216 offset:61184
  v_mfma_f32_16x16x32_bf16 v[128:131], a[240:243], a[48:51], v[128:131]
  ds_read_b64_tr_b16 v[176:177], v216 offset:61440
  v_mfma_f32_16x16x32_bf16 v[128:131], a[244:247], a[52:55], v[128:131]
  s_waitcnt lgkmcnt(15)
  s_add_u32 m0, m0, 32
  ds_read_b64_tr_b16 v[178:179], v216 offset:61696
  v_mfma_f32_16x16x32_bf16 v[24:27], a[248:251], v[104:107], v[24:27]
  ds_read_b64_tr_b16 a[224:225], v217 offset:34816
  v_mfma_f32_16x16x32_bf16 v[24:27], a[252:255], v[108:111], v[24:27]
  s_sub_u32 s89, s59, 4
  s_and_b32 s89, s89, 7
  ds_read_b64_tr_b16 a[226:227], v217 offset:35072
  v_mfma_f32_16x16x32_bf16 v[28:31], a[248:251], v[120:123], v[28:31]
  s_mul_i32 s90, s89, 18432
  s_lshl_b32 s89, s89, 2
  ds_read_b64_tr_b16 a[228:229], v217 offset:35328
  v_mfma_f32_16x16x32_bf16 v[28:31], a[252:255], v[124:127], v[28:31]
  s_add_u32 s89, s89, s62
  s_add_u32 s90, s90, s63
  ds_read_b64_tr_b16 a[230:231], v217 offset:35584
  v_mfma_f32_16x16x32_bf16 v[128:131], a[248:251], a[56:59], v[128:131]
  s_add_u32 s91, s90, s64
  buffer_load_dwordx4 v227, s[24:27], s42 offen offset:2048 lds
  v_mfma_f32_16x16x32_bf16 v[128:131], a[252:255], a[60:63], v[128:131]
  s_waitcnt lgkmcnt(12)
  ds_read_b64_tr_b16 a[232:233], v217 offset:43520
  v_mfma_f32_16x16x32_bf16 v[32:35], v[148:151], a[128:131], 0
  ds_read_b64_tr_b16 a[234:235], v217 offset:43776
  v_mfma_f32_16x16x32_bf16 v[32:35], v[152:155], a[132:135], v[32:35]
  ds_read_b64_tr_b16 a[236:237], v217 offset:44032
  v_mfma_f32_16x16x32_bf16 v[36:39], v[148:151], a[144:147], 0
  s_add_u32 m0, m0, 32
  ds_read_b64_tr_b16 a[238:239], v217 offset:44288
  v_mfma_f32_16x16x32_bf16 v[36:39], v[152:155], a[148:151], v[36:39]
  v_cvt_pk_bf16_f32 v70, v24, v25
  v_cvt_pk_bf16_f32 v71, v26, v27
  v_mfma_f32_16x16x32_bf16 v[32:35], v[156:159], a[136:139], v[32:35]
  buffer_store_dwordx4 v[68:71], v225, s[28:31], s84 offen offset:1024 sc1
  v_cvt_pk_bf16_f32 v76, v20, v21
  v_mfma_f32_16x16x32_bf16 v[32:35], v[160:163], a[140:143], v[32:35]
  v_cvt_pk_bf16_f32 v77, v22, v23
  v_cvt_pk_bf16_f32 v78, v28, v29
  v_mfma_f32_16x16x32_bf16 v[36:39], v[156:159], a[152:155], v[36:39]
  buffer_load_dwordx4 v227, s[24:27], s42 offen offset:3072 lds
  v_cvt_pk_bf16_f32 v79, v30, v31
  v_mfma_f32_16x16x32_bf16 v[36:39], v[160:163], a[156:159], v[36:39]
  s_waitcnt lgkmcnt(8)
  buffer_store_dwordx4 v[76:79], v225, s[28:31], s84 offen offset:3072 sc1
  v_cvt_pk_bf16_f32 v232, v128, v129
  v_mfma_f32_16x16x32_bf16 v[32:35], v[164:167], a[160:163], v[32:35]
  v_cvt_pk_bf16_f32 v233, v130, v131
  s_add_u32 s92, s84, s64
  v_mfma_f32_16x16x32_bf16 v[32:35], v[168:171], a[164:167], v[32:35]
  s_nop 0
  buffer_store_dwordx2 v[232:233], v222, s[28:31], s92 offen sc1
  ds_read_b64_tr_b16 a[240:241], v217 offset:52224
  v_mfma_f32_16x16x32_bf16 v[36:39], v[164:167], a[176:179], v[36:39]
  s_add_u32 s42, s42, s52
  ds_read_b64_tr_b16 a[242:243], v217 offset:52480
  ds_read_b64_tr_b16 a[244:245], v217 offset:52736
  v_mfma_f32_16x16x32_bf16 v[36:39], v[168:171], a[180:183], v[36:39]
  s_add_u32 m0, m0, s53
  ds_read_b64_tr_b16 a[246:247], v217 offset:52992
  v_mfma_f32_16x16x32_bf16 v[32:35], v[172:175], a[168:171], v[32:35]
  s_nop 0
  ds_read_b64_tr_b16 a[248:249], v217 offset:60928
  ds_read_b64_tr_b16 a[250:251], v217 offset:61184
  v_mfma_f32_16x16x32_bf16 v[32:35], v[176:179], a[172:175], v[32:35]
  s_nop 0
  ds_read_b64_tr_b16 a[252:253], v217 offset:61440
  ds_read_b64_tr_b16 a[254:255], v217 offset:61696
  v_mfma_f32_16x16x32_bf16 v[36:39], v[172:175], a[184:187], v[36:39]
  buffer_load_dwordx4 v227, s[24:27], s42 offen lds
  v_mfma_f32_16x16x32_bf16 v[36:39], v[176:179], a[188:191], v[36:39]
  s_waitcnt lgkmcnt(8)
  ds_read_b64_tr_b16 v[148:149], v218 offset:34816
  ds_read_b64_tr_b16 v[150:151], v218 offset:35072
  v_mfma_f32_16x16x32_bf16 v[40:43], a[224:227], a[128:131], 0
  s_nop 0
  ds_read_b64_tr_b16 v[152:153], v218 offset:35328
  ds_read_b64_tr_b16 v[154:155], v218 offset:35584
  v_mfma_f32_16x16x32_bf16 v[40:43], a[228:231], a[132:135], v[40:43]
  ds_read_b64_tr_b16 v[156:157], v218 offset:43520
  v_mfma_f32_16x16x32_bf16 v[44:47], a[224:227], a[144:147], 0
  s_add_u32 m0, m0, 32
  ds_read_b64_tr_b16 v[158:159], v218 offset:43776
  v_mfma_f32_16x16x32_bf16 v[44:47], a[228:231], a[148:151], v[44:47]
  buffer_load_dwordx4 v227, s[24:27], s42 offen offset:1024 lds
  v_mfma_f32_16x16x32_bf16 v[40:43], a[232:235], a[136:139], v[40:43]
  s_nop 0
  ds_read_b64_tr_b16 v[160:161], v218 offset:44032
  ds_read_b64_tr_b16 v[162:163], v218 offset:44288
  v_mfma_f32_16x16x32_bf16 v[40:43], a[236:239], a[140:143], v[40:43]
  ds_read_b64_tr_b16 v[164:165], v218 offset:52224
  v_mfma_f32_16x16x32_bf16 v[44:47], a[232:235], a[152:155], v[44:47]
  ds_read_b64_tr_b16 v[166:167], v218 offset:52480
  v_mfma_f32_16x16x32_bf16 v[44:47], a[236:239], a[156:159], v[44:47]
  s_waitcnt lgkmcnt(10)
  s_add_u32 m0, m0, 32
  ds_read_b64_tr_b16 v[168:169], v218 offset:52736
  v_mfma_f32_16x16x32_bf16 v[40:43], a[240:243], a[160:163], v[40:43]
  s_nop 0
  ds_read_b64_tr_b16 v[170:171], v218 offset:52992
  buffer_load_dwordx4 v227, s[24:27], s42 offen offset:2048 lds
  v_mfma_f32_16x16x32_bf16 v[40:43], a[244:247], a[164:167], v[40:43]
  buffer_load_dword v229, off, s[28:31], s89 sc1
  s_add_u32 s43, s59, 5
  s_and_b32 s43, s43, 7
  v_mfma_f32_16x16x32_bf16 v[44:47], a[240:243], a[176:179], v[44:47]
  s_lshl_b32 s43, s43, 9
  s_add_u32 s43, s43, s61
  ds_read_b64_tr_b16 v[172:173], v218 offset:60928
  v_mfma_f32_16x16x32_bf16 v[44:47], a[244:247], a[180:183], v[44:47]
  ds_read_b64_tr_b16 v[174:175], v218 offset:61184
  v_mfma_f32_16x16x32_bf16 v[40:43], a[248:251], a[168:171], v[40:43]
  s_nop 0
  ds_read_b64_tr_b16 v[176:177], v218 offset:61440
  ds_read_b64_tr_b16 v[178:179], v218 offset:61696
  v_mfma_f32_16x16x32_bf16 v[40:43], a[252:255], a[172:175], v[40:43]
  s_add_u32 m0, m0, 32
  ds_read_b64_tr_b16 a[224:225], v219 offset:34816
  v_mfma_f32_16x16x32_bf16 v[44:47], a[248:251], a[184:187], v[44:47]
  buffer_load_dwordx4 v227, s[24:27], s42 offen offset:3072 lds
  v_mfma_f32_16x16x32_bf16 v[44:47], a[252:255], a[188:191], v[44:47]
  s_waitcnt lgkmcnt(9)
  ds_read_b64_tr_b16 a[226:227], v219 offset:35072
  v_mfma_f32_16x16x32_bf16 v[48:51], v[148:151], a[128:131], 0
  s_nop 0
  ds_read_b64_tr_b16 a[228:229], v219 offset:35328
  ds_read_b64_tr_b16 a[230:231], v219 offset:35584
  v_mfma_f32_16x16x32_bf16 v[48:51], v[152:155], a[132:135], v[48:51]
  ds_read_b64_tr_b16 a[232:233], v219 offset:43520
  v_mfma_f32_16x16x32_bf16 v[52:55], v[148:151], a[144:147], 0
  ds_read_b64_tr_b16 a[234:235], v219 offset:43776
  v_mfma_f32_16x16x32_bf16 v[52:55], v[152:155], a[148:151], v[52:55]
  ds_read_b64_tr_b16 a[236:237], v219 offset:44032
  v_mfma_f32_16x16x32_bf16 v[48:51], v[156:159], a[136:139], v[48:51]
  ds_read_b64_tr_b16 a[238:239], v219 offset:44288
  v_mfma_f32_16x16x32_bf16 v[48:51], v[160:163], a[140:143], v[48:51]
  ds_read_b64_tr_b16 a[240:241], v219 offset:52224
  v_mfma_f32_16x16x32_bf16 v[52:55], v[156:159], a[152:155], v[52:55]
  ds_read_b64_tr_b16 a[242:243], v219 offset:52480
  v_mfma_f32_16x16x32_bf16 v[52:55], v[160:163], a[156:159], v[52:55]
  s_waitcnt lgkmcnt(10)
  ds_read_b64_tr_b16 a[244:245], v219 offset:52736
  v_mfma_f32_16x16x32_bf16 v[48:51], v[164:167], a[160:163], v[48:51]
  ds_read_b64_tr_b16 a[246:247], v219 offset:52992
  v_mfma_f32_16x16x32_bf16 v[48:51], v[168:171], a[164:167], v[48:51]
  ds_read_b64_tr_b16 a[248:249], v219 offset:60928
  v_mfma_f32_16x16x32_bf16 v[52:55], v[164:167], a[176:179], v[52:55]
  ds_read_b64_tr_b16 a[250:251], v219 offset:61184
  v_mfma_f32_16x16x32_bf16 v[52:55], v[168:171], a[180:183], v[52:55]
  ds_read_b64_tr_b16 a[252:253], v219 offset:61440
  v_mfma_f32_16x16x32_bf16 v[48:51], v[172:175], a[168:171], v[48:51]
  ds_read_b64_tr_b16 a[254:255], v219 offset:61696
  s_waitcnt vmcnt(20)
  s_barrier
  v_mfma_f32_16x16x32_bf16 v[48:51], v[176:179], a[172:175], v[48:51]
  s_add_u32 s42, s78, 262144
  s_mov_b32 m0, s39
  ds_read_b64_tr_b16 v[148:149], v216 offset:0
  v_mfma_f32_16x16x32_bf16 v[52:55], v[172:175], a[184:187], v[52:55]
  buffer_load_dwordx4 v227, s[24:27], s42 offen lds
  v_mfma_f32_16x16x32_bf16 v[52:55], v[176:179], a[188:191], v[52:55]
  s_waitcnt lgkmcnt(13)
  ds_read_b64_tr_b16 v[150:151], v216 offset:256
  v_mfma_f32_16x16x32_bf16 v[56:59], a[224:227], a[128:131], 0
  ds_read_b64_tr_b16 v[152:153], v216 offset:512
  v_mfma_f32_16x16x32_bf16 v[56:59], a[228:231], a[132:135], v[56:59]
  ds_read_b64_tr_b16 v[154:155], v216 offset:768
  v_mfma_f32_16x16x32_bf16 v[60:63], a[224:227], a[144:147], 0
  s_add_u32 m0, m0, 32
  ds_read_b64_tr_b16 v[156:157], v216 offset:8704
  v_mfma_f32_16x16x32_bf16 v[60:63], a[228:231], a[148:151], v[60:63]
  buffer_load_dwordx4 v227, s[24:27], s42 offen offset:1024 lds
  v_mfma_f32_16x16x32_bf16 v[132:135], a[224:227], a[0:3], 0
  ds_read_b64_tr_b16 v[158:159], v216 offset:8960
  v_mfma_f32_16x16x32_bf16 v[132:135], a[228:231], a[4:7], v[132:135]
  s_waitcnt lgkmcnt(14)
  ds_read_b64_tr_b16 v[160:161], v216 offset:9216
  v_mfma_f32_16x16x32_bf16 v[56:59], a[232:235], a[136:139], v[56:59]
  ds_read_b64_tr_b16 v[162:163], v216 offset:9472
  v_mfma_f32_16x16x32_bf16 v[56:59], a[236:239], a[140:143], v[56:59]
  s_add_u32 m0, m0, 32
  ds_read_b64_tr_b16 v[164:165], v216 offset:17408
  v_mfma_f32_16x16x32_bf16 v[60:63], a[232:235], a[152:155], v[60:63]
  ds_read_b64_tr_b16 v[166:167], v216 offset:17664
  v_mfma_f32_16x16x32_bf16 v[60:63], a[236:239], a[156:159], v[60:63]
  buffer_load_dwordx4 v227, s[24:27], s42 offen offset:2048 lds
  v_mfma_f32_16x16x32_bf16 v[132:135], a[232:235], a[8:11], v[132:135]
  ds_read_b64_tr_b16 v[168:169], v216 offset:17920
  v_mfma_f32_16x16x32_bf16 v[132:135], a[236:239], a[12:15], v[132:135]
  s_waitcnt lgkmcnt(15)
  ds_read_b64_tr_b16 v[170:171], v216 offset:18176
  v_mfma_f32_16x16x32_bf16 v[56:59], a[240:243], a[160:163], v[56:59]
  ds_read_b64_tr_b16 v[172:173], v216 offset:26112
  v_mfma_f32_16x16x32_bf16 v[56:59], a[244:247], a[164:167], v[56:59]
  s_add_u32 m0, m0, 32
  ds_read_b64_tr_b16 v[174:175], v216 offset:26368
  v_mfma_f32_16x16x32_bf16 v[60:63], a[240:243], a[176:179], v[60:63]
  ds_read_b64_tr_b16 v[176:177], v216 offset:26624
  v_mfma_f32_16x16x32_bf16 v[60:63], a[244:247], a[180:183], v[60:63]
  ds_read_b64_tr_b16 v[178:179], v216 offset:26880
  v_mfma_f32_16x16x32_bf16 v[132:135], a[240:243], a[16:19], v[132:135]
  buffer_load_dwordx4 v227, s[24:27], s42 offen offset:3072 lds
  v_mfma_f32_16x16x32_bf16 v[132:135], a[244:247], a[20:23], v[132:135]
  s_waitcnt lgkmcnt(15)
  ds_read_b64_tr_b16 a[224:225], v217 offset:0
  v_mfma_f32_16x16x32_bf16 v[56:59], a[248:251], a[168:171], v[56:59]
  ds_read_b64_tr_b16 a[226:227], v217 offset:256
  v_mfma_f32_16x16x32_bf16 v[56:59], a[252:255], a[172:175], v[56:59]
  ds_read_b64_tr_b16 a[228:229], v217 offset:512
  v_mfma_f32_16x16x32_bf16 v[60:63], a[248:251], a[184:187], v[60:63]
  s_add_u32 s42, s42, s52
  s_add_u32 m0, m0, s53
  ds_read_b64_tr_b16 a[230:231], v217 offset:768
  v_mfma_f32_16x16x32_bf16 v[60:63], a[252:255], a[188:191], v[60:63]
  ds_read_b64_tr_b16 a[232:233], v217 offset:8704
  v_mfma_f32_16x16x32_bf16 v[132:135], a[248:251], a[24:27], v[132:135]
  s_waitcnt vmcnt(18)
  ds_read_b64_tr_b16 a[234:235], v217 offset:8960
  v_mfma_f32_16x16x32_bf16 v[132:135], a[252:255], a[28:31], v[132:135]
  buffer_load_dwordx4 v227, s[24:27], s42 offen lds
  v_mfma_f32_16x16x32_bf16 v[180:183], v[142:145], a[104:107], v[180:183]
  ds_read_b64_tr_b16 a[236:237], v217 offset:9216
  v_mfma_f32_16x16x32_bf16 v[188:191], v[140:143], a[104:107], v[188:191]
  ds_read_b64_tr_b16 a[238:239], v217 offset:9472
  v_mfma_f32_16x16x32_bf16 v[196:199], v[142:145], a[108:111], v[196:199]
  ds_read_b64_tr_b16 a[240:241], v217 offset:17408
  v_mfma_f32_16x16x32_bf16 v[204:207], v[140:143], a[108:111], v[204:207]
  s_add_u32 m0, m0, 32
  ds_read_b64_tr_b16 a[242:243], v217 offset:17664
  v_mfma_f32_16x16x32_bf16 v[184:187], v[142:145], a[112:115], v[184:187]
  ds_read_b64_tr_b16 a[244:245], v217 offset:17920
  v_mfma_f32_16x16x32_bf16 v[192:195], v[140:143], a[112:115], v[192:195]
  ds_read_b64_tr_b16 a[246:247], v217 offset:18176
  v_mfma_f32_16x16x32_bf16 v[200:203], v[142:145], a[116:119], v[200:203]
  buffer_load_dwordx4 v227, s[24:27], s42 offen offset:1024 lds
  v_mfma_f32_16x16x32_bf16 v[208:211], v[140:143], a[116:119], v[208:211]
  ds_read_b64_tr_b16 a[248:249], v217 offset:26112
  v_mfma_f32_16x16x32_bf16 v[136:139], v[142:145], a[120:123], v[136:139]
  s_waitcnt lgkmcnt(15)
  ds_read_b64_tr_b16 a[250:251], v217 offset:26368
  v_mfma_f32_16x16x32_bf16 v[32:35], v[148:151], a[192:195], v[32:35]
  ds_read_b64_tr_b16 a[252:253], v217 offset:26624
  v_mfma_f32_16x16x32_bf16 v[32:35], v[152:155], a[196:199], v[32:35]
  s_add_u32 m0, m0, 32
  ds_read_b64_tr_b16 a[254:255], v217 offset:26880
  v_mfma_f32_16x16x32_bf16 v[36:39], v[148:151], a[208:211], v[36:39]
  ds_read_b64_tr_b16 v[148:149], v218 offset:0
  v_mfma_f32_16x16x32_bf16 v[36:39], v[152:155], a[212:215], v[36:39]
  ds_read_b64_tr_b16 v[150:151], v218 offset:256
  v_mfma_f32_16x16x32_bf16 v[32:35], v[156:159], a[200:203], v[32:35]
  buffer_load_dwordx4 v227, s[24:27], s42 offen offset:2048 lds
  v_mfma_f32_16x16x32_bf16 v[32:35], v[160:163], a[204:207], v[32:35]
  ds_read_b64_tr_b16 v[152:153], v218 offset:512
  v_mfma_f32_16x16x32_bf16 v[36:39], v[156:159], a[216:219], v[36:39]
  ds_read_b64_tr_b16 v[154:155], v218 offset:768
  v_mfma_f32_16x16x32_bf16 v[36:39], v[160:163], a[220:223], v[36:39]
  s_waitcnt lgkmcnt(15)
  ds_read_b64_tr_b16 v[156:157], v218 offset:8704
  v_mfma_f32_16x16x32_bf16 v[32:35], v[164:167], v[96:99], v[32:35]
  s_add_u32 m0, m0, 32
  ds_read_b64_tr_b16 v[158:159], v218 offset:8960
  v_mfma_f32_16x16x32_bf16 v[32:35], v[168:171], v[100:103], v[32:35]
  ds_read_b64_tr_b16 v[160:161], v218 offset:9216
  v_mfma_f32_16x16x32_bf16 v[36:39], v[164:167], v[112:115], v[36:39]
  ds_read_b64_tr_b16 v[162:163], v218 offset:9472
  v_mfma_f32_16x16x32_bf16 v[36:39], v[168:171], v[116:119], v[36:39]
  buffer_load_dwordx4 v227, s[24:27], s42 offen offset:3072 lds
  v_mfma_f32_16x16x32_bf16 v[32:35], v[172:175], v[104:107], v[32:35]
  ds_read_b64_tr_b16 v[164:165], v218 offset:17408
  v_mfma_f32_16x16x32_bf16 v[32:35], v[176:179], v[108:111], v[32:35]
  ds_read_b64_tr_b16 v[166:167], v218 offset:17664
  v_mfma_f32_16x16x32_bf16 v[36:39], v[172:175], v[120:123], v[36:39]
  s_waitcnt vmcnt(13)
  buffer_store_dword v228, off, s[28:31], s43 sc1
  ds_read_b64_tr_b16 v[168:169], v218 offset:17920
  v_mfma_f32_16x16x32_bf16 v[36:39], v[176:179], v[124:127], v[36:39]
  s_waitcnt lgkmcnt(15)
  s_waitcnt vmcnt(10)
  v_readfirstlane_b32 s65, v229
  s_cmp_ge_u32 s65, 1
  s_cbranch_scc0 L_spin3
L_spin3_back:
  v_mfma_f32_16x16x32_bf16 v[40:43], a[224:227], a[192:195], v[40:43]
  ds_read_b64_tr_b16 v[170:171], v218 offset:18176
  v_mfma_f32_16x16x32_bf16 v[40:43], a[228:231], a[196:199], v[40:43]
  ds_read_b64_tr_b16 v[172:173], v218 offset:26112
  v_mfma_f32_16x16x32_bf16 v[44:47], a[224:227], a[208:211], v[44:47]
  buffer_load_dwordx4 a[64:67], v225, s[28:31], s90 offen offset:0 sc1
  v_mfma_f32_16x16x32_bf16 v[44:47], a[228:231], a[212:215], v[44:47]
  v_cvt_pk_bf16_f32 v80, v32, v33
  v_cvt_pk_bf16_f32 v81, v34, v35
  v_mfma_f32_16x16x32_bf16 v[40:43], a[232:235], a[200:203], v[40:43]
  ds_read_b64_tr_b16 v[174:175], v218 offset:26368
  v_mfma_f32_16x16x32_bf16 v[40:43], a[236:239], a[204:207], v[40:43]
  buffer_load_dwordx4 a[68:71], v225, s[28:31], s90 offen offset:1024 sc1
  v_mfma_f32_16x16x32_bf16 v[44:47], a[232:235], a[216:219], v[44:47]
  ds_read_b64_tr_b16 v[176:177], v218 offset:26624
  v_mfma_f32_16x16x32_bf16 v[44:47], a[236:239], a[220:223], v[44:47]
  s_waitcnt lgkmcnt(15)
  ds_read_b64_tr_b16 v[178:179], v218 offset:26880
  v_mfma_f32_16x16x32_bf16 v[40:43], a[240:243], v[96:99], v[40:43]
  buffer_load_dwordx4 a[72:75], v225, s[28:31], s90 offen offset:2048 sc1
  v_mfma_f32_16x16x32_bf16 v[40:43], a[244:247], v[100:103], v[40:43]
  ds_read_b64_tr_b16 a[224:225], v219 offset:0
  v_mfma_f32_16x16x32_bf16 v[44:47], a[240:243], v[112:115], v[44:47]
  ds_read_b64_tr_b16 a[226:227], v219 offset:256
  v_mfma_f32_16x16x32_bf16 v[44:47], a[244:247], v[116:119], v[44:47]
  buffer_load_dwordx4 a[76:79], v225, s[28:31], s90 offen offset:3072 sc1
  v_mfma_f32_16x16x32_bf16 v[40:43], a[248:251], v[104:107], v[40:43]
  ds_read_b64_tr_b16 a[228:229], v219 offset:512
  v_mfma_f32_16x16x32_bf16 v[40:43], a[252:255], v[108:111], v[40:43]
  ds_read_b64_tr_b16 a[230:231], v219 offset:768
  v_mfma_f32_16x16x32_bf16 v[44:47], a[248:251], v[120:123], v[44:47]
  buffer_load_dwordx2 a[80:81], v222, s[28:31], s91 offen sc1
  v_mfma_f32_16x16x32_bf16 v[44:47], a[252:255], v[124:127], v[44:47]
  s_waitcnt lgkmcnt(12)
  ds_read_b64_tr_b16 a[232:233], v219 offset:8704
  v_mfma_f32_16x16x32_bf16 v[48:51], v[148:151], a[192:195], v[48:51]
  ds_read_b64_tr_b16 a[234:235], v219 offset:8960
  v_mfma_f32_16x16x32_bf16 v[48:51], v[152:155], a[196:199], v[48:51]
  ds_read_b64_tr_b16 a[236:237], v219 offset:9216
  v_mfma_f32_16x16x32_bf16 v[52:55], v[148:151], a[208:211], v[52:55]
  ds_read_b64_tr_b16 a[238:239], v219 offset:9472
  v_mfma_f32_16x16x32_bf16 v[52:55], v[152:155], a[212:215], v[52:55]
  v_cvt_pk_bf16_f32 v82, v40, v41
  v_cvt_pk_bf16_f32 v83, v42, v43
  v_mfma_f32_16x16x32_bf16 v[48:51], v[156:159], a[200:203], v[48:51]
  buffer_store_dwordx4 v[80:83], v225, s[28:31], s85 offen offset:0 sc1
  v_cvt_pk_bf16_f32 v88, v36, v37
  v_mfma_f32_16x16x32_bf16 v[48:51], v[160:163], a[204:207], v[48:51]
  v_cvt_pk_bf16_f32 v89, v38, v39
  v_cvt_pk_bf16_f32 v90, v44, v45
  v_mfma_f32_16x16x32_bf16 v[52:55], v[156:159], a[216:219], v[52:55]
  ds_read_b64_tr_b16 a[240:241], v219 offset:17408
  v_cvt_pk_bf16_f32 v91, v46, v47
  v_mfma_f32_16x16x32_bf16 v[52:55], v[160:163], a[220:223], v[52:55]
  s_waitcnt lgkmcnt(9)
  buffer_store_dwordx4 v[88:91], v225, s[28:31], s85 offen offset:2048 sc1
  v_mfma_f32_16x16x32_bf16 v[48:51], v[164:167], v[96:99], v[48:51]
  ds_read_b64_tr_b16 a[242:243], v219 offset:17664
  v_mfma_f32_16x16x32_bf16 v[48:51], v[168:171], v[100:103], v[48:51]
  ds_read_b64_tr_b16 a[244:245], v219 offset:17920
  v_mfma_f32_16x16x32_bf16 v[52:55], v[164:167], v[112:115], v[52:55]
  ds_read_b64_tr_b16 a[246:247], v219 offset:18176
  v_mfma_f32_16x16x32_bf16 v[52:55], v[168:171], v[116:119], v[52:55]
  ds_read_b64_tr_b16 a[248:249], v219 offset:26112
  v_mfma_f32_16x16x32_bf16 v[48:51], v[172:175], v[104:107], v[48:51]
  ds_read_b64_tr_b16 a[250:251], v219 offset:26368
  v_mfma_f32_16x16x32_bf16 v[48:51], v[176:179], v[108:111], v[48:51]
  ds_read_b64_tr_b16 a[252:253], v219 offset:26624
  v_mfma_f32_16x16x32_bf16 v[52:55], v[172:175], v[120:123], v[52:55]
  ds_read_b64_tr_b16 a[254:255], v219 offset:26880
  s_waitcnt vmcnt(16)
  s_barrier
  v_mfma_f32_16x16x32_bf16 v[52:55], v[176:179], v[124:127], v[52:55]
  s_waitcnt lgkmcnt(12)
  s_add_u32 s42, s79, 0
  ds_read_b64_tr_b16 v[148:149], v212 offset:0
  v_mfma_f32_16x16x32_bf16 v[56:59], a[224:227], a[192:195], v[56:59]
  s_mov_b32 m0, s40
  ds_read_b64_tr_b16 v[150:151], v212 offset:256
  v_mfma_f32_16x16x32_bf16 v[56:59], a[228:231], a[196:199], v[56:59]
  ds_read_b64_tr_b16 v[152:153], v212 offset:512
  v_mfma_f32_16x16x32_bf16 v[60:63], a[224:227], a[208:211], v[60:63]
  ds_read_b64_tr_b16 v[154:155], v212 offset:768
  v_mfma_f32_16x16x32_bf16 v[60:63], a[228:231], a[212:215], v[60:63]
  v_cvt_pk_bf16_f32 v84, v48, v49
  v_cvt_pk_bf16_f32 v85, v50, v51
  v_mfma_f32_16x16x32_bf16 v[132:135], a[224:227], a[32:35], v[132:135]
  ds_read_b64_tr_b16 v[156:157], v212 offset:8704
  v_mfma_f32_16x16x32_bf16 v[132:135], a[228:231], a[36:39], v[132:135]
  s_waitcnt lgkmcnt(13)
  ds_read_b64_tr_b16 v[158:159], v212 offset:8960
  v_mfma_f32_16x16x32_bf16 v[56:59], a[232:235], a[200:203], v[56:59]
  ds_read_b64_tr_b16 v[160:161], v212 offset:9216
  v_mfma_f32_16x16x32_bf16 v[56:59], a[236:239], a[204:207], v[56:59]
  ds_read_b64_tr_b16 v[162:163], v212 offset:9472
  v_mfma_f32_16x16x32_bf16 v[60:63], a[232:235], a[216:219], v[60:63]
  buffer_load_dwordx4 v227, s[24:27], s42 offen lds
  v_mfma_f32_16x16x32_bf16 v[60:63], a[236:239], a[220:223], v[60:63]
  ds_read_b64_tr_b16 v[164:165], v212 offset:17408
  v_mfma_f32_16x16x32_bf16 v[132:135], a[232:235], a[40:43], v[132:135]
  ds_read_b64_tr_b16 v[166:167], v212 offset:17664
  v_mfma_f32_16x16x32_bf16 v[132:135], a[236:239], a[44:47], v[132:135]
  s_waitcnt lgkmcnt(14)
  ds_read_b64_tr_b16 v[168:169], v212 offset:17920
  v_mfma_f32_16x16x32_bf16 v[56:59], a[240:243], v[96:99], v[56:59]
  s_add_u32 m0, m0, 32
  ds_read_b64_tr_b16 v[170:171], v212 offset:18176
  v_mfma_f32_16x16x32_bf16 v[56:59], a[244:247], v[100:103], v[56:59]
  buffer_load_dwordx4 v227, s[24:27], s42 offen offset:1024 lds
  v_mfma_f32_16x16x32_bf16 v[60:63], a[240:243], v[112:115], v[60:63]
  ds_read_b64_tr_b16 v[172:173], v212 offset:26112
  v_mfma_f32_16x16x32_bf16 v[60:63], a[244:247], v[116:119], v[60:63]
  ds_read_b64_tr_b16 v[174:175], v212 offset:26368
  v_mfma_f32_16x16x32_bf16 v[132:135], a[240:243], a[48:51], v[132:135]
  ds_read_b64_tr_b16 v[176:177], v212 offset:26624
  v_mfma_f32_16x16x32_bf16 v[132:135], a[244:247], a[52:55], v[132:135]
  s_waitcnt lgkmcnt(15)
  s_add_u32 m0, m0, 32
  ds_read_b64_tr_b16 v[178:179], v212 offset:26880
  v_mfma_f32_16x16x32_bf16 v[56:59], a[248:251], v[104:107], v[56:59]
  ds_read_b64_tr_b16 a[224:225], v213 offset:0
  v_mfma_f32_16x16x32_bf16 v[56:59], a[252:255], v[108:111], v[56:59]
  s_sub_u32 s89, s59, 5
  s_and_b32 s89, s89, 7
  ds_read_b64_tr_b16 a[226:227], v213 offset:256
  v_mfma_f32_16x16x32_bf16 v[60:63], a[248:251], v[120:123], v[60:63]
  s_mul_i32 s90, s89, 18432
  s_lshl_b32 s89, s89, 2
  ds_read_b64_tr_b16 a[228:229], v213 offset:512
  v_mfma_f32_16x16x32_bf16 v[60:63], a[252:255], v[124:127], v[60:63]
  s_add_u32 s89, s89, s62
  s_add_u32 s90, s90, s63
  ds_read_b64_tr_b16 a[230:231], v213 offset:768
  v_mfma_f32_16x16x32_bf16 v[132:135], a[248:251], a[56:59], v[132:135]
  s_add_u32 s91, s90, s64
  buffer_load_dwordx4 v227, s[24:27], s42 offen offset:2048 lds
  v_mfma_f32_16x16x32_bf16 v[132:135], a[252:255], a[60:63], v[132:135]
  s_waitcnt lgkmcnt(12)
  ds_read_b64_tr_b16 a[232:233], v213 offset:8704
  v_mfma_f32_16x16x32_bf16 v[0:3], v[148:151], a[128:131], 0
  ds_read_b64_tr_b16 a[234:235], v213 offset:8960
  v_mfma_f32_16x16x32_bf16 v[0:3], v[152:155], a[132:135], v[0:3]
  ds_read_b64_tr_b16 a[236:237], v213 offset:9216
  v_mfma_f32_16x16x32_bf16 v[4:7], v[148:151], a[144:147], 0
  s_add_u32 m0, m0, 32
  ds_read_b64_tr_b16 a[238:239], v213 offset:9472
  v_mfma_f32_16x16x32_bf16 v[4:7], v[152:155], a[148:151], v[4:7]
  v_cvt_pk_bf16_f32 v86, v56, v57
  v_cvt_pk_bf16_f32 v87, v58, v59
  v_mfma_f32_16x16x32_bf16 v[0:3], v[156:159], a[136:139], v[0:3]
  buffer_store_dwordx4 v[84:87], v225, s[28:31], s85 offen offset:1024 sc1
  v_cvt_pk_bf16_f32 v92, v52, v53
  v_mfma_f32_16x16x32_bf16 v[0:3], v[160:163], a[140:143], v[0:3]
  v_cvt_pk_bf16_f32 v93, v54, v55
  v_cvt_pk_bf16_f32 v94, v60, v61
  v_mfma_f32_16x16x32_bf16 v[4:7], v[156:159], a[152:155], v[4:7]
  buffer_load_dwordx4 v227, s[24:27], s42 offen offset:3072 lds
  v_cvt_pk_bf16_f32 v95, v62, v63
  v_mfma_f32_16x16x32_bf16 v[4:7], v[160:163], a[156:159], v[4:7]
  s_waitcnt lgkmcnt(8)
  buffer_store_dwordx4 v[92:95], v225, s[28:31], s85 offen offset:3072 sc1
  v_cvt_pk_bf16_f32 v236, v132, v133
  v_mfma_f32_16x16x32_bf16 v[0:3], v[164:167], a[160:163], v[0:3]
  v_cvt_pk_bf16_f32 v237, v134, v135
  s_add_u32 s92, s85, s64
  v_mfma_f32_16x16x32_bf16 v[0:3], v[168:171], a[164:167], v[0:3]
  s_nop 0
  buffer_store_dwordx2 v[236:237], v222, s[28:31], s92 offen sc1
  ds_read_b64_tr_b16 a[240:241], v213 offset:17408
  v_mfma_f32_16x16x32_bf16 v[4:7], v[164:167], a[176:179], v[4:7]
  s_add_u32 s42, s42, s52
  ds_read_b64_tr_b16 a[242:243], v213 offset:17664
  ds_read_b64_tr_b16 a[244:245], v213 offset:17920
  v_mfma_f32_16x16x32_bf16 v[4:7], v[168:171], a[180:183], v[4:7]
  s_add_u32 m0, m0, s53
  ds_read_b64_tr_b16 a[246:247], v213 offset:18176
  v_mfma_f32_16x16x32_bf16 v[0:3], v[172:175], a[168:171], v[0:3]
  s_nop 0
  ds_read_b64_tr_b16 a[248:249], v213 offset:26112
  ds_read_b64_tr_b16 a[250:251], v213 offset:26368
  v_mfma_f32_16x16x32_bf16 v[0:3], v[176:179], a[172:175], v[0:3]
  s_nop 0
  ds_read_b64_tr_b16 a[252:253], v213 offset:26624
  ds_read_b64_tr_b16 a[254:255], v213 offset:26880
  v_mfma_f32_16x16x32_bf16 v[4:7], v[172:175], a[184:187], v[4:7]
  buffer_load_dwordx4 v227, s[24:27], s42 offen lds
  v_mfma_f32_16x16x32_bf16 v[4:7], v[176:179], a[188:191], v[4:7]
  s_waitcnt lgkmcnt(8)
  ds_read_b64_tr_b16 v[148:149], v214 offset:0
  ds_read_b64_tr_b16 v[150:151], v214 offset:256
  v_mfma_f32_16x16x32_bf16 v[8:11], a[224:227], a[128:131], 0
  s_nop 0
  ds_read_b64_tr_b16 v[152:153], v214 offset:512
  ds_read_b64_tr_b16 v[154:155], v214 offset:768
  v_mfma_f32_16x16x32_bf16 v[8:11], a[228:231], a[132:135], v[8:11]
  ds_read_b64_tr_b16 v[156:157], v214 offset:8704
  v_mfma_f32_16x16x32_bf16 v[12:15], a[224:227], a[144:147], 0
  s_add_u32 m0, m0, 32
  ds_read_b64_tr_b16 v[158:159], v214 offset:8960
  v_mfma_f32_16x16x32_bf16 v[12:15], a[228:231], a[148:151], v[12:15]
  buffer_load_dwordx4 v227, s[24:27], s42 offen offset:1024 lds
  v_mfma_f32_16x16x32_bf16 v[8:11], a[232:235], a[136:139], v[8:11]
  s_nop 0
  ds_read_b64_tr_b16 v[160:161], v214 offset:9216
  ds_read_b64_tr_b16 v[162:163], v214 offset:9472
  v_mfma_f32_16x16x32_bf16 v[8:11], a[236:239], a[140:143], v[8:11]
  ds_read_b64_tr_b16 v[164:165], v214 offset:17408
  v_mfma_f32_16x16x32_bf16 v[12:15], a[232:235], a[152:155], v[12:15]
  ds_read_b64_tr_b16 v[166:167], v214 offset:17664
  v_mfma_f32_16x16x32_bf16 v[12:15], a[236:239], a[156:159], v[12:15]
  s_waitcnt lgkmcnt(10)
  s_add_u32 m0, m0, 32
  ds_read_b64_tr_b16 v[168:169], v214 offset:17920
  v_mfma_f32_16x16x32_bf16 v[8:11], a[240:243], a[160:163], v[8:11]
  s_nop 0
  ds_read_b64_tr_b16 v[170:171], v214 offset:18176
  buffer_load_dwordx4 v227, s[24:27], s42 offen offset:2048 lds
  v_mfma_f32_16x16x32_bf16 v[8:11], a[244:247], a[164:167], v[8:11]
  buffer_load_dword v229, off, s[28:31], s89 sc1
  s_add_u32 s43, s59, 6
  s_and_b32 s43, s43, 7
  v_mfma_f32_16x16x32_bf16 v[12:15], a[240:243], a[176:179], v[12:15]
  s_lshl_b32 s43, s43, 9
  s_add_u32 s43, s43, s61
  ds_read_b64_tr_b16 v[172:173], v214 offset:26112
  v_mfma_f32_16x16x32_bf16 v[12:15], a[244:247], a[180:183], v[12:15]
  ds_read_b64_tr_b16 v[174:175], v214 offset:26368
  v_mfma_f32_16x16x32_bf16 v[8:11], a[248:251], a[168:171], v[8:11]
  s_nop 0
  ds_read_b64_tr_b16 v[176:177], v214 offset:26624
  ds_read_b64_tr_b16 v[178:179], v214 offset:26880
  v_mfma_f32_16x16x32_bf16 v[8:11], a[252:255], a[172:175], v[8:11]
  s_add_u32 m0, m0, 32
  ds_read_b64_tr_b16 a[224:225], v215 offset:0
  v_mfma_f32_16x16x32_bf16 v[12:15], a[248:251], a[184:187], v[12:15]
  buffer_load_dwordx4 v227, s[24:27], s42 offen offset:3072 lds
  v_mfma_f32_16x16x32_bf16 v[12:15], a[252:255], a[188:191], v[12:15]
  s_waitcnt lgkmcnt(9)
  ds_read_b64_tr_b16 a[226:227], v215 offset:256
  v_mfma_f32_16x16x32_bf16 v[16:19], v[148:151], a[128:131], 0
  s_nop 0
  ds_read_b64_tr_b16 a[228:229], v215 offset:512
  ds_read_b64_tr_b16 a[230:231], v215 offset:768
  v_mfma_f32_16x16x32_bf16 v[16:19], v[152:155], a[132:135], v[16:19]
  ds_read_b64_tr_b16 a[232:233], v215 offset:8704
  v_mfma_f32_16x16x32_bf16 v[20:23], v[148:151], a[144:147], 0
  ds_read_b64_tr_b16 a[234:235], v215 offset:8960
  v_mfma_f32_16x16x32_bf16 v[20:23], v[152:155], a[148:151], v[20:23]
  ds_read_b64_tr_b16 a[236:237], v215 offset:9216
  v_mfma_f32_16x16x32_bf16 v[16:19], v[156:159], a[136:139], v[16:19]
  ds_read_b64_tr_b16 a[238:239], v215 offset:9472
  v_mfma_f32_16x16x32_bf16 v[16:19], v[160:163], a[140:143], v[16:19]
  ds_read_b64_tr_b16 a[240:241], v215 offset:17408
  v_mfma_f32_16x16x32_bf16 v[20:23], v[156:159], a[152:155], v[20:23]
  ds_read_b64_tr_b16 a[242:243], v215 offset:17664
  v_mfma_f32_16x16x32_bf16 v[20:23], v[160:163], a[156:159], v[20:23]
  s_waitcnt lgkmcnt(10)
  ds_read_b64_tr_b16 a[244:245], v215 offset:17920
  v_mfma_f32_16x16x32_bf16 v[16:19], v[164:167], a[160:163], v[16:19]
  ds_read_b64_tr_b16 a[246:247], v215 offset:18176
  v_mfma_f32_16x16x32_bf16 v[16:19], v[168:171], a[164:167], v[16:19]
  ds_read_b64_tr_b16 a[248:249], v215 offset:26112
  v_mfma_f32_16x16x32_bf16 v[20:23], v[164:167], a[176:179], v[20:23]
  ds_read_b64_tr_b16 a[250:251], v215 offset:26368
  v_mfma_f32_16x16x32_bf16 v[20:23], v[168:171], a[180:183], v[20:23]
  ds_read_b64_tr_b16 a[252:253], v215 offset:26624
  v_mfma_f32_16x16x32_bf16 v[16:19], v[172:175], a[168:171], v[16:19]
  ds_read_b64_tr_b16 a[254:255], v215 offset:26880
  s_waitcnt vmcnt(20)
  s_barrier
  v_mfma_f32_16x16x32_bf16 v[16:19], v[176:179], a[172:175], v[16:19]
  s_add_u32 s42, s79, 262144
  s_mov_b32 m0, s38
  ds_read_b64_tr_b16 v[148:149], v212 offset:34816
  v_mfma_f32_16x16x32_bf16 v[20:23], v[172:175], a[184:187], v[20:23]
  buffer_load_dwordx4 v227, s[24:27], s42 offen lds
  v_mfma_f32_16x16x32_bf16 v[20:23], v[176:179], a[188:191], v[20:23]
  s_waitcnt lgkmcnt(13)
  ds_read_b64_tr_b16 v[150:151], v212 offset:35072
  v_mfma_f32_16x16x32_bf16 v[24:27], a[224:227], a[128:131], 0
  ds_read_b64_tr_b16 v[152:153], v212 offset:35328
  v_mfma_f32_16x16x32_bf16 v[24:27], a[228:231], a[132:135], v[24:27]
  ds_read_b64_tr_b16 v[154:155], v212 offset:35584
  v_mfma_f32_16x16x32_bf16 v[28:31], a[224:227], a[144:147], 0
  s_add_u32 m0, m0, 32
  ds_read_b64_tr_b16 v[156:157], v212 offset:43520
  v_mfma_f32_16x16x32_bf16 v[28:31], a[228:231], a[148:151], v[28:31]
  buffer_load_dwordx4 v227, s[24:27], s42 offen offset:1024 lds
  v_mfma_f32_16x16x32_bf16 v[128:131], a[224:227], a[0:3], 0
  ds_read_b64_tr_b16 v[158:159], v212 offset:43776
  v_mfma_f32_16x16x32_bf16 v[128:131], a[228:231], a[4:7], v[128:131]
  s_waitcnt lgkmcnt(14)
  ds_read_b64_tr_b16 v[160:161], v212 offset:44032
  v_mfma_f32_16x16x32_bf16 v[24:27], a[232:235], a[136:139], v[24:27]
  ds_read_b64_tr_b16 v[162:163], v212 offset:44288
  v_mfma_f32_16x16x32_bf16 v[24:27], a[236:239], a[140:143], v[24:27]
  s_add_u32 m0, m0, 32
  ds_read_b64_tr_b16 v[164:165], v212 offset:52224
  v_mfma_f32_16x16x32_bf16 v[28:31], a[232:235], a[152:155], v[28:31]
  ds_read_b64_tr_b16 v[166:167], v212 offset:52480
  v_mfma_f32_16x16x32_bf16 v[28:31], a[236:239], a[156:159], v[28:31]
  buffer_load_dwordx4 v227, s[24:27], s42 offen offset:2048 lds
  v_mfma_f32_16x16x32_bf16 v[128:131], a[232:235], a[8:11], v[128:131]
  ds_read_b64_tr_b16 v[168:169], v212 offset:52736
  v_mfma_f32_16x16x32_bf16 v[128:131], a[236:239], a[12:15], v[128:131]
  s_waitcnt lgkmcnt(15)
  ds_read_b64_tr_b16 v[170:171], v212 offset:52992
  v_mfma_f32_16x16x32_bf16 v[24:27], a[240:243], a[160:163], v[24:27]
  ds_read_b64_tr_b16 v[172:173], v212 offset:60928
  v_mfma_f32_16x16x32_bf16 v[24:27], a[244:247], a[164:167], v[24:27]
  s_add_u32 m0, m0, 32
  ds_read_b64_tr_b16 v[174:175], v212 offset:61184
  v_mfma_f32_16x16x32_bf16 v[28:31], a[240:243], a[176:179], v[28:31]
  ds_read_b64_tr_b16 v[176:177], v212 offset:61440
  v_mfma_f32_16x16x32_bf16 v[28:31], a[244:247], a[180:183], v[28:31]
  ds_read_b64_tr_b16 v[178:179], v212 offset:61696
  v_mfma_f32_16x16x32_bf16 v[128:131], a[240:243], a[16:19], v[128:131]
  buffer_load_dwordx4 v227, s[24:27], s42 offen offset:3072 lds
  v_mfma_f32_16x16x32_bf16 v[128:131], a[244:247], a[20:23], v[128:131]
  s_waitcnt lgkmcnt(15)
  ds_read_b64_tr_b16 a[224:225], v213 offset:34816
  v_mfma_f32_16x16x32_bf16 v[24:27], a[248:251], a[168:171], v[24:27]
  ds_read_b64_tr_b16 a[226:227], v213 offset:35072
  v_mfma_f32_16x16x32_bf16 v[24:27], a[252:255], a[172:175], v[24:27]
  ds_read_b64_tr_b16 a[228:229], v213 offset:35328
  v_mfma_f32_16x16x32_bf16 v[28:31], a[248:251], a[184:187], v[28:31]
  s_add_u32 s42, s42, s52
  s_add_u32 m0, m0, s53
  ds_read_b64_tr_b16 a[230:231], v213 offset:35584
  v_mfma_f32_16x16x32_bf16 v[28:31], a[252:255], a[188:191], v[28:31]
  ds_read_b64_tr_b16 a[232:233], v213 offset:43520
  v_mfma_f32_16x16x32_bf16 v[128:131], a[248:251], a[24:27], v[128:131]
  s_waitcnt vmcnt(18)
  ds_read_b64_tr_b16 a[234:235], v213 offset:43776
  v_mfma_f32_16x16x32_bf16 v[128:131], a[252:255], a[28:31], v[128:131]
  buffer_load_dwordx4 v227, s[24:27], s42 offen lds
  v_mfma_f32_16x16x32_bf16 v[180:183], v[142:145], a[64:67], v[180:183]
  ds_read_b64_tr_b16 a[236:237], v213 offset:44032
  v_mfma_f32_16x16x32_bf16 v[188:191], v[140:143], a[64:67], v[188:191]
  ds_read_b64_tr_b16 a[238:239], v213 offset:44288
  v_mfma_f32_16x16x32_bf16 v[196:199], v[142:145], a[68:71], v[196:199]
  ds_read_b64_tr_b16 a[240:241], v213 offset:52224
  v_mfma_f32_16x16x32_bf16 v[204:207], v[140:143], a[68:71], v[204:207]
  s_add_u32 m0, m0, 32
  ds_read_b64_tr_b16 a[242:243], v213 offset:52480
  v_mfma_f32_16x16x32_bf16 v[184:187], v[142:145], a[72:75], v[184:187]
  ds_read_b64_tr_b16 a[244:245], v213 offset:52736
  v_mfma_f32_16x16x32_bf16 v[192:195], v[140:143], a[72:75], v[192:195]
  ds_read_b64_tr_b16 a[246:247], v213 offset:52992
  v_mfma_f32_16x16x32_bf16 v[200:203], v[142:145], a[76:79], v[200:203]
  buffer_load_dwordx4 v227, s[24:27], s42 offen offset:1024 lds
  v_mfma_f32_16x16x32_bf16 v[208:211], v[140:143], a[76:79], v[208:211]
  ds_read_b64_tr_b16 a[248:249], v213 offset:60928
  v_mfma_f32_16x16x32_bf16 v[136:139], v[142:145], a[80:83], v[136:139]
  s_waitcnt lgkmcnt(15)
  ds_read_b64_tr_b16 a[250:251], v213 offset:61184
  v_mfma_f32_16x16x32_bf16 v[0:3], v[148:151], a[192:195], v[0:3]
  ds_read_b64_tr_b16 a[252:253], v213 offset:61440
  v_mfma_f32_16x16x32_bf16 v[0:3], v[152:155], a[196:199], v[0:3]
  s_add_u32 m0, m0, 32
  ds_read_b64_tr_b16 a[254:255], v213 offset:61696
  v_mfma_f32_16x16x32_bf16 v[4:7], v[148:151], a[208:211], v[4:7]
  ds_read_b64_tr_b16 v[148:149], v214 offset:34816
  v_mfma_f32_16x16x32_bf16 v[4:7], v[152:155], a[212:215], v[4:7]
  ds_read_b64_tr_b16 v[150:151], v214 offset:35072
  v_mfma_f32_16x16x32_bf16 v[0:3], v[156:159], a[200:203], v[0:3]
  buffer_load_dwordx4 v227, s[24:27], s42 offen offset:2048 lds
  v_mfma_f32_16x16x32_bf16 v[0:3], v[160:163], a[204:207], v[0:3]
  ds_read_b64_tr_b16 v[152:153], v214 offset:35328
  v_mfma_f32_16x16x32_bf16 v[4:7], v[156:159], a[216:219], v[4:7]
  ds_read_b64_tr_b16 v[154:155], v214 offset:35584
  v_mfma_f32_16x16x32_bf16 v[4:7], v[160:163], a[220:223], v[4:7]
  s_waitcnt lgkmcnt(15)
  ds_read_b64_tr_b16 v[156:157], v214 offset:43520
  v_mfma_f32_16x16x32_bf16 v[0:3], v[164:167], v[96:99], v[0:3]
  s_add_u32 m0, m0, 32
  ds_read_b64_tr_b16 v[158:159], v214 offset:43776
  v_mfma_f32_16x16x32_bf16 v[0:3], v[168:171], v[100:103], v[0:3]
  ds_read_b64_tr_b16 v[160:161], v214 offset:44032
  v_mfma_f32_16x16x32_bf16 v[4:7], v[164:167], v[112:115], v[4:7]
  ds_read_b64_tr_b16 v[162:163], v214 offset:44288
  v_mfma_f32_16x16x32_bf16 v[4:7], v[168:171], v[116:119], v[4:7]
  buffer_load_dwordx4 v227, s[24:27], s42 offen offset:3072 lds
  v_mfma_f32_16x16x32_bf16 v[0:3], v[172:175], v[104:107], v[0:3]
  ds_read_b64_tr_b16 v[164:165], v214 offset:52224
  v_mfma_f32_16x16x32_bf16 v[0:3], v[176:179], v[108:111], v[0:3]
  ds_read_b64_tr_b16 v[166:167], v214 offset:52480
  v_mfma_f32_16x16x32_bf16 v[4:7], v[172:175], v[120:123], v[4:7]
  s_waitcnt vmcnt(13)
  buffer_store_dword v228, off, s[28:31], s43 sc1
  ds_read_b64_tr_b16 v[168:169], v214 offset:52736
  v_mfma_f32_16x16x32_bf16 v[4:7], v[176:179], v[124:127], v[4:7]
  s_waitcnt lgkmcnt(15)
  s_waitcnt vmcnt(10)
  v_readfirstlane_b32 s65, v229
  s_cmp_ge_u32 s65, 1
  s_cbranch_scc0 L_spin4
L_spin4_back:
  v_mfma_f32_16x16x32_bf16 v[8:11], a[224:227], a[192:195], v[8:11]
  ds_read_b64_tr_b16 v[170:171], v214 offset:52992
  v_mfma_f32_16x16x32_bf16 v[8:11], a[228:231], a[196:199], v[8:11]
  ds_read_b64_tr_b16 v[172:173], v214 offset:60928
  v_mfma_f32_16x16x32_bf16 v[12:15], a[224:227], a[208:211], v[12:15]
  buffer_load_dwordx4 a[84:87], v225, s[28:31], s90 offen offset:0 sc1
  v_mfma_f32_16x16x32_bf16 v[12:15], a[228:231], a[212:215], v[12:15]
  v_cvt_pk_bf16_f32 v64, v0, v1
  v_cvt_pk_bf16_f32 v65, v2, v3
  v_mfma_f32_16x16x32_bf16 v[8:11], a[232:235], a[200:203], v[8:11]
  ds_read_b64_tr_b16 v[174:175], v214 offset:61184
  v_mfma_f32_16x16x32_bf16 v[8:11], a[236:239], a[204:207], v[8:11]
  buffer_load_dwordx4 a[88:91], v225, s[28:31], s90 offen offset:1024 sc1
  v_mfma_f32_16x16x32_bf16 v[12:15], a[232:235], a[216:219], v[12:15]
  ds_read_b64_tr_b16 v[176:177], v214 offset:61440
  v_mfma_f32_16x16x32_bf16 v[12:15], a[236:239], a[220:223], v[12:15]
  s_waitcnt lgkmcnt(15)
  ds_read_b64_tr_b16 v[178:179], v214 offset:61696
  v_mfma_f32_16x16x32_bf16 v[8:11], a[240:243], v[96:99], v[8:11]
  buffer_load_dwordx4 a[92:95], v225, s[28:31], s90 offen offset:2048 sc1
  v_mfma_f32_16x16x32_bf16 v[8:11], a[244:247], v[100:103], v[8:11]
  ds_read_b64_tr_b16 a[224:225], v215 offset:34816
  v_mfma_f32_16x16x32_bf16 v[12:15], a[240:243], v[112:115], v[12:15]
  ds_read_b64_tr_b16 a[226:227], v215 offset:35072
  v_mfma_f32_16x16x32_bf16 v[12:15], a[244:247], v[116:119], v[12:15]
  buffer_load_dwordx4 a[96:99], v225, s[28:31], s90 offen offset:3072 sc1
  v_mfma_f32_16x16x32_bf16 v[8:11], a[248:251], v[104:107], v[8:11]
  ds_read_b64_tr_b16 a[228:229], v215 offset:35328
  v_mfma_f32_16x16x32_bf16 v[8:11], a[252:255], v[108:111], v[8:11]
  ds_read_b64_tr_b16 a[230:231], v215 offset:35584
  v_mfma_f32_16x16x32_bf16 v[12:15], a[248:251], v[120:123], v[12:15]
  buffer_load_dwordx2 a[100:101], v222, s[28:31], s91 offen sc1
  v_mfma_f32_16x16x32_bf16 v[12:15], a[252:255], v[124:127], v[12:15]
  s_waitcnt lgkmcnt(12)
  ds_read_b64_tr_b16 a[232:233], v215 offset:43520
  v_mfma_f32_16x16x32_bf16 v[16:19], v[148:151], a[192:195], v[16:19]
  ds_read_b64_tr_b16 a[234:235], v215 offset:43776
  v_mfma_f32_16x16x32_bf16 v[16:19], v[152:155], a[196:199], v[16:19]
  ds_read_b64_tr_b16 a[236:237], v215 offset:44032
  v_mfma_f32_16x16x32_bf16 v[20:23], v[148:151], a[208:211], v[20:23]
  ds_read_b64_tr_b16 a[238:239], v215 offset:44288
  v_mfma_f32_16x16x32_bf16 v[20:23], v[152:155], a[212:215], v[20:23]
  v_cvt_pk_bf16_f32 v66, v8, v9
  v_cvt_pk_bf16_f32 v67, v10, v11
  v_mfma_f32_16x16x32_bf16 v[16:19], v[156:159], a[200:203], v[16:19]
  buffer_store_dwordx4 v[64:67], v225, s[28:31], s86 offen offset:0 sc1
  v_cvt_pk_bf16_f32 v72, v4, v5
  v_mfma_f32_16x16x32_bf16 v[16:19], v[160:163], a[204:207], v[16:19]
  v_cvt_pk_bf16_f32 v73, v6, v7
  v_cvt_pk_bf16_f32 v74, v12, v13
  v_mfma_f32_16x16x32_bf16 v[20:23], v[156:159], a[216:219], v[20:23]
  ds_read_b64_tr_b16 a[240:241], v215 offset:52224
  v_cvt_pk_bf16_f32 v75, v14, v15
  v_mfma_f32_16x16x32_bf16 v[20:23], v[160:163], a[220:223], v[20:23]
  s_waitcnt lgkmcnt(9)
  buffer_store_dwordx4 v[72:75], v225, s[28:31], s86 offen offset:2048 sc1
  v_mfma_f32_16x16x32_bf16 v[16:19], v[164:167], v[96:99], v[16:19]
  ds_read_b64_tr_b16 a[242:243], v215 offset:52480
  v_mfma_f32_16x16x32_bf16 v[16:19], v[168:171], v[100:103], v[16:19]
  ds_read_b64_tr_b16 a[244:245], v215 offset:52736
  v_mfma_f32_16x16x32_bf16 v[20:23], v[164:167], v[112:115], v[20:23]
  ds_read_b64_tr_b16 a[246:247], v215 offset:52992
  v_mfma_f32_16x16x32_bf16 v[20:23], v[168:171], v[116:119], v[20:23]
  ds_read_b64_tr_b16 a[248:249], v215 offset:60928
  v_mfma_f32_16x16x32_bf16 v[16:19], v[172:175], v[104:107], v[16:19]
  ds_read_b64_tr_b16 a[250:251], v215 offset:61184
  v_mfma_f32_16x16x32_bf16 v[16:19], v[176:179], v[108:111], v[16:19]
  ds_read_b64_tr_b16 a[252:253], v215 offset:61440
  v_mfma_f32_16x16x32_bf16 v[20:23], v[172:175], v[120:123], v[20:23]
  ds_read_b64_tr_b16 a[254:255], v215 offset:61696
  s_waitcnt vmcnt(16)
  s_barrier
  v_mfma_f32_16x16x32_bf16 v[20:23], v[176:179], v[124:127], v[20:23]
  s_waitcnt lgkmcnt(12)
  ds_read_b64_tr_b16 v[148:149], v216 offset:34816
  v_mfma_f32_16x16x32_bf16 v[24:27], a[224:227], a[192:195], v[24:27]
  ds_read_b64_tr_b16 v[150:151], v216 offset:35072
  v_mfma_f32_16x16x32_bf16 v[24:27], a[228:231], a[196:199], v[24:27]
  ds_read_b64_tr_b16 v[152:153], v216 offset:35328
  v_mfma_f32_16x16x32_bf16 v[28:31], a[224:227], a[208:211], v[28:31]
  ds_read_b64_tr_b16 v[154:155], v216 offset:35584
  v_mfma_f32_16x16x32_bf16 v[28:31], a[228:231], a[212:215], v[28:31]
  v_cvt_pk_bf16_f32 v68, v16, v17
  v_cvt_pk_bf16_f32 v69, v18, v19
  v_mfma_f32_16x16x32_bf16 v[128:131], a[224:227], a[32:35], v[128:131]
  ds_read_b64_tr_b16 v[156:157], v216 offset:43520
  v_mfma_f32_16x16x32_bf16 v[128:131], a[228:231], a[36:39], v[128:131]
  s_waitcnt lgkmcnt(13)
  ds_read_b64_tr_b16 v[158:159], v216 offset:43776
  v_mfma_f32_16x16x32_bf16 v[24:27], a[232:235], a[200:203], v[24:27]
  ds_read_b64_tr_b16 v[160:161], v216 offset:44032
  v_mfma_f32_16x16x32_bf16 v[24:27], a[236:239], a[204:207], v[24:27]
  ds_read_b64_tr_b16 v[162:163], v216 offset:44288
  v_mfma_f32_16x16x32_bf16 v[28:31], a[232:235], a[216:219], v[28:31]
  ds_read_b64_tr_b16 v[164:165], v216 offset:52224
  v_mfma_f32_16x16x32_bf16 v[28:31], a[236:239], a[220:223], v[28:31]
  ds_read_b64_tr_b16 v[166:167], v216 offset:52480
  v_mfma_f32_16x16x32_bf16 v[128:131], a[232:235], a[40:43], v[128:131]
  ds_read_b64_tr_b16 v[168:169], v216 offset:52736
  v_mfma_f32_16x16x32_bf16 v[128:131], a[236:239], a[44:47], v[128:131]
  s_waitcnt lgkmcnt(15)
  ds_read_b64_tr_b16 v[170:171], v216 offset:52992
  v_mfma_f32_16x16x32_bf16 v[24:27], a[240:243], v[96:99], v[24:27]
  ds_read_b64_tr_b16 v[172:173], v216 offset:60928
  v_mfma_f32_16x16x32_bf16 v[24:27], a[244:247], v[100:103], v[24:27]
  ds_read_b64_tr_b16 v[174:175], v216 offset:61184
  v_mfma_f32_16x16x32_bf16 v[28:31], a[240:243], v[112:115], v[28:31]
  ds_read_b64_tr_b16 v[176:177], v216 offset:61440
  v_mfma_f32_16x16x32_bf16 v[28:31], a[244:247], v[116:119], v[28:31]
  ds_read_b64_tr_b16 v[178:179], v216 offset:61696
  v_mfma_f32_16x16x32_bf16 v[128:131], a[240:243], a[48:51], v[128:131]
  ds_read_b64_tr_b16 a[224:225], v217 offset:34816
  v_mfma_f32_16x16x32_bf16 v[128:131], a[244:247], a[52:55], v[128:131]
  s_waitcnt lgkmcnt(15)
  ds_read_b64_tr_b16 a[226:227], v217 offset:35072
  v_mfma_f32_16x16x32_bf16 v[24:27], a[248:251], v[104:107], v[24:27]
  ds_read_b64_tr_b16 a[228:229], v217 offset:35328
  v_mfma_f32_16x16x32_bf16 v[24:27], a[252:255], v[108:111], v[24:27]
  s_sub_u32 s89, s59, 6
  s_and_b32 s89, s89, 7
  ds_read_b64_tr_b16 a[230:231], v217 offset:35584
  v_mfma_f32_16x16x32_bf16 v[28:31], a[248:251], v[120:123], v[28:31]
  s_mul_i32 s90, s89, 18432
  s_lshl_b32 s89, s89, 2
  ds_read_b64_tr_b16 a[232:233], v217 offset:43520
  v_mfma_f32_16x16x32_bf16 v[28:31], a[252:255], v[124:127], v[28:31]
  s_add_u32 s89, s89, s62
  s_add_u32 s90, s90, s63
  ds_read_b64_tr_b16 a[234:235], v217 offset:43776
  v_mfma_f32_16x16x32_bf16 v[128:131], a[248:251], a[56:59], v[128:131]
  s_add_u32 s91, s90, s64
  ds_read_b64_tr_b16 a[236:237], v217 offset:44032
  v_mfma_f32_16x16x32_bf16 v[128:131], a[252:255], a[60:63], v[128:131]
  s_waitcnt lgkmcnt(15)
  ds_read_b64_tr_b16 a[238:239], v217 offset:44288
  v_mfma_f32_16x16x32_bf16 v[180:183], v[148:151], a[128:131], v[180:183]
  ds_read_b64_tr_b16 a[240:241], v217 offset:52224
  v_mfma_f32_16x16x32_bf16 v[180:183], v[152:155], a[132:135], v[180:183]
  ds_read_b64_tr_b16 a[242:243], v217 offset:52480
  v_mfma_f32_16x16x32_bf16 v[184:187], v[148:151], a[144:147], v[184:187]
  ds_read_b64_tr_b16 a[244:245], v217 offset:52736
  v_mfma_f32_16x16x32_bf16 v[184:187], v[152:155], a[148:151], v[184:187]
  v_cvt_pk_bf16_f32 v70, v24, v25
  v_cvt_pk_bf16_f32 v71, v26, v27
  v_mfma_f32_16x16x32_bf16 v[180:183], v[156:159], a[136:139], v[180:183]
  buffer_store_dwordx4 v[68:71], v225, s[28:31], s86 offen offset:1024 sc1
  v_cvt_pk_bf16_f32 v76, v20, v21
  v_mfma_f32_16x16x32_bf16 v[180:183], v[160:163], a[140:143], v[180:183]
  v_cvt_pk_bf16_f32 v77, v22, v23
  v_cvt_pk_bf16_f32 v78, v28, v29
  v_mfma_f32_16x16x32_bf16 v[184:187], v[156:159], a[152:155], v[184:187]
  ds_read_b64_tr_b16 a[246:247], v217 offset:52992
  v_cvt_pk_bf16_f32 v79, v30, v31
  v_mfma_f32_16x16x32_bf16 v[184:187], v[160:163], a[156:159], v[184:187]
  s_waitcnt lgkmcnt(12)
  buffer_store_dwordx4 v[76:79], v225, s[28:31], s86 offen offset:3072 sc1
  v_cvt_pk_bf16_f32 v232, v128, v129
  v_mfma_f32_16x16x32_bf16 v[180:183], v[164:167], a[160:163], v[180:183]
  v_cvt_pk_bf16_f32 v233, v130, v131
  s_add_u32 s92, s86, s64
  v_mfma_f32_16x16x32_bf16 v[180:183], v[168:171], a[164:167], v[180:183]
  buffer_store_dwordx2 v[232:233], v222, s[28:31], s92 offen sc1
  v_mfma_f32_16x16x32_bf16 v[184:187], v[164:167], a[176:179], v[184:187]
  ds_read_b64_tr_b16 a[248:249], v217 offset:60928
  v_mfma_f32_16x16x32_bf16 v[184:187], v[168:171], a[180:183], v[184:187]
  ds_read_b64_tr_b16 a[250:251], v217 offset:61184
  v_mfma_f32_16x16x32_bf16 v[180:183], v[172:175], a[168:171], v[180:183]
  s_nop 0
  ds_read_b64_tr_b16 a[252:253], v217 offset:61440
  ds_read_b64_tr_b16 a[254:255], v217 offset:61696
  v_mfma_f32_16x16x32_bf16 v[180:183], v[176:179], a[172:175], v[180:183]
  ds_read_b64_tr_b16 v[148:149], v218 offset:34816
  v_mfma_f32_16x16x32_bf16 v[184:187], v[172:175], a[184:187], v[184:187]
  ds_read_b64_tr_b16 v[150:151], v218 offset:35072
  v_mfma_f32_16x16x32_bf16 v[184:187], v[176:179], a[188:191], v[184:187]
  s_waitcnt lgkmcnt(10)
  ds_read_b64_tr_b16 v[152:153], v218 offset:35328
  v_mfma_f32_16x16x32_bf16 v[188:191], a[224:227], a[128:131], v[188:191]
  ds_read_b64_tr_b16 v[154:155], v218 offset:35584
  v_mfma_f32_16x16x32_bf16 v[188:191], a[228:231], a[132:135], v[188:191]
  ds_read_b64_tr_b16 v[156:157], v218 offset:43520
  v_mfma_f32_16x16x32_bf16 v[192:195], a[224:227], a[144:147], v[192:195]
  ds_read_b64_tr_b16 v[158:159], v218 offset:43776
  v_mfma_f32_16x16x32_bf16 v[192:195], a[228:231], a[148:151], v[192:195]
  ds_read_b64_tr_b16 v[160:161], v218 offset:44032
  v_mfma_f32_16x16x32_bf16 v[188:191], a[232:235], a[136:139], v[188:191]
  ds_read_b64_tr_b16 v[162:163], v218 offset:44288
  v_mfma_f32_16x16x32_bf16 v[188:191], a[236:239], a[140:143], v[188:191]
  ds_read_b64_tr_b16 v[164:165], v218 offset:52224
  v_mfma_f32_16x16x32_bf16 v[192:195], a[232:235], a[152:155], v[192:195]
  ds_read_b64_tr_b16 v[166:167], v218 offset:52480
  v_mfma_f32_16x16x32_bf16 v[192:195], a[236:239], a[156:159], v[192:195]
  s_waitcnt lgkmcnt(10)
  ds_read_b64_tr_b16 v[168:169], v218 offset:52736
  v_mfma_f32_16x16x32_bf16 v[188:191], a[240:243], a[160:163], v[188:191]
  ds_read_b64_tr_b16 v[170:171], v218 offset:52992
  v_mfma_f32_16x16x32_bf16 v[188:191], a[244:247], a[164:167], v[188:191]
  buffer_load_dword v229, off, s[28:31], s89 sc1
  s_add_u32 s43, s59, 7
  s_and_b32 s43, s43, 7
  v_mfma_f32_16x16x32_bf16 v[192:195], a[240:243], a[176:179], v[192:195]
  s_lshl_b32 s43, s43, 9
  s_add_u32 s43, s43, s61
  ds_read_b64_tr_b16 v[172:173], v218 offset:60928
  v_mfma_f32_16x16x32_bf16 v[192:195], a[244:247], a[180:183], v[192:195]
  ds_read_b64_tr_b16 v[174:175], v218 offset:61184
  v_mfma_f32_16x16x32_bf16 v[188:191], a[248:251], a[168:171], v[188:191]
  s_nop 0
  ds_read_b64_tr_b16 v[176:177], v218 offset:61440
  ds_read_b64_tr_b16 v[178:179], v218 offset:61696
  v_mfma_f32_16x16x32_bf16 v[188:191], a[252:255], a[172:175], v[188:191]
  ds_read_b64_tr_b16 a[224:225], v219 offset:34816
  v_mfma_f32_16x16x32_bf16 v[192:195], a[248:251], a[184:187], v[192:195]
  ds_read_b64_tr_b16 a[226:227], v219 offset:35072
  v_mfma_f32_16x16x32_bf16 v[192:195], a[252:255], a[188:191], v[192:195]
  s_waitcnt lgkmcnt(10)
  ds_read_b64_tr_b16 a[228:229], v219 offset:35328
  v_mfma_f32_16x16x32_bf16 v[196:199], v[148:151], a[128:131], v[196:199]
  ds_read_b64_tr_b16 a[230:231], v219 offset:35584
  v_mfma_f32_16x16x32_bf16 v[196:199], v[152:155], a[132:135], v[196:199]
  ds_read_b64_tr_b16 a[232:233], v219 offset:43520
  v_mfma_f32_16x16x32_bf16 v[200:203], v[148:151], a[144:147], v[200:203]
  ds_read_b64_tr_b16 a[234:235], v219 offset:43776
  v_mfma_f32_16x16x32_bf16 v[200:203], v[152:155], a[148:151], v[200:203]
  ds_read_b64_tr_b16 a[236:237], v219 offset:44032
  v_mfma_f32_16x16x32_bf16 v[196:199], v[156:159], a[136:139], v[196:199]
  ds_read_b64_tr_b16 a[238:239], v219 offset:44288
  v_mfma_f32_16x16x32_bf16 v[196:199], v[160:163], a[140:143], v[196:199]
  ds_read_b64_tr_b16 a[240:241], v219 offset:52224
  v_mfma_f32_16x16x32_bf16 v[200:203], v[156:159], a[152:155], v[200:203]
  ds_read_b64_tr_b16 a[242:243], v219 offset:52480
  v_mfma_f32_16x16x32_bf16 v[200:203], v[160:163], a[156:159], v[200:203]
  s_waitcnt lgkmcnt(10)
  ds_read_b64_tr_b16 a[244:245], v219 offset:52736
  v_mfma_f32_16x16x32_bf16 v[196:199], v[164:167], a[160:163], v[196:199]
  ds_read_b64_tr_b16 a[246:247], v219 offset:52992
  v_bfe_u32 v88, v225, 4, 4
  v_mfma_f32_16x16x32_bf16 v[196:199], v[168:171], a[164:167], v[196:199]
  ds_read_b64_tr_b16 a[248:249], v219 offset:60928
  v_lshlrev_b32 v88, 11, v88
  v_mfma_f32_16x16x32_bf16 v[200:203], v[164:167], a[176:179], v[200:203]
  ds_read_b64_tr_b16 a[250:251], v219 offset:61184
  v_lshrrev_b32 v91, 8, v225
  v_mfma_f32_16x16x32_bf16 v[200:203], v[168:171], a[180:183], v[200:203]
  ds_read_b64_tr_b16 a[252:253], v219 offset:61440
  v_lshl_add_u32 v90, v91, 3, v88
  v_mfma_f32_16x16x32_bf16 v[196:199], v[172:175], a[168:171], v[196:199]
  ds_read_b64_tr_b16 a[254:255], v219 offset:61696
  s_waitcnt vmcnt(12)
  s_barrier
  v_mfma_f32_16x16x32_bf16 v[196:199], v[176:179], a[172:175], v[196:199]
  s_lshl_b32 s66, s36, 5
  v_add_u32 v90, s66, v90
  v_and_b32 v92, 1, v91
  v_mfma_f32_16x16x32_bf16 v[200:203], v[172:175], a[184:187], v[200:203]
  v_lshl_add_u32 v88, v92, 4, v88
  v_lshrrev_b32 v91, 1, v91
  v_mfma_f32_16x16x32_bf16 v[200:203], v[176:179], a[188:191], v[200:203]
  s_waitcnt lgkmcnt(12)
  v_add_u32 v91, s36, v91
  v_add_u32 v92, 3, v91
  v_mfma_f32_16x16x32_bf16 v[204:207], a[224:227], a[128:131], v[204:207]
  v_add_u32 v91, 1, v91
  v_and_b32 v91, 3, v91
  v_mfma_f32_16x16x32_bf16 v[204:207], a[228:231], a[132:135], v[204:207]
  v_and_b32 v92, 3, v92
  v_lshl_add_u32 v89, v92, 5, v88
  v_mfma_f32_16x16x32_bf16 v[208:211], a[224:227], a[144:147], v[208:211]
  ds_read_b64_tr_b16 v[148:149], v216 offset:0
  v_lshl_add_u32 v88, v91, 5, v88
  v_mfma_f32_16x16x32_bf16 v[208:211], a[228:231], a[148:151], v[208:211]
  ds_read_b64_tr_b16 v[150:151], v216 offset:256
  v_mfma_f32_16x16x32_bf16 v[136:139], a[224:227], a[0:3], v[136:139]
  ds_read_b64_tr_b16 v[152:153], v216 offset:512
  v_mfma_f32_16x16x32_bf16 v[136:139], a[228:231], a[4:7], v[136:139]
  s_waitcnt lgkmcnt(11)
  ds_read_b64_tr_b16 v[154:155], v216 offset:768
  v_mfma_f32_16x16x32_bf16 v[204:207], a[232:235], a[136:139], v[204:207]
  ds_read_b64_tr_b16 v[156:157], v216 offset:8704
  v_mfma_f32_16x16x32_bf16 v[204:207], a[236:239], a[140:143], v[204:207]
  ds_read_b64_tr_b16 v[158:159], v216 offset:8960
  v_mfma_f32_16x16x32_bf16 v[208:211], a[232:235], a[152:155], v[208:211]
  ds_read_b64_tr_b16 v[160:161], v216 offset:9216
  v_mfma_f32_16x16x32_bf16 v[208:211], a[236:239], a[156:159], v[208:211]
  ds_read_b64_tr_b16 v[162:163], v216 offset:9472
  v_mfma_f32_16x16x32_bf16 v[136:139], a[232:235], a[8:11], v[136:139]
  ds_read_b64_tr_b16 v[164:165], v216 offset:17408
  v_mfma_f32_16x16x32_bf16 v[136:139], a[236:239], a[12:15], v[136:139]
  s_waitcnt lgkmcnt(13)
  ds_read_b64_tr_b16 v[166:167], v216 offset:17664
  v_mfma_f32_16x16x32_bf16 v[204:207], a[240:243], a[160:163], v[204:207]
  ds_read_b64_tr_b16 v[168:169], v216 offset:17920
  v_mfma_f32_16x16x32_bf16 v[204:207], a[244:247], a[164:167], v[204:207]
  ds_read_b64_tr_b16 v[170:171], v216 offset:18176
  v_mfma_f32_16x16x32_bf16 v[208:211], a[240:243], a[176:179], v[208:211]
  ds_read_b64_tr_b16 v[172:173], v216 offset:26112
  v_mfma_f32_16x16x32_bf16 v[208:211], a[244:247], a[180:183], v[208:211]
  ds_read_b64_tr_b16 v[174:175], v216 offset:26368
  v_mfma_f32_16x16x32_bf16 v[136:139], a[240:243], a[16:19], v[136:139]
  ds_read_b64_tr_b16 v[176:177], v216 offset:26624
  v_mfma_f32_16x16x32_bf16 v[136:139], a[244:247], a[20:23], v[136:139]
  s_waitcnt lgkmcnt(15)
  ds_read_b64_tr_b16 v[178:179], v216 offset:26880
  v_mfma_f32_16x16x32_bf16 v[204:207], a[248:251], a[168:171], v[204:207]
  ds_read_b64_tr_b16 a[224:225], v217 offset:0
  v_mfma_f32_16x16x32_bf16 v[204:207], a[252:255], a[172:175], v[204:207]
  ds_read_b64_tr_b16 a[226:227], v217 offset:256
  v_mfma_f32_16x16x32_bf16 v[208:211], a[248:251], a[184:187], v[208:211]
  ds_read_b64_tr_b16 a[228:229], v217 offset:512
  v_mfma_f32_16x16x32_bf16 v[208:211], a[252:255], a[188:191], v[208:211]
  ds_read_b64_tr_b16 a[230:231], v217 offset:768
  v_mfma_f32_16x16x32_bf16 v[136:139], a[248:251], a[24:27], v[136:139]
  s_waitcnt vmcnt(6)
  ds_read_b64_tr_b16 a[232:233], v217 offset:8704
  v_mfma_f32_16x16x32_bf16 v[136:139], a[252:255], a[28:31], v[136:139]
  ds_read_b64_tr_b16 a[234:235], v217 offset:8960
  v_mfma_f32_16x16x32_bf16 v[180:183], v[142:145], a[84:87], v[180:183]
  ds_read_b64_tr_b16 a[236:237], v217 offset:9216
  v_mfma_f32_16x16x32_bf16 v[188:191], v[140:143], a[84:87], v[188:191]
  ds_read_b64_tr_b16 a[238:239], v217 offset:9472
  v_mfma_f32_16x16x32_bf16 v[196:199], v[142:145], a[88:91], v[196:199]
  ds_read_b64_tr_b16 a[240:241], v217 offset:17408
  v_mfma_f32_16x16x32_bf16 v[204:207], v[140:143], a[88:91], v[204:207]
  ds_read_b64_tr_b16 a[242:243], v217 offset:17664
  v_mfma_f32_16x16x32_bf16 v[184:187], v[142:145], a[92:95], v[184:187]
  ds_read_b64_tr_b16 a[244:245], v217 offset:17920
  v_mfma_f32_16x16x32_bf16 v[192:195], v[140:143], a[92:95], v[192:195]
  ds_read_b64_tr_b16 a[246:247], v217 offset:18176
  v_mfma_f32_16x16x32_bf16 v[200:203], v[142:145], a[96:99], v[200:203]
  ds_read_b64_tr_b16 a[248:249], v217 offset:26112
  v_mfma_f32_16x16x32_bf16 v[208:211], v[140:143], a[96:99], v[208:211]
  ds_read_b64_tr_b16 a[250:251], v217 offset:26368
  v_mfma_f32_16x16x32_bf16 v[136:139], v[142:145], a[100:103], v[136:139]
  s_waitcnt lgkmcnt(15)
  ds_read_b64_tr_b16 a[252:253], v217 offset:26624
  v_mfma_f32_16x16x32_bf16 v[180:183], v[148:151], a[192:195], v[180:183]
  ds_read_b64_tr_b16 a[254:255], v217 offset:26880
  v_mfma_f32_16x16x32_bf16 v[180:183], v[152:155], a[196:199], v[180:183]
  v_mfma_f32_16x16x32_bf16 v[184:187], v[148:151], a[208:211], v[184:187]
  ds_read_b64_tr_b16 v[148:149], v218 offset:0
  v_mfma_f32_16x16x32_bf16 v[184:187], v[152:155], a[212:215], v[184:187]
  ds_read_b64_tr_b16 v[150:151], v218 offset:256
  v_mfma_f32_16x16x32_bf16 v[180:183], v[156:159], a[200:203], v[180:183]
  ds_read_b64_tr_b16 v[152:153], v218 offset:512
  v_mfma_f32_16x16x32_bf16 v[180:183], v[160:163], a[204:207], v[180:183]
  ds_read_b64_tr_b16 v[154:155], v218 offset:768
  v_mfma_f32_16x16x32_bf16 v[184:187], v[156:159], a[216:219], v[184:187]
  ds_read_b64_tr_b16 v[156:157], v218 offset:8704
  v_mfma_f32_16x16x32_bf16 v[184:187], v[160:163], a[220:223], v[184:187]
  s_waitcnt lgkmcnt(15)
  ds_read_b64_tr_b16 v[158:159], v218 offset:8960
  v_mfma_f32_16x16x32_bf16 v[180:183], v[164:167], v[96:99], v[180:183]
  ds_read_b64_tr_b16 v[160:161], v218 offset:9216
  v_mfma_f32_16x16x32_bf16 v[180:183], v[168:171], v[100:103], v[180:183]
  ds_read_b64_tr_b16 v[162:163], v218 offset:9472
  v_mfma_f32_16x16x32_bf16 v[184:187], v[164:167], v[112:115], v[184:187]
  ds_read_b64_tr_b16 v[164:165], v218 offset:17408
  v_mfma_f32_16x16x32_bf16 v[184:187], v[168:171], v[116:119], v[184:187]
  ds_read_b64_tr_b16 v[166:167], v218 offset:17664
  v_mfma_f32_16x16x32_bf16 v[180:183], v[172:175], v[104:107], v[180:183]
  ds_read_b64_tr_b16 v[168:169], v218 offset:17920
  v_mfma_f32_16x16x32_bf16 v[180:183], v[176:179], v[108:111], v[180:183]
  ds_read_b64_tr_b16 v[170:171], v218 offset:18176
  v_mfma_f32_16x16x32_bf16 v[184:187], v[172:175], v[120:123], v[184:187]
  s_waitcnt vmcnt(1)
  buffer_store_dword v228, off, s[28:31], s43 sc1
  ds_read_b64_tr_b16 v[172:173], v218 offset:26112
  v_mfma_f32_16x16x32_bf16 v[184:187], v[176:179], v[124:127], v[184:187]
  s_waitcnt lgkmcnt(15)
  s_waitcnt vmcnt(1)
  v_readfirstlane_b32 s65, v229
  s_cmp_ge_u32 s65, 1
  s_cbranch_scc0 L_spin5
L_spin5_back:
  v_mfma_f32_16x16x32_bf16 v[188:191], a[224:227], a[192:195], v[188:191]
  ds_read_b64_tr_b16 v[174:175], v218 offset:26368
  v_mfma_f32_16x16x32_bf16 v[188:191], a[228:231], a[196:199], v[188:191]
  ds_read_b64_tr_b16 v[176:177], v218 offset:26624
  v_mfma_f32_16x16x32_bf16 v[192:195], a[224:227], a[208:211], v[192:195]
  buffer_load_dwordx4 a[104:107], v225, s[28:31], s90 offen offset:0 sc1
  v_mfma_f32_16x16x32_bf16 v[192:195], a[228:231], a[212:215], v[192:195]
  ds_read_b64_tr_b16 v[178:179], v218 offset:26880
  v_mfma_f32_16x16x32_bf16 v[188:191], a[232:235], a[200:203], v[188:191]
  ds_read_b64_tr_b16 a[224:225], v219 offset:0
  v_mfma_f32_16x16x32_bf16 v[188:191], a[236:239], a[204:207], v[188:191]
  buffer_load_dwordx4 a[108:111], v225, s[28:31], s90 offen offset:1024 sc1
  v_mfma_f32_16x16x32_bf16 v[192:195], a[232:235], a[216:219], v[192:195]
  ds_read_b64_tr_b16 a[226:227], v219 offset:256
  v_mfma_f32_16x16x32_bf16 v[192:195], a[236:239], a[220:223], v[192:195]
  s_waitcnt lgkmcnt(15)
  ds_read_b64_tr_b16 a[228:229], v219 offset:512
  v_mfma_f32_16x16x32_bf16 v[188:191], a[240:243], v[96:99], v[188:191]
  buffer_load_dwordx4 a[112:115], v225, s[28:31], s90 offen offset:2048 sc1
  v_mfma_f32_16x16x32_bf16 v[188:191], a[244:247], v[100:103], v[188:191]
  ds_read_b64_tr_b16 a[230:231], v219 offset:768
  v_mfma_f32_16x16x32_bf16 v[192:195], a[240:243], v[112:115], v[192:195]
  ds_read_b64_tr_b16 a[232:233], v219 offset:8704
  v_mfma_f32_16x16x32_bf16 v[192:195], a[244:247], v[116:119], v[192:195]
  buffer_load_dwordx4 a[116:119], v225, s[28:31], s90 offen offset:3072 sc1
  v_mfma_f32_16x16x32_bf16 v[188:191], a[248:251], v[104:107], v[188:191]
  ds_read_b64_tr_b16 a[234:235], v219 offset:8960
  v_mfma_f32_16x16x32_bf16 v[188:191], a[252:255], v[108:111], v[188:191]
  ds_read_b64_tr_b16 a[236:237], v219 offset:9216
  v_mfma_f32_16x16x32_bf16 v[192:195], a[248:251], v[120:123], v[192:195]
  buffer_load_dwordx2 a[120:121], v222, s[28:31], s91 offen sc1
  s_sub_u32 s89, s59, 7
  s_and_b32 s89, s89, 7
  v_mfma_f32_16x16x32_bf16 v[192:195], a[252:255], v[124:127], v[192:195]
  s_waitcnt lgkmcnt(15)
  s_mul_i32 s90, s89, 18432
  s_lshl_b32 s89, s89, 2
  v_mfma_f32_16x16x32_bf16 v[196:199], v[148:151], a[192:195], v[196:199]
  s_add_u32 s89, s89, s62
  s_add_u32 s90, s90, s63
  v_mfma_f32_16x16x32_bf16 v[196:199], v[152:155], a[196:199], v[196:199]
  s_add_u32 s91, s90, s64
  ds_read_b64_tr_b16 a[238:239], v219 offset:9472
  v_mfma_f32_16x16x32_bf16 v[200:203], v[148:151], a[208:211], v[200:203]
  ds_read_b64_tr_b16 a[240:241], v219 offset:17408
  v_mfma_f32_16x16x32_bf16 v[200:203], v[152:155], a[212:215], v[200:203]
  ds_read_b64_tr_b16 a[242:243], v219 offset:17664
  v_mfma_f32_16x16x32_bf16 v[196:199], v[156:159], a[200:203], v[196:199]
  ds_read_b64_tr_b16 a[244:245], v219 offset:17920
  v_mfma_f32_16x16x32_bf16 v[196:199], v[160:163], a[204:207], v[196:199]
  ds_read_b64_tr_b16 a[246:247], v219 offset:18176
  v_mfma_f32_16x16x32_bf16 v[200:203], v[156:159], a[216:219], v[200:203]
  ds_read_b64_tr_b16 a[248:249], v219 offset:26112
  v_mfma_f32_16x16x32_bf16 v[200:203], v[160:163], a[220:223], v[200:203]
  s_waitcnt lgkmcnt(13)
  ds_read_b64_tr_b16 a[250:251], v219 offset:26368
  v_mfma_f32_16x16x32_bf16 v[196:199], v[164:167], v[96:99], v[196:199]
  ds_read_b64_tr_b16 a[252:253], v219 offset:26624
  v_mfma_f32_16x16x32_bf16 v[196:199], v[168:171], v[100:103], v[196:199]
  ds_read_b64_tr_b16 a[254:255], v219 offset:26880
  v_mfma_f32_16x16x32_bf16 v[200:203], v[164:167], v[112:115], v[200:203]
  v_mfma_f32_16x16x32_bf16 v[200:203], v[168:171], v[116:119], v[200:203]
  v_mfma_f32_16x16x32_bf16 v[196:199], v[172:175], v[104:107], v[196:199]
  buffer_load_dword v229, off, s[28:31], s89 sc1
  v_mfma_f32_16x16x32_bf16 v[196:199], v[176:179], v[108:111], v[196:199]
  v_mfma_f32_16x16x32_bf16 v[200:203], v[172:175], v[120:123], v[200:203]
  v_mfma_f32_16x16x32_bf16 v[200:203], v[176:179], v[124:127], v[200:203]
  s_waitcnt lgkmcnt(12)
  v_mfma_f32_16x16x32_bf16 v[204:207], a[224:227], a[192:195], v[204:207]
  v_mfma_f32_16x16x32_bf16 v[204:207], a[228:231], a[196:199], v[204:207]
  v_mfma_f32_16x16x32_bf16 v[208:211], a[224:227], a[208:211], v[208:211]
  v_mfma_f32_16x16x32_bf16 v[208:211], a[228:231], a[212:215], v[208:211]
  v_mfma_f32_16x16x32_bf16 v[136:139], a[224:227], a[32:35], v[136:139]
  v_mfma_f32_16x16x32_bf16 v[136:139], a[228:231], a[36:39], v[136:139]
  s_waitcnt lgkmcnt(8)
  v_mfma_f32_16x16x32_bf16 v[204:207], a[232:235], a[200:203], v[204:207]
  v_mfma_f32_16x16x32_bf16 v[204:207], a[236:239], a[204:207], v[204:207]
  v_mfma_f32_16x16x32_bf16 v[208:211], a[232:235], a[216:219], v[208:211]
  v_mfma_f32_16x16x32_bf16 v[208:211], a[236:239], a[220:223], v[208:211]
  v_mfma_f32_16x16x32_bf16 v[136:139], a[232:235], a[40:43], v[136:139]
  v_mfma_f32_16x16x32_bf16 v[136:139], a[236:239], a[44:47], v[136:139]
  s_waitcnt lgkmcnt(4)
  v_mfma_f32_16x16x32_bf16 v[204:207], a[240:243], v[96:99], v[204:207]
  v_mfma_f32_16x16x32_bf16 v[204:207], a[244:247], v[100:103], v[204:207]
  v_mfma_f32_16x16x32_bf16 v[208:211], a[240:243], v[112:115], v[208:211]
  v_mfma_f32_16x16x32_bf16 v[208:211], a[244:247], v[116:119], v[208:211]
  v_mfma_f32_16x16x32_bf16 v[136:139], a[240:243], a[48:51], v[136:139]
  v_mfma_f32_16x16x32_bf16 v[136:139], a[244:247], a[52:55], v[136:139]
  s_waitcnt lgkmcnt(0)
  v_mfma_f32_16x16x32_bf16 v[204:207], a[248:251], v[104:107], v[204:207]
  v_mfma_f32_16x16x32_bf16 v[204:207], a[252:255], v[108:111], v[204:207]
  v_mfma_f32_16x16x32_bf16 v[208:211], a[248:251], v[120:123], v[208:211]
  v_mfma_f32_16x16x32_bf16 v[208:211], a[252:255], v[124:127], v[208:211]
  v_mfma_f32_16x16x32_bf16 v[136:139], a[248:251], a[56:59], v[136:139]
  v_mfma_f32_16x16x32_bf16 v[136:139], a[252:255], a[60:63], v[136:139]
  s_waitcnt vmcnt(1)
  v_mfma_f32_16x16x32_bf16 v[180:183], v[142:145], a[104:107], v[180:183]
  v_mfma_f32_16x16x32_bf16 v[188:191], v[140:143], a[104:107], v[188:191]
  v_mfma_f32_16x16x32_bf16 v[196:199], v[142:145], a[108:111], v[196:199]
  v_mfma_f32_16x16x32_bf16 v[204:207], v[140:143], a[108:111], v[204:207]
  v_mfma_f32_16x16x32_bf16 v[184:187], v[142:145], a[112:115], v[184:187]
  v_mfma_f32_16x16x32_bf16 v[192:195], v[140:143], a[112:115], v[192:195]
  v_mfma_f32_16x16x32_bf16 v[200:203], v[142:145], a[116:119], v[200:203]
  v_mfma_f32_16x16x32_bf16 v[208:211], v[140:143], a[116:119], v[208:211]
  v_mfma_f32_16x16x32_bf16 v[136:139], v[142:145], a[120:123], v[136:139]
  s_lshl_b32 s42, s36, 16
  s_add_u32 s42, s42, s88
  s_add_u32 s43, s42, 32768
  s_add_u32 s88, s88, 262144
  s_waitcnt vmcnt(0)
  v_readfirstlane_b32 s65, v229
  s_cmp_ge_u32 s65, 1
  s_cbranch_scc0 L_spin6
L_spin6_back:
  buffer_load_dwordx4 a[64:67], v225, s[28:31], s90 offen offset:0 sc1
  buffer_load_dwordx4 a[68:71], v225, s[28:31], s90 offen offset:1024 sc1
  buffer_load_dwordx4 a[72:75], v225, s[28:31], s90 offen offset:2048 sc1
  buffer_load_dwordx4 a[76:79], v225, s[28:31], s90 offen offset:3072 sc1
  buffer_load_dwordx2 a[80:81], v222, s[28:31], s91 offen sc1
  s_waitcnt vmcnt(0)
  v_mfma_f32_16x16x32_bf16 v[180:183], v[142:145], a[64:67], v[180:183]
  v_mfma_f32_16x16x32_bf16 v[188:191], v[140:143], a[64:67], v[188:191]
  v_mfma_f32_16x16x32_bf16 v[196:199], v[142:145], a[68:71], v[196:199]
  v_mfma_f32_16x16x32_bf16 v[204:207], v[140:143], a[68:71], v[204:207]
  v_mfma_f32_16x16x32_bf16 v[184:187], v[142:145], a[72:75], v[184:187]
  v_mfma_f32_16x16x32_bf16 v[192:195], v[140:143], a[72:75], v[192:195]
  v_mfma_f32_16x16x32_bf16 v[200:203], v[142:145], a[76:79], v[200:203]
  v_mfma_f32_16x16x32_bf16 v[208:211], v[140:143], a[76:79], v[208:211]
  v_mfma_f32_16x16x32_bf16 v[136:139], v[142:145], a[80:83], v[136:139]
  s_nop 4
  v_cvt_pk_bf16_f32 v64, v180, v181
  v_cvt_pk_bf16_f32 v65, v182, v183
  v_cvt_pk_bf16_f32 v66, v188, v189
  v_cvt_pk_bf16_f32 v67, v190, v191
  v_cvt_pk_bf16_f32 v68, v196, v197
  v_cvt_pk_bf16_f32 v69, v198, v199
  v_cvt_pk_bf16_f32 v70, v204, v205
  v_cvt_pk_bf16_f32 v71, v206, v207
  v_cvt_pk_bf16_f32 v72, v184, v185
  v_cvt_pk_bf16_f32 v73, v186, v187
  v_cvt_pk_bf16_f32 v74, v192, v193
  v_cvt_pk_bf16_f32 v75, v194, v195
  v_cvt_pk_bf16_f32 v76, v200, v201
  v_cvt_pk_bf16_f32 v77, v202, v203
  v_cvt_pk_bf16_f32 v78, v208, v209
  v_cvt_pk_bf16_f32 v79, v210, v211
  v_cvt_pk_bf16_f32 v80, v136, v137
  v_cvt_pk_bf16_f32 v81, v138, v139
  v_permlane32_swap_b32 v64, v66
  v_permlane32_swap_b32 v65, v67
  v_permlane32_swap_b32 v68, v70
  v_permlane32_swap_b32 v69, v71
  v_permlane32_swap_b32 v72, v74
  v_permlane32_swap_b32 v73, v75
  v_permlane32_swap_b32 v76, v78
  v_permlane32_swap_b32 v77, v79
  buffer_store_dwordx2 v[80:81], v90, s[8:11], s88 offen
  v_permlane16_swap_b32 v64, v66
  v_permlane16_swap_b32 v65, v67
  buffer_store_dwordx4 v[64:67], v88, s[8:11], s42 offen
  v_permlane16_swap_b32 v68, v70
  v_permlane16_swap_b32 v69, v71
  buffer_store_dwordx4 v[68:71], v89, s[8:11], s42 offen
  v_permlane16_swap_b32 v72, v74
  v_permlane16_swap_b32 v73, v75
  buffer_store_dwordx4 v[72:75], v88, s[8:11], s43 offen
  v_permlane16_swap_b32 v76, v78
  v_permlane16_swap_b32 v77, v79
  buffer_store_dwordx4 v[76:79], v89, s[8:11], s43 offen
  s_endpgm
L_retry:
  s_waitcnt vmcnt(0) lgkmcnt(0)
  s_barrier
  s_mov_b32 s44, 1
  s_mov_b32 s70, 0
  s_nop 7
  v_lshrrev_b32 v96, 4, v225
  v_and_b32 v97, 7, v96
  v_mul_u32_u24 v97, 1056, v97
  v_bfe_u32 v98, v96, 3, 1
  v_lshl_add_u32 v97, v98, 8, v97
  v_lshrrev_b32 v98, 4, v96
  v_lshl_add_u32 v212, v98, 4, v97
  v_bfe_u32 v97, v96, 2, 3
  v_mul_u32_u24 v97, 1056, v97
  v_lshrrev_b32 v98, 5, v96
  v_lshl_add_u32 v97, v98, 8, v97
  v_and_b32 v98, 3, v96
  v_lshl_add_u32 v97, v98, 3, v97
  v_add_u32 v216, 69632, v97
  s_add_u32 s42, s36, 3
  s_and_b32 s42, s42, 3
  s_mul_i32 s42, s42, 8704
  v_add_u32 v215, s42, v212
  v_add_u32 v219, s42, v216
  s_add_u32 s42, s36, 2
  s_and_b32 s42, s42, 3
  s_mul_i32 s42, s42, 8704
  v_add_u32 v214, s42, v212
  v_add_u32 v218, s42, v216
  s_add_u32 s42, s36, 1
  s_and_b32 s42, s42, 3
  s_mul_i32 s42, s42, 8704
  v_add_u32 v213, s42, v212
  v_add_u32 v217, s42, v216
  s_add_u32 s42, s36, 0
  s_and_b32 s42, s42, 3
  s_mul_i32 s42, s42, 8704
  v_add_u32 v212, s42, v212
  v_add_u32 v216, s42, v216
  ds_read_b128 v[180:183], v248 offset:0
  ds_read_b128 v[184:187], v248 offset:1024
  ds_read_b128 v[188:191], v248 offset:2048
  ds_read_b128 v[192:195], v248 offset:3072
  v_mov_b32 v250, 0xff800000
  v_mov_b32 v251, 0xff800000
  v_mov_b32 v252, 0xff800000
L_mx_chunk:
  s_lshl_b32 s71, s70, 15
  s_and_b32 s65, s0, 0xfffe7fff
  s_add_u32 s71, s71, s65
  s_add_u32 s42, s71, 0
  s_mov_b32 m0, s37
  s_nop 0
  buffer_load_dwordx4 v225, s[16:19], s42 offen lds
  s_add_u32 m0, m0, 32
  s_nop 0
  buffer_load_dwordx4 v225, s[16:19], s42 offen offset:1024 lds
  s_add_u32 m0, m0, 32
  s_nop 0
  buffer_load_dwordx4 v225, s[16:19], s42 offen offset:2048 lds
  s_add_u32 m0, m0, 32
  s_nop 0
  buffer_load_dwordx4 v225, s[16:19], s42 offen offset:3072 lds
  s_add_u32 s42, s42, s52
  s_add_u32 m0, m0, s53
  s_nop 0
  buffer_load_dwordx4 v225, s[16:19], s42 offen lds
  s_add_u32 m0, m0, 32
  s_nop 0
  buffer_load_dwordx4 v225, s[16:19], s42 offen offset:1024 lds
  s_add_u32 m0, m0, 32
  s_nop 0
  buffer_load_dwordx4 v225, s[16:19], s42 offen offset:2048 lds
  s_add_u32 m0, m0, 32
  s_nop 0
  buffer_load_dwordx4 v225, s[16:19], s42 offen offset:3072 lds
  s_waitcnt vmcnt(0)
  s_barrier
  ds_read_b128 v[148:151], v212 offset:0
  ds_read_b128 v[152:155], v212 offset:64
  ds_read_b128 v[156:159], v212 offset:128
  ds_read_b128 v[160:163], v212 offset:192
  s_waitcnt lgkmcnt(0)
  v_mfma_f32_16x16x32_bf16 v[96:99], v[148:151], v[64:67], 0
  v_mfma_f32_16x16x32_bf16 v[96:99], v[152:155], v[68:71], v[96:99]
  v_mfma_f32_16x16x32_bf16 v[96:99], v[156:159], v[72:75], v[96:99]
  v_mfma_f32_16x16x32_bf16 v[96:99], v[160:163], v[76:79], v[96:99]
  v_mfma_f32_16x16x32_bf16 v[100:103], v[148:151], v[80:83], 0
  v_mfma_f32_16x16x32_bf16 v[100:103], v[152:155], v[84:87], v[100:103]
  v_mfma_f32_16x16x32_bf16 v[100:103], v[156:159], v[88:91], v[100:103]
  v_mfma_f32_16x16x32_bf16 v[100:103], v[160:163], v[92:95], v[100:103]
  v_mfma_f32_16x16x32_bf16 v[104:107], v[148:151], v[180:183], 0
  v_mfma_f32_16x16x32_bf16 v[104:107], v[152:155], v[184:187], v[104:107]
  v_mfma_f32_16x16x32_bf16 v[104:107], v[156:159], v[188:191], v[104:107]
  v_mfma_f32_16x16x32_bf16 v[104:107], v[160:163], v[192:195], v[104:107]
  s_nop 7
  v_max3_f32 v250, v96, v97, v250
  v_max3_f32 v250, v98, v99, v250
  v_max3_f32 v251, v100, v101, v251
  v_max3_f32 v251, v102, v103, v251
  v_max3_f32 v252, v104, v105, v252
  v_max3_f32 v252, v106, v107, v252
  s_nop 3
  ds_read_b128 v[148:151], v212 offset:512
  ds_read_b128 v[152:155], v212 offset:576
  ds_read_b128 v[156:159], v212 offset:640
  ds_read_b128 v[160:163], v212 offset:704
  s_waitcnt lgkmcnt(0)
  v_mfma_f32_16x16x32_bf16 v[96:99], v[148:151], v[64:67], 0
  v_mfma_f32_16x16x32_bf16 v[96:99], v[152:155], v[68:71], v[96:99]
  v_mfma_f32_16x16x32_bf16 v[96:99], v[156:159], v[72:75], v[96:99]
  v_mfma_f32_16x16x32_bf16 v[96:99], v[160:163], v[76:79], v[96:99]
  v_mfma_f32_16x16x32_bf16 v[100:103], v[148:151], v[80:83], 0
  v_mfma_f32_16x16x32_bf16 v[100:103], v[152:155], v[84:87], v[100:103]
  v_mfma_f32_16x16x32_bf16 v[100:103], v[156:159], v[88:91], v[100:103]
  v_mfma_f32_16x16x32_bf16 v[100:103], v[160:163], v[92:95], v[100:103]
  v_mfma_f32_16x16x32_bf16 v[104:107], v[148:151], v[180:183], 0
  v_mfma_f32_16x16x32_bf16 v[104:107], v[152:155], v[184:187], v[104:107]
  v_mfma_f32_16x16x32_bf16 v[104:107], v[156:159], v[188:191], v[104:107]
  v_mfma_f32_16x16x32_bf16 v[104:107], v[160:163], v[192:195], v[104:107]
  s_nop 7
  v_max3_f32 v250, v96, v97, v250
  v_max3_f32 v250, v98, v99, v250
  v_max3_f32 v251, v100, v101, v251
  v_max3_f32 v251, v102, v103, v251
  v_max3_f32 v252, v104, v105, v252
  v_max3_f32 v252, v106, v107, v252
  s_nop 3
  ds_read_b128 v[148:151], v213 offset:0
  ds_read_b128 v[152:155], v213 offset:64
  ds_read_b128 v[156:159], v213 offset:128
  ds_read_b128 v[160:163], v213 offset:192
  s_waitcnt lgkmcnt(0)
  v_mfma_f32_16x16x32_bf16 v[96:99], v[148:151], v[64:67], 0
  v_mfma_f32_16x16x32_bf16 v[96:99], v[152:155], v[68:71], v[96:99]
  v_mfma_f32_16x16x32_bf16 v[96:99], v[156:159], v[72:75], v[96:99]
  v_mfma_f32_16x16x32_bf16 v[96:99], v[160:163], v[76:79], v[96:99]
  v_mfma_f32_16x16x32_bf16 v[100:103], v[148:151], v[80:83], 0
  v_mfma_f32_16x16x32_bf16 v[100:103], v[152:155], v[84:87], v[100:103]
  v_mfma_f32_16x16x32_bf16 v[100:103], v[156:159], v[88:91], v[100:103]
  v_mfma_f32_16x16x32_bf16 v[100:103], v[160:163], v[92:95], v[100:103]
  v_mfma_f32_16x16x32_bf16 v[104:107], v[148:151], v[180:183], 0
  v_mfma_f32_16x16x32_bf16 v[104:107], v[152:155], v[184:187], v[104:107]
  v_mfma_f32_16x16x32_bf16 v[104:107], v[156:159], v[188:191], v[104:107]
  v_mfma_f32_16x16x32_bf16 v[104:107], v[160:163], v[192:195], v[104:107]
  s_nop 7
  v_max3_f32 v250, v96, v97, v250
  v_max3_f32 v250, v98, v99, v250
  v_max3_f32 v251, v100, v101, v251
  v_max3_f32 v251, v102, v103, v251
  v_max3_f32 v252, v104, v105, v252
  v_max3_f32 v252, v106, v107, v252
  s_nop 3
  ds_read_b128 v[148:151], v213 offset:512
  ds_read_b128 v[152:155], v213 offset:576
  ds_read_b128 v[156:159], v213 offset:640
  ds_read_b128 v[160:163], v213 offset:704
  s_waitcnt lgkmcnt(0)
  v_mfma_f32_16x16x32_bf16 v[96:99], v[148:151], v[64:67], 0
  v_mfma_f32_16x16x32_bf16 v[96:99], v[152:155], v[68:71], v[96:99]
  v_mfma_f32_16x16x32_bf16 v[96:99], v[156:159], v[72:75], v[96:99]
  v_mfma_f32_16x16x32_bf16 v[96:99], v[160:163], v[76:79], v[96:99]
  v_mfma_f32_16x16x32_bf16 v[100:103], v[148:151], v[80:83], 0
  v_mfma_f32_16x16x32_bf16 v[100:103], v[152:155], v[84:87], v[100:103]
  v_mfma_f32_16x16x32_bf16 v[100:103], v[156:159], v[88:91], v[100:103]
  v_mfma_f32_16x16x32_bf16 v[100:103], v[160:163], v[92:95], v[100:103]
  v_mfma_f32_16x16x32_bf16 v[104:107], v[148:151], v[180:183], 0
  v_mfma_f32_16x16x32_bf16 v[104:107], v[152:155], v[184:187], v[104:107]
  v_mfma_f32_16x16x32_bf16 v[104:107], v[156:159], v[188:191], v[104:107]
  v_mfma_f32_16x16x32_bf16 v[104:107], v[160:163], v[192:195], v[104:107]
  s_nop 7
  v_max3_f32 v250, v96, v97, v250
  v_max3_f32 v250, v98, v99, v250
  v_max3_f32 v251, v100, v101, v251
  v_max3_f32 v251, v102, v103, v251
  v_max3_f32 v252, v104, v105, v252
  v_max3_f32 v252, v106, v107, v252
  s_nop 3
  ds_read_b128 v[148:151], v214 offset:0
  ds_read_b128 v[152:155], v214 offset:64
  ds_read_b128 v[156:159], v214 offset:128
  ds_read_b128 v[160:163], v214 offset:192
  s_waitcnt lgkmcnt(0)
  v_mfma_f32_16x16x32_bf16 v[96:99], v[148:151], v[64:67], 0
  v_mfma_f32_16x16x32_bf16 v[96:99], v[152:155], v[68:71], v[96:99]
  v_mfma_f32_16x16x32_bf16 v[96:99], v[156:159], v[72:75], v[96:99]
  v_mfma_f32_16x16x32_bf16 v[96:99], v[160:163], v[76:79], v[96:99]
  v_mfma_f32_16x16x32_bf16 v[100:103], v[148:151], v[80:83], 0
  v_mfma_f32_16x16x32_bf16 v[100:103], v[152:155], v[84:87], v[100:103]
  v_mfma_f32_16x16x32_bf16 v[100:103], v[156:159], v[88:91], v[100:103]
  v_mfma_f32_16x16x32_bf16 v[100:103], v[160:163], v[92:95], v[100:103]
  v_mfma_f32_16x16x32_bf16 v[104:107], v[148:151], v[180:183], 0
  v_mfma_f32_16x16x32_bf16 v[104:107], v[152:155], v[184:187], v[104:107]
  v_mfma_f32_16x16x32_bf16 v[104:107], v[156:159], v[188:191], v[104:107]
  v_mfma_f32_16x16x32_bf16 v[104:107], v[160:163], v[192:195], v[104:107]
  s_nop 7
  v_max3_f32 v250, v96, v97, v250
  v_max3_f32 v250, v98, v99, v250
  v_max3_f32 v251, v100, v101, v251
  v_max3_f32 v251, v102, v103, v251
  v_max3_f32 v252, v104, v105, v252
  v_max3_f32 v252, v106, v107, v252
  s_nop 3
  ds_read_b128 v[148:151], v214 offset:512
  ds_read_b128 v[152:155], v214 offset:576
  ds_read_b128 v[156:159], v214 offset:640
  ds_read_b128 v[160:163], v214 offset:704
  s_waitcnt lgkmcnt(0)
  v_mfma_f32_16x16x32_bf16 v[96:99], v[148:151], v[64:67], 0
  v_mfma_f32_16x16x32_bf16 v[96:99], v[152:155], v[68:71], v[96:99]
  v_mfma_f32_16x16x32_bf16 v[96:99], v[156:159], v[72:75], v[96:99]
  v_mfma_f32_16x16x32_bf16 v[96:99], v[160:163], v[76:79], v[96:99]
  v_mfma_f32_16x16x32_bf16 v[100:103], v[148:151], v[80:83], 0
  v_mfma_f32_16x16x32_bf16 v[100:103], v[152:155], v[84:87], v[100:103]
  v_mfma_f32_16x16x32_bf16 v[100:103], v[156:159], v[88:91], v[100:103]
  v_mfma_f32_16x16x32_bf16 v[100:103], v[160:163], v[92:95], v[100:103]
  v_mfma_f32_16x16x32_bf16 v[104:107], v[148:151], v[180:183], 0
  v_mfma_f32_16x16x32_bf16 v[104:107], v[152:155], v[184:187], v[104:107]
  v_mfma_f32_16x16x32_bf16 v[104:107], v[156:159], v[188:191], v[104:107]
  v_mfma_f32_16x16x32_bf16 v[104:107], v[160:163], v[192:195], v[104:107]
  s_nop 7
  v_max3_f32 v250, v96, v97, v250
  v_max3_f32 v250, v98, v99, v250
  v_max3_f32 v251, v100, v101, v251
  v_max3_f32 v251, v102, v103, v251
  v_max3_f32 v252, v104, v105, v252
  v_max3_f32 v252, v106, v107, v252
  s_nop 3
  ds_read_b128 v[148:151], v215 offset:0
  ds_read_b128 v[152:155], v215 offset:64
  ds_read_b128 v[156:159], v215 offset:128
  ds_read_b128 v[160:163], v215 offset:192
  s_waitcnt lgkmcnt(0)
  v_mfma_f32_16x16x32_bf16 v[96:99], v[148:151], v[64:67], 0
  v_mfma_f32_16x16x32_bf16 v[96:99], v[152:155], v[68:71], v[96:99]
  v_mfma_f32_16x16x32_bf16 v[96:99], v[156:159], v[72:75], v[96:99]
  v_mfma_f32_16x16x32_bf16 v[96:99], v[160:163], v[76:79], v[96:99]
  v_mfma_f32_16x16x32_bf16 v[100:103], v[148:151], v[80:83], 0
  v_mfma_f32_16x16x32_bf16 v[100:103], v[152:155], v[84:87], v[100:103]
  v_mfma_f32_16x16x32_bf16 v[100:103], v[156:159], v[88:91], v[100:103]
  v_mfma_f32_16x16x32_bf16 v[100:103], v[160:163], v[92:95], v[100:103]
  v_mfma_f32_16x16x32_bf16 v[104:107], v[148:151], v[180:183], 0
  v_mfma_f32_16x16x32_bf16 v[104:107], v[152:155], v[184:187], v[104:107]
  v_mfma_f32_16x16x32_bf16 v[104:107], v[156:159], v[188:191], v[104:107]
  v_mfma_f32_16x16x32_bf16 v[104:107], v[160:163], v[192:195], v[104:107]
  s_nop 7
  v_max3_f32 v250, v96, v97, v250
  v_max3_f32 v250, v98, v99, v250
  v_max3_f32 v251, v100, v101, v251
  v_max3_f32 v251, v102, v103, v251
  v_max3_f32 v252, v104, v105, v252
  v_max3_f32 v252, v106, v107, v252
  s_nop 3
  ds_read_b128 v[148:151], v215 offset:512
  ds_read_b128 v[152:155], v215 offset:576
  ds_read_b128 v[156:159], v215 offset:640
  ds_read_b128 v[160:163], v215 offset:704
  s_waitcnt lgkmcnt(0)
  v_mfma_f32_16x16x32_bf16 v[96:99], v[148:151], v[64:67], 0
  v_mfma_f32_16x16x32_bf16 v[96:99], v[152:155], v[68:71], v[96:99]
  v_mfma_f32_16x16x32_bf16 v[96:99], v[156:159], v[72:75], v[96:99]
  v_mfma_f32_16x16x32_bf16 v[96:99], v[160:163], v[76:79], v[96:99]
  v_mfma_f32_16x16x32_bf16 v[100:103], v[148:151], v[80:83], 0
  v_mfma_f32_16x16x32_bf16 v[100:103], v[152:155], v[84:87], v[100:103]
  v_mfma_f32_16x16x32_bf16 v[100:103], v[156:159], v[88:91], v[100:103]
  v_mfma_f32_16x16x32_bf16 v[100:103], v[160:163], v[92:95], v[100:103]
  v_mfma_f32_16x16x32_bf16 v[104:107], v[148:151], v[180:183], 0
  v_mfma_f32_16x16x32_bf16 v[104:107], v[152:155], v[184:187], v[104:107]
  v_mfma_f32_16x16x32_bf16 v[104:107], v[156:159], v[188:191], v[104:107]
  v_mfma_f32_16x16x32_bf16 v[104:107], v[160:163], v[192:195], v[104:107]
  s_nop 7
  v_max3_f32 v250, v96, v97, v250
  v_max3_f32 v250, v98, v99, v250
  v_max3_f32 v251, v100, v101, v251
  v_max3_f32 v251, v102, v103, v251
  v_max3_f32 v252, v104, v105, v252
  v_max3_f32 v252, v106, v107, v252
  s_nop 3
  s_barrier
  s_add_u32 s70, s70, 1
  s_cmp_lt_u32 s70, 4
  s_cbranch_scc1 L_mx_chunk
  v_mov_b32 v96, v250
  s_nop 1
  v_permlane32_swap_b32 v96, v250
  s_nop 1
  v_max_f32 v250, v250, v96
  v_mov_b32 v96, v250
  s_nop 1
  v_permlane16_swap_b32 v96, v250
  s_nop 1
  v_max_f32 v250, v250, v96
  v_sub_f32 v136, 0, v250
  v_sub_f32 v137, 0, v250
  v_sub_f32 v138, 0, v250
  v_sub_f32 v139, 0, v250
  v_mov_b32 v96, v251
  s_nop 1
  v_permlane32_swap_b32 v96, v251
  s_nop 1
  v_max_f32 v251, v251, v96
  v_mov_b32 v96, v251
  s_nop 1
  v_permlane16_swap_b32 v96, v251
  s_nop 1
  v_max_f32 v251, v251, v96
  v_sub_f32 v140, 0, v251
  v_sub_f32 v141, 0, v251
  v_sub_f32 v142, 0, v251
  v_sub_f32 v143, 0, v251
  v_mov_b32 v96, v252
  s_nop 1
  v_permlane32_swap_b32 v96, v252
  s_nop 1
  v_max_f32 v252, v252, v96
  v_mov_b32 v96, v252
  s_nop 1
  v_permlane16_swap_b32 v96, v252
  s_nop 1
  v_max_f32 v252, v252, v96
  v_sub_f32 v144, 0, v252
  v_sub_f32 v145, 0, v252
  v_sub_f32 v146, 0, v252
  v_sub_f32 v147, 0, v252
  s_add_u32 s42, s0, 0
  s_mov_b32 m0, s37
  s_nop 0
  buffer_load_dwordx4 v225, s[16:19], s42 offen nt lds
  s_add_u32 m0, m0, 32
  s_nop 0
  buffer_load_dwordx4 v225, s[16:19], s42 offen offset:1024 nt lds
  s_add_u32 m0, m0, 32
  s_nop 0
  buffer_load_dwordx4 v225, s[16:19], s42 offen offset:2048 nt lds
  s_add_u32 m0, m0, 32
  s_nop 0
  buffer_load_dwordx4 v225, s[16:19], s42 offen offset:3072 nt lds
  s_add_u32 s42, s42, s52
  s_add_u32 m0, m0, s53
  s_nop 0
  buffer_load_dwordx4 v225, s[16:19], s42 offen nt lds
  s_add_u32 m0, m0, 32
  s_nop 0
  buffer_load_dwordx4 v225, s[16:19], s42 offen offset:1024 nt lds
  s_add_u32 m0, m0, 32
  s_nop 0
  buffer_load_dwordx4 v225, s[16:19], s42 offen offset:2048 nt lds
  s_add_u32 m0, m0, 32
  s_nop 0
  buffer_load_dwordx4 v225, s[16:19], s42 offen offset:3072 nt lds
  s_add_u32 s42, s0, 0
  s_mov_b32 m0, s38
  s_nop 0
  buffer_load_dwordx4 v225, s[20:23], s42 offen nt lds
  s_add_u32 m0, m0, 32
  s_nop 0
  buffer_load_dwordx4 v225, s[20:23], s42 offen offset:1024 nt lds
  s_add_u32 m0, m0, 32
  s_nop 0
  buffer_load_dwordx4 v225, s[20:23], s42 offen offset:2048 nt lds
  s_add_u32 m0, m0, 32
  s_nop 0
  buffer_load_dwordx4 v225, s[20:23], s42 offen offset:3072 nt lds
  s_add_u32 s42, s42, s52
  s_add_u32 m0, m0, s53
  s_nop 0
  buffer_load_dwordx4 v225, s[20:23], s42 offen nt lds
  s_add_u32 m0, m0, 32
  s_nop 0
  buffer_load_dwordx4 v225, s[20:23], s42 offen offset:1024 nt lds
  s_add_u32 m0, m0, 32
  s_nop 0
  buffer_load_dwordx4 v225, s[20:23], s42 offen offset:2048 nt lds
  s_add_u32 m0, m0, 32
  s_nop 0
  buffer_load_dwordx4 v225, s[20:23], s42 offen offset:3072 nt lds
  s_add_u32 s42, s1, 0
  s_mov_b32 m0, s39
  s_nop 0
  buffer_load_dwordx4 v225, s[16:19], s42 offen nt lds
  s_add_u32 m0, m0, 32
  s_nop 0
  buffer_load_dwordx4 v225, s[16:19], s42 offen offset:1024 nt lds
  s_add_u32 m0, m0, 32
  s_nop 0
  buffer_load_dwordx4 v225, s[16:19], s42 offen offset:2048 nt lds
  s_add_u32 m0, m0, 32
  s_nop 0
  buffer_load_dwordx4 v225, s[16:19], s42 offen offset:3072 nt lds
  s_add_u32 s42, s42, s52
  s_add_u32 m0, m0, s53
  s_nop 0
  buffer_load_dwordx4 v225, s[16:19], s42 offen nt lds
  s_add_u32 m0, m0, 32
  s_nop 0
  buffer_load_dwordx4 v225, s[16:19], s42 offen offset:1024 nt lds
  s_add_u32 m0, m0, 32
  s_nop 0
  buffer_load_dwordx4 v225, s[16:19], s42 offen offset:2048 nt lds
  s_add_u32 m0, m0, 32
  s_nop 0
  buffer_load_dwordx4 v225, s[16:19], s42 offen offset:3072 nt lds
  s_waitcnt vmcnt(0)
  s_barrier
  ds_read_b128 v[148:151], v212 offset:0
  ds_read_b128 v[152:155], v212 offset:64
  ds_read_b128 v[156:159], v212 offset:128
  ds_read_b128 v[160:163], v212 offset:192
  s_waitcnt lgkmcnt(0)
  s_branch L_attn
L_spin_r:
  s_sleep 2
  v_bfe_u32 v229, v225, 4, 3
  buffer_load_ubyte v229, v229, s[4:7], s89 offen sc1
  s_add_u32 s93, s93, 1
  s_waitcnt vmcnt(0)
  v_cmp_eq_u32 vcc, 0, v229
  s_cmp_gt_u32 s93, 0x100000
  s_cbranch_scc1 L_spin_r_back
  s_cbranch_vccnz L_spin_r
  s_branch L_spin_r_back
L_spin0:
  s_sleep 2
  buffer_load_dword v229, off, s[28:31], s89 sc1
  s_add_u32 s93, s93, 1
  s_waitcnt vmcnt(0)
  v_readfirstlane_b32 s65, v229
  s_cmp_gt_u32 s93, 0x100000
  s_cbranch_scc1 L_spin0_back
  s_cmp_ge_u32 s65, 1
  s_cbranch_scc0 L_spin0
  s_branch L_spin0_back
L_spin1:
  s_sleep 2
  buffer_load_dword v229, off, s[28:31], s89 sc1
  s_add_u32 s93, s93, 1
  s_waitcnt vmcnt(0)
  v_readfirstlane_b32 s65, v229
  s_cmp_gt_u32 s93, 0x100000
  s_cbranch_scc1 L_spin1_back
  s_cmp_ge_u32 s65, 1
  s_cbranch_scc0 L_spin1
  s_branch L_spin1_back
L_spin2:
  s_sleep 2
  buffer_load_dword v229, off, s[28:31], s89 sc1
  s_add_u32 s93, s93, 1
  s_waitcnt vmcnt(0)
  v_readfirstlane_b32 s65, v229
  s_cmp_gt_u32 s93, 0x100000
  s_cbranch_scc1 L_spin2_back
  s_cmp_ge_u32 s65, 1
  s_cbranch_scc0 L_spin2
  s_branch L_spin2_back
L_spin3:
  s_sleep 2
  buffer_load_dword v229, off, s[28:31], s89 sc1
  s_add_u32 s93, s93, 1
  s_waitcnt vmcnt(0)
  v_readfirstlane_b32 s65, v229
  s_cmp_gt_u32 s93, 0x100000
  s_cbranch_scc1 L_spin3_back
  s_cmp_ge_u32 s65, 1
  s_cbranch_scc0 L_spin3
  s_branch L_spin3_back
L_spin4:
  s_sleep 2
  buffer_load_dword v229, off, s[28:31], s89 sc1
  s_add_u32 s93, s93, 1
  s_waitcnt vmcnt(0)
  v_readfirstlane_b32 s65, v229
  s_cmp_gt_u32 s93, 0x100000
  s_cbranch_scc1 L_spin4_back
  s_cmp_ge_u32 s65, 1
  s_cbranch_scc0 L_spin4
  s_branch L_spin4_back
L_spin5:
  s_sleep 2
  buffer_load_dword v229, off, s[28:31], s89 sc1
  s_add_u32 s93, s93, 1
  s_waitcnt vmcnt(0)
  v_readfirstlane_b32 s65, v229
  s_cmp_gt_u32 s93, 0x100000
  s_cbranch_scc1 L_spin5_back
  s_cmp_ge_u32 s65, 1
  s_cbranch_scc0 L_spin5
  s_branch L_spin5_back
L_spin6:
  s_sleep 2
  buffer_load_dword v229, off, s[28:31], s89 sc1
  s_add_u32 s93, s93, 1
  s_waitcnt vmcnt(0)
  v_readfirstlane_b32 s65, v229
  s_cmp_gt_u32 s93, 0x100000
  s_cbranch_scc1 L_spin6_back
  s_cmp_ge_u32 s65, 1
  s_cbranch_scc0 L_spin6
  s_branch L_spin6_back
L_b1:
  s_add_u32 s42, s0, 0
  s_mov_b32 m0, s37
  s_nop 0
  buffer_load_dwordx4 v225, s[16:19], s42 offen nt lds
  s_add_u32 m0, m0, 32
  s_nop 0
  buffer_load_dwordx4 v225, s[16:19], s42 offen offset:1024 nt lds
  s_add_u32 m0, m0, 32
  s_nop 0
  buffer_load_dwordx4 v225, s[16:19], s42 offen offset:2048 nt lds
  s_add_u32 m0, m0, 32
  s_nop 0
  buffer_load_dwordx4 v225, s[16:19], s42 offen offset:3072 nt lds
  s_add_u32 s42, s42, s52
  s_add_u32 m0, m0, s53
  s_nop 0
  buffer_load_dwordx4 v225, s[16:19], s42 offen nt lds
  s_add_u32 m0, m0, 32
  s_nop 0
  buffer_load_dwordx4 v225, s[16:19], s42 offen offset:1024 nt lds
  s_add_u32 m0, m0, 32
  s_nop 0
  buffer_load_dwordx4 v225, s[16:19], s42 offen offset:2048 nt lds
  s_add_u32 m0, m0, 32
  s_nop 0
  buffer_load_dwordx4 v225, s[16:19], s42 offen offset:3072 nt lds
  s_lshl_b32 s42, s36, 12
  s_add_u32 s42, s42, 131072
  s_mul_i32 s65, s36, 4160
  s_add_u32 m0, s65, 139264
  s_nop 0
  buffer_load_dwordx4 v7, s[8:11], s42 offen lds
  s_add_u32 m0, m0, 16
  s_nop 0
  buffer_load_dwordx4 v7, s[8:11], s42 offen offset:1024 lds
  s_add_u32 m0, m0, 16
  s_nop 0
  buffer_load_dwordx4 v7, s[8:11], s42 offen offset:2048 lds
  s_add_u32 m0, m0, 16
  s_nop 0
  buffer_load_dwordx4 v7, s[8:11], s42 offen offset:3072 lds
  s_branch L_join
L_b2:
  s_add_u32 s42, s0, 0
  s_mov_b32 m0, s38
  s_nop 0
  buffer_load_dwordx4 v225, s[20:23], s42 offen nt lds
  s_add_u32 m0, m0, 32
  s_nop 0
  buffer_load_dwordx4 v225, s[20:23], s42 offen offset:1024 nt lds
  s_add_u32 m0, m0, 32
  s_nop 0
  buffer_load_dwordx4 v225, s[20:23], s42 offen offset:2048 nt lds
  s_add_u32 m0, m0, 32
  s_nop 0
  buffer_load_dwordx4 v225, s[20:23], s42 offen offset:3072 nt lds
  s_add_u32 s42, s42, s52
  s_add_u32 m0, m0, s53
  s_nop 0
  buffer_load_dwordx4 v225, s[20:23], s42 offen nt lds
  s_add_u32 m0, m0, 32
  s_nop 0
  buffer_load_dwordx4 v225, s[20:23], s42 offen offset:1024 nt lds
  s_add_u32 m0, m0, 32
  s_nop 0
  buffer_load_dwordx4 v225, s[20:23], s42 offen offset:2048 nt lds
  s_add_u32 m0, m0, 32
  s_nop 0
  buffer_load_dwordx4 v225, s[20:23], s42 offen offset:3072 nt lds
  v_add_u32 v245, 34816, v245
  v_add_u32 v246, 34816, v246
  s_add_u32 s42, s90, 0
  s_mov_b32 m0, s39
  s_nop 0
  buffer_load_dwordx4 v244, s[8:11], s42 offen lds
  s_add_u32 m0, m0, 32
  s_nop 0
  buffer_load_dwordx4 v244, s[8:11], s42 offen offset:1024 lds
  s_add_u32 m0, m0, 32
  s_nop 0
  buffer_load_dwordx4 v244, s[8:11], s42 offen offset:2048 lds
  s_add_u32 m0, m0, 32
  s_nop 0
  buffer_load_dwordx4 v244, s[8:11], s42 offen offset:3072 lds
  s_add_u32 s42, s42, s52
  s_add_u32 m0, m0, s53
  s_nop 0
  buffer_load_dwordx4 v244, s[8:11], s42 offen lds
  s_add_u32 m0, m0, 32
  s_nop 0
  buffer_load_dwordx4 v244, s[8:11], s42 offen offset:1024 lds
  s_add_u32 m0, m0, 32
  s_nop 0
  buffer_load_dwordx4 v244, s[8:11], s42 offen offset:2048 lds
  s_add_u32 m0, m0, 32
  s_nop 0
  buffer_load_dwordx4 v244, s[8:11], s42 offen offset:3072 lds
  s_add_u32 s42, s90, 256
  s_mov_b32 m0, s40
  s_nop 0
  buffer_load_dwordx4 v244, s[8:11], s42 offen lds
  s_add_u32 m0, m0, 32
  s_nop 0
  buffer_load_dwordx4 v244, s[8:11], s42 offen offset:1024 lds
  s_add_u32 m0, m0, 32
  s_nop 0
  buffer_load_dwordx4 v244, s[8:11], s42 offen offset:2048 lds
  s_add_u32 m0, m0, 32
  s_nop 0
  buffer_load_dwordx4 v244, s[8:11], s42 offen offset:3072 lds
  s_add_u32 s42, s42, s52
  s_add_u32 m0, m0, s53
  s_nop 0
  buffer_load_dwordx4 v244, s[8:11], s42 offen lds
  s_add_u32 m0, m0, 32
  s_nop 0
  buffer_load_dwordx4 v244, s[8:11], s42 offen offset:1024 lds
  s_add_u32 m0, m0, 32
  s_nop 0
  buffer_load_dwordx4 v244, s[8:11], s42 offen offset:2048 lds
  s_add_u32 m0, m0, 32
  s_nop 0
  buffer_load_dwordx4 v244, s[8:11], s42 offen offset:3072 lds
  s_waitcnt vmcnt(8)
  ds_read_b64 a[0:1], v245 offset:0
  ds_read_b64 a[2:3], v245 offset:32
  ds_read_b64 a[4:5], v245 offset:64
  ds_read_b64 a[6:7], v245 offset:96
  ds_read_b64 a[8:9], v245 offset:128
  ds_read_b64 a[10:11], v245 offset:160
  ds_read_b64 a[12:13], v245 offset:192
  ds_read_b64 a[14:15], v245 offset:224
  ds_read_b64 a[64:65], v245 offset:512
  ds_read_b64 a[66:67], v245 offset:544
  ds_read_b64 a[68:69], v245 offset:576
  ds_read_b64 a[70:71], v245 offset:608
  ds_read_b64 a[72:73], v245 offset:640
  ds_read_b64 a[74:75], v245 offset:672
  ds_read_b64 a[76:77], v245 offset:704
  ds_read_b64 a[78:79], v245 offset:736
  s_waitcnt lgkmcnt(0)
  s_add_u32 s42, s91, 512
  s_mov_b32 m0, s39
  s_nop 0
  buffer_load_dwordx4 v244, s[8:11], s42 offen lds
  s_add_u32 m0, m0, 32
  s_nop 0
  buffer_load_dwordx4 v244, s[8:11], s42 offen offset:1024 lds
  s_add_u32 m0, m0, 32
  s_nop 0
  buffer_load_dwordx4 v244, s[8:11], s42 offen offset:2048 lds
  s_add_u32 m0, m0, 32
  s_nop 0
  buffer_load_dwordx4 v244, s[8:11], s42 offen offset:3072 lds
  s_add_u32 s42, s42, s52
  s_add_u32 m0, m0, s53
  s_nop 0
  buffer_load_dwordx4 v244, s[8:11], s42 offen lds
  s_add_u32 m0, m0, 32
  s_nop 0
  buffer_load_dwordx4 v244, s[8:11], s42 offen offset:1024 lds
  s_add_u32 m0, m0, 32
  s_nop 0
  buffer_load_dwordx4 v244, s[8:11], s42 offen offset:2048 lds
  s_add_u32 m0, m0, 32
  s_nop 0
  buffer_load_dwordx4 v244, s[8:11], s42 offen offset:3072 lds
  s_waitcnt vmcnt(8)
  ds_read_b64 a[16:17], v246 offset:0
  ds_read_b64 a[18:19], v246 offset:32
  ds_read_b64 a[20:21], v246 offset:64
  ds_read_b64 a[22:23], v246 offset:96
  ds_read_b64 a[24:25], v246 offset:128
  ds_read_b64 a[26:27], v246 offset:160
  ds_read_b64 a[28:29], v246 offset:192
  ds_read_b64 a[30:31], v246 offset:224
  ds_read_b64 a[80:81], v246 offset:512
  ds_read_b64 a[82:83], v246 offset:544
  ds_read_b64 a[84:85], v246 offset:576
  ds_read_b64 a[86:87], v246 offset:608
  ds_read_b64 a[88:89], v246 offset:640
  ds_read_b64 a[90:91], v246 offset:672
  ds_read_b64 a[92:93], v246 offset:704
  ds_read_b64 a[94:95], v246 offset:736
  s_waitcnt lgkmcnt(0)
  s_add_u32 s42, s91, 768
  s_mov_b32 m0, s40
  s_nop 0
  buffer_load_dwordx4 v244, s[8:11], s42 offen lds
  s_add_u32 m0, m0, 32
  s_nop 0
  buffer_load_dwordx4 v244, s[8:11], s42 offen offset:1024 lds
  s_add_u32 m0, m0, 32
  s_nop 0
  buffer_load_dwordx4 v244, s[8:11], s42 offen offset:2048 lds
  s_add_u32 m0, m0, 32
  s_nop 0
  buffer_load_dwordx4 v244, s[8:11], s42 offen offset:3072 lds
  s_add_u32 s42, s42, s52
  s_add_u32 m0, m0, s53
  s_nop 0
  buffer_load_dwordx4 v244, s[8:11], s42 offen lds
  s_add_u32 m0, m0, 32
  s_nop 0
  buffer_load_dwordx4 v244, s[8:11], s42 offen offset:1024 lds
  s_add_u32 m0, m0, 32
  s_nop 0
  buffer_load_dwordx4 v244, s[8:11], s42 offen offset:2048 lds
  s_add_u32 m0, m0, 32
  s_nop 0
  buffer_load_dwordx4 v244, s[8:11], s42 offen offset:3072 lds
  s_waitcnt vmcnt(8)
  ds_read_b64 a[32:33], v245 offset:0
  ds_read_b64 a[34:35], v245 offset:32
  ds_read_b64 a[36:37], v245 offset:64
  ds_read_b64 a[38:39], v245 offset:96
  ds_read_b64 a[40:41], v245 offset:128
  ds_read_b64 a[42:43], v245 offset:160
  ds_read_b64 a[44:45], v245 offset:192
  ds_read_b64 a[46:47], v245 offset:224
  ds_read_b64 a[96:97], v245 offset:512
  ds_read_b64 a[98:99], v245 offset:544
  ds_read_b64 a[100:101], v245 offset:576
  ds_read_b64 a[102:103], v245 offset:608
  ds_read_b64 a[104:105], v245 offset:640
  ds_read_b64 a[106:107], v245 offset:672
  ds_read_b64 a[108:109], v245 offset:704
  ds_read_b64 a[110:111], v245 offset:736
  s_waitcnt lgkmcnt(0)
  s_add_u32 s42, s47, 0
  s_mov_b32 m0, s39
  s_nop 0
  buffer_load_dwordx4 v227, s[12:15], s42 offen lds
  s_add_u32 s42, s42, s49
  s_add_u32 m0, m0, s50
  s_nop 0
  buffer_load_dwordx4 v227, s[12:15], s42 offen lds
  s_add_u32 s42, s42, s49
  s_add_u32 m0, m0, s50
  s_nop 0
  buffer_load_dwordx4 v227, s[12:15], s42 offen lds
  s_add_u32 s42, s42, s49
  s_add_u32 m0, m0, s50
  s_nop 0
  buffer_load_dwordx4 v227, s[12:15], s42 offen lds
  s_add_u32 s42, s42, s49
  s_add_u32 m0, m0, s51
  s_nop 0
  buffer_load_dwordx4 v227, s[12:15], s42 offen lds
  s_add_u32 s42, s42, s49
  s_add_u32 m0, m0, s50
  s_nop 0
  buffer_load_dwordx4 v227, s[12:15], s42 offen lds
  s_add_u32 s42, s42, s49
  s_add_u32 m0, m0, s50
  s_nop 0
  buffer_load_dwordx4 v227, s[12:15], s42 offen lds
  s_add_u32 s42, s42, s49
  s_add_u32 m0, m0, s50
  s_nop 0
  buffer_load_dwordx4 v227, s[12:15], s42 offen lds
  s_waitcnt vmcnt(8)
  ds_read_b64 a[48:49], v246 offset:0
  ds_read_b64 a[50:51], v246 offset:32
  ds_read_b64 a[52:53], v246 offset:64
  ds_read_b64 a[54:55], v246 offset:96
  ds_read_b64 a[56:57], v246 offset:128
  ds_read_b64 a[58:59], v246 offset:160
  ds_read_b64 a[60:61], v246 offset:192
  ds_read_b64 a[62:63], v246 offset:224
  ds_read_b64 a[112:113], v246 offset:512
  ds_read_b64 a[114:115], v246 offset:544
  ds_read_b64 a[116:117], v246 offset:576
  ds_read_b64 a[118:119], v246 offset:608
  ds_read_b64 a[120:121], v246 offset:640
  ds_read_b64 a[122:123], v246 offset:672
  ds_read_b64 a[124:125], v246 offset:704
  ds_read_b64 a[126:127], v246 offset:736
  s_waitcnt lgkmcnt(0)
  s_add_u32 s42, s47, 1048576
  s_mov_b32 m0, s40
  s_nop 0
  buffer_load_dwordx4 v227, s[12:15], s42 offen lds
  s_add_u32 s42, s42, s49
  s_add_u32 m0, m0, s50
  s_nop 0
  buffer_load_dwordx4 v227, s[12:15], s42 offen lds
  s_add_u32 s42, s42, s49
  s_add_u32 m0, m0, s50
  s_nop 0
  buffer_load_dwordx4 v227, s[12:15], s42 offen lds
  s_add_u32 s42, s42, s49
  s_add_u32 m0, m0, s50
  s_nop 0
  buffer_load_dwordx4 v227, s[12:15], s42 offen lds
  s_add_u32 s42, s42, s49
  s_add_u32 m0, m0, s51
  s_nop 0
  buffer_load_dwordx4 v227, s[12:15], s42 offen lds
  s_add_u32 s42, s42, s49
  s_add_u32 m0, m0, s50
  s_nop 0
  buffer_load_dwordx4 v227, s[12:15], s42 offen lds
  s_add_u32 s42, s42, s49
  s_add_u32 m0, m0, s50
  s_nop 0
  buffer_load_dwordx4 v227, s[12:15], s42 offen lds
  s_add_u32 s42, s42, s49
  s_add_u32 m0, m0, s50
  s_nop 0
  buffer_load_dwordx4 v227, s[12:15], s42 offen lds
  s_waitcnt vmcnt(8)
  s_barrier
  ds_read_b64_tr_b16 v[148:149], v220 offset:0
  ds_read_b64_tr_b16 v[150:151], v220 offset:512
  ds_read_b64_tr_b16 v[152:153], v220 offset:8704
  ds_read_b64_tr_b16 v[154:155], v220 offset:9216
  ds_read_b64_tr_b16 v[156:157], v220 offset:17408
  ds_read_b64_tr_b16 v[158:159], v220 offset:17920
  ds_read_b64_tr_b16 v[160:161], v220 offset:26112
  ds_read_b64_tr_b16 v[162:163], v220 offset:26624
  ds_read_b64 v[164:165], v224 offset:0
  ds_read_b64 v[166:167], v224 offset:32
  ds_read_b64_tr_b16 v[168:169], v222 offset:0
  ds_read_b64_tr_b16 v[170:171], v222 offset:512
  ds_read_b64_tr_b16 v[172:173], v222 offset:8
  ds_read_b64_tr_b16 v[174:175], v222 offset:520
  s_waitcnt lgkmcnt(12)
  v_mfma_f32_16x16x32_bf16 v[0:3], v[148:151], a[0:3], 0
  s_waitcnt lgkmcnt(10)
  v_mfma_f32_16x16x32_bf16 v[0:3], v[152:155], a[4:7], v[0:3]
  s_waitcnt lgkmcnt(8)
  v_mfma_f32_16x16x32_bf16 v[0:3], v[156:159], a[8:11], v[0:3]
  s_waitcnt lgkmcnt(6)
  ds_read_b64_tr_b16 v[176:177], v220 offset:8
  ds_read_b64_tr_b16 v[178:179], v220 offset:520
  v_mfma_f32_16x16x32_bf16 v[0:3], v[160:163], a[12:15], v[0:3]
  s_nop 0
  ds_read_b64_tr_b16 a[224:225], v220 offset:8712
  ds_read_b64_tr_b16 a[226:227], v220 offset:9224
  v_mfma_f32_16x16x32_bf16 v[4:7], v[148:151], a[64:67], 0
  s_nop 0
  ds_read_b64_tr_b16 a[228:229], v220 offset:17416
  ds_read_b64_tr_b16 a[230:231], v220 offset:17928
  v_mfma_f32_16x16x32_bf16 v[4:7], v[152:155], a[68:71], v[4:7]
  s_nop 0
  ds_read_b64_tr_b16 a[232:233], v220 offset:26120
  ds_read_b64_tr_b16 a[234:235], v220 offset:26632
  v_mfma_f32_16x16x32_bf16 v[4:7], v[156:159], a[72:75], v[4:7]
  v_mfma_f32_16x16x32_bf16 v[4:7], v[160:163], a[76:79], v[4:7]
  s_waitcnt lgkmcnt(8)
  v_mfma_f32_16x16x32_bf16 v[128:131], v[168:171], v[164:167], 0
  v_mfma_f32_16x16x32_bf16 v[132:135], v[172:175], v[164:167], 0
  s_waitcnt lgkmcnt(6)
  v_mfma_f32_16x16x32_bf16 v[8:11], v[176:179], a[0:3], 0
  s_waitcnt lgkmcnt(4)
  ds_read_b64 a[236:237], v224 offset:64
  ds_read_b64 a[238:239], v224 offset:96
  ds_read_b64_tr_b16 a[240:241], v222 offset:8704
  ds_read_b64_tr_b16 a[242:243], v222 offset:9216
  v_mfma_f32_16x16x32_bf16 v[8:11], a[224:227], a[4:7], v[8:11]
  s_waitcnt lgkmcnt(6)
  ds_read_b64_tr_b16 a[244:245], v222 offset:8712
  ds_read_b64_tr_b16 a[246:247], v222 offset:9224
  v_mfma_f32_16x16x32_bf16 v[8:11], a[228:231], a[8:11], v[8:11]
  s_waitcnt lgkmcnt(6)
  ds_read_b64_tr_b16 a[248:249], v220 offset:64
  ds_read_b64_tr_b16 a[250:251], v220 offset:576
  v_mfma_f32_16x16x32_bf16 v[8:11], a[232:235], a[12:15], v[8:11]
  s_nop 0
  ds_read_b64_tr_b16 a[252:253], v220 offset:8768
  ds_read_b64_tr_b16 a[254:255], v220 offset:9280
  v_mfma_f32_16x16x32_bf16 v[12:15], v[176:179], a[64:67], 0
  s_nop 0
  ds_read_b64_tr_b16 v[148:149], v220 offset:17472
  ds_read_b64_tr_b16 v[150:151], v220 offset:17984
  v_mfma_f32_16x16x32_bf16 v[12:15], a[224:227], a[68:71], v[12:15]
  s_nop 0
  ds_read_b64_tr_b16 v[152:153], v220 offset:26176
  ds_read_b64_tr_b16 v[154:155], v220 offset:26688
  v_mfma_f32_16x16x32_bf16 v[12:15], a[228:231], a[72:75], v[12:15]
  v_mfma_f32_16x16x32_bf16 v[12:15], a[232:235], a[76:79], v[12:15]
  s_waitcnt lgkmcnt(10)
  ds_read_b64 v[156:157], v224 offset:128
  ds_read_b64 v[158:159], v224 offset:160
  v_mfma_f32_16x16x32_bf16 v[128:131], a[240:243], a[236:239], v[128:131]
  s_waitcnt lgkmcnt(10)
  ds_read_b64_tr_b16 v[160:161], v222 offset:17408
  ds_read_b64_tr_b16 v[162:163], v222 offset:17920
  v_mfma_f32_16x16x32_bf16 v[132:135], a[244:247], a[236:239], v[132:135]
  s_waitcnt lgkmcnt(10)
  ds_read_b64_tr_b16 v[164:165], v222 offset:17416
  ds_read_b64_tr_b16 v[166:167], v222 offset:17928
  v_mfma_f32_16x16x32_bf16 v[16:19], a[248:251], a[0:3], 0
  s_waitcnt lgkmcnt(10)
  ds_read_b64_tr_b16 v[168:169], v220 offset:72
  ds_read_b64_tr_b16 v[170:171], v220 offset:584
  v_mfma_f32_16x16x32_bf16 v[16:19], a[252:255], a[4:7], v[16:19]
  s_waitcnt lgkmcnt(10)
  ds_read_b64_tr_b16 v[172:173], v220 offset:8776
  ds_read_b64_tr_b16 v[174:175], v220 offset:9288
  v_mfma_f32_16x16x32_bf16 v[16:19], v[148:151], a[8:11], v[16:19]
  s_waitcnt lgkmcnt(10)
  ds_read_b64_tr_b16 v[176:177], v220 offset:17480
  ds_read_b64_tr_b16 v[178:179], v220 offset:17992
  v_mfma_f32_16x16x32_bf16 v[16:19], v[152:155], a[12:15], v[16:19]
  s_nop 0
  ds_read_b64_tr_b16 a[224:225], v220 offset:26184
  ds_read_b64_tr_b16 a[226:227], v220 offset:26696
  v_mfma_f32_16x16x32_bf16 v[20:23], a[248:251], a[64:67], 0
  s_nop 0
  ds_read_b64 a[228:229], v224 offset:192
  ds_read_b64 a[230:231], v224 offset:224
  v_mfma_f32_16x16x32_bf16 v[20:23], a[252:255], a[68:71], v[20:23]
  s_nop 0
  ds_read_b64_tr_b16 a[232:233], v222 offset:26112
  ds_read_b64_tr_b16 a[234:235], v222 offset:26624
  v_mfma_f32_16x16x32_bf16 v[20:23], v[148:151], a[72:75], v[20:23]
  s_nop 0
  ds_read_b64_tr_b16 a[236:237], v222 offset:26120
  ds_read_b64_tr_b16 a[238:239], v222 offset:26632
  v_mfma_f32_16x16x32_bf16 v[20:23], v[152:155], a[76:79], v[20:23]
  s_waitcnt lgkmcnt(12)
  ds_read_b64_tr_b16 a[240:241], v220 offset:128
  ds_read_b64_tr_b16 a[242:243], v220 offset:640
  v_mfma_f32_16x16x32_bf16 v[128:131], v[160:163], v[156:159], v[128:131]
  s_nop 0
  ds_read_b64_tr_b16 a[244:245], v220 offset:8832
  ds_read_b64_tr_b16 a[246:247], v220 offset:9344
  v_mfma_f32_16x16x32_bf16 v[132:135], v[164:167], v[156:159], v[132:135]
  s_nop 0
  ds_read_b64_tr_b16 a[248:249], v220 offset:17536
  ds_read_b64_tr_b16 a[250:251], v220 offset:18048
  v_mfma_f32_16x16x32_bf16 v[24:27], v[168:171], a[0:3], 0
  s_waitcnt lgkmcnt(12)
  ds_read_b64_tr_b16 a[252:253], v220 offset:26240
  ds_read_b64_tr_b16 a[254:255], v220 offset:26752
  v_mfma_f32_16x16x32_bf16 v[24:27], v[172:175], a[4:7], v[24:27]
  s_nop 0
  ds_read_b64_tr_b16 v[148:149], v220 offset:136
  ds_read_b64_tr_b16 v[150:151], v220 offset:648
  v_mfma_f32_16x16x32_bf16 v[24:27], v[176:179], a[8:11], v[24:27]
  s_nop 0
  ds_read_b64_tr_b16 v[152:153], v220 offset:8840
  ds_read_b64_tr_b16 v[154:155], v220 offset:9352
  v_mfma_f32_16x16x32_bf16 v[24:27], a[224:227], a[12:15], v[24:27]
  s_nop 0
  ds_read_b64_tr_b16 v[156:157], v220 offset:17544
  ds_read_b64_tr_b16 v[158:159], v220 offset:18056
  v_mfma_f32_16x16x32_bf16 v[28:31], v[168:171], a[64:67], 0
  s_nop 0
  ds_read_b64_tr_b16 v[160:161], v220 offset:26248
  ds_read_b64_tr_b16 v[162:163], v220 offset:26760
  v_mfma_f32_16x16x32_bf16 v[28:31], v[172:175], a[68:71], v[28:31]
  s_nop 0
  ds_read_b64_tr_b16 v[164:165], v220 offset:192
  ds_read_b64_tr_b16 v[166:167], v220 offset:704
  v_mfma_f32_16x16x32_bf16 v[28:31], v[176:179], a[72:75], v[28:31]
  s_nop 0
  ds_read_b64_tr_b16 v[168:169], v220 offset:8896
  ds_read_b64_tr_b16 v[170:171], v220 offset:9408
  v_mfma_f32_16x16x32_bf16 v[28:31], a[224:227], a[76:79], v[28:31]
  s_waitcnt lgkmcnt(12)
  ds_read_b64_tr_b16 v[172:173], v220 offset:17600
  ds_read_b64_tr_b16 v[174:175], v220 offset:18112
  v_mfma_f32_16x16x32_bf16 v[128:131], a[232:235], a[228:231], v[128:131]
  s_nop 0
  ds_read_b64_tr_b16 v[176:177], v220 offset:26304
  ds_read_b64_tr_b16 v[178:179], v220 offset:26816
  v_mfma_f32_16x16x32_bf16 v[132:135], a[236:239], a[228:231], v[132:135]
  ds_read_b64_tr_b16 a[224:225], v220 offset:200
  v_mfma_f32_16x16x32_bf16 v[32:35], a[240:243], a[0:3], 0
  ds_read_b64_tr_b16 a[226:227], v220 offset:712
  v_mfma_f32_16x16x32_bf16 v[32:35], a[244:247], a[4:7], v[32:35]
  s_nop 0
  ds_read_b64_tr_b16 a[228:229], v220 offset:8904
  ds_read_b64_tr_b16 a[230:231], v220 offset:9416
  v_mfma_f32_16x16x32_bf16 v[32:35], a[248:251], a[8:11], v[32:35]
  s_nop 0
  ds_read_b64_tr_b16 a[232:233], v220 offset:17608
  ds_read_b64_tr_b16 a[234:235], v220 offset:18120
  v_mfma_f32_16x16x32_bf16 v[32:35], a[252:255], a[12:15], v[32:35]
  s_nop 0
  ds_read_b64_tr_b16 a[236:237], v220 offset:26312
  ds_read_b64_tr_b16 a[238:239], v220 offset:26824
  v_mfma_f32_16x16x32_bf16 v[36:39], a[240:243], a[64:67], 0
  v_mfma_f32_16x16x32_bf16 v[36:39], a[244:247], a[68:71], v[36:39]
  v_mfma_f32_16x16x32_bf16 v[36:39], a[248:251], a[72:75], v[36:39]
  v_mfma_f32_16x16x32_bf16 v[36:39], a[252:255], a[76:79], v[36:39]
  s_waitcnt lgkmcnt(15)
  v_mfma_f32_16x16x32_bf16 v[40:43], v[148:151], a[0:3], 0
  v_mfma_f32_16x16x32_bf16 v[40:43], v[152:155], a[4:7], v[40:43]
  s_waitcnt lgkmcnt(0)
  s_waitcnt vmcnt(0)
  s_barrier
  ds_read_b64_tr_b16 a[240:241], v221 offset:0
  v_mfma_f32_16x16x32_bf16 v[40:43], v[156:159], a[8:11], v[40:43]
  s_add_u32 s42, s48, 2097152
  ds_read_b64_tr_b16 a[242:243], v221 offset:512
  v_mfma_f32_16x16x32_bf16 v[40:43], v[160:163], a[12:15], v[40:43]
  s_mov_b32 m0, s39
  ds_read_b64_tr_b16 a[244:245], v221 offset:8704
  v_mfma_f32_16x16x32_bf16 v[44:47], v[148:151], a[64:67], 0
  ds_read_b64_tr_b16 a[246:247], v221 offset:9216
  v_mfma_f32_16x16x32_bf16 v[44:47], v[152:155], a[68:71], v[44:47]
  ds_read_b64_tr_b16 a[248:249], v221 offset:17408
  v_mfma_f32_16x16x32_bf16 v[44:47], v[156:159], a[72:75], v[44:47]
  ds_read_b64_tr_b16 a[250:251], v221 offset:17920
  v_mfma_f32_16x16x32_bf16 v[44:47], v[160:163], a[76:79], v[44:47]
  ds_read_b64_tr_b16 a[252:253], v221 offset:26112
  v_mfma_f32_16x16x32_bf16 v[48:51], v[164:167], a[0:3], 0
  ds_read_b64_tr_b16 a[254:255], v221 offset:26624
  v_mfma_f32_16x16x32_bf16 v[48:51], v[168:171], a[4:7], v[48:51]
  buffer_load_dwordx4 v227, s[12:15], s42 offen lds
  v_mfma_f32_16x16x32_bf16 v[48:51], v[172:175], a[8:11], v[48:51]
  ds_read_b64 v[148:149], v224 offset:256
  v_mfma_f32_16x16x32_bf16 v[48:51], v[176:179], a[12:15], v[48:51]
  s_add_u32 s42, s42, s49
  s_add_u32 m0, m0, s50
  ds_read_b64 v[150:151], v224 offset:288
  v_mfma_f32_16x16x32_bf16 v[52:55], v[164:167], a[64:67], 0
  buffer_load_dwordx4 v227, s[12:15], s42 offen lds
  v_mfma_f32_16x16x32_bf16 v[52:55], v[168:171], a[68:71], v[52:55]
  ds_read_b64_tr_b16 v[152:153], v223 offset:0
  v_mfma_f32_16x16x32_bf16 v[52:55], v[172:175], a[72:75], v[52:55]
  s_add_u32 s42, s42, s49
  s_add_u32 m0, m0, s50
  ds_read_b64_tr_b16 v[154:155], v223 offset:512
  v_mfma_f32_16x16x32_bf16 v[52:55], v[176:179], a[76:79], v[52:55]
  ds_read_b64_tr_b16 v[156:157], v223 offset:8
  v_mfma_f32_16x16x32_bf16 v[56:59], a[224:227], a[0:3], 0
  ds_read_b64_tr_b16 v[158:159], v223 offset:520
  v_mfma_f32_16x16x32_bf16 v[56:59], a[228:231], a[4:7], v[56:59]
  s_nop 0
  ds_read_b64_tr_b16 v[160:161], v221 offset:8
  ds_read_b64_tr_b16 v[162:163], v221 offset:520
  v_mfma_f32_16x16x32_bf16 v[56:59], a[232:235], a[8:11], v[56:59]
  s_nop 0
  ds_read_b64_tr_b16 v[164:165], v221 offset:8712
  ds_read_b64_tr_b16 v[166:167], v221 offset:9224
  v_mfma_f32_16x16x32_bf16 v[56:59], a[236:239], a[12:15], v[56:59]
  s_nop 0
  buffer_load_dwordx4 v227, s[12:15], s42 offen lds
  ds_read_b64_tr_b16 v[168:169], v221 offset:17416
  v_mfma_f32_16x16x32_bf16 v[60:63], a[224:227], a[64:67], 0
  s_nop 0
  ds_read_b64_tr_b16 v[170:171], v221 offset:17928
  ds_read_b64_tr_b16 v[172:173], v221 offset:26120
  v_mfma_f32_16x16x32_bf16 v[60:63], a[228:231], a[68:71], v[60:63]
  s_add_u32 s42, s42, s49
  s_add_u32 m0, m0, s50
  ds_read_b64_tr_b16 v[174:175], v221 offset:26632
  v_mfma_f32_16x16x32_bf16 v[60:63], a[232:235], a[72:75], v[60:63]
  buffer_load_dwordx4 v227, s[12:15], s42 offen lds
  v_mfma_f32_16x16x32_bf16 v[60:63], a[236:239], a[76:79], v[60:63]
  s_waitcnt lgkmcnt(14)
  ds_read_b64 v[176:177], v224 offset:320
  v_mfma_f32_16x16x32_bf16 v[0:3], a[240:243], a[16:19], v[0:3]
  s_add_u32 s42, s42, s49
  s_add_u32 m0, m0, s51
  v_mfma_f32_16x16x32_bf16 v[0:3], a[244:247], a[20:23], v[0:3]
  s_nop 0
  ds_read_b64 v[178:179], v224 offset:352
  ds_read_b64_tr_b16 a[224:225], v223 offset:8704
  v_mfma_f32_16x16x32_bf16 v[0:3], a[248:251], a[24:27], v[0:3]
  s_nop 0
  ds_read_b64_tr_b16 a[226:227], v223 offset:9216
  ds_read_b64_tr_b16 a[228:229], v223 offset:8712
  v_mfma_f32_16x16x32_bf16 v[0:3], a[252:255], a[28:31], v[0:3]
  s_nop 0
  ds_read_b64_tr_b16 a[230:231], v223 offset:9224
  buffer_load_dwordx4 v227, s[12:15], s42 offen lds
  v_mfma_f32_16x16x32_bf16 v[4:7], a[240:243], a[80:83], v[4:7]
  s_nop 0
  ds_read_b64_tr_b16 a[232:233], v221 offset:64
  ds_read_b64_tr_b16 a[234:235], v221 offset:576
  v_mfma_f32_16x16x32_bf16 v[4:7], a[244:247], a[84:87], v[4:7]
  s_add_u32 s42, s42, s49
  ds_read_b64_tr_b16 a[236:237], v221 offset:8768
  ds_read_b64_tr_b16 a[238:239], v221 offset:9280
  v_mfma_f32_16x16x32_bf16 v[4:7], a[248:251], a[88:91], v[4:7]
  s_add_u32 m0, m0, s50
  ds_read_b64_tr_b16 a[240:241], v221 offset:17472
  ds_read_b64_tr_b16 a[242:243], v221 offset:17984
  v_mfma_f32_16x16x32_bf16 v[4:7], a[252:255], a[92:95], v[4:7]
  s_waitcnt lgkmcnt(12)
  ds_read_b64_tr_b16 a[244:245], v221 offset:26176
  ds_read_b64_tr_b16 a[246:247], v221 offset:26688
  v_mfma_f32_16x16x32_bf16 v[128:131], v[152:155], v[148:151], v[128:131]
  buffer_load_dwordx4 v227, s[12:15], s42 offen lds
  v_mfma_f32_16x16x32_bf16 v[132:135], v[156:159], v[148:151], v[132:135]
  ds_read_b64 a[248:249], v224 offset:384
  v_mfma_f32_16x16x32_bf16 v[8:11], v[160:163], a[16:19], v[8:11]
  s_add_u32 s42, s42, s49
  s_add_u32 m0, m0, s50
  v_mfma_f32_16x16x32_bf16 v[8:11], v[164:167], a[20:23], v[8:11]
  s_nop 0
  buffer_load_dwordx4 v227, s[12:15], s42 offen lds
  ds_read_b64 a[250:251], v224 offset:416
  v_mfma_f32_16x16x32_bf16 v[8:11], v[168:171], a[24:27], v[8:11]
  s_nop 0
  ds_read_b64_tr_b16 a[252:253], v223 offset:17408
  ds_read_b64_tr_b16 a[254:255], v223 offset:17920
  v_mfma_f32_16x16x32_bf16 v[8:11], v[172:175], a[28:31], v[8:11]
  s_add_u32 s42, s42, s49
  ds_read_b64_tr_b16 v[148:149], v223 offset:17416
  ds_read_b64_tr_b16 v[150:151], v223 offset:17928
  v_mfma_f32_16x16x32_bf16 v[12:15], v[160:163], a[80:83], v[12:15]
  s_add_u32 m0, m0, s50
  ds_read_b64_tr_b16 v[152:153], v221 offset:72
  ds_read_b64_tr_b16 v[154:155], v221 offset:584
  v_mfma_f32_16x16x32_bf16 v[12:15], v[164:167], a[84:87], v[12:15]
  s_nop 0
  ds_read_b64_tr_b16 v[156:157], v221 offset:8776
  ds_read_b64_tr_b16 v[158:159], v221 offset:9288
  v_mfma_f32_16x16x32_bf16 v[12:15], v[168:171], a[88:91], v[12:15]
  s_nop 0
  buffer_load_dwordx4 v227, s[12:15], s42 offen lds
  ds_read_b64_tr_b16 v[160:161], v221 offset:17480
  v_mfma_f32_16x16x32_bf16 v[12:15], v[172:175], a[92:95], v[12:15]
  s_waitcnt lgkmcnt(11)
  ds_read_b64_tr_b16 v[162:163], v221 offset:17992
  ds_read_b64_tr_b16 v[164:165], v221 offset:26184
  v_mfma_f32_16x16x32_bf16 v[128:131], a[224:227], v[176:179], v[128:131]
  ds_read_b64_tr_b16 v[166:167], v221 offset:26696
  v_mfma_f32_16x16x32_bf16 v[132:135], a[228:231], v[176:179], v[132:135]
  ds_read_b64 v[168:169], v224 offset:448
  v_mfma_f32_16x16x32_bf16 v[16:19], a[232:235], a[16:19], v[16:19]
  ds_read_b64 v[170:171], v224 offset:480
  v_mfma_f32_16x16x32_bf16 v[16:19], a[236:239], a[20:23], v[16:19]
  s_nop 0
  ds_read_b64_tr_b16 v[172:173], v223 offset:26112
  ds_read_b64_tr_b16 v[174:175], v223 offset:26624
  v_mfma_f32_16x16x32_bf16 v[16:19], a[240:243], a[24:27], v[16:19]
  s_nop 0
  ds_read_b64_tr_b16 v[176:177], v223 offset:26120
  ds_read_b64_tr_b16 v[178:179], v223 offset:26632
  v_mfma_f32_16x16x32_bf16 v[16:19], a[244:247], a[28:31], v[16:19]
  s_nop 0
  ds_read_b64_tr_b16 a[224:225], v221 offset:128
  ds_read_b64_tr_b16 a[226:227], v221 offset:640
  v_mfma_f32_16x16x32_bf16 v[20:23], a[232:235], a[80:83], v[20:23]
  s_nop 0
  ds_read_b64_tr_b16 a[228:229], v221 offset:8832
  ds_read_b64_tr_b16 a[230:231], v221 offset:9344
  v_mfma_f32_16x16x32_bf16 v[20:23], a[236:239], a[84:87], v[20:23]
  s_nop 0
  ds_read_b64_tr_b16 a[232:233], v221 offset:17536
  ds_read_b64_tr_b16 a[234:235], v221 offset:18048
  v_mfma_f32_16x16x32_bf16 v[20:23], a[240:243], a[88:91], v[20:23]
  s_nop 0
  ds_read_b64_tr_b16 a[236:237], v221 offset:26240
  ds_read_b64_tr_b16 a[238:239], v221 offset:26752
  v_mfma_f32_16x16x32_bf16 v[20:23], a[244:247], a[92:95], v[20:23]
  s_waitcnt lgkmcnt(14)
  ds_read_b64_tr_b16 a[240:241], v221 offset:136
  v_mfma_f32_16x16x32_bf16 v[128:131], a[252:255], a[248:251], v[128:131]
  ds_read_b64_tr_b16 a[242:243], v221 offset:648
  v_mfma_f32_16x16x32_bf16 v[132:135], v[148:151], a[248:251], v[132:135]
  ds_read_b64_tr_b16 a[244:245], v221 offset:8840
  v_mfma_f32_16x16x32_bf16 v[24:27], v[152:155], a[16:19], v[24:27]
  ds_read_b64_tr_b16 a[246:247], v221 offset:9352
  v_mfma_f32_16x16x32_bf16 v[24:27], v[156:159], a[20:23], v[24:27]
  s_nop 0
  ds_read_b64_tr_b16 a[248:249], v221 offset:17544
  ds_read_b64_tr_b16 a[250:251], v221 offset:18056
  v_mfma_f32_16x16x32_bf16 v[24:27], v[160:163], a[24:27], v[24:27]
  s_nop 0
  ds_read_b64_tr_b16 a[252:253], v221 offset:26248
  ds_read_b64_tr_b16 a[254:255], v221 offset:26760
  v_mfma_f32_16x16x32_bf16 v[24:27], v[164:167], a[28:31], v[24:27]
  ds_read_b64_tr_b16 v[148:149], v221 offset:192
  v_mfma_f32_16x16x32_bf16 v[28:31], v[152:155], a[80:83], v[28:31]
  ds_read_b64_tr_b16 v[150:151], v221 offset:704
  v_mfma_f32_16x16x32_bf16 v[28:31], v[156:159], a[84:87], v[28:31]
  ds_read_b64_tr_b16 v[152:153], v221 offset:8896
  v_mfma_f32_16x16x32_bf16 v[28:31], v[160:163], a[88:91], v[28:31]
  s_nop 0
  ds_read_b64_tr_b16 v[154:155], v221 offset:9408
  ds_read_b64_tr_b16 v[156:157], v221 offset:17600
  v_mfma_f32_16x16x32_bf16 v[28:31], v[164:167], a[92:95], v[28:31]
  s_waitcnt lgkmcnt(13)
  ds_read_b64_tr_b16 v[158:159], v221 offset:18112
  ds_read_b64_tr_b16 v[160:161], v221 offset:26304
  v_mfma_f32_16x16x32_bf16 v[128:131], v[172:175], v[168:171], v[128:131]
  ds_read_b64_tr_b16 v[162:163], v221 offset:26816
  v_mfma_f32_16x16x32_bf16 v[132:135], v[176:179], v[168:171], v[132:135]
  ds_read_b64_tr_b16 v[164:165], v221 offset:200
  v_mfma_f32_16x16x32_bf16 v[32:35], a[224:227], a[16:19], v[32:35]
  ds_read_b64_tr_b16 v[166:167], v221 offset:712
  v_mfma_f32_16x16x32_bf16 v[32:35], a[228:231], a[20:23], v[32:35]
  s_nop 0
  ds_read_b64_tr_b16 v[168:169], v221 offset:8904
  ds_read_b64_tr_b16 v[170:171], v221 offset:9416
  v_mfma_f32_16x16x32_bf16 v[32:35], a[232:235], a[24:27], v[32:35]
  s_nop 0
  ds_read_b64_tr_b16 v[172:173], v221 offset:17608
  ds_read_b64_tr_b16 v[174:175], v221 offset:18120
  v_mfma_f32_16x16x32_bf16 v[32:35], a[236:239], a[28:31], v[32:35]
  s_nop 0
  ds_read_b64_tr_b16 v[176:177], v221 offset:26312
  ds_read_b64_tr_b16 v[178:179], v221 offset:26824
  v_mfma_f32_16x16x32_bf16 v[36:39], a[224:227], a[80:83], v[36:39]
  v_mfma_f32_16x16x32_bf16 v[36:39], a[228:231], a[84:87], v[36:39]
  v_mfma_f32_16x16x32_bf16 v[36:39], a[232:235], a[88:91], v[36:39]
  v_mfma_f32_16x16x32_bf16 v[36:39], a[236:239], a[92:95], v[36:39]
  s_waitcnt lgkmcnt(15)
  v_mfma_f32_16x16x32_bf16 v[40:43], a[240:243], a[16:19], v[40:43]
  v_mfma_f32_16x16x32_bf16 v[40:43], a[244:247], a[20:23], v[40:43]
  s_waitcnt lgkmcnt(0)
  s_waitcnt vmcnt(0)
  s_barrier
  ds_read_b64_tr_b16 a[224:225], v220 offset:0
  v_mfma_f32_16x16x32_bf16 v[40:43], a[248:251], a[24:27], v[40:43]
  s_add_u32 s42, s48, 3145728
  ds_read_b64_tr_b16 a[226:227], v220 offset:512
  v_mfma_f32_16x16x32_bf16 v[40:43], a[252:255], a[28:31], v[40:43]
  s_mov_b32 m0, s40
  ds_read_b64_tr_b16 a[228:229], v220 offset:8704
  v_mfma_f32_16x16x32_bf16 v[44:47], a[240:243], a[80:83], v[44:47]
  ds_read_b64_tr_b16 a[230:231], v220 offset:9216
  v_mfma_f32_16x16x32_bf16 v[44:47], a[244:247], a[84:87], v[44:47]
  ds_read_b64_tr_b16 a[232:233], v220 offset:17408
  v_mfma_f32_16x16x32_bf16 v[44:47], a[248:251], a[88:91], v[44:47]
  ds_read_b64_tr_b16 a[234:235], v220 offset:17920
  v_mfma_f32_16x16x32_bf16 v[44:47], a[252:255], a[92:95], v[44:47]
  ds_read_b64_tr_b16 a[236:237], v220 offset:26112
  v_mfma_f32_16x16x32_bf16 v[48:51], v[148:151], a[16:19], v[48:51]
  ds_read_b64_tr_b16 a[238:239], v220 offset:26624
  v_mfma_f32_16x16x32_bf16 v[48:51], v[152:155], a[20:23], v[48:51]
  buffer_load_dwordx4 v227, s[12:15], s42 offen lds
  v_mfma_f32_16x16x32_bf16 v[48:51], v[156:159], a[24:27], v[48:51]
  ds_read_b64 a[240:241], v224 offset:512
  v_mfma_f32_16x16x32_bf16 v[48:51], v[160:163], a[28:31], v[48:51]
  s_add_u32 s42, s42, s49
  s_add_u32 m0, m0, s50
  ds_read_b64 a[242:243], v224 offset:544
  v_mfma_f32_16x16x32_bf16 v[52:55], v[148:151], a[80:83], v[52:55]
  buffer_load_dwordx4 v227, s[12:15], s42 offen lds
  v_mfma_f32_16x16x32_bf16 v[52:55], v[152:155], a[84:87], v[52:55]
  ds_read_b64_tr_b16 a[244:245], v222 offset:0
  v_mfma_f32_16x16x32_bf16 v[52:55], v[156:159], a[88:91], v[52:55]
  s_add_u32 s42, s42, s49
  s_add_u32 m0, m0, s50
  ds_read_b64_tr_b16 a[246:247], v222 offset:512
  v_mfma_f32_16x16x32_bf16 v[52:55], v[160:163], a[92:95], v[52:55]
  ds_read_b64_tr_b16 a[248:249], v222 offset:8
  v_mfma_f32_16x16x32_bf16 v[56:59], v[164:167], a[16:19], v[56:59]
  ds_read_b64_tr_b16 a[250:251], v222 offset:520
  v_mfma_f32_16x16x32_bf16 v[56:59], v[168:171], a[20:23], v[56:59]
  s_nop 0
  ds_read_b64_tr_b16 a[252:253], v220 offset:8
  ds_read_b64_tr_b16 a[254:255], v220 offset:520
  v_mfma_f32_16x16x32_bf16 v[56:59], v[172:175], a[24:27], v[56:59]
  s_nop 0
  ds_read_b64_tr_b16 v[148:149], v220 offset:8712
  ds_read_b64_tr_b16 v[150:151], v220 offset:9224
  v_mfma_f32_16x16x32_bf16 v[56:59], v[176:179], a[28:31], v[56:59]
  s_nop 0
  buffer_load_dwordx4 v227, s[12:15], s42 offen lds
  ds_read_b64_tr_b16 v[152:153], v220 offset:17416
  v_mfma_f32_16x16x32_bf16 v[60:63], v[164:167], a[80:83], v[60:63]
  s_nop 0
  ds_read_b64_tr_b16 v[154:155], v220 offset:17928
  ds_read_b64_tr_b16 v[156:157], v220 offset:26120
  v_mfma_f32_16x16x32_bf16 v[60:63], v[168:171], a[84:87], v[60:63]
  s_add_u32 s42, s42, s49
  s_add_u32 m0, m0, s50
  ds_read_b64_tr_b16 v[158:159], v220 offset:26632
  v_mfma_f32_16x16x32_bf16 v[60:63], v[172:175], a[88:91], v[60:63]
  buffer_load_dwordx4 v227, s[12:15], s42 offen lds
  v_mfma_f32_16x16x32_bf16 v[60:63], v[176:179], a[92:95], v[60:63]
  s_waitcnt lgkmcnt(14)
  ds_read_b64 v[160:161], v224 offset:576
  v_mfma_f32_16x16x32_bf16 v[0:3], a[224:227], a[32:35], v[0:3]
  s_add_u32 s42, s42, s49
  s_add_u32 m0, m0, s51
  v_mfma_f32_16x16x32_bf16 v[0:3], a[228:231], a[36:39], v[0:3]
  s_nop 0
  ds_read_b64 v[162:163], v224 offset:608
  ds_read_b64_tr_b16 v[164:165], v222 offset:8704
  v_mfma_f32_16x16x32_bf16 v[0:3], a[232:235], a[40:43], v[0:3]
  s_nop 0
  ds_read_b64_tr_b16 v[166:167], v222 offset:9216
  ds_read_b64_tr_b16 v[168:169], v222 offset:8712
  v_mfma_f32_16x16x32_bf16 v[0:3], a[236:239], a[44:47], v[0:3]
  s_nop 0
  ds_read_b64_tr_b16 v[170:171], v222 offset:9224
  buffer_load_dwordx4 v227, s[12:15], s42 offen lds
  v_mfma_f32_16x16x32_bf16 v[4:7], a[224:227], a[96:99], v[4:7]
  s_nop 0
  ds_read_b64_tr_b16 v[172:173], v220 offset:64
  ds_read_b64_tr_b16 v[174:175], v220 offset:576
  v_mfma_f32_16x16x32_bf16 v[4:7], a[228:231], a[100:103], v[4:7]
  s_add_u32 s42, s42, s49
  ds_read_b64_tr_b16 v[176:177], v220 offset:8768
  ds_read_b64_tr_b16 v[178:179], v220 offset:9280
  v_mfma_f32_16x16x32_bf16 v[4:7], a[232:235], a[104:107], v[4:7]
  s_add_u32 m0, m0, s50
  ds_read_b64_tr_b16 a[224:225], v220 offset:17472
  ds_read_b64_tr_b16 a[226:227], v220 offset:17984
  v_mfma_f32_16x16x32_bf16 v[4:7], a[236:239], a[108:111], v[4:7]
  s_waitcnt lgkmcnt(12)
  ds_read_b64_tr_b16 a[228:229], v220 offset:26176
  ds_read_b64_tr_b16 a[230:231], v220 offset:26688
  v_mfma_f32_16x16x32_bf16 v[128:131], a[244:247], a[240:243], v[128:131]
  buffer_load_dwordx4 v227, s[12:15], s42 offen lds
  v_mfma_f32_16x16x32_bf16 v[132:135], a[248:251], a[240:243], v[132:135]
  ds_read_b64 a[232:233], v224 offset:640
  v_mfma_f32_16x16x32_bf16 v[8:11], a[252:255], a[32:35], v[8:11]
  s_add_u32 s42, s42, s49
  s_add_u32 m0, m0, s50
  v_mfma_f32_16x16x32_bf16 v[8:11], v[148:151], a[36:39], v[8:11]
  s_nop 0
  buffer_load_dwordx4 v227, s[12:15], s42 offen lds
  ds_read_b64 a[234:235], v224 offset:672
  v_mfma_f32_16x16x32_bf16 v[8:11], v[152:155], a[40:43], v[8:11]
  s_nop 0
  ds_read_b64_tr_b16 a[236:237], v222 offset:17408
  ds_read_b64_tr_b16 a[238:239], v222 offset:17920
  v_mfma_f32_16x16x32_bf16 v[8:11], v[156:159], a[44:47], v[8:11]
  s_add_u32 s42, s42, s49
  ds_read_b64_tr_b16 a[240:241], v222 offset:17416
  ds_read_b64_tr_b16 a[242:243], v222 offset:17928
  v_mfma_f32_16x16x32_bf16 v[12:15], a[252:255], a[96:99], v[12:15]
  s_add_u32 m0, m0, s50
  ds_read_b64_tr_b16 a[244:245], v220 offset:72
  ds_read_b64_tr_b16 a[246:247], v220 offset:584
  v_mfma_f32_16x16x32_bf16 v[12:15], v[148:151], a[100:103], v[12:15]
  s_nop 0
  ds_read_b64_tr_b16 a[248:249], v220 offset:8776
  ds_read_b64_tr_b16 a[250:251], v220 offset:9288
  v_mfma_f32_16x16x32_bf16 v[12:15], v[152:155], a[104:107], v[12:15]
  s_nop 0
  buffer_load_dwordx4 v227, s[12:15], s42 offen lds
  ds_read_b64_tr_b16 a[252:253], v220 offset:17480
  v_mfma_f32_16x16x32_bf16 v[12:15], v[156:159], a[108:111], v[12:15]
  s_waitcnt lgkmcnt(11)
  ds_read_b64_tr_b16 a[254:255], v220 offset:17992
  ds_read_b64_tr_b16 v[148:149], v220 offset:26184
  v_mfma_f32_16x16x32_bf16 v[128:131], v[164:167], v[160:163], v[128:131]
  ds_read_b64_tr_b16 v[150:151], v220 offset:26696
  v_mfma_f32_16x16x32_bf16 v[132:135], v[168:171], v[160:163], v[132:135]
  ds_read_b64 v[152:153], v224 offset:704
  v_mfma_f32_16x16x32_bf16 v[16:19], v[172:175], a[32:35], v[16:19]
  ds_read_b64 v[154:155], v224 offset:736
  v_mfma_f32_16x16x32_bf16 v[16:19], v[176:179], a[36:39], v[16:19]
  s_nop 0
  ds_read_b64_tr_b16 v[156:157], v222 offset:26112
  ds_read_b64_tr_b16 v[158:159], v222 offset:26624
  v_mfma_f32_16x16x32_bf16 v[16:19], a[224:227], a[40:43], v[16:19]
  s_nop 0
  ds_read_b64_tr_b16 v[160:161], v222 offset:26120
  ds_read_b64_tr_b16 v[162:163], v222 offset:26632
  v_mfma_f32_16x16x32_bf16 v[16:19], a[228:231], a[44:47], v[16:19]
  s_nop 0
  ds_read_b64_tr_b16 v[164:165], v220 offset:128
  ds_read_b64_tr_b16 v[166:167], v220 offset:640
  v_mfma_f32_16x16x32_bf16 v[20:23], v[172:175], a[96:99], v[20:23]
  s_nop 0
  ds_read_b64_tr_b16 v[168:169], v220 offset:8832
  ds_read_b64_tr_b16 v[170:171], v220 offset:9344
  v_mfma_f32_16x16x32_bf16 v[20:23], v[176:179], a[100:103], v[20:23]
  s_nop 0
  ds_read_b64_tr_b16 v[172:173], v220 offset:17536
  ds_read_b64_tr_b16 v[174:175], v220 offset:18048
  v_mfma_f32_16x16x32_bf16 v[20:23], a[224:227], a[104:107], v[20:23]
  s_nop 0
  ds_read_b64_tr_b16 v[176:177], v220 offset:26240
  ds_read_b64_tr_b16 v[178:179], v220 offset:26752
  v_mfma_f32_16x16x32_bf16 v[20:23], a[228:231], a[108:111], v[20:23]
  s_waitcnt lgkmcnt(14)
  ds_read_b64_tr_b16 a[224:225], v220 offset:136
  v_mfma_f32_16x16x32_bf16 v[128:131], a[236:239], a[232:235], v[128:131]
  ds_read_b64_tr_b16 a[226:227], v220 offset:648
  v_mfma_f32_16x16x32_bf16 v[132:135], a[240:243], a[232:235], v[132:135]
  ds_read_b64_tr_b16 a[228:229], v220 offset:8840
  v_mfma_f32_16x16x32_bf16 v[24:27], a[244:247], a[32:35], v[24:27]
  ds_read_b64_tr_b16 a[230:231], v220 offset:9352
  v_mfma_f32_16x16x32_bf16 v[24:27], a[248:251], a[36:39], v[24:27]
  s_nop 0
  ds_read_b64_tr_b16 a[232:233], v220 offset:17544
  ds_read_b64_tr_b16 a[234:235], v220 offset:18056
  v_mfma_f32_16x16x32_bf16 v[24:27], a[252:255], a[40:43], v[24:27]
  s_nop 0
  ds_read_b64_tr_b16 a[236:237], v220 offset:26248
  ds_read_b64_tr_b16 a[238:239], v220 offset:26760
  v_mfma_f32_16x16x32_bf16 v[24:27], v[148:151], a[44:47], v[24:27]
  ds_read_b64_tr_b16 a[240:241], v220 offset:192
  v_mfma_f32_16x16x32_bf16 v[28:31], a[244:247], a[96:99], v[28:31]
  ds_read_b64_tr_b16 a[242:243], v220 offset:704
  v_mfma_f32_16x16x32_bf16 v[28:31], a[248:251], a[100:103], v[28:31]
  ds_read_b64_tr_b16 a[244:245], v220 offset:8896
  v_mfma_f32_16x16x32_bf16 v[28:31], a[252:255], a[104:107], v[28:31]
  s_nop 0
  ds_read_b64_tr_b16 a[246:247], v220 offset:9408
  ds_read_b64_tr_b16 a[248:249], v220 offset:17600
  v_mfma_f32_16x16x32_bf16 v[28:31], v[148:151], a[108:111], v[28:31]
  s_waitcnt lgkmcnt(13)
  ds_read_b64_tr_b16 a[250:251], v220 offset:18112
  ds_read_b64_tr_b16 a[252:253], v220 offset:26304
  v_mfma_f32_16x16x32_bf16 v[128:131], v[156:159], v[152:155], v[128:131]
  ds_read_b64_tr_b16 a[254:255], v220 offset:26816
  v_mfma_f32_16x16x32_bf16 v[132:135], v[160:163], v[152:155], v[132:135]
  ds_read_b64_tr_b16 v[148:149], v220 offset:200
  v_mfma_f32_16x16x32_bf16 v[32:35], v[164:167], a[32:35], v[32:35]
  ds_read_b64_tr_b16 v[150:151], v220 offset:712
  v_mfma_f32_16x16x32_bf16 v[32:35], v[168:171], a[36:39], v[32:35]
  s_nop 0
  ds_read_b64_tr_b16 v[152:153], v220 offset:8904
  ds_read_b64_tr_b16 v[154:155], v220 offset:9416
  v_mfma_f32_16x16x32_bf16 v[32:35], v[172:175], a[40:43], v[32:35]
  s_nop 0
  ds_read_b64_tr_b16 v[156:157], v220 offset:17608
  ds_read_b64_tr_b16 v[158:159], v220 offset:18120
  v_mfma_f32_16x16x32_bf16 v[32:35], v[176:179], a[44:47], v[32:35]
  s_nop 0
  ds_read_b64_tr_b16 v[160:161], v220 offset:26312
  ds_read_b64_tr_b16 v[162:163], v220 offset:26824
  v_mfma_f32_16x16x32_bf16 v[36:39], v[164:167], a[96:99], v[36:39]
  v_mfma_f32_16x16x32_bf16 v[36:39], v[168:171], a[100:103], v[36:39]
  v_mfma_f32_16x16x32_bf16 v[36:39], v[172:175], a[104:107], v[36:39]
  v_mfma_f32_16x16x32_bf16 v[36:39], v[176:179], a[108:111], v[36:39]
  s_waitcnt lgkmcnt(15)
  v_mfma_f32_16x16x32_bf16 v[40:43], a[224:227], a[32:35], v[40:43]
  v_mfma_f32_16x16x32_bf16 v[40:43], a[228:231], a[36:39], v[40:43]
  s_waitcnt lgkmcnt(0)
  s_waitcnt vmcnt(0)
  s_barrier
  ds_read_b64_tr_b16 v[164:165], v221 offset:0
  v_mfma_f32_16x16x32_bf16 v[40:43], a[232:235], a[40:43], v[40:43]
  s_add_u32 s42, s1, 0
  ds_read_b64_tr_b16 v[166:167], v221 offset:512
  v_mfma_f32_16x16x32_bf16 v[40:43], a[236:239], a[44:47], v[40:43]
  s_mov_b32 m0, s39
  ds_read_b64_tr_b16 v[168:169], v221 offset:8704
  v_mfma_f32_16x16x32_bf16 v[44:47], a[224:227], a[96:99], v[44:47]
  ds_read_b64_tr_b16 v[170:171], v221 offset:9216
  v_mfma_f32_16x16x32_bf16 v[44:47], a[228:231], a[100:103], v[44:47]
  ds_read_b64_tr_b16 v[172:173], v221 offset:17408
  v_mfma_f32_16x16x32_bf16 v[44:47], a[232:235], a[104:107], v[44:47]
  ds_read_b64_tr_b16 v[174:175], v221 offset:17920
  v_mfma_f32_16x16x32_bf16 v[44:47], a[236:239], a[108:111], v[44:47]
  ds_read_b64_tr_b16 v[176:177], v221 offset:26112
  v_mfma_f32_16x16x32_bf16 v[48:51], a[240:243], a[32:35], v[48:51]
  ds_read_b64_tr_b16 v[178:179], v221 offset:26624
  v_mfma_f32_16x16x32_bf16 v[48:51], a[244:247], a[36:39], v[48:51]
  buffer_load_dwordx4 v225, s[16:19], s42 offen nt lds
  v_mfma_f32_16x16x32_bf16 v[48:51], a[248:251], a[40:43], v[48:51]
  ds_read_b64 a[224:225], v224 offset:768
  v_mfma_f32_16x16x32_bf16 v[48:51], a[252:255], a[44:47], v[48:51]
  ds_read_b64 a[226:227], v224 offset:800
  v_mfma_f32_16x16x32_bf16 v[52:55], a[240:243], a[96:99], v[52:55]
  s_add_u32 m0, m0, 32
  ds_read_b64_tr_b16 a[228:229], v223 offset:0
  v_mfma_f32_16x16x32_bf16 v[52:55], a[244:247], a[100:103], v[52:55]
  ds_read_b64_tr_b16 a[230:231], v223 offset:512
  v_mfma_f32_16x16x32_bf16 v[52:55], a[248:251], a[104:107], v[52:55]
  ds_read_b64_tr_b16 a[232:233], v223 offset:8
  v_mfma_f32_16x16x32_bf16 v[52:55], a[252:255], a[108:111], v[52:55]
  ds_read_b64_tr_b16 a[234:235], v223 offset:520
  v_mfma_f32_16x16x32_bf16 v[56:59], v[148:151], a[32:35], v[56:59]
  buffer_load_dwordx4 v225, s[16:19], s42 offen offset:1024 nt lds
  v_mfma_f32_16x16x32_bf16 v[56:59], v[152:155], a[36:39], v[56:59]
  s_nop 0
  ds_read_b64_tr_b16 a[236:237], v221 offset:8
  ds_read_b64_tr_b16 a[238:239], v221 offset:520
  v_mfma_f32_16x16x32_bf16 v[56:59], v[156:159], a[40:43], v[56:59]
  s_nop 0
  ds_read_b64_tr_b16 a[240:241], v221 offset:8712
  ds_read_b64_tr_b16 a[242:243], v221 offset:9224
  v_mfma_f32_16x16x32_bf16 v[56:59], v[160:163], a[44:47], v[56:59]
  s_add_u32 m0, m0, 32
  ds_read_b64_tr_b16 a[244:245], v221 offset:17416
  ds_read_b64_tr_b16 a[246:247], v221 offset:17928
  v_mfma_f32_16x16x32_bf16 v[60:63], v[148:151], a[96:99], v[60:63]
  s_nop 0
  ds_read_b64_tr_b16 a[248:249], v221 offset:26120
  ds_read_b64_tr_b16 a[250:251], v221 offset:26632
  v_mfma_f32_16x16x32_bf16 v[60:63], v[152:155], a[100:103], v[60:63]
  buffer_load_dwordx4 v225, s[16:19], s42 offen offset:2048 nt lds
  v_mfma_f32_16x16x32_bf16 v[60:63], v[156:159], a[104:107], v[60:63]
  ds_read_b64 a[252:253], v224 offset:832
  v_mfma_f32_16x16x32_bf16 v[60:63], v[160:163], a[108:111], v[60:63]
  s_waitcnt lgkmcnt(15)
  ds_read_b64 a[254:255], v224 offset:864
  v_mfma_f32_16x16x32_bf16 v[0:3], v[164:167], a[48:51], v[0:3]
  s_add_u32 m0, m0, 32
  ds_read_b64_tr_b16 v[148:149], v223 offset:8704
  v_mfma_f32_16x16x32_bf16 v[0:3], v[168:171], a[52:55], v[0:3]
  ds_read_b64_tr_b16 v[150:151], v223 offset:9216
  v_mfma_f32_16x16x32_bf16 v[0:3], v[172:175], a[56:59], v[0:3]
  s_nop 0
  ds_read_b64_tr_b16 v[152:153], v223 offset:8712
  ds_read_b64_tr_b16 v[154:155], v223 offset:9224
  v_mfma_f32_16x16x32_bf16 v[0:3], v[176:179], a[60:63], v[0:3]
  s_nop 0
  buffer_load_dwordx4 v225, s[16:19], s42 offen offset:3072 nt lds
  ds_read_b64_tr_b16 v[156:157], v221 offset:64
  v_mfma_f32_16x16x32_bf16 v[4:7], v[164:167], a[112:115], v[4:7]
  s_nop 0
  ds_read_b64_tr_b16 v[158:159], v221 offset:576
  ds_read_b64_tr_b16 v[160:161], v221 offset:8768
  v_mfma_f32_16x16x32_bf16 v[4:7], v[168:171], a[116:119], v[4:7]
  s_nop 0
  ds_read_b64_tr_b16 v[162:163], v221 offset:9280
  ds_read_b64_tr_b16 v[164:165], v221 offset:17472
  v_mfma_f32_16x16x32_bf16 v[4:7], v[172:175], a[120:123], v[4:7]
  s_add_u32 s42, s42, s52
  s_add_u32 m0, m0, s53
  ds_read_b64_tr_b16 v[166:167], v221 offset:17984
  v_mfma_f32_16x16x32_bf16 v[4:7], v[176:179], a[124:127], v[4:7]
  s_waitcnt lgkmcnt(12)
  ds_read_b64_tr_b16 v[168:169], v221 offset:26176
  ds_read_b64_tr_b16 v[170:171], v221 offset:26688
  v_mfma_f32_16x16x32_bf16 v[128:131], a[228:231], a[224:227], v[128:131]
  buffer_load_dwordx4 v225, s[16:19], s42 offen nt lds
  v_mfma_f32_16x16x32_bf16 v[132:135], a[232:235], a[224:227], v[132:135]
  ds_read_b64 v[172:173], v224 offset:896
  v_mfma_f32_16x16x32_bf16 v[8:11], a[236:239], a[48:51], v[8:11]
  ds_read_b64 v[174:175], v224 offset:928
  v_mfma_f32_16x16x32_bf16 v[8:11], a[240:243], a[52:55], v[8:11]
  v_mul_f32 v0, s54, v0
  v_mul_f32 v1, s54, v1
  v_mfma_f32_16x16x32_bf16 v[8:11], a[244:247], a[56:59], v[8:11]
  v_mul_f32 v2, s54, v2
  v_mul_f32 v3, s54, v3
  v_mfma_f32_16x16x32_bf16 v[8:11], a[248:251], a[60:63], v[8:11]
  s_add_u32 m0, m0, 32
  v_cvt_pk_bf16_f32 v64, v0, v1
  v_cvt_pk_bf16_f32 v65, v2, v3
  v_mfma_f32_16x16x32_bf16 v[12:15], a[236:239], a[112:115], v[12:15]
  v_mul_f32 v4, s54, v4
  v_mul_f32 v5, s54, v5
  v_mfma_f32_16x16x32_bf16 v[12:15], a[240:243], a[116:119], v[12:15]
  v_mul_f32 v6, s54, v6
  v_mul_f32 v7, s54, v7
  v_mfma_f32_16x16x32_bf16 v[12:15], a[244:247], a[120:123], v[12:15]
  v_cvt_pk_bf16_f32 v80, v4, v5
  v_cvt_pk_bf16_f32 v81, v6, v7
  v_mfma_f32_16x16x32_bf16 v[12:15], a[248:251], a[124:127], v[12:15]
  s_waitcnt lgkmcnt(2)
  ds_read_b64_tr_b16 v[176:177], v223 offset:17408
  ds_read_b64_tr_b16 v[178:179], v223 offset:17920
  v_mfma_f32_16x16x32_bf16 v[128:131], v[148:151], a[252:255], v[128:131]
  s_nop 0
  ds_read_b64_tr_b16 a[224:225], v223 offset:17416
  ds_read_b64_tr_b16 a[226:227], v223 offset:17928
  v_mfma_f32_16x16x32_bf16 v[132:135], v[152:155], a[252:255], v[132:135]
  s_nop 0
  buffer_load_dwordx4 v225, s[16:19], s42 offen offset:1024 nt lds
  ds_read_b64_tr_b16 a[228:229], v221 offset:72
  v_mfma_f32_16x16x32_bf16 v[16:19], v[156:159], a[48:51], v[16:19]
  s_nop 0
  ds_read_b64_tr_b16 a[230:231], v221 offset:584
  ds_read_b64_tr_b16 a[232:233], v221 offset:8776
  v_mfma_f32_16x16x32_bf16 v[16:19], v[160:163], a[52:55], v[16:19]
  s_nop 0
  ds_read_b64_tr_b16 a[234:235], v221 offset:9288
  ds_read_b64_tr_b16 a[236:237], v221 offset:17480
  v_mfma_f32_16x16x32_bf16 v[16:19], v[164:167], a[56:59], v[16:19]
  s_add_u32 m0, m0, 32
  ds_read_b64_tr_b16 a[238:239], v221 offset:17992
  v_mfma_f32_16x16x32_bf16 v[16:19], v[168:171], a[60:63], v[16:19]
  s_nop 0
  ds_read_b64_tr_b16 a[240:241], v221 offset:26184
  ds_read_b64_tr_b16 a[242:243], v221 offset:26696
  v_mfma_f32_16x16x32_bf16 v[20:23], v[156:159], a[112:115], v[20:23]
  buffer_load_dwordx4 v225, s[16:19], s42 offen offset:2048 nt lds
  v_mul_f32 v8, s54, v8
  v_mfma_f32_16x16x32_bf16 v[20:23], v[160:163], a[116:119], v[20:23]
  v_mul_f32 v9, s54, v9
  v_mul_f32 v10, s54, v10
  v_mfma_f32_16x16x32_bf16 v[20:23], v[164:167], a[120:123], v[20:23]
  v_mul_f32 v11, s54, v11
  v_cvt_pk_bf16_f32 v66, v8, v9
  v_mfma_f32_16x16x32_bf16 v[20:23], v[168:171], a[124:127], v[20:23]
  s_waitcnt lgkmcnt(6)
  v_cvt_pk_bf16_f32 v67, v10, v11
  v_mul_f32 v12, s54, v12
  v_mfma_f32_16x16x32_bf16 v[128:131], v[176:179], v[172:175], v[128:131]
  v_mul_f32 v13, s54, v13
  v_mul_f32 v14, s54, v14
  v_mfma_f32_16x16x32_bf16 v[132:135], a[224:227], v[172:175], v[132:135]
  v_mul_f32 v15, s54, v15
  v_cvt_pk_bf16_f32 v82, v12, v13
  v_mfma_f32_16x16x32_bf16 v[24:27], a[228:231], a[48:51], v[24:27]
  s_waitcnt lgkmcnt(0)
  ds_read_b64 a[244:245], v224 offset:960
  ds_read_b64 a[246:247], v224 offset:992
  ds_read_b64_tr_b16 a[248:249], v223 offset:26112
  ds_read_b64_tr_b16 a[250:251], v223 offset:26624
  v_mfma_f32_16x16x32_bf16 v[24:27], a[232:235], a[52:55], v[24:27]
  s_add_u32 m0, m0, 32
  ds_read_b64_tr_b16 a[252:253], v223 offset:26120
  ds_read_b64_tr_b16 a[254:255], v223 offset:26632
  v_mfma_f32_16x16x32_bf16 v[24:27], a[236:239], a[56:59], v[24:27]
  s_nop 0
  buffer_load_dwordx4 v225, s[16:19], s42 offen offset:3072 nt lds
  ds_read_b64_tr_b16 v[148:149], v221 offset:128
  ds_read_b64_tr_b16 v[150:151], v221 offset:640
  v_mfma_f32_16x16x32_bf16 v[24:27], a[240:243], a[60:63], v[24:27]
  s_nop 0
  ds_read_b64_tr_b16 v[152:153], v221 offset:8832
  ds_read_b64_tr_b16 v[154:155], v221 offset:9344
  v_mfma_f32_16x16x32_bf16 v[28:31], a[228:231], a[112:115], v[28:31]
  s_nop 0
  ds_read_b64_tr_b16 v[156:157], v221 offset:17536
  ds_read_b64_tr_b16 v[158:159], v221 offset:18048
  v_mfma_f32_16x16x32_bf16 v[28:31], a[232:235], a[116:119], v[28:31]
  s_nop 0
  ds_read_b64_tr_b16 v[160:161], v221 offset:26240
  ds_read_b64_tr_b16 v[162:163], v221 offset:26752
  v_mfma_f32_16x16x32_bf16 v[28:31], a[236:239], a[120:123], v[28:31]
  v_cvt_pk_bf16_f32 v83, v14, v15
  v_mul_f32 v16, s54, v16
  v_mfma_f32_16x16x32_bf16 v[28:31], a[240:243], a[124:127], v[28:31]
  s_waitcnt lgkmcnt(10)
  v_mul_f32 v17, s54, v17
  v_mul_f32 v18, s54, v18
  v_mfma_f32_16x16x32_bf16 v[128:131], a[248:251], a[244:247], v[128:131]
  s_waitcnt lgkmcnt(8)
  v_mul_f32 v19, s54, v19
  v_cvt_pk_bf16_f32 v68, v16, v17
  v_mfma_f32_16x16x32_bf16 v[132:135], a[252:255], a[244:247], v[132:135]
  s_waitcnt lgkmcnt(6)
  ds_read_b64_tr_b16 v[164:165], v221 offset:136
  ds_read_b64_tr_b16 v[166:167], v221 offset:648
  ds_read_b64_tr_b16 v[168:169], v221 offset:8840
  ds_read_b64_tr_b16 v[170:171], v221 offset:9352
  v_mfma_f32_16x16x32_bf16 v[32:35], v[148:151], a[48:51], v[32:35]
  s_waitcnt lgkmcnt(8)
  ds_read_b64_tr_b16 v[172:173], v221 offset:17544
  ds_read_b64_tr_b16 v[174:175], v221 offset:18056
  ds_read_b64_tr_b16 v[176:177], v221 offset:26248
  ds_read_b64_tr_b16 v[178:179], v221 offset:26760
  v_mfma_f32_16x16x32_bf16 v[32:35], v[152:155], a[52:55], v[32:35]
  s_waitcnt lgkmcnt(10)
  v_cvt_pk_bf16_f32 v69, v18, v19
  v_mul_f32 v20, s54, v20
  v_mfma_f32_16x16x32_bf16 v[32:35], v[156:159], a[56:59], v[32:35]
  s_waitcnt lgkmcnt(8)
  v_mul_f32 v21, s54, v21
  v_mul_f32 v22, s54, v22
  v_mfma_f32_16x16x32_bf16 v[32:35], v[160:163], a[60:63], v[32:35]
  v_mul_f32 v23, s54, v23
  v_cvt_pk_bf16_f32 v84, v20, v21
  v_mfma_f32_16x16x32_bf16 v[36:39], v[148:151], a[112:115], v[36:39]
  s_nop 0
  ds_read_b64_tr_b16 a[224:225], v221 offset:192
  ds_read_b64_tr_b16 a[226:227], v221 offset:704
  v_mfma_f32_16x16x32_bf16 v[36:39], v[152:155], a[116:119], v[36:39]
  s_nop 0
  ds_read_b64_tr_b16 a[228:229], v221 offset:8896
  ds_read_b64_tr_b16 a[230:231], v221 offset:9408
  ds_read_b64_tr_b16 a[232:233], v221 offset:17600
  ds_read_b64_tr_b16 a[234:235], v221 offset:18112
  ds_read_b64_tr_b16 a[236:237], v221 offset:26304
  ds_read_b64_tr_b16 a[238:239], v221 offset:26816
  v_mfma_f32_16x16x32_bf16 v[36:39], v[156:159], a[120:123], v[36:39]
  v_cvt_pk_bf16_f32 v85, v22, v23
  v_mul_f32 v128, s54, v128
  v_mfma_f32_16x16x32_bf16 v[36:39], v[160:163], a[124:127], v[36:39]
  s_waitcnt lgkmcnt(8)
  v_mul_f32 v129, s54, v129
  v_mul_f32 v130, s54, v130
  v_mfma_f32_16x16x32_bf16 v[40:43], v[164:167], a[48:51], v[40:43]
  v_mul_f32 v131, s54, v131
  v_mul_f32 v132, s54, v132
  v_mfma_f32_16x16x32_bf16 v[40:43], v[168:171], a[52:55], v[40:43]
  v_mul_f32 v133, s54, v133
  v_mul_f32 v134, s54, v134
  v_mfma_f32_16x16x32_bf16 v[40:43], v[172:175], a[56:59], v[40:43]
  s_nop 0
  ds_read_b64_tr_b16 a[240:241], v221 offset:200
  ds_read_b64_tr_b16 a[242:243], v221 offset:712
  ds_read_b64_tr_b16 a[244:245], v221 offset:8904
  ds_read_b64_tr_b16 a[246:247], v221 offset:9416
  ds_read_b64_tr_b16 a[248:249], v221 offset:17608
  ds_read_b64_tr_b16 a[250:251], v221 offset:18120
  v_mfma_f32_16x16x32_bf16 v[40:43], v[176:179], a[60:63], v[40:43]
  s_nop 0
  ds_read_b64_tr_b16 a[252:253], v221 offset:26312
  ds_read_b64_tr_b16 a[254:255], v221 offset:26824
  v_mul_f32 v135, s54, v135
  v_mfma_f32_16x16x32_bf16 v[44:47], v[164:167], a[112:115], v[44:47]
  v_cvt_pk_bf16_f32 v128, v128, v129
  v_cvt_pk_bf16_f32 v129, v130, v131
  v_mfma_f32_16x16x32_bf16 v[44:47], v[168:171], a[116:119], v[44:47]
  v_cvt_pk_bf16_f32 v130, v132, v133
  v_cvt_pk_bf16_f32 v131, v134, v135
  v_mfma_f32_16x16x32_bf16 v[44:47], v[172:175], a[120:123], v[44:47]
  ds_write_b128 v230, v[128:131]
  v_mfma_f32_16x16x32_bf16 v[44:47], v[176:179], a[124:127], v[44:47]
  s_waitcnt lgkmcnt(9)
  v_mul_f32 v24, s54, v24
  v_mul_f32 v25, s54, v25
  v_mfma_f32_16x16x32_bf16 v[48:51], a[224:227], a[48:51], v[48:51]
  v_mul_f32 v26, s54, v26
  v_mul_f32 v27, s54, v27
  v_mfma_f32_16x16x32_bf16 v[48:51], a[228:231], a[52:55], v[48:51]
  v_cvt_pk_bf16_f32 v70, v24, v25
  v_cvt_pk_bf16_f32 v71, v26, v27
  v_mfma_f32_16x16x32_bf16 v[48:51], a[232:235], a[56:59], v[48:51]
  v_mul_f32 v28, s54, v28
  v_mul_f32 v29, s54, v29
  v_mfma_f32_16x16x32_bf16 v[48:51], a[236:239], a[60:63], v[48:51]
  v_mul_f32 v30, s54, v30
  v_mul_f32 v31, s54, v31
  v_mfma_f32_16x16x32_bf16 v[52:55], a[224:227], a[112:115], v[52:55]
  v_cvt_pk_bf16_f32 v86, v28, v29
  v_cvt_pk_bf16_f32 v87, v30, v31
  v_mfma_f32_16x16x32_bf16 v[52:55], a[228:231], a[116:119], v[52:55]
  buffer_store_dword v136, v247, s[28:31], s62 offen sc1
  v_mul_f32 v32, s54, v32
  v_mfma_f32_16x16x32_bf16 v[52:55], a[232:235], a[120:123], v[52:55]
  v_mul_f32 v33, s54, v33
  v_mul_f32 v34, s54, v34
  v_mfma_f32_16x16x32_bf16 v[52:55], a[236:239], a[124:127], v[52:55]
  s_waitcnt lgkmcnt(1)
  v_mul_f32 v35, s54, v35
  v_cvt_pk_bf16_f32 v72, v32, v33
  v_mfma_f32_16x16x32_bf16 v[56:59], a[240:243], a[48:51], v[56:59]
  s_waitcnt lgkmcnt(0)
  s_barrier
  v_cvt_pk_bf16_f32 v73, v34, v35
  v_mfma_f32_16x16x32_bf16 v[56:59], a[244:247], a[52:55], v[56:59]
  v_mul_f32 v36, s54, v36
  v_mul_f32 v37, s54, v37
  v_mfma_f32_16x16x32_bf16 v[56:59], a[248:251], a[56:59], v[56:59]
  v_mul_f32 v38, s54, v38
  v_mul_f32 v39, s54, v39
  v_mfma_f32_16x16x32_bf16 v[56:59], a[252:255], a[60:63], v[56:59]
  v_cvt_pk_bf16_f32 v88, v36, v37
  v_cvt_pk_bf16_f32 v89, v38, v39
  v_mfma_f32_16x16x32_bf16 v[60:63], a[240:243], a[112:115], v[60:63]
  s_nop 0
  ds_read_b128 v[148:151], v212 offset:0
  ds_read_b128 v[180:183], v248 offset:0
  v_mfma_f32_16x16x32_bf16 v[60:63], a[244:247], a[116:119], v[60:63]
  s_nop 0
  ds_read_b128 v[184:187], v248 offset:1024
  ds_read_b128 v[188:191], v248 offset:2048
  v_mfma_f32_16x16x32_bf16 v[60:63], a[248:251], a[120:123], v[60:63]
  s_nop 0
  ds_read_b128 v[192:195], v248 offset:3072
  ds_read_b128 v[152:155], v212 offset:64
  v_mfma_f32_16x16x32_bf16 v[60:63], a[252:255], a[124:127], v[60:63]
  s_nop 5
  s_nop 0
  ds_read_b128 v[156:159], v212 offset:128
  ds_read_b128 v[160:163], v212 offset:192
  v_mul_f32 v40, s54, v40
  v_mul_f32 v41, s54, v41
  v_mul_f32 v42, s54, v42
  v_mul_f32 v43, s54, v43
  v_cvt_pk_bf16_f32 v74, v40, v41
  v_cvt_pk_bf16_f32 v75, v42, v43
  v_mul_f32 v44, s54, v44
  v_mul_f32 v45, s54, v45
  v_mul_f32 v46, s54, v46
  v_mul_f32 v47, s54, v47
  v_cvt_pk_bf16_f32 v90, v44, v45
  v_cvt_pk_bf16_f32 v91, v46, v47
  v_mul_f32 v48, s54, v48
  v_mul_f32 v49, s54, v49
  v_mul_f32 v50, s54, v50
  v_mul_f32 v51, s54, v51
  v_cvt_pk_bf16_f32 v76, v48, v49
  v_cvt_pk_bf16_f32 v77, v50, v51
  v_mul_f32 v52, s54, v52
  v_mul_f32 v53, s54, v53
  v_mul_f32 v54, s54, v54
  v_mul_f32 v55, s54, v55
  v_cvt_pk_bf16_f32 v92, v52, v53
  v_cvt_pk_bf16_f32 v93, v54, v55
  v_mul_f32 v56, s54, v56
  v_mul_f32 v57, s54, v57
  v_mul_f32 v58, s54, v58
  v_mul_f32 v59, s54, v59
  v_cvt_pk_bf16_f32 v78, v56, v57
  v_cvt_pk_bf16_f32 v79, v58, v59
  v_mul_f32 v60, s54, v60
  v_mul_f32 v61, s54, v61
  v_mul_f32 v62, s54, v62
  v_mul_f32 v63, s54, v63
  v_cvt_pk_bf16_f32 v94, v60, v61
  v_cvt_pk_bf16_f32 v95, v62, v63
  s_add_u32 s45, s0, 131072
  s_add_u32 s46, s47, 256
  s_mov_b32 s42, 256
  buffer_load_dword v229, v228, s[12:15], s42 offen
  s_lshl_b32 s65, s58, 2
  s_add_u32 s65, s65, s36
  s_lshl_b32 s65, s65, 11
  s_add_u32 s65, s65, 0
  v_lshlrev_b32 v250, 1, v225
  buffer_load_dword v229, v250, s[24:27], s65 offen
  s_mov_b32 s8, s66
  s_and_b32 s9, s67, 0xffff
  s_mov_b32 s10, 4718592
  s_branch L_attn
L_code_end:
  s_endpgm
.section .rodata,"a"
.p2align 6
.amdhsa_kernel concat_heads__mha_block_cached__mha_block_cached__near_ridge_kernel
  .amdhsa_next_free_vgpr 512
  .amdhsa_next_free_sgpr 102
  .amdhsa_accum_offset 256
  .amdhsa_group_segment_fixed_size 0
  .amdhsa_kernarg_size 104
  .amdhsa_user_sgpr_count 2
  .amdhsa_user_sgpr_kernarg_segment_ptr 1
  .amdhsa_system_sgpr_workgroup_id_x 1
.end_amdhsa_kernel
```
